```python
import torch

def _softmax(x, axis=-1):
    return torch.softmax(x, dim=axis)
def _gelu(x):
    return torch.nn.functional.gelu(x, approximate="tanh")
def _silu(x):
    return torch.nn.functional.silu(x)
def _sigmoid(x):
    return torch.sigmoid(x)
def _layernorm(x, axis=-1, eps=1e-5):
    m = x.mean(dim=axis, keepdim=True)
    v = x.var(dim=axis, keepdim=True, unbiased=False)
    return (x - m) / torch.sqrt(v + eps)
def _scatter_add(tgt, idx, src, axis=0):
    return tgt.clone().index_add_(axis, idx, src)
def _segment_sum(src, seg, n):
    out = torch.zeros((n,) + src.shape[1:], dtype=src.dtype)
    return out.index_add_(0, seg, src)
def _pad(x, pw):
    flat = tuple(v for pair in reversed(pw) for v in pair)
    return torch.nn.functional.pad(x, flat)

kernel_name = 'recurrent_scan__ssm_conv_s4d__moe_arch_mod__prompt'

def setup_inputs():

    _w = (lambda a: (lambda t: t.to(torch.bfloat16) if t.is_floating_point() else t)(torch.as_tensor(a)))
    def _A_setup():
        Bsz, L, D, N = 1, 2048, 1024, 128
        return {
            "u": _w((lambda *s: torch.randn(*s, dtype=torch.bfloat16) * 0.05)(Bsz, L, D)),
            "log_A_real": _w((lambda *s: torch.randn(*s, dtype=torch.bfloat16) * 6.4)(D, N) * 0.5),
            "A_imag": _w((lambda *s: torch.randn(*s, dtype=torch.bfloat16) * 0.05)(D, N) * 3.14),
            "C_real": _w((lambda *s: torch.randn(*s, dtype=torch.bfloat16) * 0.05)(D, N) / N ** 0.5),
            "C_imag": _w((lambda *s: torch.randn(*s, dtype=torch.bfloat16) * 0.05)(D, N) / N ** 0.5),
            "log_dt": _w((lambda *s: torch.randn(*s, dtype=torch.bfloat16) * 0.05)(D) * 0.5 - 4.0),
            "D_skip": _w((lambda *s: torch.randn(*s, dtype=torch.bfloat16) * 0.05)(D)),
        }
    _A_in = _A_setup()

    def _B_setup():
        B, S, D, F, C = 1, 2048, 1024, 3584, 2
        return {
            "x": _w((lambda *s: torch.randn(*s, dtype=torch.bfloat16) * 0.05)(B, S, D)),
            "w_r": _w((lambda *s: torch.randn(*s, dtype=torch.bfloat16) * 0.05)(D)),
            "w_gate": _w((lambda *s: torch.randn(*s, dtype=torch.bfloat16) * 0.05)(D, F)),
            "w_up": _w((lambda *s: torch.randn(*s, dtype=torch.bfloat16) * 0.05)(D, F)),
            "w_down": _w((lambda *s: torch.randn(*s, dtype=torch.bfloat16) * 0.05)(F, D)),
        }
    _B_in = _B_setup()

    return {
        "A_u": _A_in["u"],
        "A_log_A_real": _A_in["log_A_real"],
        "A_A_imag": _A_in["A_imag"],
        "A_C_real": _A_in["C_real"],
        "A_C_imag": _A_in["C_imag"],
        "A_log_dt": _A_in["log_dt"],
        "A_D_skip": _A_in["D_skip"],
        "B_x": _B_in["x"],
        "B_w_r": _B_in["w_r"],
        "B_w_gate": _B_in["w_gate"],
        "B_w_up": _B_in["w_up"],
        "B_w_down": _B_in["w_down"],
    }

def reference(A_u, A_log_A_real, A_A_imag, A_C_real, A_C_imag, A_log_dt, A_D_skip, B_x, B_w_r, B_w_gate, B_w_up, B_w_down):
    def _A_ref(u, log_A_real, A_imag, C_real, C_imag, log_dt, D_skip):
        L = u.shape[1]
        dt = torch.exp(log_dt)
        A = -torch.exp(log_A_real) + 1j * A_imag
        C = (C_real + 1j * C_imag) * dt[:, None]
        pos = (lambda x, dt: x.to(dt))(torch.arange(L), log_dt.dtype)
        P = torch.exp((A * dt[:, None])[:, :, None] * pos[None, None, :])
        K = 2.0 * torch.einsum("dn,dnl->dl", C, P).real
        L2 = 2 * L
        u_t = (lambda x, *d: x.permute(*d))(u, 0, 2, 1)
        Kf = (lambda x, *a, **k: torch.fft.rfft(x.float(), *a, **k))(K, L2)
        Uf = (lambda x, *a, **k: torch.fft.rfft(x.float(), *a, **k))(u_t, L2)
        y = (lambda x, *a, **k: torch.fft.irfft(x, *a, **k).to(torch.bfloat16))(Uf * Kf[None, :, :], L2)[:, :, :L]
        y = (lambda x, *d: x.permute(*d))(y, 0, 2, 1)
        return y + u * D_skip[None, None, :]

    def _B_ref(x, w_r, w_gate, w_up, w_down):
        B, S, D = x.shape
        C = 2
        r = x @ w_r
        idx = torch.argsort(-r, axis=-1)[:, :C]
        idx_e = (lambda x, n, axis: torch.repeat_interleave(x, n, dim=axis))(idx.reshape(B, C, 1), D, axis=2)
        x_sel = (lambda x, i, axis: torch.take_along_dim(x, i, dim=axis))(x, idx_e, axis=1)
        g = _silu(x_sel @ w_gate)
        u = x_sel @ w_up
        y = (g * u) @ w_down
        r_sel = _sigmoid((lambda x, i, axis: torch.take_along_dim(x, i, dim=axis))(r, idx, axis=1))
        y = y * r_sel.reshape(B, C, 1)
        b_off = (torch.arange(B) * S).reshape(B, 1)
        flat_idx = (idx + b_off).reshape(B * C)
        zero = (x * 0.0).reshape(B * S, D)
        upd = _scatter_add(zero, flat_idx, y.reshape(B * C, D), axis=0)
        return x + upd.reshape(B, S, D)

    x = A_u
    xn = _layernorm(x, axis=-1)
    s = _A_ref(xn, A_log_A_real, A_A_imag, A_C_real, A_C_imag, A_log_dt, A_D_skip)
    g = _silu(_B_ref(xn, B_w_r, B_w_gate, B_w_up, B_w_down))
    return x + s * g
```

```asm
; @launch grid=(256,1,1) block=(1024,1,1) lds=151040
.amdgcn_target "amdgcn-amd-amdhsa--gfx950"
.text
.p2align 8
.globl recurrent_scan__ssm_conv_s4d__moe_arch_mod__prompt_kernel
.type recurrent_scan__ssm_conv_s4d__moe_arch_mod__prompt_kernel,@function
recurrent_scan__ssm_conv_s4d__moe_arch_mod__prompt_kernel:
  s_cmp_ge_u32 s2, 256
  s_cbranch_scc1 K_END
  s_load_dwordx2 s[44:45], s[0:1], 0
  s_load_dwordx16 s[4:19], s[0:1], 8
  s_load_dwordx8 s[20:27], s[0:1], 72
  s_load_dwordx4 s[40:43], s[0:1], 104
  v_readfirstlane_b32 s30, v0
  v_and_b32 v1, 63, v0
  s_and_b32 s28, s2, 7
  s_lshr_b32 s29, s2, 3
  s_mov_b32 s31, 0xffff0000
  s_mov_b32 s58, 0x3fb8aa3b
  s_lshr_b32 s30, s30, 6
  s_cmp_ge_u32 s30, 8
  s_cbranch_scc1 K_C
  v_lshlrev_b32 v97, 4, v1
  v_lshrrev_b32 v2, 4, v1
  v_and_b32 v3, 15, v1
  v_lshlrev_b32 v5, 4, v3
  s_setprio 3
  s_getpc_b64 s[48:49]
K_PC:
  s_cmp_lg_u32 s30, 0
  s_cbranch_scc1 K_NOPF
  s_lshl_b32 s50, s29, 10
  s_min_u32 s50, s50, K_END - K_PC - 1024
  s_add_u32 s50, s50, s48
  s_addc_u32 s51, s49, 0
  global_load_dwordx4 v[32:35], v97, s[50:51]
K_NOPF:
  s_lshr_b32 s3, s29, 3
  s_lshl_b32 s3, s3, 5
  s_and_b32 s63, s29, 7
  s_add_u32 s3, s3, s63
  s_lshl_b32 s63, s28, 7
  s_add_u32 s3, s3, s63
  v_lshl_add_u32 v4, v2, 12, v5
  v_lshl_add_u32 v120, v2, 11, v5
  s_lshl_b32 s60, s29, 3
  s_add_u32 s60, s60, s30
  s_lshl_b32 s61, s60, 14
  s_lshl_b32 s62, s28, 8
  s_add_u32 s61, s61, s62
  v_add_u32 v6, s62, v5
  v_mov_b32 v126, 0
  v_mov_b32 v127, 1
  v_lshlrev_b32 v7, 2, v1
  ds_write_b32 v7, v126
  s_mov_b32 s38, 0x400000
  s_mov_b32 s39, 0x00020000
  s_lshl_b32 s63, s3, 8
  v_add_u32 v7, s63, v120
  s_lshl_b32 s3, s3, 1
  s_and_b32 s3, s3, -64
  s_mov_b32 m0, 77824
  s_cmp_lg_u32 s30, 0
  s_waitcnt lgkmcnt(0)
  s_load_dword s46, s[42:43], 0x0
  s_mov_b32 s36, s44
  s_mov_b32 s37, s45
  s_cbranch_scc1 K_NOPRM
  global_load_lds_dwordx4 v7, s[4:5]
  s_mov_b32 m0, 78848
  s_load_dword s47, s[12:13], s3
  global_load_lds_dwordx4 v7, s[6:7]
  s_mov_b32 m0, 79872
  s_nop 0
  global_load_lds_dwordx4 v7, s[8:9]
  s_mov_b32 m0, 80896
  s_nop 0
  global_load_lds_dwordx4 v7, s[10:11]
K_NOPRM:
  buffer_load_dwordx4 v[8:11], v4, s[36:39], s61 offen
  buffer_load_dwordx4 v[12:15], v4, s[36:39], s61 offen offset:2048
  global_load_dwordx4 v[16:19], v6, s[18:19]
  s_barrier
  s_mov_b32 s32, s42
  s_mov_b32 s33, s43
  s_mov_b32 s34, 0x800000
  s_mov_b32 s35, 0x00020000
  v_lshlrev_b32 v95, 1, v1
  s_lshl_b32 s63, s29, 13
  s_lshl_b32 s73, s30, 7
  s_add_u32 s63, s63, s73
  s_add_u32 s63, s63, 0x400000
  s_lshl_b32 s73, s28, 10
  s_add_u32 s57, s73, 0x441000
  s_add_u32 s73, s73, s63
  s_add_u32 s74, s62, 0x440000
  s_getreg_b32 s56, hwreg(HW_REG_XCC_ID)
  v_mov_b32 v124, 0xffff0000
  s_mov_b32 s8, 0x0000bf80
  s_mov_b32 s9, 0xbf800000
  v_mov_b32 v84, 0
  v_mov_b32 v85, 0
  s_waitcnt lgkmcnt(0)
  s_add_u32 s46, s46, 0x9e3779b9
  v_mov_b32 v91, s46
  s_cmp_lg_u32 s30, 0
  s_cbranch_scc1 K_NOPS
  s_mov_b64 exec, 1
  ds_write_b32 v126, v91 offset:0
  s_waitcnt vmcnt(3)
  ds_add_u32 v126, v127 offset:12
  s_mov_b64 exec, -1
K_NOPS:
  s_waitcnt vmcnt(2)
  v_and_b32_dpp v26, v8, v124 row_newbcast:0 row_mask:0xf bank_mask:0xf
  v_dot2_f32_bf16 v32, v8, s8, v26
  v_dot2_f32_bf16 v34, v8, s9, v26
  v_dot2_f32_bf16 v36, v9, s8, v26
  v_dot2_f32_bf16 v38, v9, s9, v26
  v_dot2_f32_bf16 v40, v10, s8, v26
  v_dot2_f32_bf16 v42, v10, s9, v26
  v_dot2_f32_bf16 v44, v11, s8, v26
  v_dot2_f32_bf16 v46, v11, s9, v26
  s_waitcnt vmcnt(1)
  v_and_b32_dpp v27, v12, v124 row_newbcast:0 row_mask:0xf bank_mask:0xf
  v_dot2_f32_bf16 v33, v12, s8, v27
  v_dot2_f32_bf16 v35, v12, s9, v27
  v_dot2_f32_bf16 v37, v13, s8, v27
  v_dot2_f32_bf16 v39, v13, s9, v27
  v_dot2_f32_bf16 v41, v14, s8, v27
  v_dot2_f32_bf16 v43, v14, s9, v27
  v_dot2_f32_bf16 v45, v15, s8, v27
  v_dot2_f32_bf16 v47, v15, s9, v27
  s_waitcnt vmcnt(0)
  v_pk_add_f32 v[28:29], v[32:33], v[34:35]
  v_pk_mul_f32 v[30:31], v[32:33], v[32:33]
  v_dot2c_f32_bf16 v84, v8, v16
  v_pk_add_f32 v[80:81], v[36:37], v[38:39]
  v_pk_mul_f32 v[82:83], v[34:35], v[34:35]
  v_dot2c_f32_bf16 v85, v12, v16
  v_pk_fma_f32 v[30:31], v[36:37], v[36:37], v[30:31]
  v_dot2c_f32_bf16 v84, v9, v17
  v_pk_fma_f32 v[82:83], v[38:39], v[38:39], v[82:83]
  v_dot2c_f32_bf16 v85, v13, v17
  v_pk_fma_f32 v[30:31], v[40:41], v[40:41], v[30:31]
  v_dot2c_f32_bf16 v84, v10, v18
  v_pk_add_f32 v[28:29], v[28:29], v[40:41]
  v_pk_fma_f32 v[82:83], v[42:43], v[42:43], v[82:83]
  v_dot2c_f32_bf16 v85, v14, v18
  v_pk_add_f32 v[80:81], v[80:81], v[42:43]
  v_pk_fma_f32 v[30:31], v[44:45], v[44:45], v[30:31]
  v_dot2c_f32_bf16 v84, v11, v19
  v_pk_add_f32 v[28:29], v[28:29], v[44:45]
  v_pk_fma_f32 v[82:83], v[46:47], v[46:47], v[82:83]
  v_dot2c_f32_bf16 v85, v15, v19
  v_pk_add_f32 v[80:81], v[80:81], v[46:47]
  v_pk_add_f32 v[30:31], v[30:31], v[82:83]
  v_mov_b32 v86, v26
  v_pk_add_f32 v[28:29], v[28:29], v[80:81]
  v_add_f32_dpp v90, v84, v84 row_ror:8 row_mask:0xf bank_mask:0x3
  v_add_f32_dpp v89, v30, v30 row_ror:8 row_mask:0xf bank_mask:0x3
  v_add_f32_dpp v88, v28, v28 row_ror:8 row_mask:0xf bank_mask:0x3
  v_add_f32_dpp v90, v85, v85 row_ror:8 row_mask:0xf bank_mask:0xc
  v_add_f32_dpp v89, v31, v31 row_ror:8 row_mask:0xf bank_mask:0xc
  v_add_f32_dpp v88, v29, v29 row_ror:8 row_mask:0xf bank_mask:0xc
  v_mov_b32_dpp v86, v27 quad_perm:[0,1,2,3] row_mask:0xf bank_mask:0xc
  s_nop 0
  v_add_f32_dpp v88, v88, v88 row_half_mirror row_mask:0xf bank_mask:0xf
  v_add_f32_dpp v90, v90, v90 row_half_mirror row_mask:0xf bank_mask:0xf
  v_add_f32_dpp v89, v89, v89 row_half_mirror row_mask:0xf bank_mask:0xf
  v_add_f32_dpp v88, v88, v88 quad_perm:[1,0,3,2] row_mask:0xf bank_mask:0xf
  v_add_f32_dpp v90, v90, v90 quad_perm:[1,0,3,2] row_mask:0xf bank_mask:0xf
  v_add_f32_dpp v89, v89, v89 quad_perm:[1,0,3,2] row_mask:0xf bank_mask:0xf
  v_add_f32_dpp v88, v88, v88 quad_perm:[2,3,0,1] row_mask:0xf bank_mask:0xf
  v_add_f32_dpp v90, v90, v90 quad_perm:[2,3,0,1] row_mask:0xf bank_mask:0xf
  v_add_f32_dpp v89, v89, v89 quad_perm:[2,3,0,1] row_mask:0xf bank_mask:0xf
  v_mul_f32 v87, 0x3c000000, v88
  s_mov_b32 exec_lo, 0x01010101
  s_mov_b32 exec_hi, 0x01010101
  v_fma_f32 v89, -v87, v88, v89
  v_sub_f32 v88, v86, v87
  buffer_store_dwordx4 v[88:91], v95, s[32:35], s73 offen sc1
  s_mov_b64 exec, -1
  global_load_dwordx4 v[20:23], v6, s[14:15]
  s_cmp_lt_u32 s30, 3
  s_cbranch_scc1 K_NOBAND
  s_sub_u32 s78, s30, 3
  s_lshl_b32 s78, s78, 10
  s_add_u32 m0, s78, 72704
  s_add_u32 s78, s78, K_BAND - K_PC
  s_add_u32 s48, s48, s78
  s_addc_u32 s49, s49, 0
  global_load_lds_dwordx4 v97, s[48:49]
  s_branch K_NOSM
K_NOBAND:
  s_cmp_lg_u32 s30, 1
  s_cbranch_scc1 K_NOSM
  global_load_dwordx4 v[48:51], v97, s[18:19]
  global_load_dwordx4 v[52:55], v97, s[18:19] offset:1024
K_NOSM:
  s_setprio 0
  s_mov_b32 s20, s26
  s_mov_b32 s21, s27
  s_mov_b32 s22, 0x400000
  s_mov_b32 s23, 0x00020000
  v_and_b32 v7, 3, v1
  v_mul_u32_u24 v121, 4640, v7
  v_lshlrev_b32 v96, 4, v7
  v_lshrrev_b32 v7, 2, v1
  v_lshl_add_u32 v121, v7, 4, v121
  v_lshl_add_u32 v96, v7, 14, v96
  s_lshl_b32 s78, s30, 9
  v_add_u32 v121, s78, v121
  s_lshl_b32 s75, s30, 19
  s_lshl_b32 s78, s28, 8
  s_add_u32 s75, s75, s78
  s_and_b32 s78, s29, 3
  s_lshl_b32 s78, s78, 12
  s_add_u32 s75, s75, s78
  s_and_b32 s78, s29, 4
  s_lshl_b32 s78, s78, 9
  s_add_u32 s75, s75, s78
  s_lshr_b32 s78, s29, 3
  s_lshl_b32 s78, s78, 6
  s_add_u32 s75, s75, s78
  s_add_u32 s76, s75, 0x40000
  v_and_b32 v92, 7, v1
  v_lshlrev_b32 v92, 10, v92
  v_lshrrev_b32 v7, 3, v1
  v_lshl_add_u32 v92, v7, 4, v92
  v_and_b32 v93, 31, v1
  v_lshlrev_b32 v93, 3, v93
  v_mov_b32 v122, 0x30003
  v_mov_b32 v125, 0x80000000
  s_mov_b32 s17, 0
  s_mov_b32 s4, 0x10002
  s_mov_b32 s5, 0x20001
  s_mov_b32 s6, 0x20002
  s_mov_b32 s7, 0x10001
  s_mov_b32 s83, 0x20000
  s_lshl_b32 s78, s60, 4
  v_lshl_add_u32 v6, v2, 2, s78
  v_lshrrev_b32 v7, 2, v1
  s_sub_u32 s78, 4094, s78
  v_sub_u32 v7, s78, v7
  s_lshl_b32 s78, s30, 6
  v_add_u32 v98, s78, v1
  s_setprio 3
  s_waitcnt vmcnt(0)
  s_mov_b64 exec, 1
  ds_add_u32 v126, v127 offset:28
  s_mov_b64 exec, -1
  s_cmp_lg_u32 s30, 1
  s_cbranch_scc1 K_NOSW
  v_mov_b32 v56, 0
  v_dot2c_f32_bf16 v56, 0x3f803f80, v48
  v_dot2c_f32_bf16 v56, 0x3f803f80, v49
  v_dot2c_f32_bf16 v56, 0x3f803f80, v50
  v_dot2c_f32_bf16 v56, 0x3f803f80, v51
  v_dot2c_f32_bf16 v56, 0x3f803f80, v52
  v_dot2c_f32_bf16 v56, 0x3f803f80, v53
  v_dot2c_f32_bf16 v56, 0x3f803f80, v54
  v_dot2c_f32_bf16 v56, 0x3f803f80, v55
  s_nop 2
  v_add_f32_dpp v56, v56, v56 quad_perm:[1,0,3,2] row_mask:0xf bank_mask:0xf
  s_nop 1
  v_add_f32_dpp v56, v56, v56 quad_perm:[2,3,0,1] row_mask:0xf bank_mask:0xf
  s_nop 1
  v_add_f32_dpp v56, v56, v56 row_half_mirror row_mask:0xf bank_mask:0xf
  s_nop 1
  v_add_f32_dpp v56, v56, v56 row_mirror row_mask:0xf bank_mask:0xf
  s_nop 1
  v_add_f32_dpp v56, v56, v56 row_bcast:15 row_mask:0xa bank_mask:0xf
  s_nop 1
  v_add_f32_dpp v56, v56, v56 row_bcast:31 row_mask:0xc bank_mask:0xf
  v_or_b32 v56, 1, v56
  s_mov_b32 exec_lo, 0
  s_mov_b32 exec_hi, 0x80000000
  ds_write_b32 v126, v56 offset:4
  s_mov_b64 exec, -1
K_NOSW:
  s_branch K_AWB
K_AW:
  s_sleep 1
K_AWB:
  ds_read_b32 v80, v126 offset:28
  s_waitcnt lgkmcnt(0)
  v_cmp_gt_u32 vcc, 8, v80
  s_cbranch_vccnz K_AW
  s_sleep 1
  buffer_load_dwordx4 v[88:91], v92, s[32:35], s63 offen sc1
  buffer_load_dwordx2 v[94:95], v93, s[32:35], s74 offen sc1
  s_waitcnt vmcnt(1)
  s_branch K_P1C
K_P1:
  s_sleep 2
  buffer_load_dwordx4 v[88:91], v92, s[32:35], s63 offen sc1
  s_sub_u32 s83, s83, 1
  s_waitcnt vmcnt(0)
  s_cbranch_scc1 K_P1D
K_P1C:
  v_cmp_ne_u32 vcc, s46, v91
  s_cbranch_vccnz K_P1
K_P1D:
  ds_read_b32 v85, v126 offset:4
  s_max_i32 s83, s83, 0
  v_mov_b32_dpp v80, v88 row_newbcast:0 row_mask:0xf bank_mask:0x3
  s_nop 1
  v_mov_b32_dpp v80, v88 row_newbcast:8 row_mask:0xf bank_mask:0xc
  v_sub_f32 v88, v88, v80
  v_mul_f32 v81, 0x43000000, v88
  v_fmac_f32 v89, v81, v88
  v_add_f32_dpp v90, v90, v90 row_half_mirror row_mask:0xf bank_mask:0xf
  v_add_f32_dpp v88, v88, v88 row_half_mirror row_mask:0xf bank_mask:0xf
  v_add_f32_dpp v89, v89, v89 row_half_mirror row_mask:0xf bank_mask:0xf
  v_add_f32_dpp v90, v90, v90 quad_perm:[1,0,3,2] row_mask:0xf bank_mask:0xf
  v_add_f32_dpp v88, v88, v88 quad_perm:[1,0,3,2] row_mask:0xf bank_mask:0xf
  v_add_f32_dpp v89, v89, v89 quad_perm:[1,0,3,2] row_mask:0xf bank_mask:0xf
  v_add_f32_dpp v90, v90, v90 quad_perm:[2,3,0,1] row_mask:0xf bank_mask:0xf
  v_add_f32_dpp v88, v88, v88 quad_perm:[2,3,0,1] row_mask:0xf bank_mask:0xf
  v_add_f32_dpp v89, v89, v89 quad_perm:[2,3,0,1] row_mask:0xf bank_mask:0xf
  v_mul_f32 v81, 0x41800000, v88
  v_fmac_f32 v80, 0x3e000000, v88
  v_fma_f32 v89, -v81, v88, v89
  v_mul_f32 v89, 0x3a800000, v89
  v_max_f32 v89, 0, v89
  v_cvt_pk_bf16_f32 v81, v80, v89
  v_and_b32 v89, v124, v81
  v_lshlrev_b32 v80, 16, v81
  v_add_f32 v89, 0x3727c5ac, v89
  v_cvt_pk_bf16_f32 v89, 0, v89
  v_sub_f32 v86, v86, v80
  v_sqrt_f32 v89, v89
  s_waitcnt vmcnt(0)
  v_cmp_ne_u32 s[78:79], s46, v94
  v_cvt_pk_bf16_f32 v83, v80, v89
  v_and_b32 v89, v124, v83
  v_rcp_f32 v81, v89
  s_waitcnt lgkmcnt(0)
  v_cmp_eq_u32 vcc, 0, v85
  v_mul_f32 v86, v86, v81
  s_or_b64 vcc, vcc, s[78:79]
  s_cbranch_vccnz K_RARE
K_RB:
  v_cmp_ne_u32 vcc, s56, v95
  v_fma_f32 v82, -v80, v85, v90
  v_mov_b32_dpp v28, v81 row_newbcast:0 row_mask:0xf bank_mask:0xf
  v_mul_f32 v82, v82, v81
  v_mov_b32_dpp v29, v81 row_newbcast:8 row_mask:0xf bank_mask:0xf
  v_cvt_pk_bf16_f32 v82, v82, v82
  v_mov_b32_dpp v30, v86 row_newbcast:0 row_mask:0xf bank_mask:0xf
  v_ashrrev_i32 v81, 31, v82
  v_mov_b32_dpp v31, v86 row_newbcast:8 row_mask:0xf bank_mask:0xf
  v_bitop3_b32 v82, v82, v81, v125 bitop3:0x1e
  s_cmp_lg_u64 vcc, 0
  s_cselect_b32 s47, 1, 0
  v_and_or_b32 v82, v82, v124, v7
  v_mov_b32 v80, s47
  s_mov_b32 exec_lo, 0x01010101
  s_mov_b32 exec_hi, 0x01010101
  ds_write_b64 v98, v[82:83] offset:128
  s_mov_b64 exec, 1
  ds_write_b32 v126, v80 offset:8
  ds_add_u32 v126, v127 offset:20
  s_mov_b64 exec, -1
  v_pk_fma_f32 v[48:49], v[32:33], v[28:29], v[30:31] neg_lo:[1,0,0] neg_hi:[1,0,0]
  v_pk_fma_f32 v[50:51], v[34:35], v[28:29], v[30:31] neg_lo:[1,0,0] neg_hi:[1,0,0]
  v_pk_fma_f32 v[52:53], v[36:37], v[28:29], v[30:31] neg_lo:[1,0,0] neg_hi:[1,0,0]
  v_pk_fma_f32 v[54:55], v[38:39], v[28:29], v[30:31] neg_lo:[1,0,0] neg_hi:[1,0,0]
  v_pk_fma_f32 v[56:57], v[40:41], v[28:29], v[30:31] neg_lo:[1,0,0] neg_hi:[1,0,0]
  v_pk_fma_f32 v[58:59], v[42:43], v[28:29], v[30:31] neg_lo:[1,0,0] neg_hi:[1,0,0]
  v_pk_fma_f32 v[60:61], v[44:45], v[28:29], v[30:31] neg_lo:[1,0,0] neg_hi:[1,0,0]
  v_pk_fma_f32 v[62:63], v[46:47], v[28:29], v[30:31] neg_lo:[1,0,0] neg_hi:[1,0,0]
  v_cvt_pk_f16_f32 v64, v48, v49
  v_cvt_pk_f16_f32 v65, v50, v51
  v_cvt_pk_f16_f32 v66, v52, v53
  v_cvt_pk_f16_f32 v67, v54, v55
  v_cvt_pk_f16_f32 v68, v56, v57
  v_cvt_pk_f16_f32 v69, v58, v59
  v_cvt_pk_f16_f32 v70, v60, v61
  v_cvt_pk_f16_f32 v71, v62, v63
  v_permlane32_swap_b32 v64, v66
  v_permlane32_swap_b32 v65, v67
  v_permlane32_swap_b32 v68, v70
  v_permlane32_swap_b32 v69, v71
  v_permlane16_swap_b32 v64, v65
  v_permlane16_swap_b32 v66, v67
  v_permlane16_swap_b32 v68, v69
  v_permlane16_swap_b32 v70, v71
  v_bfi_b32 v64, v122, s4, v64
  v_bfi_b32 v65, v122, s5, v65
  v_bfi_b32 v66, v122, s6, v66
  v_bfi_b32 v67, v122, s7, v67
  v_bfi_b32 v68, v122, s4, v68
  v_bfi_b32 v69, v122, s5, v69
  v_bfi_b32 v70, v122, s6, v70
  v_bfi_b32 v71, v122, s7, v71
  s_cmp_lg_u32 s47, 0
  s_cbranch_scc1 K_US_W
  buffer_store_dwordx4 v[64:67], v4, s[20:23], s61 offen
  buffer_store_dwordx4 v[68:71], v4, s[20:23], s61 offen offset:2048
  s_branch K_US_D
K_US_W:
  buffer_store_dwordx4 v[64:67], v4, s[20:23], s61 offen sc1
  buffer_store_dwordx4 v[68:71], v4, s[20:23], s61 offen offset:2048 sc1
K_US_D:
K_P2:
  s_nop 0
  buffer_load_dwordx4 v[64:67], v96, s[20:23], s75 offen sc1
  buffer_load_dwordx4 v[68:71], v96, s[20:23], s76 offen sc1
  s_cmp_eq_u32 s17, 1
  s_cbranch_scc1 K_E1
  s_cmp_lg_u32 s17, 0
  s_cbranch_scc1 K_E2
  s_setprio 0
  v_pk_mul_f32 v[8:9], v[48:49], s[58:59] op_sel_hi:[1,0]
  v_pk_mul_f32 v[10:11], v[50:51], s[58:59] op_sel_hi:[1,0]
  v_pk_mul_f32 v[12:13], v[52:53], s[58:59] op_sel_hi:[1,0]
  v_pk_mul_f32 v[14:15], v[54:55], s[58:59] op_sel_hi:[1,0]
  v_exp_f32 v8, -v8
  v_lshlrev_b32 v100, 16, v20
  v_exp_f32 v9, -v9
  v_pk_add_f32 v[32:33], v[26:27], v[32:33] neg_lo:[0,1] neg_hi:[0,1]
  v_exp_f32 v10, -v10
  v_and_b32 v102, 0xffff0000, v20
  v_exp_f32 v11, -v11
  v_pk_add_f32 v[34:35], v[26:27], v[34:35] neg_lo:[0,1] neg_hi:[0,1]
  v_exp_f32 v12, -v12
  v_lshlrev_b32 v104, 16, v21
  v_exp_f32 v13, -v13
  v_pk_add_f32 v[36:37], v[26:27], v[36:37] neg_lo:[0,1] neg_hi:[0,1]
  v_exp_f32 v14, -v14
  v_and_b32 v106, 0xffff0000, v21
  v_exp_f32 v15, -v15
  v_pk_add_f32 v[38:39], v[26:27], v[38:39] neg_lo:[0,1] neg_hi:[0,1]
  v_pk_add_f32 v[8:9], v[8:9], 1.0 op_sel_hi:[1,0]
  v_pk_add_f32 v[10:11], v[10:11], 1.0 op_sel_hi:[1,0]
  v_pk_add_f32 v[12:13], v[12:13], 1.0 op_sel_hi:[1,0]
  v_pk_add_f32 v[14:15], v[14:15], 1.0 op_sel_hi:[1,0]
  v_rcp_f32 v8, v8
  v_pk_mul_f32 v[100:101], v[48:49], v[100:101] op_sel_hi:[1,0]
  v_rcp_f32 v9, v9
  v_rcp_f32 v10, v10
  v_pk_mul_f32 v[102:103], v[50:51], v[102:103] op_sel_hi:[1,0]
  v_rcp_f32 v11, v11
  v_rcp_f32 v12, v12
  v_pk_mul_f32 v[104:105], v[52:53], v[104:105] op_sel_hi:[1,0]
  v_rcp_f32 v13, v13
  v_rcp_f32 v14, v14
  v_pk_mul_f32 v[106:107], v[54:55], v[106:107] op_sel_hi:[1,0]
  v_rcp_f32 v15, v15
  v_pk_mul_f32 v[8:9], v[8:9], v[48:49]
  v_pk_mul_f32 v[10:11], v[10:11], v[50:51]
  v_pk_mul_f32 v[12:13], v[12:13], v[52:53]
  v_pk_mul_f32 v[14:15], v[14:15], v[54:55]
  v_pk_fma_f32 v[32:33], v[100:101], v[8:9], v[32:33]
  v_cvt_pk_bf16_f32 v48, v8, 0
  v_cvt_pk_bf16_f32 v49, 0, v9
  v_pk_fma_f32 v[34:35], v[102:103], v[10:11], v[34:35]
  v_cvt_pk_bf16_f32 v50, v10, 0
  v_cvt_pk_bf16_f32 v51, 0, v11
  v_pk_fma_f32 v[36:37], v[104:105], v[12:13], v[36:37]
  v_cvt_pk_bf16_f32 v52, v12, 0
  v_cvt_pk_bf16_f32 v53, 0, v13
  v_pk_fma_f32 v[38:39], v[106:107], v[14:15], v[38:39]
  v_cvt_pk_bf16_f32 v54, v14, 0
  v_cvt_pk_bf16_f32 v55, 0, v15
  s_mov_b32 s17, 1
  s_branch K_E2
K_E1:
  s_setprio 0
  v_pk_mul_f32 v[8:9], v[56:57], s[58:59] op_sel_hi:[1,0]
  v_pk_mul_f32 v[10:11], v[58:59], s[58:59] op_sel_hi:[1,0]
  v_pk_mul_f32 v[12:13], v[60:61], s[58:59] op_sel_hi:[1,0]
  v_pk_mul_f32 v[14:15], v[62:63], s[58:59] op_sel_hi:[1,0]
  v_exp_f32 v8, -v8
  v_lshlrev_b32 v100, 16, v22
  v_exp_f32 v9, -v9
  v_pk_add_f32 v[40:41], v[26:27], v[40:41] neg_lo:[0,1] neg_hi:[0,1]
  v_exp_f32 v10, -v10
  v_and_b32 v102, 0xffff0000, v22
  v_exp_f32 v11, -v11
  v_pk_add_f32 v[42:43], v[26:27], v[42:43] neg_lo:[0,1] neg_hi:[0,1]
  v_exp_f32 v12, -v12
  v_lshlrev_b32 v104, 16, v23
  v_exp_f32 v13, -v13
  v_pk_add_f32 v[44:45], v[26:27], v[44:45] neg_lo:[0,1] neg_hi:[0,1]
  v_exp_f32 v14, -v14
  v_and_b32 v106, 0xffff0000, v23
  v_exp_f32 v15, -v15
  v_pk_add_f32 v[46:47], v[26:27], v[46:47] neg_lo:[0,1] neg_hi:[0,1]
  v_pk_add_f32 v[8:9], v[8:9], 1.0 op_sel_hi:[1,0]
  v_pk_add_f32 v[10:11], v[10:11], 1.0 op_sel_hi:[1,0]
  v_pk_add_f32 v[12:13], v[12:13], 1.0 op_sel_hi:[1,0]
  v_pk_add_f32 v[14:15], v[14:15], 1.0 op_sel_hi:[1,0]
  v_rcp_f32 v8, v8
  v_pk_mul_f32 v[100:101], v[56:57], v[100:101] op_sel_hi:[1,0]
  v_rcp_f32 v9, v9
  v_rcp_f32 v10, v10
  v_pk_mul_f32 v[102:103], v[58:59], v[102:103] op_sel_hi:[1,0]
  v_rcp_f32 v11, v11
  v_rcp_f32 v12, v12
  v_pk_mul_f32 v[104:105], v[60:61], v[104:105] op_sel_hi:[1,0]
  v_rcp_f32 v13, v13
  v_rcp_f32 v14, v14
  v_pk_mul_f32 v[106:107], v[62:63], v[106:107] op_sel_hi:[1,0]
  v_rcp_f32 v15, v15
  v_pk_mul_f32 v[8:9], v[8:9], v[56:57]
  v_pk_mul_f32 v[10:11], v[10:11], v[58:59]
  v_pk_mul_f32 v[12:13], v[12:13], v[60:61]
  v_pk_mul_f32 v[14:15], v[14:15], v[62:63]
  v_pk_fma_f32 v[40:41], v[100:101], v[8:9], v[40:41]
  v_cvt_pk_bf16_f32 v56, v8, 0
  v_cvt_pk_bf16_f32 v57, 0, v9
  v_pk_fma_f32 v[42:43], v[102:103], v[10:11], v[42:43]
  v_cvt_pk_bf16_f32 v58, v10, 0
  v_cvt_pk_bf16_f32 v59, 0, v11
  v_pk_fma_f32 v[44:45], v[104:105], v[12:13], v[44:45]
  v_cvt_pk_bf16_f32 v60, v12, 0
  v_cvt_pk_bf16_f32 v61, 0, v13
  v_pk_fma_f32 v[46:47], v[106:107], v[14:15], v[46:47]
  v_cvt_pk_bf16_f32 v62, v14, 0
  v_cvt_pk_bf16_f32 v63, 0, v15
  s_mov_b32 s17, 2
K_E2:
  s_setprio 3
  s_sub_u32 s83, s83, 1
  s_waitcnt vmcnt(0)
  v_bitop3_b32 v80, v64, v68, s4 bitop3:0x7e
  v_bitop3_b32 v81, v65, v69, s5 bitop3:0x7e
  v_bitop3_b32 v82, v66, v70, s6 bitop3:0x7e
  v_bitop3_b32 v83, v67, v71, s7 bitop3:0x7e
  s_cbranch_scc1 K_P2D
  v_or3_b32 v80, v80, v81, v82
  v_bitop3_b32 v80, v80, v83, v122 bitop3:0xa8
  v_cmp_ne_u32 vcc, 0, v80
  s_cbranch_vccnz K_P2
K_P2D:
  ds_write_b128 v121, v[64:67] offset:1312
  ds_write_b128 v121, v[68:71] offset:1568
  s_max_i32 s83, s83, 0
  s_mov_b64 exec, 1
  ds_add_u32 v126, v127 offset:16
  s_mov_b64 exec, -1
  s_setprio 0
  v_lshrrev_b32 v80, 2, v3
  v_lshl_add_u32 v99, v2, 3, v80
  v_lshlrev_b32 v99, 8, v99
  v_and_b32 v81, 1, v2
  v_lshl_or_b32 v80, v81, 2, v80
  v_lshl_or_b32 v99, v80, 5, v99
  v_and_b32 v80, 3, v1
  s_lshr_b32 s78, s30, 1
  s_lshl_b32 s78, s78, 6
  s_and_b32 s79, s30, 1
  s_lshl_b32 s79, s79, 3
  s_add_u32 s78, s78, s79
  v_lshl_add_u32 v121, v80, 4, s78
  v_xor_b32 v121, v121, v99
  v_add_u32 v121, 19328, v121
  s_lshl_b32 s78, s30, 5
  v_lshl_add_u32 v81, v80, 3, s78
  v_xor_b32 v99, v99, v81
  v_add_u32 v99, 83968, v99
  v_lshlrev_b32 v123, 6, v80
  v_and_b32 v81, 12, v1
  v_lshl_add_u32 v123, v81, 2, v123
  v_lshlrev_b32 v92, 1, v2
  v_xor_b32 v92, v92, v3
  v_lshlrev_b32 v92, 4, v92
  v_lshl_add_u32 v92, v2, 11, v92
  v_xor_b32 v93, 0x80, v92
  v_lshlrev_b32 v98, 8, v80
  v_lshl_add_u32 v98, v2, 4, v98
  v_add_u32 v98, 150016, v98
  v_and_b32 v81, 1, v1
  v_lshlrev_b32 v5, 8, v81
  v_lshl_add_u32 v5, v2, 4, v5
  v_add_u32 v5, 149504, v5
  v_lshlrev_b32 v7, 8, v2
  v_lshl_add_u32 v7, v3, 1, v7
  s_add_u32 s78, s78, 149504
  v_add_u32 v7, s78, v7
  s_lshl_b32 s63, s29, 14
  s_lshl_b32 s79, s30, 8
  s_add_u32 s63, s63, s79
  s_add_u32 s63, s63, 0x450000
  s_add_u32 s74, s63, 8192
  s_lshl_b32 s73, s28, 11
  s_add_u32 s73, s73, s63
  s_lshl_b32 s77, s28, 16
  s_add_u32 s77, s77, 0x500000
  s_lshl_b32 s57, s60, 8
  s_add_u32 s57, s57, s77
  s_mov_b32 s12, 0x07060503
  s_mov_b32 s13, 0x07060502
  s_mov_b32 s14, 0x07060501
  s_mov_b32 s15, 0x04000c0c
  s_mov_b32 s16, 0x0706000c
  s_mov_b32 s64, s24
  s_mov_b32 s65, s25
  s_mov_b32 s66, 0x700000
  s_mov_b32 s67, 0x00020000
  s_cmp_ge_u32 s29, 28
  s_cselect_b32 s66, 0, s66
  s_lshl_b32 s78, s60, 15
  s_add_u32 s78, s78, s62
  s_lshl_b32 s79, s30, 12
  s_branch K_GOB
K_GO:
  s_sleep 4
K_GOB:
  ds_read_b32 v64, v126 offset:124
  s_waitcnt lgkmcnt(0)
  v_cmp_gt_u32 vcc, 4, v64
  s_cbranch_vccnz K_GO
  s_setprio 3
  s_add_u32 m0, s79, 19328
  s_nop 0
  buffer_load_dwordx4 v92, s[64:67], s78 offen nt lds
  s_add_u32 s78, s78, 8192
  s_add_u32 m0, s79, 20352
  s_nop 0
  buffer_load_dwordx4 v92, s[64:67], s78 offen nt lds
  s_add_u32 s78, s78, 8192
  s_add_u32 m0, s79, 21376
  s_nop 0
  buffer_load_dwordx4 v93, s[64:67], s78 offen nt lds
  s_add_u32 s78, s78, 8192
  s_add_u32 m0, s79, 22400
  s_nop 0
  buffer_load_dwordx4 v93, s[64:67], s78 offen nt lds
  s_setprio 0
  s_branch K_GWB
K_GW:
  s_sleep 4
K_GWB:
  ds_read_b32 v64, v126 offset:24
  s_waitcnt lgkmcnt(0)
  v_cmp_gt_u32 vcc, 4, v64
  s_cbranch_vccnz K_GW
  s_setprio 3
  ds_read_b128 v[92:95], v126 offset:96
  s_cmp_ge_u32 s29, 28
  s_cbranch_scc1 K_NOG1
  ds_read_b128 v[100:103], v98 offset:0
  ds_read_b64_tr_b16 v[64:65], v99 offset:0
  ds_read_b64_tr_b16 v[66:67], v99 offset:1024
  ds_read_b64_tr_b16 v[68:69], v99 offset:32768
  ds_read_b64_tr_b16 v[70:71], v99 offset:33792
  ds_read_b128 v[104:107], v98 offset:64
  ds_read_b64_tr_b16 v[72:73], v99 offset:8192
  ds_read_b64_tr_b16 v[74:75], v99 offset:9216
  ds_read_b64_tr_b16 v[76:77], v99 offset:40960
  ds_read_b64_tr_b16 v[78:79], v99 offset:41984
  ds_read_b128 v[108:111], v98 offset:128
  ds_read_b64_tr_b16 v[80:81], v99 offset:16384
  ds_read_b64_tr_b16 v[82:83], v99 offset:17408
  s_waitcnt lgkmcnt(10)
  v_mfma_f32_16x16x32_bf16 v[16:19], v[100:103], v[64:67], 0
  ds_read_b64_tr_b16 v[84:85], v99 offset:49152
  ds_read_b64_tr_b16 v[86:87], v99 offset:50176
  ds_read_b128 v[112:115], v98 offset:192
  s_waitcnt lgkmcnt(11)
  v_mfma_f32_16x16x32_bf16 v[28:31], v[100:103], v[68:71], 0
  ds_read_b64_tr_b16 v[88:89], v99 offset:24576
  ds_read_b64_tr_b16 v[90:91], v99 offset:25600
  s_waitcnt lgkmcnt(10)
  v_mfma_f32_16x16x32_bf16 v[16:19], v[104:107], v[72:75], v[16:19]
  ds_read_b64_tr_b16 v[64:65], v99 offset:57344
  ds_read_b64_tr_b16 v[66:67], v99 offset:58368
  s_waitcnt lgkmcnt(10)
  v_mfma_f32_16x16x32_bf16 v[28:31], v[104:107], v[76:79], v[28:31]
  s_waitcnt lgkmcnt(7)
  v_mfma_f32_16x16x32_bf16 v[16:19], v[108:111], v[80:83], v[16:19]
  s_waitcnt lgkmcnt(5)
  v_mfma_f32_16x16x32_bf16 v[28:31], v[108:111], v[84:87], v[28:31]
  s_waitcnt lgkmcnt(2)
  v_mfma_f32_16x16x32_bf16 v[16:19], v[112:115], v[88:91], v[16:19]
  s_waitcnt lgkmcnt(0)
  v_mfma_f32_16x16x32_bf16 v[28:31], v[112:115], v[64:67], v[28:31]
  v_and_b32 v116, v124, v93
  v_and_b32 v117, v124, v95
  v_lshlrev_b32 v118, 16, v93
  v_lshlrev_b32 v119, 16, v95
  v_rcp_f32 v116, v116
  v_rcp_f32 v117, v117
  v_fma_f32 v16, -v118, v18, v16
  v_fma_f32 v17, -v119, v18, v17
  v_fma_f32 v18, -v118, v30, v28
  v_fma_f32 v19, -v119, v30, v29
  v_mul_f32 v16, v16, v116
  v_mul_f32 v17, v17, v117
  v_mul_f32 v18, v18, v116
  v_mul_f32 v19, v19, v117
  v_add_u32 v16, 0x80, v16
  v_add_u32 v17, 0x80, v17
  v_add_u32 v18, 0x80, v18
  v_add_u32 v19, 0x80, v19
  v_perm_b32 v16, v16, v19, s12
  v_perm_b32 v17, v17, v19, s13
  v_perm_b32 v18, v18, v19, s14
  v_mov_b32 v19, s46
  s_mov_b64 exec, 0xffff
  buffer_store_dwordx4 v[16:19], v97, s[32:35], s73 offen sc1
  s_mov_b64 exec, -1
K_NOG1:
  s_waitcnt lgkmcnt(0)
  v_readfirstlane_b32 s6, v92
  v_readfirstlane_b32 s7, v94
  s_andn2_b32 s6, 0xffe, s6
  s_andn2_b32 s7, 0xffe, s7
  s_lshr_b32 s75, s6, 4
  s_lshr_b32 s76, s7, 4
  v_cmp_ne_u32 s[52:53], s6, v6
  v_cmp_ne_u32 vcc, s7, v6
  v_add_u32 v6, 2, v6
  s_and_b64 s[52:53], s[52:53], vcc
  v_cmp_ne_u32 s[54:55], s6, v6
  v_cmp_ne_u32 vcc, s7, v6
  s_nop 0
  s_and_b64 s[54:55], s[54:55], vcc
  s_cmp_ge_u32 s29, 28
  s_cbranch_scc1 K_NOG2
  s_waitcnt vmcnt(0)
  s_branch K_P4B
K_P4:
  s_sleep 2
K_P4B:
  buffer_load_dwordx4 v[64:67], v120, s[32:35], s63 offen sc1
  buffer_load_dwordx4 v[68:71], v120, s[32:35], s74 offen sc1
  s_sub_u32 s83, s83, 1
  s_waitcnt vmcnt(0)
  s_cbranch_scc1 K_P4D
  v_cmp_ne_u32 vcc, s46, v67
  v_cmp_ne_u32 s[78:79], s46, v71
  s_nop 0
  s_or_b64 vcc, vcc, s[78:79]
  s_cbranch_vccnz K_P4
K_P4D:
  s_max_i32 s83, s83, 0
  v_perm_b32 v67, v64, v65, s15
  v_perm_b32 v67, v67, v66, s16
  v_perm_b32 v71, v68, v69, s15
  v_perm_b32 v71, v71, v70, s16
  v_pk_add_f32 v[64:65], v[64:65], v[68:69]
  v_pk_add_f32 v[66:67], v[66:67], v[70:71]
  s_nop 0
  v_permlane16_swap_b32 v64, v65
  v_permlane16_swap_b32 v66, v67
  v_add_f32 v64, v64, v65
  v_add_f32 v66, v66, v67
  s_nop 1
  v_permlane32_swap_b32 v64, v66
  v_add_f32 v64, v64, v66
  v_cvt_pk_bf16_f32 v65, 0, v64
  v_cvt_pk_bf16_f32 v64, 0, v64
  s_nop 1
  v_permlane32_swap_b32 v65, v64
  v_mul_f32 v66, 0xbfb8aa3b, v65
  v_exp_f32 v66, v66
  s_nop 0
  v_add_f32 v66, 1.0, v66
  v_rcp_f32 v66, v66
  s_nop 0
  v_mul_f32 v66, v66, v65
  v_cvt_pk_bf16_f32 v66, 0, v66
  v_mul_f32 v66, v66, v64
  v_cvt_pk_bf16_f32 v66, v66, v66
  s_mov_b32 exec_hi, 0
  ds_write_b16 v7, v66
  s_mov_b32 exec_lo, 1
  ds_add_u32 v126, v127 offset:116
  s_mov_b64 exec, -1
  s_branch K_HWB
K_HW:
  s_sleep 1
K_HWB:
  ds_read_b32 v64, v126 offset:116
  s_waitcnt lgkmcnt(0)
  v_cmp_gt_u32 vcc, 8, v64
  s_cbranch_vccnz K_HW
  ds_read_b128 v[100:103], v5 offset:0
  ds_read_b64_tr_b16 v[80:81], v121 offset:0
  ds_read_b64_tr_b16 v[82:83], v121 offset:1024
  ds_read_b128 v[104:107], v5 offset:64
  ds_read_b64_tr_b16 v[84:85], v121 offset:8192
  ds_read_b64_tr_b16 v[86:87], v121 offset:9216
  ds_read_b128 v[108:111], v5 offset:128
  ds_read_b64_tr_b16 v[88:89], v121 offset:16384
  ds_read_b64_tr_b16 v[90:91], v121 offset:17408
  ds_read_b128 v[112:115], v5 offset:192
  ds_read_b64_tr_b16 v[92:93], v121 offset:24576
  ds_read_b64_tr_b16 v[94:95], v121 offset:25600
  s_waitcnt lgkmcnt(9)
  v_mfma_f32_16x16x32_bf16 v[16:19], v[100:103], v[80:83], 0
  s_waitcnt lgkmcnt(6)
  v_mfma_f32_16x16x32_bf16 v[16:19], v[104:107], v[84:87], v[16:19]
  s_waitcnt lgkmcnt(3)
  v_mfma_f32_16x16x32_bf16 v[16:19], v[108:111], v[88:91], v[16:19]
  s_waitcnt lgkmcnt(0)
  v_mfma_f32_16x16x32_bf16 v[16:19], v[112:115], v[92:95], v[16:19]
  s_mov_b64 exec, 0xffff
  s_nop 6
  v_mov_b32 v18, s46
  s_cmp_lg_u32 s47, 0
  s_cbranch_scc1 K_DS_W
  buffer_store_dwordx3 v[16:18], v123, s[32:35], s57 offen
  s_branch K_DS_D
K_DS_W:
  buffer_store_dwordx3 v[16:18], v123, s[32:35], s57 offen sc1
K_DS_D:
  s_mov_b64 exec, -1
K_NOG2:
  s_cmp_eq_u32 s75, s60
  s_cselect_b32 s75, 0x55555555, 0
  s_cmp_eq_u32 s76, s60
  s_cselect_b32 s76, 0xaaaaaaaa, 0
  s_or_b32 s75, s75, s76
  s_cbranch_scc0 K_NOOWN
K_PO:
  buffer_load_dwordx4 v[72:75], v4, s[20:23], s61 offen sc1
  buffer_load_dwordx4 v[76:79], v4, s[20:23], s61 offen offset:2048 sc1
  s_sub_u32 s83, s83, 1
  s_waitcnt vmcnt(0)
  s_cbranch_scc1 K_POD
  v_xor_b32 v64, s4, v72
  v_xor_b32 v65, s4, v76
  v_bitop3_b32 v64, v64, v73, s5 bitop3:0xf6
  v_bitop3_b32 v65, v65, v77, s5 bitop3:0xf6
  v_and_b32 v64, v122, v64
  v_and_b32 v65, v122, v65
  v_min_u32 v64, v64, v65
  v_cmp_eq_u32 vcc, 0, v64
  s_cbranch_vccnz K_PO
K_POD:
  s_max_i32 s83, s83, 0
  v_mov_b32 v64, 0
  v_mov_b32 v65, 0
  v_mov_b32 v66, s46
  v_lshlrev_b32 v67, 5, v1
  s_mov_b32 exec_lo, s75
  s_mov_b32 exec_hi, s75
  s_add_u32 s78, s77, 57344
  s_cmp_lg_u32 s47, 0
  s_cbranch_scc1 K_OS_W
  buffer_store_dwordx3 v[64:66], v67, s[32:35], s78 offen
  s_branch K_OS_D
K_OS_W:
  buffer_store_dwordx3 v[64:66], v67, s[32:35], s78 offen sc1
K_OS_D:
  s_mov_b64 exec, -1
K_NOOWN:
  s_and_b32 s78, s30, 3
  s_lshl_b32 s78, s78, 2
  s_lshr_b32 s78, 0xc480, s78
  s_and_b32 s78, s78, 15
  v_mov_b32 v65, s78
  s_setprio 0
  s_branch K_DWB
K_DW:
  s_sleep 4
K_DWB:
  ds_read_b32 v64, v65 offset:48
  s_waitcnt lgkmcnt(0)
  v_cmp_gt_u32 vcc, 8, v64
  s_cbranch_vccnz K_DW
  s_setprio 3
  s_cmp_lg_u32 s17, 0
  s_cbranch_scc1 K_L1
  v_pk_mul_f32 v[8:9], v[48:49], s[58:59] op_sel_hi:[1,0]
  v_pk_mul_f32 v[10:11], v[50:51], s[58:59] op_sel_hi:[1,0]
  v_pk_mul_f32 v[12:13], v[52:53], s[58:59] op_sel_hi:[1,0]
  v_pk_mul_f32 v[14:15], v[54:55], s[58:59] op_sel_hi:[1,0]
  v_exp_f32 v8, -v8
  v_lshlrev_b32 v100, 16, v20
  v_exp_f32 v9, -v9
  v_pk_add_f32 v[32:33], v[26:27], v[32:33] neg_lo:[0,1] neg_hi:[0,1]
  v_exp_f32 v10, -v10
  v_and_b32 v102, 0xffff0000, v20
  v_exp_f32 v11, -v11
  v_pk_add_f32 v[34:35], v[26:27], v[34:35] neg_lo:[0,1] neg_hi:[0,1]
  v_exp_f32 v12, -v12
  v_lshlrev_b32 v104, 16, v21
  v_exp_f32 v13, -v13
  v_pk_add_f32 v[36:37], v[26:27], v[36:37] neg_lo:[0,1] neg_hi:[0,1]
  v_exp_f32 v14, -v14
  v_and_b32 v106, 0xffff0000, v21
  v_exp_f32 v15, -v15
  v_pk_add_f32 v[38:39], v[26:27], v[38:39] neg_lo:[0,1] neg_hi:[0,1]
  v_pk_add_f32 v[8:9], v[8:9], 1.0 op_sel_hi:[1,0]
  v_pk_add_f32 v[10:11], v[10:11], 1.0 op_sel_hi:[1,0]
  v_pk_add_f32 v[12:13], v[12:13], 1.0 op_sel_hi:[1,0]
  v_pk_add_f32 v[14:15], v[14:15], 1.0 op_sel_hi:[1,0]
  v_rcp_f32 v8, v8
  v_pk_mul_f32 v[100:101], v[48:49], v[100:101] op_sel_hi:[1,0]
  v_rcp_f32 v9, v9
  v_rcp_f32 v10, v10
  v_pk_mul_f32 v[102:103], v[50:51], v[102:103] op_sel_hi:[1,0]
  v_rcp_f32 v11, v11
  v_rcp_f32 v12, v12
  v_pk_mul_f32 v[104:105], v[52:53], v[104:105] op_sel_hi:[1,0]
  v_rcp_f32 v13, v13
  v_rcp_f32 v14, v14
  v_pk_mul_f32 v[106:107], v[54:55], v[106:107] op_sel_hi:[1,0]
  v_rcp_f32 v15, v15
  v_pk_mul_f32 v[8:9], v[8:9], v[48:49]
  v_pk_mul_f32 v[10:11], v[10:11], v[50:51]
  v_pk_mul_f32 v[12:13], v[12:13], v[52:53]
  v_pk_mul_f32 v[14:15], v[14:15], v[54:55]
  v_pk_fma_f32 v[32:33], v[100:101], v[8:9], v[32:33]
  v_cvt_pk_bf16_f32 v48, v8, 0
  v_cvt_pk_bf16_f32 v49, 0, v9
  v_pk_fma_f32 v[34:35], v[102:103], v[10:11], v[34:35]
  v_cvt_pk_bf16_f32 v50, v10, 0
  v_cvt_pk_bf16_f32 v51, 0, v11
  v_pk_fma_f32 v[36:37], v[104:105], v[12:13], v[36:37]
  v_cvt_pk_bf16_f32 v52, v12, 0
  v_cvt_pk_bf16_f32 v53, 0, v13
  v_pk_fma_f32 v[38:39], v[106:107], v[14:15], v[38:39]
  v_cvt_pk_bf16_f32 v54, v14, 0
  v_cvt_pk_bf16_f32 v55, 0, v15
K_L1:
  s_cmp_lg_u32 s75, 0
  s_cbranch_scc1 K_NOYL
  buffer_load_dwordx4 v[72:75], v4, s[20:23], s61 offen sc1
  buffer_load_dwordx4 v[76:79], v4, s[20:23], s61 offen offset:2048 sc1
K_NOYL:
  s_cmp_eq_u32 s17, 2
  s_cbranch_scc1 K_L2
  v_pk_mul_f32 v[8:9], v[56:57], s[58:59] op_sel_hi:[1,0]
  v_pk_mul_f32 v[10:11], v[58:59], s[58:59] op_sel_hi:[1,0]
  v_pk_mul_f32 v[12:13], v[60:61], s[58:59] op_sel_hi:[1,0]
  v_pk_mul_f32 v[14:15], v[62:63], s[58:59] op_sel_hi:[1,0]
  v_exp_f32 v8, -v8
  v_lshlrev_b32 v100, 16, v22
  v_exp_f32 v9, -v9
  v_pk_add_f32 v[40:41], v[26:27], v[40:41] neg_lo:[0,1] neg_hi:[0,1]
  v_exp_f32 v10, -v10
  v_and_b32 v102, 0xffff0000, v22
  v_exp_f32 v11, -v11
  v_pk_add_f32 v[42:43], v[26:27], v[42:43] neg_lo:[0,1] neg_hi:[0,1]
  v_exp_f32 v12, -v12
  v_lshlrev_b32 v104, 16, v23
  v_exp_f32 v13, -v13
  v_pk_add_f32 v[44:45], v[26:27], v[44:45] neg_lo:[0,1] neg_hi:[0,1]
  v_exp_f32 v14, -v14
  v_and_b32 v106, 0xffff0000, v23
  v_exp_f32 v15, -v15
  v_pk_add_f32 v[46:47], v[26:27], v[46:47] neg_lo:[0,1] neg_hi:[0,1]
  v_pk_add_f32 v[8:9], v[8:9], 1.0 op_sel_hi:[1,0]
  v_pk_add_f32 v[10:11], v[10:11], 1.0 op_sel_hi:[1,0]
  v_pk_add_f32 v[12:13], v[12:13], 1.0 op_sel_hi:[1,0]
  v_pk_add_f32 v[14:15], v[14:15], 1.0 op_sel_hi:[1,0]
  v_rcp_f32 v8, v8
  v_pk_mul_f32 v[100:101], v[56:57], v[100:101] op_sel_hi:[1,0]
  v_rcp_f32 v9, v9
  v_rcp_f32 v10, v10
  v_pk_mul_f32 v[102:103], v[58:59], v[102:103] op_sel_hi:[1,0]
  v_rcp_f32 v11, v11
  v_rcp_f32 v12, v12
  v_pk_mul_f32 v[104:105], v[60:61], v[104:105] op_sel_hi:[1,0]
  v_rcp_f32 v13, v13
  v_rcp_f32 v14, v14
  v_pk_mul_f32 v[106:107], v[62:63], v[106:107] op_sel_hi:[1,0]
  v_rcp_f32 v15, v15
  v_pk_mul_f32 v[8:9], v[8:9], v[56:57]
  v_pk_mul_f32 v[10:11], v[10:11], v[58:59]
  v_pk_mul_f32 v[12:13], v[12:13], v[60:61]
  v_pk_mul_f32 v[14:15], v[14:15], v[62:63]
  v_pk_fma_f32 v[40:41], v[100:101], v[8:9], v[40:41]
  v_cvt_pk_bf16_f32 v56, v8, 0
  v_cvt_pk_bf16_f32 v57, 0, v9
  v_pk_fma_f32 v[42:43], v[102:103], v[10:11], v[42:43]
  v_cvt_pk_bf16_f32 v58, v10, 0
  v_cvt_pk_bf16_f32 v59, 0, v11
  v_pk_fma_f32 v[44:45], v[104:105], v[12:13], v[44:45]
  v_cvt_pk_bf16_f32 v60, v12, 0
  v_cvt_pk_bf16_f32 v61, 0, v13
  v_pk_fma_f32 v[46:47], v[106:107], v[14:15], v[46:47]
  v_cvt_pk_bf16_f32 v62, v14, 0
  v_cvt_pk_bf16_f32 v63, 0, v15
K_L2:
  s_waitcnt vmcnt(0)
  s_branch K_PYC
K_PY:
  buffer_load_dwordx4 v[72:75], v4, s[20:23], s61 offen sc1
  buffer_load_dwordx4 v[76:79], v4, s[20:23], s61 offen offset:2048 sc1
  s_sub_u32 s83, s83, 1
  s_waitcnt vmcnt(0)
  s_cbranch_scc1 K_PYD
K_PYC:
  v_xor_b32 v64, s4, v72
  v_xor_b32 v65, s4, v76
  v_bitop3_b32 v64, v64, v73, s5 bitop3:0xf6
  v_bitop3_b32 v65, v65, v77, s5 bitop3:0xf6
  v_and_b32 v64, v122, v64
  v_and_b32 v65, v122, v65
  v_min_u32 v64, v64, v65
  v_cmp_eq_u32 vcc, 0, v64
  s_cbranch_vccnz K_PY
K_PYD:
  v_permlane32_swap_b32 v72, v74
  v_permlane32_swap_b32 v73, v75
  v_permlane32_swap_b32 v76, v78
  v_permlane32_swap_b32 v77, v79
  v_permlane16_swap_b32 v72, v73
  v_permlane16_swap_b32 v74, v75
  v_permlane16_swap_b32 v76, v77
  v_permlane16_swap_b32 v78, v79
  v_dot2c_f32_bf16 v32, v72, v48
  v_dot2c_f32_bf16 v34, v73, v50
  v_dot2c_f32_bf16 v36, v74, v52
  v_dot2c_f32_bf16 v38, v75, v54
  v_dot2c_f32_bf16 v40, v76, v56
  v_dot2c_f32_bf16 v42, v77, v58
  v_dot2c_f32_bf16 v44, v78, v60
  v_dot2c_f32_bf16 v46, v79, v62
  v_dot2c_f32_bf16 v33, v72, v49
  v_dot2c_f32_bf16 v35, v73, v51
  v_dot2c_f32_bf16 v37, v74, v53
  v_dot2c_f32_bf16 v39, v75, v55
  v_dot2c_f32_bf16 v41, v76, v57
  v_dot2c_f32_bf16 v43, v77, v59
  v_dot2c_f32_bf16 v45, v78, v61
  v_dot2c_f32_bf16 v47, v79, v63
  v_cvt_pk_bf16_f32 v8, v32, v34
  v_cvt_pk_bf16_f32 v9, v36, v38
  v_cvt_pk_bf16_f32 v10, v40, v42
  v_cvt_pk_bf16_f32 v11, v44, v46
  s_mov_b64 exec, s[52:53]
  buffer_store_dwordx4 v[8:11], v4, s[20:23], s61 offen offset:0
  s_mov_b64 exec, -1
  v_cvt_pk_bf16_f32 v12, v33, v35
  v_cvt_pk_bf16_f32 v13, v37, v39
  v_cvt_pk_bf16_f32 v14, v41, v43
  v_cvt_pk_bf16_f32 v15, v45, v47
  s_mov_b64 exec, s[54:55]
  buffer_store_dwordx4 v[12:15], v4, s[20:23], s61 offen offset:2048
  s_mov_b64 exec, -1
  s_endpgm
K_RARE:
  s_sleep 2
  buffer_load_dwordx2 v[94:95], v93, s[32:35], s74 offen sc1
  ds_read_b32 v85, v126 offset:4
  s_sub_u32 s83, s83, 1
  s_waitcnt vmcnt(0) lgkmcnt(0)
  s_cbranch_scc1 K_RE
  v_cmp_ne_u32 s[78:79], s46, v94
  v_cmp_eq_u32 vcc, 0, v85
  s_nop 0
  s_or_b64 vcc, vcc, s[78:79]
  s_cbranch_vccnz K_RARE
K_RE:
  s_max_i32 s83, s83, 0
  s_branch K_RB
.p2align 6
K_C:
  s_sub_u32 s30, s30, 8
  s_lshr_b32 s3, s29, 3
  s_lshl_b32 s3, s3, 5
  s_and_b32 s55, s29, 7
  s_add_u32 s3, s3, s55
  s_lshl_b32 s55, s28, 7
  s_add_u32 s3, s3, s55
  s_lshr_b32 s59, s30, 1
  s_lshl_b32 s55, s59, 3
  s_add_u32 s56, s3, s55
  s_lshl_b32 s57, s56, 1
  s_and_b32 s57, s57, -4
  v_lshlrev_b32 v95, 4, v1
  v_and_b32 v96, 15, v1
  v_lshrrev_b32 v97, 4, v1
  v_mov_b32 v12, 0
  v_mov_b32 v13, 0
  v_mov_b32 v14, 0
  v_mov_b32 v15, 0
  s_mov_b32 s34, 0x800000
  s_mov_b32 s35, 0x00020000
  s_waitcnt lgkmcnt(0)
  s_load_dword s47, s[12:13], s57
  s_mov_b32 s32, s42
  s_mov_b32 s33, s43
  s_barrier
  s_mov_b32 m0, 81920
  s_cmp_lg_u32 s30, 2
  s_cbranch_scc1 K_NOT
  s_lshl_b32 s60, s28, 16
  s_lshl_b32 s61, s29, 11
  s_add_u32 s60, s60, s61
  s_add_u32 s60, s60, 0x500000
  s_lshl_b32 s61, s28, 10
  s_add_u32 s61, s61, 0x441000
  buffer_load_dwordx4 v95, s[32:35], s60 offen sc1 lds
  buffer_load_dwordx4 v95, s[32:35], s60 offen offset:1024 sc1 lds
  buffer_load_dwordx4 v95, s[32:35], s61 offen sc1 lds
K_NOT:
  s_mov_b32 s4, s20
  s_mov_b32 s5, s21
  s_mov_b32 s6, 0x700000
  s_mov_b32 s7, 0x00020000
  s_mov_b32 s8, s22
  s_mov_b32 s9, s23
  s_mov_b32 s10, 0x700000
  s_mov_b32 s11, 0x00020000
  s_cmp_ge_u32 s29, 28
  s_cselect_b32 s6, 0, s6
  s_cselect_b32 s10, 0, s10
  v_lshlrev_b32 v88, 1, v97
  v_xor_b32 v88, v88, v96
  v_mul_u32_u24 v18, 7168, v97
  v_lshl_add_u32 v88, v88, 4, v18
  v_xor_b32 v98, 0x80, v88
  s_lshl_b32 s16, s28, 3
  s_add_u32 s16, s16, s30
  s_mul_i32 s16, s16, 114688
  s_lshl_b32 s17, s29, 8
  s_add_u32 s16, s16, s17
  s_add_u32 s17, s16, 28672
  s_add_u32 s18, s16, 57344
  s_add_u32 s19, s16, 86016
  s_lshl_b32 s36, s30, 12
  s_add_u32 s36, s36, 83968
  s_add_u32 m0, s36, 0
  s_nop 0
  buffer_load_dwordx4 v88, s[4:7], s16 offen nt lds
  s_mov_b32 s52, s59
  s_lshr_b32 s53, s30, 2
  s_xor_b32 s53, s53, s30
  s_and_b32 s53, s53, 1
  s_mul_i32 s66, s52, 4640
  s_add_u32 s66, s66, 768
  v_add_u32 v11, s66, v95
  s_mov_b32 exec_hi, 3
  ds_write_b128 v11, v[12:15]
  s_mov_b32 exec_hi, -1
  s_lshl_b32 s68, s52, 12
  s_add_u32 s68, s68, 56320
  s_lshl_b32 s67, s53, 11
  s_add_u32 s67, s67, s68
  v_add_u32 v90, s67, v95
  ds_write_b128 v90, v[12:15]
  ds_write_b128 v90, v[12:15] offset:1024
  s_mov_b32 s67, 0x32a57060
  s_mov_b32 s71, 0x3f317218
  s_lshl_b32 s61, s30, 2
  v_mov_b32 v92, s61
  s_xor_b32 s61, s61, 4
  v_mov_b32 v93, s61
  s_mul_i32 s69, s52, 9216
  s_add_u32 s69, s69, 19328
  s_xor_b32 s70, s53, 1
  s_mul_i32 s70, s70, 4608
  s_add_u32 s70, s70, s69
  s_sub_u32 m0, s70, 16384
  v_mul_u32_u24 v41, 288, v96
  v_lshl_add_u32 v41, v97, 4, v41
  v_add_u32 v41, s70, v41
  v_add_u32 v99, s69, v95
  s_lshl_b32 s60, s52, 8
  s_add_u32 s60, s60, 77824
  v_lshl_add_u32 v17, v1, 2, s60
  s_lshl_b32 s61, s53, 7
  s_add_u32 s60, s60, s61
  v_lshl_add_u32 v16, v1, 1, s60
  v_mov_b32 v2, 0
  v_mov_b32 v3, 0
  v_mov_b32 v4, 0
  v_mov_b32 v5, 0
  v_mov_b32 v42, 0x3c00
  s_mov_b32 s37, m0
  s_mov_b32 s72, -1
  s_mov_b32 s73, 0
  s_waitcnt lgkmcnt(0)
  s_lshl_b32 s60, s47, 16
  s_and_b32 s61, s47, s31
  s_bitcmp1_b32 s56, 0
  s_cselect_b32 s60, s61, s60
  v_mov_b32 v8, s60
  v_mul_f32 v10, s58, v8
  v_fma_f32 v11, v8, s58, -v10
  v_exp_f32 v9, v10
  v_fmac_f32 v11, s67, v8
  v_mul_f32 v11, s71, v11
  v_fmac_f32 v9, v9, v11
  v_cvt_pk_bf16_f32 v9, 0, v9
  v_mul_f32 v91, s58, v9
  v_mul_f32 v90, 0.15915494, v9
  s_branch K_PWB
K_PW:
  s_sleep 1
K_PWB:
  ds_read_b32 v18, v12 offset:12
  s_waitcnt lgkmcnt(0)
  v_cmp_eq_u32 vcc, 0, v18
  s_cbranch_vccnz K_PW
  s_cmp_lg_u32 s30, 0
  s_cbranch_scc1 K_NOCI
  ds_read_b32 v18, v12 offset:0
  s_getreg_b32 s60, hwreg(HW_REG_XCC_ID)
  v_mov_b32 v19, s60
  s_lshl_b32 s60, s28, 8
  s_lshl_b32 s61, s29, 3
  s_add_u32 s60, s60, s61
  s_add_u32 s60, s60, 0x440000
  s_waitcnt lgkmcnt(0)
  s_mov_b64 exec, 1
  buffer_store_dwordx2 v[18:19], v12, s[32:35], s60 offen sc1
  s_mov_b64 exec, -1
K_NOCI:
  ds_read_u16_d16_hi v2, v16
  ds_read_u16_d16_hi v3, v16 offset:1024
  ds_read_b32 v6, v17 offset:2048
  ds_read_b32 v7, v17 offset:3072
  ds_read_u16_d16_hi v4, v16 offset:2048
  ds_read_u16_d16_hi v5, v16 offset:3072
  s_waitcnt lgkmcnt(5)
  v_mul_f32 v2, 0x3fb8aa3b, v2
  s_waitcnt lgkmcnt(4)
  v_mul_f32 v10, v3, v90
  v_exp_f32 v8, v2
  v_mul_f32 v11, 0x43000000, v10
  v_fract_f32 v10, v10
  v_fract_f32 v11, v11
  s_waitcnt lgkmcnt(2)
  v_and_b32 v6, 0x7fff7fff, v6
  v_and_b32 v7, 0x7fff7fff, v7
  v_cvt_pk_bf16_f32 v8, v8, v8
  v_pk_max_u16 v6, v6, v7
  v_and_b32 v8, 0xffff0000, v8
  v_pk_max_u16 v6, v6, v6 op_sel:[0,1] op_sel_hi:[1,0]
  v_mul_f32 v8, v8, v91
  v_sin_f32 v26, v11
  v_mul_f32 v12, 0x43000000, v8
  v_max_u32_dpp v6, v6, v6 quad_perm:[1,0,3,2] row_mask:0xf bank_mask:0xf
  v_exp_f32 v8, -v8
  v_cos_f32 v27, v11
  v_max_u32_dpp v6, v6, v6 quad_perm:[2,3,0,1] row_mask:0xf bank_mask:0xf
  v_cos_f32 v11, v10
  v_sin_f32 v10, v10
  v_max_u32_dpp v6, v6, v6 row_half_mirror row_mask:0xf bank_mask:0xf
  v_exp_f32 v12, -v12
  v_mul_f32 v11, v11, v8
  v_max_u32_dpp v6, v6, v6 row_mirror row_mask:0xf bank_mask:0xf
  v_mul_f32 v10, v10, v8
  v_mul_f32 v26, v26, v12
  v_max_u32_dpp v6, v6, v6 row_bcast:15 row_mask:0xa bank_mask:0xf
  v_mul_f32 v27, v27, v12
  v_add_f32 v9, v9, v9
  v_max_u32_dpp v6, v6, v6 row_bcast:31 row_mask:0xc bank_mask:0xf
  v_pk_mul_f32 v[24:25], v[10:11], v[10:11] op_sel:[1,0] op_sel_hi:[1,1]
  v_mul_f32 v6, v6, v9
  v_pk_fma_f32 v[24:25], v[10:11], v[10:11], v[24:25] op_sel:[1,0,0] op_sel_hi:[0,0,1] neg_hi:[1,0,0]
  v_readlane_b32 s78, v6, 63
  s_nop 0
  s_lshr_b32 s78, s78, 23
  s_max_u32 s78, s78, 33
  s_min_u32 s78, s78, 233
  s_sub_u32 s70, s78, 6
  s_sub_u32 s78, 260, s78
  s_lshl_b32 s70, s70, 23
  s_lshl_b32 s78, s78, 23
  v_mul_f32 v9, s78, v9
  s_waitcnt lgkmcnt(0)
  v_mul_f32 v33, v4, v9
  v_mul_f32 v32, v5, v9
  v_pk_mul_f32 v[12:13], v[24:25], v[24:25] op_sel:[1,0] op_sel_hi:[1,1]
  s_add_u32 m0, s36, 32768
  s_nop 0
  buffer_load_dwordx4 v88, s[8:11], s16 offen nt lds
  s_mov_b32 m0, s37
  v_cvt_pk_f16_f32 v100, v33, -v32
  v_cvt_pk_f16_f32 v101, v11, -v10
  v_pk_fma_f32 v[12:13], v[24:25], v[24:25], v[12:13] op_sel:[1,0,0] op_sel_hi:[0,0,1] neg_hi:[1,0,0]
  v_cvt_pk_f16_f32 v102, v25, -v24
  v_pk_mul_f16 v103, v100, v101 op_sel:[0,0] op_sel_hi:[0,1]
  v_pk_mul_f32 v[14:15], v[12:13], v[12:13] op_sel:[1,0] op_sel_hi:[1,1]
  v_pk_mul_f16 v104, v100, v102 op_sel:[0,0] op_sel_hi:[0,1]
  v_pk_fma_f16 v103, v100, v101, v103 op_sel:[1,1,0] op_sel_hi:[1,0,1] neg_lo:[1,0,0]
  v_pk_fma_f32 v[14:15], v[12:13], v[12:13], v[14:15] op_sel:[1,0,0] op_sel_hi:[0,0,1] neg_hi:[1,0,0]
  v_pk_fma_f16 v104, v100, v102, v104 op_sel:[1,1,0] op_sel_hi:[1,0,1] neg_lo:[1,0,0]
  v_pk_mul_f32 v[16:17], v[24:25], v[10:11] op_sel:[1,0] op_sel_hi:[1,1]
  v_pk_mul_f32 v[18:19], v[14:15], v[14:15] op_sel:[1,0] op_sel_hi:[1,1]
  v_cvt_pk_f16_f32 v105, v13, -v12
  v_pk_fma_f32 v[16:17], v[10:11], v[24:25], v[16:17] op_sel:[1,0,0] op_sel_hi:[0,0,1] neg_hi:[1,0,0]
  v_pk_fma_f32 v[18:19], v[14:15], v[14:15], v[18:19] op_sel:[1,0,0] op_sel_hi:[0,0,1] neg_hi:[1,0,0]
  v_pk_mul_f16 v106, v100, v105 op_sel:[0,0] op_sel_hi:[0,1]
  v_cvt_pk_f16_f32 v107, v17, -v16
  v_pk_mul_f32 v[20:21], v[18:19], v[18:19] op_sel:[1,0] op_sel_hi:[1,1]
  v_pk_fma_f16 v106, v100, v105, v106 op_sel:[1,1,0] op_sel_hi:[1,0,1] neg_lo:[1,0,0]
  v_pk_mul_f16 v108, v100, v107 op_sel:[0,0] op_sel_hi:[0,1]
  v_pk_fma_f32 v[20:21], v[18:19], v[18:19], v[20:21] op_sel:[1,0,0] op_sel_hi:[0,0,1] neg_hi:[1,0,0]
  v_pk_mul_f16 v109, v105, v101 op_sel:[0,0] op_sel_hi:[0,1]
  v_pk_fma_f16 v108, v100, v107, v108 op_sel:[1,1,0] op_sel_hi:[1,0,1] neg_lo:[1,0,0]
  v_pk_mul_f32 v[22:23], v[20:21], v[20:21] op_sel:[1,0] op_sel_hi:[1,1]
  v_pk_fma_f16 v109, v105, v101, v109 op_sel:[1,1,0] op_sel_hi:[1,0,1] neg_lo:[1,0,0]
  v_pk_mul_f16 v110, v105, v102 op_sel:[0,0] op_sel_hi:[0,1]
  v_pk_fma_f32 v[22:23], v[20:21], v[20:21], v[22:23] op_sel:[1,0,0] op_sel_hi:[0,0,1] neg_hi:[1,0,0]
  v_pk_mul_f16 v111, v100, v109 op_sel:[0,0] op_sel_hi:[0,1]
  v_pk_fma_f16 v110, v105, v102, v110 op_sel:[1,1,0] op_sel_hi:[1,0,1] neg_lo:[1,0,0]
  v_pk_mul_f16 v112, v105, v107 op_sel:[0,0] op_sel_hi:[0,1]
  v_pk_fma_f16 v111, v100, v109, v111 op_sel:[1,1,0] op_sel_hi:[1,0,1] neg_lo:[1,0,0]
  v_pk_mul_f16 v113, v100, v110 op_sel:[0,0] op_sel_hi:[0,1]
  v_pk_fma_f16 v112, v105, v107, v112 op_sel:[1,1,0] op_sel_hi:[1,0,1] neg_lo:[1,0,0]
  v_pk_mul_f32 v[28:29], v[32:33], v[26:27] op_sel:[1,0] op_sel_hi:[1,1]
  v_pk_fma_f16 v113, v100, v110, v113 op_sel:[1,1,0] op_sel_hi:[1,0,1] neg_lo:[1,0,0]
  v_pk_mul_f16 v114, v100, v112 op_sel:[0,0] op_sel_hi:[0,1]
  v_pk_fma_f32 v[28:29], v[26:27], v[32:33], v[28:29] op_sel:[1,0,0] op_sel_hi:[0,0,1] neg_hi:[1,0,0]
  v_cvt_pk_f16_f32 v115, v15, v14
  v_pk_fma_f16 v114, v100, v112, v114 op_sel:[1,1,0] op_sel_hi:[1,0,1] neg_lo:[1,0,0]
  v_cvt_pk_f16_f32 v116, v29, -v28
  v_cvt_pk_f16_f32 v117, v19, v18
  ds_write_addtid_b32 v100 offset:16384
  ds_write_addtid_b32 v103 offset:16672
  ds_write_addtid_b32 v104 offset:16960
  ds_write_addtid_b32 v108 offset:17248
  ds_write_addtid_b32 v106 offset:17536
  ds_write_addtid_b32 v111 offset:17824
  ds_write_addtid_b32 v113 offset:18112
  ds_write_addtid_b32 v114 offset:18400
  s_add_u32 m0, s36, 1024
  s_nop 0
  buffer_load_dwordx4 v88, s[4:7], s17 offen nt lds
  s_mov_b32 m0, s37
  v_pk_mul_f16 v118, v116, v101 op_sel:[0,0] op_sel_hi:[0,1]
  v_pk_mul_f16 v119, v116, v102 op_sel:[0,0] op_sel_hi:[0,1]
  v_pk_mul_f16 v120, v116, v107 op_sel:[0,0] op_sel_hi:[0,1]
  v_pk_fma_f16 v118, v116, v101, v118 op_sel:[1,1,0] op_sel_hi:[1,0,1] neg_lo:[1,0,0]
  v_pk_fma_f16 v119, v116, v102, v119 op_sel:[1,1,0] op_sel_hi:[1,0,1] neg_lo:[1,0,0]
  v_pk_fma_f16 v120, v116, v107, v120 op_sel:[1,1,0] op_sel_hi:[1,0,1] neg_lo:[1,0,0]
  v_pk_mul_f16 v121, v116, v105 op_sel:[0,0] op_sel_hi:[0,1]
  v_pk_mul_f16 v122, v116, v109 op_sel:[0,0] op_sel_hi:[0,1]
  v_pk_mul_f16 v123, v116, v110 op_sel:[0,0] op_sel_hi:[0,1]
  v_pk_fma_f16 v121, v116, v105, v121 op_sel:[1,1,0] op_sel_hi:[1,0,1] neg_lo:[1,0,0]
  v_pk_fma_f16 v122, v116, v109, v122 op_sel:[1,1,0] op_sel_hi:[1,0,1] neg_lo:[1,0,0]
  v_pk_fma_f16 v123, v116, v110, v123 op_sel:[1,1,0] op_sel_hi:[1,0,1] neg_lo:[1,0,0]
  v_pk_mul_f16 v124, v116, v112 op_sel:[0,0] op_sel_hi:[0,1]
  v_cvt_pk_f16_f32 v125, v21, v20
  v_pk_mul_f32 v[30:31], v[18:19], v[14:15] op_sel:[1,0] op_sel_hi:[1,1]
  v_pk_fma_f16 v124, v116, v112, v124 op_sel:[1,1,0] op_sel_hi:[1,0,1] neg_lo:[1,0,0]
  v_cvt_pk_f16_f32 v126, v23, v22
  v_pk_fma_f32 v[30:31], v[14:15], v[18:19], v[30:31] op_sel:[1,0,0] op_sel_hi:[0,0,1] neg_hi:[1,0,0]
  ds_write_addtid_b32 v116 offset:18688
  ds_write_addtid_b32 v118 offset:18976
  ds_write_addtid_b32 v119 offset:19264
  ds_write_addtid_b32 v120 offset:19552
  ds_write_addtid_b32 v121 offset:19840
  ds_write_addtid_b32 v122 offset:20128
  ds_write_addtid_b32 v123 offset:20416
  ds_write_addtid_b32 v124 offset:20704
  ds_read_b128 v[60:63], v41 offset:0
  ds_read_b128 v[64:67], v41 offset:64
  ds_read_b128 v[68:71], v41 offset:128
  ds_read_b128 v[72:75], v41 offset:192
  ds_write_addtid_b32 v42 offset:16384
  v_cvt_pk_f16_f32 v127, v31, v30
  v_pk_mul_f16 v2, v125, v115 op_sel:[0,0] op_sel_hi:[0,1]
  v_pk_mul_f16 v3, v125, v117 op_sel:[0,0] op_sel_hi:[0,1]
  v_pk_mul_f16 v4, v125, v127 op_sel:[0,0] op_sel_hi:[0,1]
  v_pk_fma_f16 v2, v125, v115, v2 op_sel:[1,1,0] op_sel_hi:[1,0,1] neg_lo:[1,0,0]
  v_pk_fma_f16 v3, v125, v117, v3 op_sel:[1,1,0] op_sel_hi:[1,0,1] neg_lo:[1,0,0]
  v_pk_fma_f16 v4, v125, v127, v4 op_sel:[1,1,0] op_sel_hi:[1,0,1] neg_lo:[1,0,0]
  v_pk_mul_f32 v[34:35], v[22:23], v[20:21] op_sel:[1,0] op_sel_hi:[1,1]
  v_pk_mul_f16 v5, v126, v115 op_sel:[0,0] op_sel_hi:[0,1]
  ds_write_addtid_b32 v115 offset:16672
  ds_write_addtid_b32 v117 offset:16960
  ds_write_addtid_b32 v125 offset:17536
  ds_write_addtid_b32 v127 offset:17248
  ds_write_addtid_b32 v126 offset:18688
  ds_write_addtid_b32 v2 offset:17824
  ds_write_addtid_b32 v3 offset:18112
  ds_write_addtid_b32 v4 offset:18400
  v_pk_fma_f32 v[34:35], v[20:21], v[22:23], v[34:35] op_sel:[1,0,0] op_sel_hi:[0,0,1] neg_hi:[1,0,0]
  v_pk_fma_f16 v5, v126, v115, v5 op_sel:[1,1,0] op_sel_hi:[1,0,1] neg_lo:[1,0,0]
  s_add_u32 m0, s36, 33792
  s_nop 0
  buffer_load_dwordx4 v88, s[8:11], s17 offen nt lds
  s_mov_b32 m0, s37
  v_pk_mul_f16 v6, v126, v117 op_sel:[0,0] op_sel_hi:[0,1]
  v_cvt_pk_f16_f32 v7, v35, v34
  v_pk_mul_f16 v8, v126, v127 op_sel:[0,0] op_sel_hi:[0,1]
  v_pk_fma_f16 v6, v126, v117, v6 op_sel:[1,1,0] op_sel_hi:[1,0,1] neg_lo:[1,0,0]
  v_pk_mul_f16 v40, v7, v115 op_sel:[0,0] op_sel_hi:[0,1]
  v_pk_fma_f16 v8, v126, v127, v8 op_sel:[1,1,0] op_sel_hi:[1,0,1] neg_lo:[1,0,0]
  v_pk_mul_f16 v43, v7, v117 op_sel:[0,0] op_sel_hi:[0,1]
  v_pk_fma_f16 v40, v7, v115, v40 op_sel:[1,1,0] op_sel_hi:[1,0,1] neg_lo:[1,0,0]
  v_pk_mul_f16 v103, v7, v127 op_sel:[0,0] op_sel_hi:[0,1]
  v_pk_fma_f16 v43, v7, v117, v43 op_sel:[1,1,0] op_sel_hi:[1,0,1] neg_lo:[1,0,0]
  v_pk_mul_f32 v[36:37], v[26:27], v[26:27] op_sel:[1,0] op_sel_hi:[1,1]
  v_pk_fma_f16 v103, v7, v127, v103 op_sel:[1,1,0] op_sel_hi:[1,0,1] neg_lo:[1,0,0]
  v_cvt_pk_f16_f32 v104, v27, -v26
  v_pk_fma_f32 v[36:37], v[26:27], v[26:27], v[36:37] op_sel:[1,0,0] op_sel_hi:[0,0,1] neg_hi:[1,0,0]
  ds_write_addtid_b32 v7 offset:19840
  ds_write_addtid_b32 v5 offset:18976
  ds_write_addtid_b32 v6 offset:19264
  ds_write_addtid_b32 v8 offset:19552
  ds_write_addtid_b32 v40 offset:20128
  ds_write_addtid_b32 v43 offset:20416
  ds_write_addtid_b32 v103 offset:20704
  ds_read_b128 v[44:47], v41 offset:0
  ds_read_b128 v[48:51], v41 offset:64
  ds_read_b128 v[52:55], v41 offset:128
  ds_read_b128 v[56:59], v41 offset:192
  v_cvt_pk_f16_f32 v108, v37, -v36
  v_pk_mul_f32 v[38:39], v[36:37], v[26:27] op_sel:[1,0] op_sel_hi:[1,1]
  v_pk_mul_f32 v[12:13], v[36:37], v[36:37] op_sel:[1,0] op_sel_hi:[1,1]
  v_pk_mul_f16 v106, v100, v108 op_sel:[0,0] op_sel_hi:[0,1]
  v_pk_fma_f32 v[38:39], v[26:27], v[36:37], v[38:39] op_sel:[1,0,0] op_sel_hi:[0,0,1] neg_hi:[1,0,0]
  v_pk_fma_f32 v[12:13], v[36:37], v[36:37], v[12:13] op_sel:[1,0,0] op_sel_hi:[0,0,1] neg_hi:[1,0,0]
  v_pk_fma_f16 v106, v100, v108, v106 op_sel:[1,1,0] op_sel_hi:[1,0,1] neg_lo:[1,0,0]
  v_cvt_pk_f16_f32 v111, v39, -v38
  v_pk_mul_f32 v[24:25], v[32:33], v[12:13] op_sel:[1,0] op_sel_hi:[1,1]
  v_pk_mul_f16 v113, v106, v102 op_sel:[0,0] op_sel_hi:[0,1]
  v_pk_mul_f16 v114, v106, v105 op_sel:[0,0] op_sel_hi:[0,1]
  v_pk_mul_f16 v101, v106, v110 op_sel:[0,0] op_sel_hi:[0,1]
  v_pk_fma_f16 v113, v106, v102, v113 op_sel:[1,1,0] op_sel_hi:[1,0,1] neg_lo:[1,0,0]
  v_pk_fma_f16 v114, v106, v105, v114 op_sel:[1,1,0] op_sel_hi:[1,0,1] neg_lo:[1,0,0]
  v_pk_fma_f16 v101, v106, v110, v101 op_sel:[1,1,0] op_sel_hi:[1,0,1] neg_lo:[1,0,0]
  v_pk_mul_f16 v107, v100, v111 op_sel:[0,0] op_sel_hi:[0,1]
  v_pk_fma_f32 v[24:25], v[12:13], v[32:33], v[24:25] op_sel:[1,0,0] op_sel_hi:[0,0,1] neg_hi:[1,0,0]
  v_pk_fma_f16 v107, v100, v111, v107 op_sel:[1,1,0] op_sel_hi:[1,0,1] neg_lo:[1,0,0]
  v_cvt_pk_f16_f32 v109, v25, -v24
  v_pk_mul_f32 v[10:11], v[24:25], v[12:13] op_sel:[1,0] op_sel_hi:[1,1]
  v_pk_mul_f16 v112, v107, v102 op_sel:[0,0] op_sel_hi:[0,1]
  v_pk_mul_f16 v116, v107, v105 op_sel:[0,0] op_sel_hi:[0,1]
  v_pk_mul_f16 v118, v107, v110 op_sel:[0,0] op_sel_hi:[0,1]
  s_waitcnt lgkmcnt(0)
  s_add_u32 m0, s36, 2048
  s_nop 0
  buffer_load_dwordx4 v98, s[4:7], s18 offen nt lds
  s_mov_b32 m0, s37
  v_mfma_f32_16x16x32_f16 v[76:79], v[60:63], v[44:47], 0
  v_mfma_f32_16x16x32_f16 v[76:79], v[64:67], v[48:51], v[76:79]
  v_mfma_f32_16x16x32_f16 v[76:79], v[68:71], v[52:55], v[76:79]
  v_mfma_f32_16x16x32_f16 v[76:79], v[72:75], v[56:59], v[76:79]
  v_pk_fma_f16 v112, v107, v102, v112 op_sel:[1,1,0] op_sel_hi:[1,0,1] neg_lo:[1,0,0]
  v_pk_fma_f16 v116, v107, v105, v116 op_sel:[1,1,0] op_sel_hi:[1,0,1] neg_lo:[1,0,0]
  v_pk_fma_f16 v118, v107, v110, v118 op_sel:[1,1,0] op_sel_hi:[1,0,1] neg_lo:[1,0,0]
  v_pk_mul_f16 v119, v109, v105 op_sel:[0,0] op_sel_hi:[0,1]
  ds_write_addtid_b32 v106 offset:16384
  ds_write_addtid_b32 v113 offset:16672
  ds_write_addtid_b32 v114 offset:16960
  ds_write_addtid_b32 v101 offset:17248
  ds_write_addtid_b32 v107 offset:17536
  ds_write_addtid_b32 v112 offset:17824
  ds_write_addtid_b32 v116 offset:18112
  ds_write_addtid_b32 v109 offset:18688
  v_pk_fma_f16 v119, v109, v105, v119 op_sel:[1,1,0] op_sel_hi:[1,0,1] neg_lo:[1,0,0]
  v_pk_mul_f16 v120, v109, v104 op_sel:[0,0] op_sel_hi:[0,1]
  v_pk_mul_f16 v121, v109, v108 op_sel:[0,0] op_sel_hi:[0,1]
  v_pk_mul_f16 v122, v109, v111 op_sel:[0,0] op_sel_hi:[0,1]
  v_pk_fma_f16 v120, v109, v104, v120 op_sel:[1,1,0] op_sel_hi:[1,0,1] neg_lo:[1,0,0]
  v_pk_fma_f16 v121, v109, v108, v121 op_sel:[1,1,0] op_sel_hi:[1,0,1] neg_lo:[1,0,0]
  v_pk_fma_f16 v122, v109, v111, v122 op_sel:[1,1,0] op_sel_hi:[1,0,1] neg_lo:[1,0,0]
  v_pk_mul_f16 v123, v120, v105 op_sel:[0,0] op_sel_hi:[0,1]
  v_pk_mul_f16 v124, v121, v105 op_sel:[0,0] op_sel_hi:[0,1]
  v_pk_mul_f16 v125, v122, v105 op_sel:[0,0] op_sel_hi:[0,1]
  v_pk_fma_f16 v123, v120, v105, v123 op_sel:[1,1,0] op_sel_hi:[1,0,1] neg_lo:[1,0,0]
  v_pk_fma_f16 v124, v121, v105, v124 op_sel:[1,1,0] op_sel_hi:[1,0,1] neg_lo:[1,0,0]
  v_pk_fma_f16 v125, v122, v105, v125 op_sel:[1,1,0] op_sel_hi:[1,0,1] neg_lo:[1,0,0]
  v_pk_fma_f32 v[10:11], v[12:13], v[24:25], v[10:11] op_sel:[1,0,0] op_sel_hi:[0,0,1] neg_hi:[1,0,0]
  ds_write_addtid_b32 v118 offset:18400
  ds_write_addtid_b32 v119 offset:18976
  ds_write_addtid_b32 v120 offset:19264
  ds_write_addtid_b32 v123 offset:19552
  ds_write_addtid_b32 v121 offset:19840
  ds_write_addtid_b32 v124 offset:20128
  ds_write_addtid_b32 v122 offset:20416
  ds_write_addtid_b32 v125 offset:20704
  ds_read_b128 v[60:63], v41 offset:0
  ds_read_b128 v[64:67], v41 offset:64
  ds_read_b128 v[68:71], v41 offset:128
  ds_read_b128 v[72:75], v41 offset:192
  v_cvt_pk_f16_f32 v2, v11, -v10
  v_pk_mul_f32 v[16:17], v[10:11], v[12:13] op_sel:[1,0] op_sel_hi:[1,1]
  v_pk_mul_f16 v3, v2, v104 op_sel:[0,0] op_sel_hi:[0,1]
  v_pk_mul_f16 v4, v2, v108 op_sel:[0,0] op_sel_hi:[0,1]
  v_pk_mul_f16 v126, v2, v111 op_sel:[0,0] op_sel_hi:[0,1]
  v_pk_fma_f16 v3, v2, v104, v3 op_sel:[1,1,0] op_sel_hi:[1,0,1] neg_lo:[1,0,0]
  v_pk_fma_f16 v4, v2, v108, v4 op_sel:[1,1,0] op_sel_hi:[1,0,1] neg_lo:[1,0,0]
  v_pk_fma_f16 v126, v2, v111, v126 op_sel:[1,1,0] op_sel_hi:[1,0,1] neg_lo:[1,0,0]
  v_pk_fma_f32 v[16:17], v[12:13], v[10:11], v[16:17] op_sel:[1,0,0] op_sel_hi:[0,0,1] neg_hi:[1,0,0]
  v_cvt_pk_f16_f32 v115, v17, -v16
  v_pk_mul_f32 v[28:29], v[16:17], v[12:13] op_sel:[1,0] op_sel_hi:[1,1]
  v_pk_mul_f16 v117, v115, v104 op_sel:[0,0] op_sel_hi:[0,1]
  v_pk_mul_f16 v127, v115, v108 op_sel:[0,0] op_sel_hi:[0,1]
  v_pk_mul_f16 v7, v115, v111 op_sel:[0,0] op_sel_hi:[0,1]
  v_pk_fma_f16 v117, v115, v104, v117 op_sel:[1,1,0] op_sel_hi:[1,0,1] neg_lo:[1,0,0]
  v_pk_fma_f16 v127, v115, v108, v127 op_sel:[1,1,0] op_sel_hi:[1,0,1] neg_lo:[1,0,0]
  v_pk_fma_f16 v7, v115, v111, v7 op_sel:[1,1,0] op_sel_hi:[1,0,1] neg_lo:[1,0,0]
  v_pk_fma_f32 v[28:29], v[12:13], v[16:17], v[28:29] op_sel:[1,0,0] op_sel_hi:[0,0,1] neg_hi:[1,0,0]
  ds_write_addtid_b32 v2 offset:16384
  ds_write_addtid_b32 v3 offset:16672
  ds_write_addtid_b32 v4 offset:16960
  ds_write_addtid_b32 v126 offset:17248
  ds_write_addtid_b32 v115 offset:17536
  ds_write_addtid_b32 v117 offset:17824
  ds_write_addtid_b32 v127 offset:18112
  ds_write_addtid_b32 v7 offset:18400
  s_waitcnt lgkmcnt(8)
  v_mfma_f32_16x16x32_f16 v[80:83], v[60:63], v[44:47], 0
  v_mfma_f32_16x16x32_f16 v[80:83], v[64:67], v[48:51], v[80:83]
  v_mfma_f32_16x16x32_f16 v[80:83], v[68:71], v[52:55], v[80:83]
  v_mfma_f32_16x16x32_f16 v[80:83], v[72:75], v[56:59], v[80:83]
  v_cvt_pk_f16_f32 v5, v29, -v28
  ds_write_addtid_b32 v5 offset:18688
  ds_read_b128 v[60:63], v41 offset:0
  ds_read_b128 v[64:67], v41 offset:64
  ds_read_b128 v[68:71], v41 offset:128
  ds_read_b128 v[72:75], v41 offset:192
  s_waitcnt lgkmcnt(0)
  v_mfma_f32_16x16x32_f16 v[84:87], v[60:63], v[44:47], 0
  v_mfma_f32_16x16x32_f16 v[84:87], v[64:67], v[48:51], v[84:87]
  v_mfma_f32_16x16x32_f16 v[84:87], v[68:71], v[52:55], v[84:87]
  v_mfma_f32_16x16x32_f16 v[84:87], v[72:75], v[56:59], v[84:87]
  s_cmp_eq_u32 s53, 0
  s_cbranch_scc0 K_FAR
  v_lshlrev_b32 v8, 8, v97
  v_lshl_add_u32 v8, v96, 4, v8
  v_sub_u32 v8, 562, v8
  v_add_u32 v8, s68, v8
  v_lshrrev_b32 v9, 1, v97
  v_lshlrev_b32 v9, 8, v9
  v_lshl_add_u32 v9, v96, 4, v9
  v_and_b32 v10, 1, v97
  v_lshl_add_u32 v9, v10, 3, v9
  v_sub_u32 v9, 1080, v9
  v_add_u32 v9, s68, v9
  ds_write_b128 v99, v[80:83] offset:5120
  ds_write_b128 v99, v[84:87] offset:6144
  v_add_u32 v21, 2, v8
  v_add_u32 v22, 1986, v8
  v_mov_b32 v94, 1
  s_waitcnt lgkmcnt(0)
  ds_write_b32 v92, v94 offset:64
  s_branch K_PS1B
K_PS1:
  s_sleep 2
K_PS1B:
  ds_read_b32 v94, v93 offset:64
  s_waitcnt lgkmcnt(0)
  v_cmp_gt_u32 vcc, 1, v94
  s_cbranch_vccnz K_PS1
  ds_read_b128 v[16:19], v99 offset:1024
  ds_read_b128 v[24:27], v99
  s_waitcnt lgkmcnt(1)
  v_pk_add_f32 v[80:81], v[80:81], v[16:17]
  v_pk_add_f32 v[82:83], v[82:83], v[18:19]
  s_waitcnt lgkmcnt(0)
  v_pk_add_f32 v[76:77], v[76:77], v[24:25]
  v_pk_add_f32 v[78:79], v[78:79], v[26:27]
  v_mov_b32_dpp v13, v80 row_shl:1 row_mask:0xf bank_mask:0xf
  v_writelane_b32 v13, 0, 33
  s_mov_b32 exec_hi, 3
  v_cndmask_b32 v14, v80, v81, s[72:73]
  v_cndmask_b32 v15, v81, v82, s[72:73]
  v_cndmask_b32 v13, v13, v83, s[72:73]
  v_cvt_pk_f16_f32 v16, v13, v15
  v_cvt_pk_f16_f32 v17, v15, v15
  v_cvt_pk_f16_f32 v18, v14, v80
  v_cvt_pk_f16_f32 v19, v80, v80
  v_cvt_pk_f16_f32 v20, v15, v14
  ds_write_b16 v8, v16
  ds_write2_b32 v21, v17, v20 offset0:0 offset1:1
  ds_write_b32 v21, v19 offset:8
  ds_write_b16 v8, v19 offset:14
  ds_write2_b32 v22, v16, v17 offset0:0 offset1:1
  ds_write2_b32 v22, v18, v19 offset0:2 offset1:3
  s_mov_b32 exec_hi, -1
  v_cvt_pk_f16_f32 v24, v79, v78
  v_cvt_pk_f16_f32 v25, v77, v76
  v_cvt_pk_f16_f32 v26, v78, v77
  ds_write_b64 v9, v[24:25]
  ds_write_b16 v9, v24 offset:1986
  ds_write_b32 v9, v26 offset:1988
  ds_write_b16_d16_hi v9, v25 offset:1992
  v_lshlrev_b32 v12, 5, v96
  v_lshl_add_u32 v9, v97, 3, v12
  v_lshl_add_u32 v12, v97, 4, v12
  v_add_u32 v12, s66, v12
  v_add_u32 v9, s68, v9
  v_add_u32 v13, 72704, v95
  v_and_b32 v11, 1, v96
  v_xor_b32 v11, 1, v11
  v_mul_u32_u24 v11, 1986, v11
  v_lshlrev_b32 v10, 1, v96
  v_sub_u32 v11, v11, v10
  s_add_u32 s78, s68, 30
  v_add_u32 v11, s78, v11
  v_lshl_add_u32 v10, v97, 4, v11
  v_lshl_add_u32 v14, v97, 3, v11
  v_add_u32 v14, 1120, v14
  v_add_u32 v11, 512, v10
  s_lshl_b32 s79, s52, 2
  v_mov_b32 v15, s79
  v_mov_b32 v8, s70
  ds_read2_b32 v[96:97], v11 offset0:128 offset1:129
  ds_read2_b32 v[98:99], v11 offset0:130 offset1:131
  ds_read2_b32 v[100:101], v10 offset0:128 offset1:129
  ds_read2_b32 v[102:103], v10 offset0:130 offset1:131
  ds_read2_b32 v[92:93], v10 offset0:0 offset1:1
  ds_read2_b32 v[94:95], v10 offset0:2 offset1:3
  ds_read2_b32 v[104:105], v11 offset0:112 offset1:113
  ds_read2_b32 v[106:107], v11 offset0:114 offset1:115
  ds_read2_b32 v[108:109], v10 offset0:112 offset1:113
  ds_read2_b32 v[110:111], v10 offset0:114 offset1:115
  s_branch K_FWB
K_FW:
  s_sleep 1
K_FWB:
  ds_read_b32 v6, v15 offset:32
  s_waitcnt lgkmcnt(0)
  v_cmp_eq_u32 vcc, 0, v6
  s_cbranch_vccnz K_FW
  v_readfirstlane_b32 s71, v6
  ds_read2_b32 v[48:49], v14 offset0:16 offset1:17
  ds_read2_b32 v[50:51], v14 offset0:112 offset1:113
  ds_read2_b32 v[52:53], v14 offset0:8 offset1:9
  ds_read2_b32 v[54:55], v14 offset0:104 offset1:105
  ds_read2_b32 v[56:57], v14 offset0:0 offset1:1
  ds_read2_b32 v[58:59], v14 offset0:96 offset1:97
  ds_read2_b32 v[60:61], v14 offset0:48 offset1:49
  ds_read2_b32 v[62:63], v14 offset0:80 offset1:81
  ds_read2_b32 v[64:65], v14 offset0:40 offset1:41
  ds_read2_b32 v[66:67], v14 offset0:72 offset1:73
  ds_read2_b32 v[68:69], v14 offset0:32 offset1:33
  s_waitcnt lgkmcnt(4)
  ds_read2_b32 v[70:71], v14 offset0:64 offset1:65
  ds_read2_b32 v[72:73], v14 offset0:152 offset1:153
  ds_read2_b32 v[74:75], v14 offset0:192 offset1:193
  ds_read2_b32 v[76:77], v14 offset0:144 offset1:145
  ds_read2_b32 v[78:79], v14 offset0:184 offset1:185
  ds_read2_b32 v[80:81], v14 offset0:136 offset1:137
  ds_read2_b32 v[82:83], v14 offset0:176 offset1:177
  ds_read2_b32 v[84:85], v14 offset0:128 offset1:129
  ds_read2_b32 v[86:87], v14 offset0:168 offset1:169
  ds_read_b128 v[88:91], v13 offset:0
  s_setprio 1
  v_mov_b32 v6, 0
  v_mov_b32 v7, 1
  s_waitcnt vmcnt(0)
  s_mov_b64 exec, 1
  ds_add_u32 v6, v7 offset:112
  s_mov_b64 exec, -1
  s_branch K_W1NB
K_W1N:
  s_sleep 1
K_W1NB:
  ds_read_b32 v7, v6 offset:16
  s_waitcnt lgkmcnt(0)
  v_cmp_gt_u32 vcc, 8, v7
  s_cbranch_vccnz K_W1N
  ds_read_b128 v[112:115], v12 offset:512
  ds_read_b128 v[116:119], v12 offset:1024
  ds_read_b128 v[120:123], v12 offset:1536
  ds_read_b128 v[124:127], v12 offset:2048
  ds_read_b128 v[2:5], v12 offset:2560
  s_waitcnt lgkmcnt(4)
  v_mfma_f32_16x16x32_f16 v[16:19], v[96:99], v[112:115], 0
  v_mfma_f32_16x16x32_f16 v[20:23], v[100:103], v[112:115], 0
  v_mfma_f32_16x16x32_f16 v[24:27], v[92:95], v[112:115], 0
  ds_read_b128 v[112:115], v12 offset:3072
  s_waitcnt lgkmcnt(4)
  v_mfma_f32_16x16x32_f16 v[20:23], v[96:99], v[116:119], v[20:23]
  v_mfma_f32_16x16x32_f16 v[24:27], v[100:103], v[116:119], v[24:27]
  v_mfma_f32_16x16x32_f16 v[28:31], v[92:95], v[116:119], 0
  ds_read_b128 v[116:119], v12 offset:3584
  s_waitcnt lgkmcnt(4)
  v_mfma_f32_16x16x32_f16 v[24:27], v[96:99], v[120:123], v[24:27]
  v_mfma_f32_16x16x32_f16 v[28:31], v[100:103], v[120:123], v[28:31]
  v_mfma_f32_16x16x32_f16 v[32:35], v[92:95], v[120:123], 0
  ds_read_b128 v[120:123], v12 offset:4096
  s_waitcnt lgkmcnt(4)
  v_mfma_f32_16x16x32_f16 v[28:31], v[96:99], v[124:127], v[28:31]
  v_mfma_f32_16x16x32_f16 v[32:35], v[100:103], v[124:127], v[32:35]
  v_mfma_f32_16x16x32_f16 v[36:39], v[92:95], v[124:127], 0
  ds_read_b128 v[124:127], v12 offset:448
  s_waitcnt lgkmcnt(4)
  v_mfma_f32_16x16x32_f16 v[32:35], v[96:99], v[2:5], v[32:35]
  v_mfma_f32_16x16x32_f16 v[36:39], v[100:103], v[2:5], v[36:39]
  v_mfma_f32_16x16x32_f16 v[40:43], v[92:95], v[2:5], 0
  s_waitcnt lgkmcnt(3)
  v_mfma_f32_16x16x32_f16 v[36:39], v[96:99], v[112:115], v[36:39]
  v_mfma_f32_16x16x32_f16 v[40:43], v[100:103], v[112:115], v[40:43]
  v_mfma_f32_16x16x32_f16 v[44:47], v[92:95], v[112:115], 0
  s_waitcnt lgkmcnt(2)
  v_mfma_f32_16x16x32_f16 v[40:43], v[96:99], v[116:119], v[40:43]
  v_mfma_f32_16x16x32_f16 v[44:47], v[100:103], v[116:119], v[44:47]
  s_waitcnt lgkmcnt(1)
  v_mfma_f32_16x16x32_f16 v[44:47], v[96:99], v[120:123], v[44:47]
  ds_read_b128 v[92:95], v13 offset:1024
  ds_read_b128 v[2:5], v12 offset:960
  ds_read_b128 v[112:115], v12 offset:1472
  ds_read_b128 v[116:119], v12 offset:1984
  ds_read_b128 v[120:123], v12 offset:2496
  ds_read2_b32 v[96:97], v11 offset0:96 offset1:97
  ds_read2_b32 v[98:99], v11 offset0:98 offset1:99
  s_waitcnt lgkmcnt(7)
  v_mfma_f32_16x16x32_f16 v[16:19], v[104:107], v[124:127], v[16:19]
  v_mfma_f32_16x16x32_f16 v[20:23], v[108:111], v[124:127], v[20:23]
  ds_read_b128 v[124:127], v12 offset:3008
  ds_read2_b32 v[100:101], v10 offset0:96 offset1:97
  ds_read2_b32 v[102:103], v10 offset0:98 offset1:99
  s_waitcnt lgkmcnt(8)
  v_mfma_f32_16x16x32_f16 v[20:23], v[104:107], v[2:5], v[20:23]
  v_mfma_f32_16x16x32_f16 v[24:27], v[108:111], v[2:5], v[24:27]
  ds_read_b128 v[2:5], v12 offset:3520
  s_waitcnt lgkmcnt(8)
  v_mfma_f32_16x16x32_f16 v[24:27], v[104:107], v[112:115], v[24:27]
  v_mfma_f32_16x16x32_f16 v[28:31], v[108:111], v[112:115], v[28:31]
  ds_read_b128 v[112:115], v12 offset:4032
  s_waitcnt lgkmcnt(8)
  v_mfma_f32_16x16x32_f16 v[28:31], v[104:107], v[116:119], v[28:31]
  v_mfma_f32_16x16x32_f16 v[32:35], v[108:111], v[116:119], v[32:35]
  ds_read_b128 v[116:119], v12 offset:384
  s_waitcnt lgkmcnt(8)
  v_mfma_f32_16x16x32_f16 v[32:35], v[104:107], v[120:123], v[32:35]
  v_mfma_f32_16x16x32_f16 v[36:39], v[108:111], v[120:123], v[36:39]
  ds_read_b128 v[120:123], v12 offset:896
  s_waitcnt lgkmcnt(6)
  v_mfma_f32_16x16x32_f16 v[36:39], v[104:107], v[124:127], v[36:39]
  v_mfma_f32_16x16x32_f16 v[40:43], v[108:111], v[124:127], v[40:43]
  ds_read_b128 v[124:127], v12 offset:1408
  s_waitcnt lgkmcnt(4)
  v_mfma_f32_16x16x32_f16 v[40:43], v[104:107], v[2:5], v[40:43]
  v_mfma_f32_16x16x32_f16 v[44:47], v[108:111], v[2:5], v[44:47]
  ds_read_b128 v[2:5], v12 offset:1920
  s_waitcnt lgkmcnt(4)
  v_mfma_f32_16x16x32_f16 v[44:47], v[104:107], v[112:115], v[44:47]
  ds_read_b128 v[112:115], v12 offset:2432
  ds_read2_b32 v[104:105], v11 offset0:80 offset1:81
  ds_read2_b32 v[106:107], v11 offset0:82 offset1:83
  s_waitcnt lgkmcnt(6)
  v_mfma_f32_16x16x32_f16 v[16:19], v[96:99], v[116:119], v[16:19]
  v_mfma_f32_16x16x32_f16 v[20:23], v[100:103], v[116:119], v[20:23]
  ds_read_b128 v[116:119], v12 offset:2944
  ds_read2_b32 v[108:109], v10 offset0:80 offset1:81
  ds_read2_b32 v[110:111], v10 offset0:82 offset1:83
  s_waitcnt lgkmcnt(8)
  v_mfma_f32_16x16x32_f16 v[20:23], v[96:99], v[120:123], v[20:23]
  v_mfma_f32_16x16x32_f16 v[24:27], v[100:103], v[120:123], v[24:27]
  ds_read_b128 v[120:123], v12 offset:3456
  s_waitcnt lgkmcnt(8)
  v_mfma_f32_16x16x32_f16 v[24:27], v[96:99], v[124:127], v[24:27]
  v_mfma_f32_16x16x32_f16 v[28:31], v[100:103], v[124:127], v[28:31]
  ds_read_b128 v[124:127], v12 offset:3968
  s_waitcnt lgkmcnt(8)
  v_mfma_f32_16x16x32_f16 v[28:31], v[96:99], v[2:5], v[28:31]
  v_mfma_f32_16x16x32_f16 v[32:35], v[100:103], v[2:5], v[32:35]
  ds_read_b128 v[2:5], v12 offset:320
  s_waitcnt lgkmcnt(8)
  v_mfma_f32_16x16x32_f16 v[32:35], v[96:99], v[112:115], v[32:35]
  v_mfma_f32_16x16x32_f16 v[36:39], v[100:103], v[112:115], v[36:39]
  ds_read_b128 v[112:115], v12 offset:832
  s_waitcnt lgkmcnt(6)
  v_mfma_f32_16x16x32_f16 v[36:39], v[96:99], v[116:119], v[36:39]
  v_mfma_f32_16x16x32_f16 v[40:43], v[100:103], v[116:119], v[40:43]
  ds_read_b128 v[116:119], v12 offset:1344
  s_waitcnt lgkmcnt(4)
  v_mfma_f32_16x16x32_f16 v[40:43], v[96:99], v[120:123], v[40:43]
  v_mfma_f32_16x16x32_f16 v[44:47], v[100:103], v[120:123], v[44:47]
  ds_read_b128 v[120:123], v12 offset:1856
  s_waitcnt lgkmcnt(4)
  v_mfma_f32_16x16x32_f16 v[44:47], v[96:99], v[124:127], v[44:47]
  ds_read_b128 v[124:127], v12 offset:2368
  ds_read2_b32 v[96:97], v11 offset0:64 offset1:65
  ds_read2_b32 v[98:99], v11 offset0:66 offset1:67
  s_waitcnt lgkmcnt(6)
  v_mfma_f32_16x16x32_f16 v[16:19], v[104:107], v[2:5], v[16:19]
  v_mfma_f32_16x16x32_f16 v[20:23], v[108:111], v[2:5], v[20:23]
  ds_read_b128 v[2:5], v12 offset:2880
  ds_read2_b32 v[100:101], v10 offset0:64 offset1:65
  ds_read2_b32 v[102:103], v10 offset0:66 offset1:67
  s_waitcnt lgkmcnt(8)
  v_mfma_f32_16x16x32_f16 v[20:23], v[104:107], v[112:115], v[20:23]
  v_mfma_f32_16x16x32_f16 v[24:27], v[108:111], v[112:115], v[24:27]
  ds_read_b128 v[112:115], v12 offset:3392
  s_waitcnt lgkmcnt(8)
  v_mfma_f32_16x16x32_f16 v[24:27], v[104:107], v[116:119], v[24:27]
  v_mfma_f32_16x16x32_f16 v[28:31], v[108:111], v[116:119], v[28:31]
  ds_read_b128 v[116:119], v12 offset:3904
  s_waitcnt lgkmcnt(8)
  v_mfma_f32_16x16x32_f16 v[28:31], v[104:107], v[120:123], v[28:31]
  v_mfma_f32_16x16x32_f16 v[32:35], v[108:111], v[120:123], v[32:35]
  ds_read_b128 v[120:123], v12 offset:256
  s_waitcnt lgkmcnt(8)
  v_mfma_f32_16x16x32_f16 v[32:35], v[104:107], v[124:127], v[32:35]
  v_mfma_f32_16x16x32_f16 v[36:39], v[108:111], v[124:127], v[36:39]
  ds_read_b128 v[124:127], v12 offset:768
  s_waitcnt lgkmcnt(6)
  v_mfma_f32_16x16x32_f16 v[36:39], v[104:107], v[2:5], v[36:39]
  v_mfma_f32_16x16x32_f16 v[40:43], v[108:111], v[2:5], v[40:43]
  ds_read_b128 v[2:5], v12 offset:1280
  s_waitcnt lgkmcnt(4)
  v_mfma_f32_16x16x32_f16 v[40:43], v[104:107], v[112:115], v[40:43]
  v_mfma_f32_16x16x32_f16 v[44:47], v[108:111], v[112:115], v[44:47]
  ds_read_b128 v[112:115], v12 offset:1792
  s_waitcnt lgkmcnt(4)
  v_mfma_f32_16x16x32_f16 v[44:47], v[104:107], v[116:119], v[44:47]
  ds_read_b128 v[116:119], v12 offset:2304
  ds_read2_b32 v[104:105], v11 offset0:48 offset1:49
  ds_read2_b32 v[106:107], v11 offset0:50 offset1:51
  s_waitcnt lgkmcnt(6)
  v_mfma_f32_16x16x32_f16 v[16:19], v[96:99], v[120:123], v[16:19]
  v_mfma_f32_16x16x32_f16 v[20:23], v[100:103], v[120:123], v[20:23]
  ds_read_b128 v[120:123], v12 offset:2816
  ds_read2_b32 v[108:109], v10 offset0:48 offset1:49
  ds_read2_b32 v[110:111], v10 offset0:50 offset1:51
  s_waitcnt lgkmcnt(8)
  v_mfma_f32_16x16x32_f16 v[20:23], v[96:99], v[124:127], v[20:23]
  v_mfma_f32_16x16x32_f16 v[24:27], v[100:103], v[124:127], v[24:27]
  ds_read_b128 v[124:127], v12 offset:3328
  s_waitcnt lgkmcnt(8)
  v_mfma_f32_16x16x32_f16 v[24:27], v[96:99], v[2:5], v[24:27]
  v_mfma_f32_16x16x32_f16 v[28:31], v[100:103], v[2:5], v[28:31]
  ds_read_b128 v[2:5], v12 offset:3840
  s_waitcnt lgkmcnt(8)
  v_mfma_f32_16x16x32_f16 v[28:31], v[96:99], v[112:115], v[28:31]
  v_mfma_f32_16x16x32_f16 v[32:35], v[100:103], v[112:115], v[32:35]
  ds_read_b128 v[112:115], v12 offset:192
  s_waitcnt lgkmcnt(8)
  v_mfma_f32_16x16x32_f16 v[32:35], v[96:99], v[116:119], v[32:35]
  v_mfma_f32_16x16x32_f16 v[36:39], v[100:103], v[116:119], v[36:39]
  ds_read_b128 v[116:119], v12 offset:704
  s_waitcnt lgkmcnt(6)
  v_mfma_f32_16x16x32_f16 v[36:39], v[96:99], v[120:123], v[36:39]
  v_mfma_f32_16x16x32_f16 v[40:43], v[100:103], v[120:123], v[40:43]
  ds_read_b128 v[120:123], v12 offset:1216
  s_waitcnt lgkmcnt(4)
  v_mfma_f32_16x16x32_f16 v[40:43], v[96:99], v[124:127], v[40:43]
  v_mfma_f32_16x16x32_f16 v[44:47], v[100:103], v[124:127], v[44:47]
  ds_read_b128 v[124:127], v12 offset:1728
  s_waitcnt lgkmcnt(4)
  v_mfma_f32_16x16x32_f16 v[44:47], v[96:99], v[2:5], v[44:47]
  ds_read_b128 v[2:5], v12 offset:2240
  ds_read2_b32 v[96:97], v11 offset0:32 offset1:33
  ds_read2_b32 v[98:99], v11 offset0:34 offset1:35
  s_waitcnt lgkmcnt(6)
  v_mfma_f32_16x16x32_f16 v[16:19], v[104:107], v[112:115], v[16:19]
  v_mfma_f32_16x16x32_f16 v[20:23], v[108:111], v[112:115], v[20:23]
  ds_read_b128 v[112:115], v12 offset:2752
  ds_read2_b32 v[100:101], v10 offset0:32 offset1:33
  ds_read2_b32 v[102:103], v10 offset0:34 offset1:35
  s_waitcnt lgkmcnt(8)
  v_mfma_f32_16x16x32_f16 v[20:23], v[104:107], v[116:119], v[20:23]
  v_mfma_f32_16x16x32_f16 v[24:27], v[108:111], v[116:119], v[24:27]
  ds_read_b128 v[116:119], v12 offset:3264
  s_waitcnt lgkmcnt(8)
  v_mfma_f32_16x16x32_f16 v[24:27], v[104:107], v[120:123], v[24:27]
  v_mfma_f32_16x16x32_f16 v[28:31], v[108:111], v[120:123], v[28:31]
  ds_read_b128 v[120:123], v12 offset:3776
  s_waitcnt lgkmcnt(8)
  v_mfma_f32_16x16x32_f16 v[28:31], v[104:107], v[124:127], v[28:31]
  v_mfma_f32_16x16x32_f16 v[32:35], v[108:111], v[124:127], v[32:35]
  ds_read_b128 v[124:127], v12 offset:128
  s_waitcnt lgkmcnt(8)
  v_mfma_f32_16x16x32_f16 v[32:35], v[104:107], v[2:5], v[32:35]
  v_mfma_f32_16x16x32_f16 v[36:39], v[108:111], v[2:5], v[36:39]
  ds_read_b128 v[2:5], v12 offset:640
  s_waitcnt lgkmcnt(6)
  v_mfma_f32_16x16x32_f16 v[36:39], v[104:107], v[112:115], v[36:39]
  v_mfma_f32_16x16x32_f16 v[40:43], v[108:111], v[112:115], v[40:43]
  ds_read_b128 v[112:115], v12 offset:1152
  s_waitcnt lgkmcnt(4)
  v_mfma_f32_16x16x32_f16 v[40:43], v[104:107], v[116:119], v[40:43]
  v_mfma_f32_16x16x32_f16 v[44:47], v[108:111], v[116:119], v[44:47]
  ds_read_b128 v[116:119], v12 offset:1664
  s_waitcnt lgkmcnt(4)
  v_mfma_f32_16x16x32_f16 v[44:47], v[104:107], v[120:123], v[44:47]
  ds_read_b128 v[120:123], v12 offset:2176
  ds_read2_b32 v[104:105], v11 offset0:16 offset1:17
  ds_read2_b32 v[106:107], v11 offset0:18 offset1:19
  s_waitcnt lgkmcnt(6)
  v_mfma_f32_16x16x32_f16 v[16:19], v[96:99], v[124:127], v[16:19]
  v_mfma_f32_16x16x32_f16 v[20:23], v[100:103], v[124:127], v[20:23]
  ds_read_b128 v[124:127], v12 offset:2688
  ds_read2_b32 v[108:109], v10 offset0:16 offset1:17
  ds_read2_b32 v[110:111], v10 offset0:18 offset1:19
  s_waitcnt lgkmcnt(8)
  v_mfma_f32_16x16x32_f16 v[20:23], v[96:99], v[2:5], v[20:23]
  v_mfma_f32_16x16x32_f16 v[24:27], v[100:103], v[2:5], v[24:27]
  ds_read_b128 v[2:5], v12 offset:3200
  s_waitcnt lgkmcnt(8)
  v_mfma_f32_16x16x32_f16 v[24:27], v[96:99], v[112:115], v[24:27]
  v_mfma_f32_16x16x32_f16 v[28:31], v[100:103], v[112:115], v[28:31]
  ds_read_b128 v[112:115], v12 offset:3712
  s_waitcnt lgkmcnt(8)
  v_mfma_f32_16x16x32_f16 v[28:31], v[96:99], v[116:119], v[28:31]
  v_mfma_f32_16x16x32_f16 v[32:35], v[100:103], v[116:119], v[32:35]
  ds_read_b128 v[116:119], v12 offset:64
  s_waitcnt lgkmcnt(8)
  v_mfma_f32_16x16x32_f16 v[32:35], v[96:99], v[120:123], v[32:35]
  v_mfma_f32_16x16x32_f16 v[36:39], v[100:103], v[120:123], v[36:39]
  ds_read_b128 v[120:123], v12 offset:576
  s_waitcnt lgkmcnt(6)
  v_mfma_f32_16x16x32_f16 v[36:39], v[96:99], v[124:127], v[36:39]
  v_mfma_f32_16x16x32_f16 v[40:43], v[100:103], v[124:127], v[40:43]
  ds_read_b128 v[124:127], v12 offset:1088
  s_waitcnt lgkmcnt(4)
  v_mfma_f32_16x16x32_f16 v[40:43], v[96:99], v[2:5], v[40:43]
  v_mfma_f32_16x16x32_f16 v[44:47], v[100:103], v[2:5], v[44:47]
  ds_read_b128 v[2:5], v12 offset:1600
  s_waitcnt lgkmcnt(4)
  v_mfma_f32_16x16x32_f16 v[44:47], v[96:99], v[112:115], v[44:47]
  ds_read_b128 v[112:115], v12 offset:2112
  s_waitcnt lgkmcnt(4)
  v_mfma_f32_16x16x32_f16 v[16:19], v[104:107], v[116:119], v[16:19]
  v_mfma_f32_16x16x32_f16 v[20:23], v[108:111], v[116:119], v[20:23]
  ds_read_b128 v[116:119], v12 offset:2624
  s_waitcnt lgkmcnt(4)
  v_mfma_f32_16x16x32_f16 v[20:23], v[104:107], v[120:123], v[20:23]
  v_mfma_f32_16x16x32_f16 v[24:27], v[108:111], v[120:123], v[24:27]
  ds_read_b128 v[120:123], v12 offset:3136
  s_waitcnt lgkmcnt(4)
  v_mfma_f32_16x16x32_f16 v[24:27], v[104:107], v[124:127], v[24:27]
  v_mul_f32 v16, v16, v8
  v_mul_f32 v17, v17, v8
  v_mfma_f32_16x16x32_f16 v[28:31], v[108:111], v[124:127], v[28:31]
  ds_read_b128 v[124:127], v12 offset:3648
  v_mul_f32 v18, v18, v8
  v_mul_f32 v19, v19, v8
  s_waitcnt lgkmcnt(4)
  v_mfma_f32_16x16x32_f16 v[28:31], v[104:107], v[2:5], v[28:31]
  v_cvt_pk_bf16_f32 v16, v16, v17
  v_cvt_pk_bf16_f32 v17, v18, v19
  v_mfma_f32_16x16x32_f16 v[32:35], v[108:111], v[2:5], v[32:35]
  ds_read_b128 v[2:5], v13 offset:4096
  ds_write_b64 v9, v[16:17] offset:0
  s_waitcnt lgkmcnt(5)
  v_mfma_f32_16x16x32_f16 v[32:35], v[104:107], v[112:115], v[32:35]
  v_mul_f32 v20, v20, v8
  v_mul_f32 v21, v21, v8
  v_mfma_f32_16x16x32_f16 v[36:39], v[108:111], v[112:115], v[36:39]
  ds_read_b128 v[112:115], v12 offset:496
  ds_read_b128 v[16:19], v13 offset:2048
  v_mul_f32 v22, v22, v8
  v_mul_f32 v23, v23, v8
  s_waitcnt lgkmcnt(6)
  v_mfma_f32_16x16x32_f16 v[36:39], v[104:107], v[116:119], v[36:39]
  v_cvt_pk_bf16_f32 v20, v20, v21
  v_cvt_pk_bf16_f32 v21, v22, v23
  v_mfma_f32_16x16x32_f16 v[40:43], v[108:111], v[116:119], v[40:43]
  ds_read_b128 v[116:119], v12 offset:512
  v_mov_b32 v7, 2
  ds_write_b64 v9, v[20:21] offset:512
  ds_read_b128 v[20:23], v13 offset:3072
  s_waitcnt lgkmcnt(8)
  v_mfma_f32_16x16x32_f16 v[40:43], v[104:107], v[120:123], v[40:43]
  ds_write_b32 v15, v7 offset:48
  v_mfma_f32_16x16x32_f16 v[44:47], v[108:111], v[120:123], v[44:47]
  ds_read_b128 v[120:123], v12 offset:16
  s_waitcnt lgkmcnt(9)
  v_mfma_f32_16x16x32_f16 v[44:47], v[104:107], v[124:127], v[44:47]
  ds_read_b128 v[124:127], v12 offset:1008
  s_waitcnt lgkmcnt(7)
  v_mfma_f32_16x16x32_f16 v[96:99], v[112:115], v[88:91], 0
  v_mfma_f32_16x16x32_f16 v[100:103], v[112:115], v[92:95], 0
  s_waitcnt lgkmcnt(6)
  v_mfma_f32_16x16x32_f16 v[104:107], v[112:115], v[16:19], 0
  ds_read_b128 v[112:115], v12 offset:1024
  v_pk_mul_f16 v2, v2, s71 op_sel_hi:[1,0]
  v_pk_mul_f16 v3, v3, s71 op_sel_hi:[1,0]
  s_waitcnt lgkmcnt(4)
  v_mfma_f32_16x16x32_f16 v[108:111], v[116:119], v[20:23], 0
  v_cvt_pk_f16_f32 v96, v96, v97
  v_cvt_pk_f16_f32 v97, v98, v99
  v_cvt_pk_f16_f32 v98, v100, v101
  v_cvt_pk_f16_f32 v99, v102, v103
  s_nop 1
  v_mfma_f32_16x16x32_f16 v[24:27], v[96:99], v[48:51], v[24:27]
  v_pk_mul_f16 v4, v4, s71 op_sel_hi:[1,0]
  v_pk_mul_f16 v5, v5, s71 op_sel_hi:[1,0]
  v_mfma_f32_16x16x32_f16 v[28:31], v[96:99], v[52:55], v[28:31]
  v_cvt_pk_f16_f32 v104, v104, v105
  v_cvt_pk_f16_f32 v105, v106, v107
  v_mfma_f32_16x16x32_f16 v[32:35], v[96:99], v[56:59], v[32:35]
  v_cvt_pk_f16_f32 v106, v108, v109
  v_cvt_pk_f16_f32 v107, v110, v111
  v_mfma_f32_16x16x32_f16 v[96:99], v[116:119], v[92:95], 0
  v_mfma_f32_16x16x32_f16 v[100:103], v[116:119], v[88:91], 0
  ds_read_b128 v[116:119], v12 offset:528
  v_mfma_f32_16x16x32_f16 v[32:35], v[104:107], v[72:75], v[32:35]
  v_mfma_f32_16x16x32_f16 v[36:39], v[104:107], v[76:79], v[36:39]
  v_cvt_pk_f16_f32 v96, v96, v97
  v_cvt_pk_f16_f32 v97, v98, v99
  v_mfma_f32_16x16x32_f16 v[40:43], v[104:107], v[80:83], v[40:43]
  v_cvt_pk_f16_f32 v98, v100, v101
  v_cvt_pk_f16_f32 v99, v102, v103
  v_mfma_f32_16x16x32_f16 v[44:47], v[104:107], v[84:87], v[44:47]
  s_waitcnt lgkmcnt(3)
  v_mfma_f32_16x16x32_f16 v[28:31], v[2:5], v[120:123], v[28:31]
  ds_read_b128 v[120:123], v12 offset:1520
  s_waitcnt lgkmcnt(3)
  v_mfma_f32_16x16x32_f16 v[104:107], v[124:127], v[88:91], 0
  v_mfma_f32_16x16x32_f16 v[108:111], v[124:127], v[92:95], 0
  v_mfma_f32_16x16x32_f16 v[24:27], v[96:99], v[60:63], v[24:27]
  v_mfma_f32_16x16x32_f16 v[28:31], v[96:99], v[64:67], v[28:31]
  v_cvt_pk_f16_f32 v104, v104, v105
  v_cvt_pk_f16_f32 v105, v106, v107
  v_mfma_f32_16x16x32_f16 v[32:35], v[96:99], v[68:71], v[32:35]
  v_cvt_pk_f16_f32 v106, v108, v109
  v_cvt_pk_f16_f32 v107, v110, v111
  v_mfma_f32_16x16x32_f16 v[96:99], v[124:127], v[16:19], 0
  ds_read_b128 v[124:127], v12 offset:1536
  s_waitcnt lgkmcnt(3)
  v_mfma_f32_16x16x32_f16 v[100:103], v[112:115], v[20:23], 0
  v_mfma_f32_16x16x32_f16 v[28:31], v[104:107], v[48:51], v[28:31]
  v_mul_f32 v24, v24, v8
  v_mul_f32 v25, v25, v8
  v_mfma_f32_16x16x32_f16 v[32:35], v[104:107], v[52:55], v[32:35]
  v_cvt_pk_f16_f32 v96, v96, v97
  v_cvt_pk_f16_f32 v97, v98, v99
  v_mfma_f32_16x16x32_f16 v[36:39], v[104:107], v[56:59], v[36:39]
  v_cvt_pk_f16_f32 v98, v100, v101
  v_cvt_pk_f16_f32 v99, v102, v103
  v_mfma_f32_16x16x32_f16 v[104:107], v[112:115], v[92:95], 0
  v_mul_f32 v26, v26, v8
  v_mul_f32 v27, v27, v8
  v_mfma_f32_16x16x32_f16 v[108:111], v[112:115], v[88:91], 0
  ds_read_b128 v[112:115], v12 offset:1040
  v_cvt_pk_bf16_f32 v24, v24, v25
  v_cvt_pk_bf16_f32 v25, v26, v27
  v_mfma_f32_16x16x32_f16 v[36:39], v[96:99], v[72:75], v[36:39]
  ds_write_b64 v9, v[24:25] offset:1024
  v_mfma_f32_16x16x32_f16 v[40:43], v[96:99], v[76:79], v[40:43]
  v_cvt_pk_f16_f32 v104, v104, v105
  v_cvt_pk_f16_f32 v105, v106, v107
  v_mfma_f32_16x16x32_f16 v[44:47], v[96:99], v[80:83], v[44:47]
  v_cvt_pk_f16_f32 v106, v108, v109
  v_cvt_pk_f16_f32 v107, v110, v111
  s_waitcnt lgkmcnt(4)
  v_mfma_f32_16x16x32_f16 v[32:35], v[2:5], v[116:119], v[32:35]
  ds_read_b128 v[116:119], v12 offset:2032
  s_waitcnt lgkmcnt(4)
  v_mfma_f32_16x16x32_f16 v[96:99], v[120:123], v[88:91], 0
  v_mfma_f32_16x16x32_f16 v[100:103], v[120:123], v[92:95], 0
  v_mfma_f32_16x16x32_f16 v[28:31], v[104:107], v[60:63], v[28:31]
  v_mfma_f32_16x16x32_f16 v[32:35], v[104:107], v[64:67], v[32:35]
  v_cvt_pk_f16_f32 v96, v96, v97
  v_cvt_pk_f16_f32 v97, v98, v99
  v_mfma_f32_16x16x32_f16 v[36:39], v[104:107], v[68:71], v[36:39]
  v_cvt_pk_f16_f32 v98, v100, v101
  v_cvt_pk_f16_f32 v99, v102, v103
  v_mfma_f32_16x16x32_f16 v[104:107], v[120:123], v[16:19], 0
  ds_read_b128 v[120:123], v12 offset:2048
  s_waitcnt lgkmcnt(4)
  v_mfma_f32_16x16x32_f16 v[108:111], v[124:127], v[20:23], 0
  v_mfma_f32_16x16x32_f16 v[32:35], v[96:99], v[48:51], v[32:35]
  v_mul_f32 v28, v28, v8
  v_mul_f32 v29, v29, v8
  v_mfma_f32_16x16x32_f16 v[36:39], v[96:99], v[52:55], v[36:39]
  v_cvt_pk_f16_f32 v104, v104, v105
  v_cvt_pk_f16_f32 v105, v106, v107
  v_mfma_f32_16x16x32_f16 v[40:43], v[96:99], v[56:59], v[40:43]
  v_cvt_pk_f16_f32 v106, v108, v109
  v_cvt_pk_f16_f32 v107, v110, v111
  v_mfma_f32_16x16x32_f16 v[96:99], v[124:127], v[92:95], 0
  v_mul_f32 v30, v30, v8
  v_mul_f32 v31, v31, v8
  v_mfma_f32_16x16x32_f16 v[100:103], v[124:127], v[88:91], 0
  ds_read_b128 v[124:127], v12 offset:1552
  v_cvt_pk_bf16_f32 v28, v28, v29
  v_cvt_pk_bf16_f32 v29, v30, v31
  v_mfma_f32_16x16x32_f16 v[40:43], v[104:107], v[72:75], v[40:43]
  v_mov_b32 v7, 4
  ds_write_b64 v9, v[28:29] offset:1536
  v_mfma_f32_16x16x32_f16 v[44:47], v[104:107], v[76:79], v[44:47]
  v_cvt_pk_f16_f32 v96, v96, v97
  v_cvt_pk_f16_f32 v97, v98, v99
  s_waitcnt lgkmcnt(5)
  v_mfma_f32_16x16x32_f16 v[36:39], v[2:5], v[112:115], v[36:39]
  ds_read_b128 v[112:115], v12 offset:2544
  v_cvt_pk_f16_f32 v98, v100, v101
  v_cvt_pk_f16_f32 v99, v102, v103
  s_waitcnt lgkmcnt(4)
  v_mfma_f32_16x16x32_f16 v[104:107], v[116:119], v[88:91], 0
  ds_write_b32 v15, v7 offset:48
  v_mfma_f32_16x16x32_f16 v[108:111], v[116:119], v[92:95], 0
  v_mfma_f32_16x16x32_f16 v[32:35], v[96:99], v[60:63], v[32:35]
  v_mfma_f32_16x16x32_f16 v[36:39], v[96:99], v[64:67], v[36:39]
  v_cvt_pk_f16_f32 v104, v104, v105
  v_cvt_pk_f16_f32 v105, v106, v107
  v_mfma_f32_16x16x32_f16 v[40:43], v[96:99], v[68:71], v[40:43]
  v_cvt_pk_f16_f32 v106, v108, v109
  v_cvt_pk_f16_f32 v107, v110, v111
  v_mfma_f32_16x16x32_f16 v[96:99], v[116:119], v[16:19], 0
  ds_read_b128 v[116:119], v12 offset:2560
  s_waitcnt lgkmcnt(5)
  v_mfma_f32_16x16x32_f16 v[100:103], v[120:123], v[20:23], 0
  v_mfma_f32_16x16x32_f16 v[36:39], v[104:107], v[48:51], v[36:39]
  v_mul_f32 v32, v32, v8
  v_mul_f32 v33, v33, v8
  v_mfma_f32_16x16x32_f16 v[40:43], v[104:107], v[52:55], v[40:43]
  v_cvt_pk_f16_f32 v96, v96, v97
  v_cvt_pk_f16_f32 v97, v98, v99
  v_mfma_f32_16x16x32_f16 v[44:47], v[104:107], v[56:59], v[44:47]
  v_cvt_pk_f16_f32 v98, v100, v101
  v_cvt_pk_f16_f32 v99, v102, v103
  v_mfma_f32_16x16x32_f16 v[104:107], v[120:123], v[92:95], 0
  v_mul_f32 v34, v34, v8
  v_mul_f32 v35, v35, v8
  v_mfma_f32_16x16x32_f16 v[108:111], v[120:123], v[88:91], 0
  ds_read_b128 v[120:123], v12 offset:2064
  v_cvt_pk_bf16_f32 v32, v32, v33
  v_cvt_pk_bf16_f32 v33, v34, v35
  v_mfma_f32_16x16x32_f16 v[44:47], v[96:99], v[72:75], v[44:47]
  ds_write_b64 v9, v[32:33] offset:2048
  s_waitcnt lgkmcnt(6)
  v_mfma_f32_16x16x32_f16 v[40:43], v[2:5], v[124:127], v[40:43]
  ds_read_b128 v[124:127], v12 offset:3056
  v_cvt_pk_f16_f32 v104, v104, v105
  v_cvt_pk_f16_f32 v105, v106, v107
  s_waitcnt lgkmcnt(5)
  v_mfma_f32_16x16x32_f16 v[96:99], v[112:115], v[88:91], 0
  v_cvt_pk_f16_f32 v106, v108, v109
  v_cvt_pk_f16_f32 v107, v110, v111
  v_mfma_f32_16x16x32_f16 v[100:103], v[112:115], v[92:95], 0
  ds_read_b128 v[112:115], v12 offset:3072
  v_mfma_f32_16x16x32_f16 v[36:39], v[104:107], v[60:63], v[36:39]
  v_mfma_f32_16x16x32_f16 v[40:43], v[104:107], v[64:67], v[40:43]
  v_cvt_pk_f16_f32 v96, v96, v97
  v_cvt_pk_f16_f32 v97, v98, v99
  v_mfma_f32_16x16x32_f16 v[44:47], v[104:107], v[68:71], v[44:47]
  v_cvt_pk_f16_f32 v98, v100, v101
  v_cvt_pk_f16_f32 v99, v102, v103
  s_waitcnt lgkmcnt(4)
  v_mfma_f32_16x16x32_f16 v[104:107], v[116:119], v[92:95], 0
  v_mfma_f32_16x16x32_f16 v[108:111], v[116:119], v[88:91], 0
  v_mfma_f32_16x16x32_f16 v[40:43], v[96:99], v[48:51], v[40:43]
  v_mul_f32 v36, v36, v8
  v_mul_f32 v37, v37, v8
  v_mfma_f32_16x16x32_f16 v[44:47], v[96:99], v[52:55], v[44:47]
  v_cvt_pk_f16_f32 v104, v104, v105
  v_cvt_pk_f16_f32 v105, v106, v107
  s_waitcnt lgkmcnt(3)
  v_mfma_f32_16x16x32_f16 v[44:47], v[2:5], v[120:123], v[44:47]
  v_cvt_pk_f16_f32 v106, v108, v109
  v_cvt_pk_f16_f32 v107, v110, v111
  s_waitcnt lgkmcnt(1)
  v_mfma_f32_16x16x32_f16 v[96:99], v[124:127], v[88:91], 0
  v_mul_f32 v38, v38, v8
  v_mul_f32 v39, v39, v8
  v_mfma_f32_16x16x32_f16 v[100:103], v[124:127], v[92:95], 0
  v_cvt_pk_bf16_f32 v36, v36, v37
  v_cvt_pk_bf16_f32 v37, v38, v39
  v_mfma_f32_16x16x32_f16 v[40:43], v[104:107], v[60:63], v[40:43]
  v_mov_b32 v7, 6
  ds_write_b64 v9, v[36:37] offset:2560
  v_mfma_f32_16x16x32_f16 v[44:47], v[104:107], v[64:67], v[44:47]
  v_cvt_pk_f16_f32 v96, v96, v97
  v_cvt_pk_f16_f32 v97, v98, v99
  s_waitcnt lgkmcnt(1)
  v_mfma_f32_16x16x32_f16 v[104:107], v[112:115], v[92:95], 0
  v_cvt_pk_f16_f32 v98, v100, v101
  v_cvt_pk_f16_f32 v99, v102, v103
  v_mfma_f32_16x16x32_f16 v[108:111], v[112:115], v[88:91], 0
  ds_write_b32 v15, v7 offset:48
  v_mfma_f32_16x16x32_f16 v[44:47], v[96:99], v[48:51], v[44:47]
  v_mul_f32 v40, v40, v8
  v_mul_f32 v41, v41, v8
  v_cvt_pk_f16_f32 v104, v104, v105
  v_cvt_pk_f16_f32 v105, v106, v107
  s_nop 0
  v_cvt_pk_f16_f32 v106, v108, v109
  v_cvt_pk_f16_f32 v107, v110, v111
  s_nop 1
  v_mfma_f32_16x16x32_f16 v[44:47], v[104:107], v[60:63], v[44:47]
  v_mul_f32 v42, v42, v8
  v_mul_f32 v43, v43, v8
  v_cvt_pk_bf16_f32 v40, v40, v41
  v_cvt_pk_bf16_f32 v41, v42, v43
  ds_write_b64 v9, v[40:41] offset:3072
  s_nop 2
  v_mul_f32 v44, v44, v8
  v_mul_f32 v45, v45, v8
  v_mul_f32 v46, v46, v8
  v_mul_f32 v47, v47, v8
  v_cvt_pk_bf16_f32 v44, v44, v45
  v_cvt_pk_bf16_f32 v45, v46, v47
  v_mov_b32 v7, 8
  ds_write_b64 v9, v[44:45] offset:3584
  ds_write_b32 v15, v7 offset:48
  s_endpgm
.p2align 6
K_FAR:
  v_and_b32 v13, 1, v96
  v_lshrrev_b32 v14, 1, v96
  v_lshlrev_b32 v8, 8, v13
  v_lshlrev_b32 v15, 1, v14
  v_sub_u32 v8, v8, v15
  v_lshlrev_b32 v9, 5, v97
  v_sub_u32 v8, v8, v9
  v_add_u32 v8, 1390, v8
  v_add_u32 v8, s68, v8
  v_lshlrev_b32 v9, 1, v13
  v_sub_u32 v9, v8, v9
  v_add_u32 v9, -126, v9
  ds_write_b128 v99, v[76:79]
  ds_write_b128 v99, v[80:83] offset:1024
  v_mul_u32_u24 v10, 158, v13
  v_sub_u32 v10, v10, v15
  v_lshlrev_b32 v11, 6, v97
  v_sub_u32 v10, v10, v11
  v_add_u32 v10, 1712, v10
  v_add_u32 v10, s68, v10
  s_nop 0
  v_mov_b32 v94, 1
  s_waitcnt lgkmcnt(0)
  ds_write_b32 v92, v94 offset:64
  s_branch K_PS2B
K_PS2:
  s_sleep 2
K_PS2B:
  ds_read_b32 v94, v93 offset:64
  s_waitcnt lgkmcnt(0)
  v_cmp_gt_u32 vcc, 1, v94
  s_cbranch_vccnz K_PS2
  ds_read_b128 v[16:19], v99 offset:5120
  ds_read_b128 v[20:23], v99 offset:6144
  s_waitcnt lgkmcnt(1)
  v_pk_add_f32 v[80:81], v[80:81], v[16:17]
  v_pk_add_f32 v[82:83], v[82:83], v[18:19]
  s_waitcnt lgkmcnt(0)
  v_pk_add_f32 v[84:85], v[84:85], v[20:21]
  v_pk_add_f32 v[86:87], v[86:87], v[22:23]
  v_cvt_pk_f16_f32 v16, v80, v81
  v_cvt_pk_f16_f32 v17, v82, v83
  v_cvt_pk_f16_f32 v18, v84, v85
  v_cvt_pk_f16_f32 v19, v86, v87
  v_cvt_pk_f16_f32 v89, v84, v84
  s_mov_b32 exec_lo, 0
  ds_write_b16 v9, v17
  ds_write_b16 v9, v17 offset:1986
  ds_write_b16_d16_hi v8, v17
  ds_write_b16_d16_hi v8, v17 offset:1986
  s_mov_b32 exec_hi, -4
  ds_write_b16 v9, v16 offset:16
  ds_write_b16 v9, v16 offset:2002
  ds_write_b16_d16_hi v8, v16 offset:16
  ds_write_b16_d16_hi v8, v16 offset:2002
  s_mov_b32 exec_hi, 1
  s_mov_b32 exec_lo, -2
  ds_write_b16 v10, v18 offset:48
  ds_write_b16 v10, v18 offset:2034
  s_mov_b32 exec_hi, 0
  s_mov_b32 exec_lo, -1
  ds_write_b16_d16_hi v10, v18 offset:32
  ds_write_b16_d16_hi v10, v18 offset:2018
  ds_write_b16 v10, v19 offset:16
  ds_write_b16 v10, v19 offset:2002
  ds_write_b16_d16_hi v10, v19
  ds_write_b16_d16_hi v10, v19 offset:1986
  s_mov_b64 exec, -1
  v_mov_b32 v15, 0
  v_or_b32 v89, 0x10000, v89
  s_lshl_b32 s79, s52, 2
  v_mov_b32 v14, s79
  s_branch K_BWB
K_BW:
  s_sleep 1
K_BWB:
  ds_read_b32 v9, v15 offset:28
  s_waitcnt lgkmcnt(0)
  v_cmp_gt_u32 vcc, 8, v9
  s_cbranch_vccnz K_BW
  v_mov_b32 v9, 1
  s_mov_b64 exec, 1
  ds_write_b32 v14, v89 offset:32
  ds_add_u32 v15, v9 offset:112
  s_mov_b64 exec, -1
  s_setprio 1
  s_and_b32 s60, s30, 1
  s_mul_i32 s61, s60, 114688
  s_sub_u32 s16, s16, s61
  s_lshl_b32 s60, s60, 12
  s_sub_u32 s36, s36, s60
  s_lshl_b32 s18, s28, 8
  s_cmp_lg_u32 s30, 1
  s_cbranch_scc1 K_NOKP
  ds_read_b32 v90, v15 offset:0
  v_mov_b32 v8, 0x3f803f80
  v_mov_b32 v9, v8
  v_lshlrev_b32 v3, 3, v1
  v_add_u32 v3, 150528, v3
  ds_write_b64 v3, v[8:9]
  v_lshlrev_b32 v2, 3, v1
  s_setprio 3
  s_lshl_b32 s60, s28, 10
  s_add_u32 s60, s60, 0x441000
  s_mov_b32 s83, 0x20000
  v_lshl_add_u32 v3, v96, 4, s18
  s_mov_b32 m0, 150016
  s_branch K_KWB
K_KW:
  s_sleep 1
K_KWB:
  ds_read_b32 v9, v15 offset:20
  s_waitcnt lgkmcnt(0)
  v_cmp_gt_u32 vcc, 8, v9
  s_cbranch_vccnz K_KW
  ds_read_b64 v[72:73], v2 offset:128
  ds_read_b32 v5, v15 offset:8
  v_readfirstlane_b32 s46, v90
  v_mov_b32 v74, v90
  v_mov_b32 v75, v90
  s_lshl_b32 s61, s29, 5
  s_add_u32 s61, s61, s60
  s_waitcnt lgkmcnt(0)
  v_readfirstlane_b32 s47, v5
  v_mov_b32 v80, v72
  s_nop 1
  v_max_u32_dpp v80, v80, v80 quad_perm:[1,0,3,2] row_mask:0xf bank_mask:0xf
  s_nop 1
  v_max_u32_dpp v80, v80, v80 quad_perm:[2,3,0,1] row_mask:0xf bank_mask:0xf
  s_nop 1
  v_max_u32_dpp v80, v80, v80 row_half_mirror row_mask:0xf bank_mask:0xf
  s_nop 1
  v_max_u32_dpp v80, v80, v80 row_mirror row_mask:0xf bank_mask:0xf
  s_nop 1
  v_max_u32_dpp v80, v80, v80 row_bcast:15 row_mask:0xa bank_mask:0xf
  s_nop 1
  v_max_u32_dpp v80, v80, v80 row_bcast:31 row_mask:0xc bank_mask:0xf
  s_nop 0
  v_readlane_b32 s78, v80, 63
  s_nop 1
  v_cmp_ne_u32 s[64:65], s78, v72
  s_nop 1
  v_cndmask_b32 v80, 0, v72, s[64:65]
  s_nop 1
  v_max_u32_dpp v80, v80, v80 quad_perm:[1,0,3,2] row_mask:0xf bank_mask:0xf
  s_nop 1
  v_max_u32_dpp v80, v80, v80 quad_perm:[2,3,0,1] row_mask:0xf bank_mask:0xf
  s_nop 1
  v_max_u32_dpp v80, v80, v80 row_half_mirror row_mask:0xf bank_mask:0xf
  s_nop 1
  v_max_u32_dpp v80, v80, v80 row_mirror row_mask:0xf bank_mask:0xf
  s_nop 1
  v_max_u32_dpp v80, v80, v80 row_bcast:15 row_mask:0xa bank_mask:0xf
  s_nop 1
  v_max_u32_dpp v80, v80, v80 row_bcast:31 row_mask:0xc bank_mask:0xf
  s_nop 0
  v_readlane_b32 s79, v80, 63
  v_cndmask_b32 v80, 0, 16, s[64:65]
  s_nop 0
  v_cmp_le_u32 vcc, s79, v72
  s_nop 0
  s_mov_b64 exec, vcc
  s_cmp_lg_u32 s47, 0
  s_cbranch_scc1 K_KS_W
  buffer_store_dwordx4 v[72:75], v80, s[32:35], s61 offen
  s_branch K_KS_D
K_KS_W:
  buffer_store_dwordx4 v[72:75], v80, s[32:35], s61 offen sc1
K_KS_D:
  s_mov_b64 exec, -1
K_P3:
  s_nop 0
  buffer_load_dwordx4 v[72:75], v95, s[32:35], s60 offen sc1
  s_sub_u32 s83, s83, 1
  s_waitcnt vmcnt(0)
  s_cbranch_scc1 K_P3D
  v_cmp_ne_u32 vcc, s46, v74
  s_cbranch_vccnz K_P3
K_P3D:
  v_mov_b32 v80, v72
  s_nop 1
  v_max_u32_dpp v80, v80, v80 quad_perm:[1,0,3,2] row_mask:0xf bank_mask:0xf
  s_nop 1
  v_max_u32_dpp v80, v80, v80 quad_perm:[2,3,0,1] row_mask:0xf bank_mask:0xf
  s_nop 1
  v_max_u32_dpp v80, v80, v80 row_half_mirror row_mask:0xf bank_mask:0xf
  s_nop 1
  v_max_u32_dpp v80, v80, v80 row_mirror row_mask:0xf bank_mask:0xf
  s_nop 1
  v_max_u32_dpp v80, v80, v80 row_bcast:15 row_mask:0xa bank_mask:0xf
  s_nop 1
  v_max_u32_dpp v80, v80, v80 row_bcast:31 row_mask:0xc bank_mask:0xf
  s_nop 0
  v_readlane_b32 s78, v80, 63
  s_nop 1
  v_cmp_ne_u32 s[64:65], s78, v72
  s_nop 1
  v_cndmask_b32 v80, 0, v72, s[64:65]
  s_nop 1
  v_max_u32_dpp v80, v80, v80 quad_perm:[1,0,3,2] row_mask:0xf bank_mask:0xf
  s_nop 1
  v_max_u32_dpp v80, v80, v80 quad_perm:[2,3,0,1] row_mask:0xf bank_mask:0xf
  s_nop 1
  v_max_u32_dpp v80, v80, v80 row_half_mirror row_mask:0xf bank_mask:0xf
  s_nop 1
  v_max_u32_dpp v80, v80, v80 row_mirror row_mask:0xf bank_mask:0xf
  s_nop 1
  v_max_u32_dpp v80, v80, v80 row_bcast:15 row_mask:0xa bank_mask:0xf
  s_nop 1
  v_max_u32_dpp v80, v80, v80 row_bcast:31 row_mask:0xc bank_mask:0xf
  s_nop 0
  v_readlane_b32 s79, v80, 63
  s_andn2_b32 s78, 0xffe, s78
  s_andn2_b32 s61, 0xffe, s79
  v_cndmask_b32 v80, 0, 8, s[64:65]
  v_cmp_le_u32 vcc, s79, v72
  v_mov_b32 v8, s78
  s_mov_b64 exec, 0xffff0000
  v_mov_b32 v8, s61
  s_mov_b32 exec_lo, -1
  s_mov_b32 exec_hi, 0
  v_lshl_add_u32 v3, v8, 10, v3
  global_load_lds_dwordx4 v3, s[44:45]
  s_mov_b64 exec, vcc
  ds_write_b64 v80, v[72:73] offset:96
  v_mov_b32 v9, 1
  s_waitcnt vmcnt(0)
  ds_write_b32 v15, v9 offset:120
  s_cmp_lg_u32 s2, 0
  s_cbranch_scc1 K_NOZ
  s_mov_b32 s78, 0x0
  buffer_store_dword v74, v15, s[32:35], s78 offen sc1
K_NOZ:
  s_mov_b64 exec, -1
K_NOKP:
  s_branch K_HGB
K_HG:
  s_sleep 4
K_HGB:
  ds_read_b32 v8, v15 offset:16
  ds_read_b32 v5, v15 offset:8
  ds_read2_b32 v[10:11], v15 offset0:28 offset1:30
  s_waitcnt lgkmcnt(0)
  v_add3_u32 v8, v8, v10, v11
  v_cmp_gt_u32 vcc, 17, v8
  s_cbranch_vccnz K_HG
  s_setprio 3
  s_add_u32 m0, s36, 34816
  s_add_u32 s60, s16, 57344
  buffer_load_dwordx4 v98, s[8:11], s60 offen nt lds
  s_add_u32 m0, s36, 38912
  s_add_u32 s60, s16, 172032
  buffer_load_dwordx4 v98, s[8:11], s60 offen nt lds
  s_add_u32 m0, s36, 3072
  s_add_u32 s60, s16, 86016
  buffer_load_dwordx4 v98, s[4:7], s60 offen nt lds
  s_add_u32 m0, s36, 7168
  s_add_u32 s60, s16, 200704
  buffer_load_dwordx4 v98, s[4:7], s60 offen nt lds
  s_add_u32 m0, s36, 35840
  s_add_u32 s60, s16, 86016
  buffer_load_dwordx4 v98, s[8:11], s60 offen nt lds
  s_add_u32 m0, s36, 39936
  s_add_u32 s60, s16, 200704
  buffer_load_dwordx4 v98, s[8:11], s60 offen nt lds
  v_mov_b32 v9, 1
  v_readfirstlane_b32 s47, v5
  s_mov_b64 exec, 1
  ds_add_u32 v15, v9 offset:124
  s_waitcnt vmcnt(0)
  ds_add_u32 v15, v9 offset:24
  s_mov_b64 exec, -1
  s_setprio 0
  s_lshr_b32 s62, s52, 1
  v_and_b32 v3, 3, v1
  v_mul_u32_u24 v2, 4096, v3
  v_lshlrev_b32 v95, 4, v3
  v_lshrrev_b32 v3, 2, v1
  v_lshl_add_u32 v2, v3, 4, v2
  v_lshl_add_u32 v95, v3, 14, v95
  s_lshl_b32 s61, s62, 9
  v_add_u32 v2, s61, v2
  s_lshl_b32 s72, s62, 19
  s_lshl_b32 s61, s28, 8
  s_add_u32 s72, s72, s61
  s_and_b32 s61, s29, 3
  s_lshl_b32 s61, s61, 12
  s_add_u32 s72, s72, s61
  s_and_b32 s61, s29, 4
  s_lshl_b32 s61, s61, 9
  s_add_u32 s72, s72, s61
  s_lshr_b32 s61, s29, 3
  s_lshl_b32 s61, s61, 6
  s_add_u32 s72, s72, s61
  s_add_u32 s73, s72, 0x40000
  s_bitcmp1_b32 s52, 0
  s_cselect_b32 s72, s73, s72
  s_cselect_b32 s61, 256, 0
  v_add_u32 v2, s61, v2
  s_mov_b32 s20, s26
  s_mov_b32 s21, s27
  s_mov_b32 s22, 0x400000
  s_mov_b32 s23, 0x00020000
  v_mov_b32 v4, 0x20001
  s_mov_b32 s62, 2
  s_cmp_lg_u32 s30, 1
  s_cbranch_scc1 K_NOFP
  v_and_b32 v3, 16, v1
  v_lshrrev_b32 v3, 1, v3
  ds_read_b64 v[80:81], v3 offset:96
  v_and_b32 v7, 3, v1
  v_lshl_add_u32 v5, v7, 3, s3
  v_lshlrev_b32 v5, 1, v5
  global_load_ushort v82, v5, s[14:15]
  v_lshrrev_b32 v86, 2, v1
  v_lshlrev_b32 v86, 11, v86
  v_lshl_add_u32 v86, v7, 4, v86
  s_lshl_b32 s60, s28, 16
  s_lshl_b32 s61, s29, 6
  s_add_u32 s60, s60, s61
  s_add_u32 s60, s60, 0x500000
  s_add_u32 s63, s60, 0x8000
  s_waitcnt lgkmcnt(0)
  v_not_b32 v6, v80
  v_and_b32 v6, 0xffe, v6
  v_lshl_add_u32 v84, v7, 12, v6
  v_lshl_add_u32 v87, v6, 10, v5
  global_load_ushort v83, v87, s[44:45]
  v_and_b32 v5, s31, v80
  v_ashrrev_i32 v3, 31, v5
  v_not_b32 v3, v3
  v_or_b32 v3, 0x80000000, v3
  v_xor_b32 v5, v5, v3
  v_and_b32 v5, s31, v5
  v_mul_f32 v85, s58, v5
  v_exp_f32 v85, -v85
  v_and_b32 v88, s31, v81
  v_lshlrev_b32 v81, 16, v81
  v_add_f32 v85, 1.0, v85
  v_rcp_f32 v85, v85
  v_rcp_f32 v89, v88
  s_nop 0
  v_fma_f32 v88, -v88, v89, 1.0
  v_fmac_f32 v89, v88, v89
  v_cvt_pk_bf16_f32 v85, 0, v85
K_NOFP:
  s_branch K_YWB
K_YW:
  s_sleep 2
K_YWB:
  ds_read_b128 v[8:11], v15 offset:48
  s_waitcnt lgkmcnt(0)
  v_min_u32 v8, v8, v9
  v_min3_u32 v8, v8, v10, v11
  v_cmp_gt_u32 vcc, s62, v8
  s_cbranch_vccnz K_YW
  ds_read_b128 v[16:19], v2 offset:56320
  s_setprio 3
  s_add_u32 s62, s62, 2
  v_add_u32 v2, 1024, v2
  s_waitcnt lgkmcnt(0)
  v_xor_b32 v6, 0x10002, v16
  v_bitop3_b32 v6, v6, v17, v4 bitop3:0xf6
  v_and_b32 v6, 0x30003, v6
  v_cmp_eq_u32 vcc, 0, v6
  s_nop 1
  v_addc_co_u32 v16, vcc, 0, v16, vcc
  s_cmp_lg_u32 s47, 0
  s_cbranch_scc1 K_YS_W
  buffer_store_dwordx4 v[16:19], v95, s[20:23], s72 offen
  s_branch K_YS_D
K_YS_W:
  buffer_store_dwordx4 v[16:19], v95, s[20:23], s72 offen sc1
K_YS_D:
  s_add_u32 s72, s72, 0x100000
  s_setprio 0
  s_cmp_le_u32 s62, 8
  s_cbranch_scc1 K_YWB
  s_cmp_lg_u32 s30, 1
  s_cbranch_scc1 K_CDONE
  ds_read_u16 v40, v84 offset:56320
  s_setprio 3
  v_mov_b32 v52, 0
  v_mov_b32 v53, 0
  v_mov_b32 v54, s46
  buffer_load_dwordx3 v[48:50], v86, s[32:35], s60 offen sc1
  s_mov_b32 exec_hi, 0x5ffff
  buffer_load_dwordx3 v[52:54], v86, s[32:35], s63 offen sc1
  s_mov_b32 exec_hi, -1
  s_mov_b32 s83, 0x20000
  s_waitcnt vmcnt(6) lgkmcnt(0)
  v_lshlrev_b32 v83, 16, v83
  v_lshlrev_b32 v82, 16, v82
  v_lshlrev_b32 v84, 16, v40
  v_sub_f32 v25, v83, v81
  v_cvt_pk_bf16_f32 v25, 0, v25
  v_mul_f32 v25, v25, v89
  v_cvt_pk_bf16_f32 v25, 0, v25
  v_mul_f32 v26, v25, v82
  v_cvt_pk_bf16_f32 v26, 0, v26
  v_add_f32 v26, v26, v84
  v_cvt_pk_bf16_f32 v26, 0, v26
  s_waitcnt vmcnt(0)
  s_branch K_DC
K_DP:
  buffer_load_dwordx3 v[48:50], v86, s[32:35], s60 offen sc1
  s_mov_b32 exec_hi, 0x5ffff
  buffer_load_dwordx3 v[52:54], v86, s[32:35], s63 offen sc1
  s_mov_b32 exec_hi, -1
  s_sub_u32 s83, s83, 1
  s_waitcnt vmcnt(0)
  s_cbranch_scc1 K_DD
K_DC:
  v_cmp_ne_u32 vcc, s46, v50
  v_cmp_ne_u32 s[64:65], s46, v54
  s_nop 0
  s_or_b64 vcc, vcc, s[64:65]
  s_cbranch_vccnz K_DP
K_DD:
  v_pk_add_f32 v[48:49], v[48:49], v[52:53]
  s_nop 1
  v_permlane16_swap_b32 v48, v49
  v_add_f32 v48, v48, v49
  v_mov_b32 v49, v48
  s_nop 1
  v_permlane32_swap_b32 v48, v49
  v_add_f32 v48, v48, v49
  s_nop 1
  v_add_f32_dpp v48, v48, v48 row_ror:4 row_mask:0xf bank_mask:0xf
  s_nop 1
  v_add_f32_dpp v48, v48, v48 row_ror:8 row_mask:0xf bank_mask:0xf
  v_cvt_pk_bf16_f32 v48, 0, v48
  v_mul_f32 v20, v48, v85
  v_cvt_pk_bf16_f32 v20, 0, v20
  v_add_f32 v20, v20, v25
  v_cvt_pk_bf16_f32 v20, 0, v20
  v_mul_f32 v23, 0xbfb8aa3b, v20
  v_exp_f32 v23, v23
  s_nop 0
  v_add_f32 v23, 1.0, v23
  v_rcp_f32 v23, v23
  s_nop 0
  v_mul_f32 v23, v23, v20
  v_cvt_pk_bf16_f32 v23, 0, v23
  v_mul_f32 v23, v23, v26
  v_cvt_pk_bf16_f32 v23, 0, v23
  v_add_f32 v23, v23, v83
  v_cvt_pk_bf16_f32 v23, v23, v23
  s_mov_b64 exec, 0x000f000f
  global_store_short v87, v23, s[26:27]
K_CDONE:
  s_endpgm
K_END:
  s_endpgm
.p2align 4
.type K_BAND,@object
.size K_BAND, 5120
K_BAND:
.long 0x0, 0x0, 0x0, 0x3c003c00
.long 0x0, 0x0, 0x0, 0x3c000000
.long 0x0, 0x0, 0x0, 0x0
.long 0x0, 0x0, 0x0, 0x0
.long 0x0, 0x0, 0x0, 0x0
.long 0x0, 0x0, 0x0, 0x0
.long 0x0, 0x0, 0x0, 0x0
.long 0x0, 0x0, 0x0, 0x0
.long 0x0, 0x0, 0x0, 0x0
.long 0x0, 0x0, 0x0, 0x0
.long 0x0, 0x0, 0x0, 0x0
.long 0x0, 0x0, 0x0, 0x0
.long 0x0, 0x0, 0x0, 0x0
.long 0x0, 0x0, 0x0, 0x0
.long 0x0, 0x0, 0x0, 0x0
.long 0x0, 0x0, 0x0, 0x0
.long 0x3c003c00, 0x3c00, 0x0, 0x0
.long 0x3c003c00, 0x3c003c00, 0x0, 0x0
.long 0x3c003c00, 0x3c003c00, 0x3c00, 0x0
.long 0x3c000000, 0x3c003c00, 0x3c003c00, 0x0
.long 0x0, 0x3c003c00, 0x3c003c00, 0x3c00
.long 0x0, 0x3c000000, 0x3c003c00, 0x3c003c00
.long 0x0, 0x0, 0x3c003c00, 0x3c003c00
.long 0x0, 0x0, 0x3c000000, 0x3c003c00
.long 0x0, 0x0, 0x0, 0x3c003c00
.long 0x0, 0x0, 0x0, 0x3c000000
.long 0x0, 0x0, 0x0, 0x0
.long 0x0, 0x0, 0x0, 0x0
.long 0x0, 0x0, 0x0, 0x0
.long 0x0, 0x0, 0x0, 0x0
.long 0x0, 0x0, 0x0, 0x0
.long 0x0, 0x0, 0x0, 0x0
.long 0x0, 0x0, 0x0, 0x0
.long 0x0, 0x0, 0x0, 0x0
.long 0x0, 0x0, 0x0, 0x0
.long 0x0, 0x0, 0x0, 0x0
.long 0x0, 0x0, 0x0, 0x0
.long 0x0, 0x0, 0x0, 0x0
.long 0x3c00, 0x0, 0x0, 0x0
.long 0x3c003c00, 0x0, 0x0, 0x0
.long 0x3c003c00, 0x3c00, 0x0, 0x0
.long 0x3c003c00, 0x3c003c00, 0x0, 0x0
.long 0x3c003c00, 0x3c003c00, 0x3c00, 0x0
.long 0x3c000000, 0x3c003c00, 0x3c003c00, 0x0
.long 0x0, 0x3c003c00, 0x3c003c00, 0x3c00
.long 0x0, 0x3c000000, 0x3c003c00, 0x3c003c00
.long 0x0, 0x0, 0x3c003c00, 0x3c003c00
.long 0x0, 0x0, 0x3c000000, 0x3c003c00
.long 0x0, 0x0, 0x0, 0x0
.long 0x0, 0x0, 0x0, 0x0
.long 0x0, 0x0, 0x0, 0x0
.long 0x0, 0x0, 0x0, 0x0
.long 0x0, 0x0, 0x0, 0x0
.long 0x0, 0x0, 0x0, 0x0
.long 0x0, 0x0, 0x0, 0x0
.long 0x0, 0x0, 0x0, 0x0
.long 0x0, 0x0, 0x0, 0x0
.long 0x0, 0x0, 0x0, 0x0
.long 0x0, 0x0, 0x0, 0x0
.long 0x0, 0x0, 0x0, 0x0
.long 0x0, 0x0, 0x0, 0x0
.long 0x0, 0x0, 0x0, 0x0
.long 0x3c00, 0x0, 0x0, 0x0
.long 0x3c003c00, 0x0, 0x0, 0x0
.long 0x0, 0x0, 0x0, 0x0
.long 0x0, 0x0, 0x0, 0x0
.long 0x0, 0x0, 0x0, 0x0
.long 0x0, 0x0, 0x0, 0x0
.long 0x0, 0x0, 0x0, 0x0
.long 0x0, 0x0, 0x0, 0x0
.long 0x0, 0x0, 0x0, 0x0
.long 0x0, 0x0, 0x0, 0x0
.long 0x0, 0x0, 0x0, 0x0
.long 0x0, 0x0, 0x0, 0x0
.long 0x0, 0x0, 0x0, 0x0
.long 0x0, 0x0, 0x0, 0x0
.long 0x0, 0x0, 0x0, 0x0
.long 0x0, 0x0, 0x0, 0x0
.long 0x0, 0x0, 0x0, 0x0
.long 0x0, 0x0, 0x0, 0x0
.long 0x0, 0x3c000000, 0x3c003c00, 0x0
.long 0x0, 0x0, 0x3c003c00, 0x3c00
.long 0x0, 0x0, 0x3c000000, 0x3c003c00
.long 0x0, 0x0, 0x0, 0x3c003c00
.long 0x0, 0x0, 0x0, 0x3c000000
.long 0x0, 0x0, 0x0, 0x0
.long 0x0, 0x0, 0x0, 0x0
.long 0x0, 0x0, 0x0, 0x0
.long 0x0, 0x0, 0x0, 0x0
.long 0x0, 0x0, 0x0, 0x0
.long 0x0, 0x0, 0x0, 0x0
.long 0x0, 0x0, 0x0, 0x0
.long 0x0, 0x0, 0x0, 0x0
.long 0x0, 0x0, 0x0, 0x0
.long 0x0, 0x0, 0x0, 0x0
.long 0x0, 0x0, 0x0, 0x0
.long 0x0, 0x0, 0x0, 0x0
.long 0x0, 0x0, 0x0, 0x0
.long 0x0, 0x0, 0x0, 0x0
.long 0x3c00, 0x0, 0x0, 0x0
.long 0x3c003c00, 0x0, 0x0, 0x0
.long 0x3c003c00, 0x3c00, 0x0, 0x0
.long 0x3c000000, 0x3c003c00, 0x0, 0x0
.long 0x0, 0x3c003c00, 0x3c00, 0x0
.long 0x0, 0x3c000000, 0x3c003c00, 0x0
.long 0x0, 0x0, 0x3c003c00, 0x3c00
.long 0x0, 0x0, 0x3c000000, 0x3c003c00
.long 0x0, 0x0, 0x0, 0x3c003c00
.long 0x0, 0x0, 0x0, 0x3c000000
.long 0x0, 0x0, 0x0, 0x0
.long 0x0, 0x0, 0x0, 0x0
.long 0x0, 0x0, 0x0, 0x0
.long 0x0, 0x0, 0x0, 0x0
.long 0x0, 0x0, 0x0, 0x0
.long 0x0, 0x0, 0x0, 0x0
.long 0x0, 0x0, 0x0, 0x0
.long 0x0, 0x0, 0x0, 0x0
.long 0x0, 0x0, 0x0, 0x0
.long 0x0, 0x0, 0x0, 0x0
.long 0x0, 0x0, 0x0, 0x0
.long 0x0, 0x0, 0x0, 0x0
.long 0x0, 0x0, 0x0, 0x0
.long 0x0, 0x0, 0x0, 0x0
.long 0x3c00, 0x0, 0x0, 0x0
.long 0x3c003c00, 0x0, 0x0, 0x0
.long 0x3c003c00, 0x3c00, 0x0, 0x0
.long 0x3c000000, 0x3c003c00, 0x0, 0x0
.long 0x0, 0x3c003c00, 0x3c00, 0x0
.long 0x0, 0x0, 0x3c003c00, 0x3c003c00
.long 0x0, 0x0, 0x3c000000, 0x3c003c00
.long 0x0, 0x0, 0x0, 0x3c003c00
.long 0x0, 0x0, 0x0, 0x3c000000
.long 0x0, 0x0, 0x0, 0x0
.long 0x0, 0x0, 0x0, 0x0
.long 0x0, 0x0, 0x0, 0x0
.long 0x0, 0x0, 0x0, 0x0
.long 0x0, 0x0, 0x0, 0x0
.long 0x0, 0x0, 0x0, 0x0
.long 0x0, 0x0, 0x0, 0x0
.long 0x0, 0x0, 0x0, 0x0
.long 0x0, 0x0, 0x0, 0x0
.long 0x0, 0x0, 0x0, 0x0
.long 0x0, 0x0, 0x0, 0x0
.long 0x0, 0x0, 0x0, 0x0
.long 0x3c003c00, 0x3c003c00, 0x3c00, 0x0
.long 0x3c003c00, 0x3c003c00, 0x3c003c00, 0x0
.long 0x3c003c00, 0x3c003c00, 0x3c003c00, 0x3c00
.long 0x3c003c00, 0x3c003c00, 0x3c003c00, 0x3c003c00
.long 0x3c003c00, 0x3c003c00, 0x3c003c00, 0x3c003c00
.long 0x3c000000, 0x3c003c00, 0x3c003c00, 0x3c003c00
.long 0x0, 0x3c003c00, 0x3c003c00, 0x3c003c00
.long 0x0, 0x3c000000, 0x3c003c00, 0x3c003c00
.long 0x0, 0x0, 0x3c003c00, 0x3c003c00
.long 0x0, 0x0, 0x3c000000, 0x3c003c00
.long 0x0, 0x0, 0x0, 0x3c003c00
.long 0x0, 0x0, 0x0, 0x3c000000
.long 0x0, 0x0, 0x0, 0x0
.long 0x0, 0x0, 0x0, 0x0
.long 0x0, 0x0, 0x0, 0x0
.long 0x0, 0x0, 0x0, 0x0
.long 0x0, 0x0, 0x0, 0x0
.long 0x0, 0x0, 0x0, 0x0
.long 0x0, 0x0, 0x0, 0x0
.long 0x0, 0x0, 0x0, 0x0
.long 0x3c00, 0x0, 0x0, 0x0
.long 0x3c003c00, 0x0, 0x0, 0x0
.long 0x3c003c00, 0x3c00, 0x0, 0x0
.long 0x3c003c00, 0x3c003c00, 0x0, 0x0
.long 0x3c003c00, 0x3c003c00, 0x3c00, 0x0
.long 0x3c003c00, 0x3c003c00, 0x3c003c00, 0x0
.long 0x3c003c00, 0x3c003c00, 0x3c003c00, 0x3c00
.long 0x3c003c00, 0x3c003c00, 0x3c003c00, 0x3c003c00
.long 0x3c003c00, 0x3c003c00, 0x3c003c00, 0x3c003c00
.long 0x3c000000, 0x3c003c00, 0x3c003c00, 0x3c003c00
.long 0x0, 0x3c003c00, 0x3c003c00, 0x3c003c00
.long 0x0, 0x3c000000, 0x3c003c00, 0x3c003c00
.long 0x0, 0x0, 0x0, 0x0
.long 0x0, 0x0, 0x0, 0x0
.long 0x0, 0x0, 0x0, 0x0
.long 0x0, 0x0, 0x0, 0x0
.long 0x0, 0x0, 0x0, 0x0
.long 0x0, 0x0, 0x0, 0x0
.long 0x0, 0x0, 0x0, 0x0
.long 0x0, 0x0, 0x0, 0x0
.long 0x0, 0x0, 0x0, 0x0
.long 0x0, 0x0, 0x0, 0x0
.long 0x0, 0x0, 0x0, 0x0
.long 0x0, 0x0, 0x0, 0x0
.long 0x3c00, 0x0, 0x0, 0x0
.long 0x3c003c00, 0x0, 0x0, 0x0
.long 0x3c003c00, 0x3c00, 0x0, 0x0
.long 0x3c003c00, 0x3c003c00, 0x0, 0x0
.long 0x0, 0x0, 0x3c000000, 0x3c003c00
.long 0x0, 0x0, 0x0, 0x3c003c00
.long 0x0, 0x0, 0x0, 0x3c000000
.long 0x0, 0x0, 0x0, 0x0
.long 0x0, 0x0, 0x0, 0x0
.long 0x0, 0x0, 0x0, 0x0
.long 0x0, 0x0, 0x0, 0x0
.long 0x0, 0x0, 0x0, 0x0
.long 0x0, 0x0, 0x0, 0x0
.long 0x0, 0x0, 0x0, 0x0
.long 0x0, 0x0, 0x0, 0x0
.long 0x0, 0x0, 0x0, 0x0
.long 0x0, 0x0, 0x0, 0x0
.long 0x0, 0x0, 0x0, 0x0
.long 0x0, 0x0, 0x0, 0x0
.long 0x0, 0x0, 0x0, 0x0
.long 0x3c003c00, 0x3c003c00, 0x0, 0x0
.long 0x3c003c00, 0x3c003c00, 0x3c00, 0x0
.long 0x3c003c00, 0x3c003c00, 0x3c003c00, 0x0
.long 0x3c003c00, 0x3c003c00, 0x3c003c00, 0x3c00
.long 0x3c000000, 0x3c003c00, 0x3c003c00, 0x3c003c00
.long 0x0, 0x3c003c00, 0x3c003c00, 0x3c003c00
.long 0x0, 0x3c000000, 0x3c003c00, 0x3c003c00
.long 0x0, 0x0, 0x3c003c00, 0x3c003c00
.long 0x0, 0x0, 0x3c000000, 0x3c003c00
.long 0x0, 0x0, 0x0, 0x3c003c00
.long 0x0, 0x0, 0x0, 0x3c000000
.long 0x0, 0x0, 0x0, 0x0
.long 0x0, 0x0, 0x0, 0x0
.long 0x0, 0x0, 0x0, 0x0
.long 0x0, 0x0, 0x0, 0x0
.long 0x0, 0x0, 0x0, 0x0
.long 0x0, 0x0, 0x0, 0x0
.long 0x0, 0x0, 0x0, 0x0
.long 0x0, 0x0, 0x0, 0x0
.long 0x0, 0x0, 0x0, 0x0
.long 0x0, 0x0, 0x0, 0x0
.long 0x3c00, 0x0, 0x0, 0x0
.long 0x3c003c00, 0x0, 0x0, 0x0
.long 0x3c003c00, 0x3c00, 0x0, 0x0
.long 0x3c003c00, 0x3c003c00, 0x0, 0x0
.long 0x3c003c00, 0x3c003c00, 0x3c00, 0x0
.long 0x3c003c00, 0x3c003c00, 0x3c003c00, 0x0
.long 0x3c003c00, 0x3c003c00, 0x3c003c00, 0x3c00
.long 0x3c000000, 0x3c003c00, 0x3c003c00, 0x3c003c00
.long 0x0, 0x3c003c00, 0x3c003c00, 0x3c003c00
.long 0x0, 0x3c000000, 0x3c003c00, 0x3c003c00
.long 0x0, 0x0, 0x3c003c00, 0x3c003c00
.long 0x0, 0x0, 0x0, 0x0
.long 0x0, 0x0, 0x0, 0x0
.long 0x0, 0x0, 0x0, 0x0
.long 0x0, 0x0, 0x0, 0x0
.long 0x0, 0x0, 0x0, 0x0
.long 0x0, 0x0, 0x0, 0x0
.long 0x0, 0x0, 0x0, 0x0
.long 0x0, 0x0, 0x0, 0x0
.long 0x0, 0x0, 0x0, 0x0
.long 0x0, 0x0, 0x0, 0x0
.long 0x0, 0x0, 0x0, 0x0
.long 0x0, 0x0, 0x0, 0x0
.long 0x0, 0x0, 0x0, 0x0
.long 0x3c00, 0x0, 0x0, 0x0
.long 0x3c003c00, 0x0, 0x0, 0x0
.long 0x3c003c00, 0x3c00, 0x0, 0x0
.long 0x0, 0x0, 0x3c003c00, 0x3c003c00
.long 0x0, 0x0, 0x3c000000, 0x3c003c00
.long 0x0, 0x0, 0x0, 0x3c003c00
.long 0x0, 0x0, 0x0, 0x3c000000
.long 0x0, 0x0, 0x0, 0x0
.long 0x0, 0x0, 0x0, 0x0
.long 0x0, 0x0, 0x0, 0x0
.long 0x0, 0x0, 0x0, 0x0
.long 0x0, 0x0, 0x0, 0x0
.long 0x0, 0x0, 0x0, 0x0
.long 0x0, 0x0, 0x0, 0x0
.long 0x0, 0x0, 0x0, 0x0
.long 0x0, 0x0, 0x0, 0x0
.long 0x0, 0x0, 0x0, 0x0
.long 0x0, 0x0, 0x0, 0x0
.long 0x0, 0x0, 0x0, 0x0
.long 0x3c003c00, 0x3c00, 0x0, 0x0
.long 0x3c003c00, 0x3c003c00, 0x0, 0x0
.long 0x3c003c00, 0x3c003c00, 0x3c00, 0x0
.long 0x3c003c00, 0x3c003c00, 0x3c003c00, 0x0
.long 0x3c003c00, 0x3c003c00, 0x3c003c00, 0x3c00
.long 0x3c000000, 0x3c003c00, 0x3c003c00, 0x3c003c00
.long 0x0, 0x3c003c00, 0x3c003c00, 0x3c003c00
.long 0x0, 0x3c000000, 0x3c003c00, 0x3c003c00
.long 0x0, 0x0, 0x3c003c00, 0x3c003c00
.long 0x0, 0x0, 0x3c000000, 0x3c003c00
.long 0x0, 0x0, 0x0, 0x3c003c00
.long 0x0, 0x0, 0x0, 0x3c000000
.long 0x0, 0x0, 0x0, 0x0
.long 0x0, 0x0, 0x0, 0x0
.long 0x0, 0x0, 0x0, 0x0
.long 0x0, 0x0, 0x0, 0x0
.long 0x0, 0x0, 0x0, 0x0
.long 0x0, 0x0, 0x0, 0x0
.long 0x0, 0x0, 0x0, 0x0
.long 0x0, 0x0, 0x0, 0x0
.long 0x0, 0x0, 0x0, 0x0
.long 0x0, 0x0, 0x0, 0x0
.long 0x3c00, 0x0, 0x0, 0x0
.long 0x3c003c00, 0x0, 0x0, 0x0
.long 0x3c003c00, 0x3c00, 0x0, 0x0
.long 0x3c003c00, 0x3c003c00, 0x0, 0x0
.long 0x3c003c00, 0x3c003c00, 0x3c00, 0x0
.long 0x3c003c00, 0x3c003c00, 0x3c003c00, 0x0
.long 0x3c003c00, 0x3c003c00, 0x3c003c00, 0x3c00
.long 0x3c000000, 0x3c003c00, 0x3c003c00, 0x3c003c00
.long 0x0, 0x3c003c00, 0x3c003c00, 0x3c003c00
.long 0x0, 0x3c000000, 0x3c003c00, 0x3c003c00
.long 0x0, 0x0, 0x0, 0x0
.long 0x0, 0x0, 0x0, 0x0
.long 0x0, 0x0, 0x0, 0x0
.long 0x0, 0x0, 0x0, 0x0
.long 0x0, 0x0, 0x0, 0x0
.long 0x0, 0x0, 0x0, 0x0
.long 0x0, 0x0, 0x0, 0x0
.long 0x0, 0x0, 0x0, 0x0
.long 0x0, 0x0, 0x0, 0x0
.long 0x0, 0x0, 0x0, 0x0
.long 0x0, 0x0, 0x0, 0x0
.long 0x0, 0x0, 0x0, 0x0
.long 0x0, 0x0, 0x0, 0x0
.long 0x0, 0x0, 0x0, 0x0
.long 0x3c00, 0x0, 0x0, 0x0
.long 0x3c003c00, 0x0, 0x0, 0x0

.section .rodata,"a"
.p2align 6
.amdhsa_kernel recurrent_scan__ssm_conv_s4d__moe_arch_mod__prompt_kernel
  .amdhsa_next_free_vgpr 128
  .amdhsa_next_free_sgpr 96
  .amdhsa_accum_offset 128
  .amdhsa_group_segment_fixed_size 0
  .amdhsa_kernarg_size 120
  .amdhsa_user_sgpr_count 2
  .amdhsa_user_sgpr_kernarg_segment_ptr 1
  .amdhsa_system_sgpr_workgroup_id_x 1
.end_amdhsa_kernel
```

```asm
; @launch grid=(256,1,1) block=(1024,1,1) lds=152064
.amdgcn_target "amdgcn-amd-amdhsa--gfx950"
.text
.p2align 8
.globl recurrent_scan__ssm_conv_s4d__moe_arch_mod__prompt_kernel
.type recurrent_scan__ssm_conv_s4d__moe_arch_mod__prompt_kernel,@function
recurrent_scan__ssm_conv_s4d__moe_arch_mod__prompt_kernel:
  s_cmp_ge_u32 s2, 256
  s_cbranch_scc1 K_END
  s_load_dwordx2 s[44:45], s[0:1], 0
  s_load_dwordx16 s[4:19], s[0:1], 8
  s_load_dwordx8 s[20:27], s[0:1], 72
  s_load_dwordx4 s[40:43], s[0:1], 104
  v_readfirstlane_b32 s30, v0
  v_and_b32 v1, 63, v0
  s_and_b32 s28, s2, 7
  s_lshr_b32 s29, s2, 3
  s_mov_b32 s31, 0xffff0000
  s_mov_b32 s58, 0x3fb8aa3b
  s_lshr_b32 s30, s30, 6
  s_cmp_ge_u32 s30, 8
  s_cbranch_scc1 K_C
  v_lshlrev_b32 v97, 4, v1
  v_lshrrev_b32 v2, 4, v1
  v_and_b32 v3, 15, v1
  v_lshlrev_b32 v5, 4, v3
  s_setprio 3
  s_getpc_b64 s[48:49]
K_PC:
  s_cmp_lg_u32 s30, 0
  s_cbranch_scc1 K_NOPF
  s_lshl_b32 s50, s29, 10
  s_min_u32 s50, s50, K_END - K_PC - 1024
  s_add_u32 s50, s50, s48
  s_addc_u32 s51, s49, 0
  global_load_dwordx4 v[32:35], v97, s[50:51]
K_NOPF:
  s_lshr_b32 s3, s29, 3
  s_lshl_b32 s3, s3, 5
  s_and_b32 s63, s29, 7
  s_add_u32 s3, s3, s63
  s_lshl_b32 s63, s28, 7
  s_add_u32 s3, s3, s63
  v_lshl_add_u32 v4, v2, 12, v5
  v_lshl_add_u32 v120, v2, 11, v5
  s_lshl_b32 s60, s29, 3
  s_add_u32 s60, s60, s30
  s_lshl_b32 s61, s60, 14
  s_lshl_b32 s62, s28, 8
  s_add_u32 s61, s61, s62
  v_add_u32 v6, s62, v5
  v_mov_b32 v126, 0
  v_mov_b32 v127, 1
  v_lshlrev_b32 v7, 2, v1
  ds_write2st64_b32 v7, v126, v126 offset0:0 offset1:2
  s_mov_b32 s38, 0x400000
  s_mov_b32 s39, 0x00020000
  s_lshl_b32 s63, s3, 8
  v_add_u32 v7, s63, v120
  s_lshl_b32 s3, s3, 1
  s_and_b32 s3, s3, -64
  s_mov_b32 m0, 77824
  s_cmp_lg_u32 s30, 0
  s_waitcnt lgkmcnt(0)
  s_load_dword s46, s[42:43], 0x0
  s_mov_b32 s36, s44
  s_mov_b32 s37, s45
  s_cbranch_scc1 K_NOPRM
  global_load_lds_dwordx4 v7, s[4:5]
  s_mov_b32 m0, 78848
  s_load_dword s47, s[12:13], s3
  global_load_lds_dwordx4 v7, s[6:7]
  s_mov_b32 m0, 79872
  s_nop 0
  global_load_lds_dwordx4 v7, s[8:9]
  s_mov_b32 m0, 80896
  s_nop 0
  global_load_lds_dwordx4 v7, s[10:11]
K_NOPRM:
  s_cmp_lg_u32 s30, 1
  s_cbranch_scc1 K_NOSM
  global_load_dwordx4 v[48:51], v97, s[18:19]
  global_load_dwordx4 v[52:55], v97, s[18:19] offset:1024
K_NOSM:
  buffer_load_dwordx4 v[8:11], v4, s[36:39], s61 offen
  buffer_load_dwordx4 v[12:15], v4, s[36:39], s61 offen offset:2048
  global_load_dwordx4 v[16:19], v6, s[18:19]
  global_load_dwordx4 v[20:23], v6, s[14:15]
  s_barrier
  s_mov_b32 s32, s42
  s_mov_b32 s33, s43
  s_mov_b32 s34, 0x800000
  s_mov_b32 s35, 0x00020000
  v_lshlrev_b32 v95, 1, v1
  s_lshl_b32 s63, s29, 13
  s_lshl_b32 s73, s30, 7
  s_add_u32 s63, s63, s73
  s_add_u32 s63, s63, 0x400000
  s_lshl_b32 s73, s28, 10
  s_add_u32 s57, s73, 0x441000
  s_add_u32 s73, s73, s63
  s_add_u32 s74, s62, 0x440000
  s_getreg_b32 s56, hwreg(HW_REG_XCC_ID)
  v_mov_b32 v124, 0xffff0000
  s_mov_b32 s8, 0x0000bf80
  s_mov_b32 s9, 0xbf800000
  v_mov_b32 v84, 0
  v_mov_b32 v85, 0
  s_waitcnt lgkmcnt(0)
  s_add_u32 s46, s46, 0x9e3779b9
  v_mov_b32 v91, s46
  s_cmp_lg_u32 s30, 0
  s_cbranch_scc1 K_NOPS
  s_mov_b64 exec, 1
  ds_write_b32 v126, v91 offset:0
  s_waitcnt vmcnt(4)
  ds_add_u32 v126, v127 offset:12
  s_mov_b64 exec, -1
K_NOPS:
  s_waitcnt vmcnt(3)
  v_and_b32_dpp v26, v8, v124 row_newbcast:0 row_mask:0xf bank_mask:0xf
  v_dot2_f32_bf16 v32, v8, s8, v26
  v_dot2_f32_bf16 v34, v8, s9, v26
  v_dot2_f32_bf16 v36, v9, s8, v26
  v_dot2_f32_bf16 v38, v9, s9, v26
  v_dot2_f32_bf16 v40, v10, s8, v26
  v_dot2_f32_bf16 v42, v10, s9, v26
  v_dot2_f32_bf16 v44, v11, s8, v26
  v_dot2_f32_bf16 v46, v11, s9, v26
  s_waitcnt vmcnt(2)
  v_and_b32_dpp v27, v12, v124 row_newbcast:0 row_mask:0xf bank_mask:0xf
  v_dot2_f32_bf16 v33, v12, s8, v27
  v_dot2_f32_bf16 v35, v12, s9, v27
  v_dot2_f32_bf16 v37, v13, s8, v27
  v_dot2_f32_bf16 v39, v13, s9, v27
  v_dot2_f32_bf16 v41, v14, s8, v27
  v_dot2_f32_bf16 v43, v14, s9, v27
  v_dot2_f32_bf16 v45, v15, s8, v27
  v_dot2_f32_bf16 v47, v15, s9, v27
  s_waitcnt vmcnt(1)
  v_pk_add_f32 v[28:29], v[32:33], v[34:35]
  v_pk_mul_f32 v[30:31], v[32:33], v[32:33]
  v_dot2c_f32_bf16 v84, v8, v16
  v_pk_add_f32 v[80:81], v[36:37], v[38:39]
  v_pk_mul_f32 v[82:83], v[34:35], v[34:35]
  v_dot2c_f32_bf16 v85, v12, v16
  v_pk_fma_f32 v[30:31], v[36:37], v[36:37], v[30:31]
  v_dot2c_f32_bf16 v84, v9, v17
  v_pk_fma_f32 v[82:83], v[38:39], v[38:39], v[82:83]
  v_dot2c_f32_bf16 v85, v13, v17
  v_pk_fma_f32 v[30:31], v[40:41], v[40:41], v[30:31]
  v_dot2c_f32_bf16 v84, v10, v18
  v_pk_add_f32 v[28:29], v[28:29], v[40:41]
  v_pk_fma_f32 v[82:83], v[42:43], v[42:43], v[82:83]
  v_dot2c_f32_bf16 v85, v14, v18
  v_pk_add_f32 v[80:81], v[80:81], v[42:43]
  v_pk_fma_f32 v[30:31], v[44:45], v[44:45], v[30:31]
  v_dot2c_f32_bf16 v84, v11, v19
  v_pk_add_f32 v[28:29], v[28:29], v[44:45]
  v_pk_fma_f32 v[82:83], v[46:47], v[46:47], v[82:83]
  v_dot2c_f32_bf16 v85, v15, v19
  v_pk_add_f32 v[80:81], v[80:81], v[46:47]
  v_pk_add_f32 v[30:31], v[30:31], v[82:83]
  v_mov_b32 v86, v26
  v_pk_add_f32 v[28:29], v[28:29], v[80:81]
  v_add_f32_dpp v90, v84, v84 row_ror:8 row_mask:0xf bank_mask:0x3
  v_add_f32_dpp v89, v30, v30 row_ror:8 row_mask:0xf bank_mask:0x3
  v_add_f32_dpp v88, v28, v28 row_ror:8 row_mask:0xf bank_mask:0x3
  v_add_f32_dpp v90, v85, v85 row_ror:8 row_mask:0xf bank_mask:0xc
  v_add_f32_dpp v89, v31, v31 row_ror:8 row_mask:0xf bank_mask:0xc
  v_add_f32_dpp v88, v29, v29 row_ror:8 row_mask:0xf bank_mask:0xc
  v_mov_b32_dpp v86, v27 quad_perm:[0,1,2,3] row_mask:0xf bank_mask:0xc
  s_nop 0
  v_add_f32_dpp v88, v88, v88 row_half_mirror row_mask:0xf bank_mask:0xf
  v_add_f32_dpp v90, v90, v90 row_half_mirror row_mask:0xf bank_mask:0xf
  v_add_f32_dpp v89, v89, v89 row_half_mirror row_mask:0xf bank_mask:0xf
  v_add_f32_dpp v88, v88, v88 quad_perm:[1,0,3,2] row_mask:0xf bank_mask:0xf
  v_add_f32_dpp v90, v90, v90 quad_perm:[1,0,3,2] row_mask:0xf bank_mask:0xf
  v_add_f32_dpp v89, v89, v89 quad_perm:[1,0,3,2] row_mask:0xf bank_mask:0xf
  v_add_f32_dpp v88, v88, v88 quad_perm:[2,3,0,1] row_mask:0xf bank_mask:0xf
  v_add_f32_dpp v90, v90, v90 quad_perm:[2,3,0,1] row_mask:0xf bank_mask:0xf
  v_add_f32_dpp v89, v89, v89 quad_perm:[2,3,0,1] row_mask:0xf bank_mask:0xf
  v_mul_f32 v87, 0x3c000000, v88
  s_mov_b32 exec_lo, 0x01010101
  s_mov_b32 exec_hi, 0x01010101
  v_fma_f32 v89, -v87, v88, v89
  v_sub_f32 v88, v86, v87
  buffer_store_dwordx4 v[88:91], v95, s[32:35], s73 offen sc1
  s_mov_b64 exec, -1
  s_setprio 0
  s_cmp_lg_u32 s30, 1
  s_cbranch_scc1 K_NOSW
  v_mov_b32 v56, 0
  v_dot2c_f32_bf16 v56, 0x3f803f80, v48
  v_dot2c_f32_bf16 v56, 0x3f803f80, v49
  v_dot2c_f32_bf16 v56, 0x3f803f80, v50
  v_dot2c_f32_bf16 v56, 0x3f803f80, v51
  v_dot2c_f32_bf16 v56, 0x3f803f80, v52
  v_dot2c_f32_bf16 v56, 0x3f803f80, v53
  v_dot2c_f32_bf16 v56, 0x3f803f80, v54
  v_dot2c_f32_bf16 v56, 0x3f803f80, v55
  s_nop 2
  v_add_f32_dpp v56, v56, v56 quad_perm:[1,0,3,2] row_mask:0xf bank_mask:0xf
  s_nop 1
  v_add_f32_dpp v56, v56, v56 quad_perm:[2,3,0,1] row_mask:0xf bank_mask:0xf
  s_nop 1
  v_add_f32_dpp v56, v56, v56 row_half_mirror row_mask:0xf bank_mask:0xf
  s_nop 1
  v_add_f32_dpp v56, v56, v56 row_mirror row_mask:0xf bank_mask:0xf
  s_nop 1
  v_add_f32_dpp v56, v56, v56 row_bcast:15 row_mask:0xa bank_mask:0xf
  s_nop 1
  v_add_f32_dpp v56, v56, v56 row_bcast:31 row_mask:0xc bank_mask:0xf
  v_or_b32 v56, 1, v56
  s_mov_b32 exec_lo, 0
  s_mov_b32 exec_hi, 0x80000000
  ds_write_b32 v126, v56 offset:4
  s_mov_b64 exec, -1
K_NOSW:
  s_setprio 0
  s_mov_b32 s64, s20
  s_mov_b32 s65, s21
  s_mov_b32 s66, 0x700000
  s_mov_b32 s67, 0x00020000
  s_mov_b32 s68, s22
  s_mov_b32 s69, s23
  s_mov_b32 s70, 0x700000
  s_mov_b32 s71, 0x00020000
  s_cmp_ge_u32 s29, 28
  s_cselect_b32 s66, 0, s66
  s_cselect_b32 s70, 0, s70
  v_lshlrev_b32 v24, 1, v2
  v_xor_b32 v24, v24, v3
  v_mul_u32_u24 v7, 7168, v2
  v_lshl_add_u32 v24, v24, 4, v7
  v_xor_b32 v25, 0x80, v24
  s_lshl_b32 s12, s28, 3
  s_add_u32 s12, s12, s30
  s_mul_i32 s12, s12, 114688
  s_lshl_b32 s13, s29, 8
  s_add_u32 s12, s12, s13
  s_add_u32 s13, s12, 28672
  s_add_u32 s14, s12, 57344
  s_add_u32 s15, s12, 86016
  s_lshl_b32 s16, s30, 12
  s_add_u32 s16, s16, 83968
  s_mov_b32 s40, s24
  s_mov_b32 s41, s25
  s_mov_b32 s42, 0x700000
  s_mov_b32 s43, 0x00020000
  s_mov_b32 s42, s66
  v_mul_u32_u24 v7, 5120, v2
  v_sub_u32 v118, v24, v7
  v_sub_u32 v119, v25, v7
  s_lshl_b32 s18, s60, 15
  s_add_u32 s18, s18, s62
  s_lshl_b32 s19, s30, 12
  s_mov_b32 s20, s26
  s_mov_b32 s21, s27
  s_mov_b32 s22, 0x400000
  s_mov_b32 s23, 0x00020000
  v_and_b32 v7, 3, v1
  v_mul_u32_u24 v121, 4640, v7
  v_lshlrev_b32 v96, 4, v7
  v_lshrrev_b32 v7, 2, v1
  v_lshl_add_u32 v121, v7, 4, v121
  v_lshl_add_u32 v96, v7, 14, v96
  s_lshl_b32 s78, s30, 9
  v_add_u32 v121, s78, v121
  s_lshl_b32 s75, s30, 19
  s_lshl_b32 s78, s28, 8
  s_add_u32 s75, s75, s78
  s_and_b32 s78, s29, 3
  s_lshl_b32 s78, s78, 12
  s_add_u32 s75, s75, s78
  s_and_b32 s78, s29, 4
  s_lshl_b32 s78, s78, 9
  s_add_u32 s75, s75, s78
  s_lshr_b32 s78, s29, 3
  s_lshl_b32 s78, s78, 6
  s_add_u32 s75, s75, s78
  s_add_u32 s76, s75, 0x40000
  v_and_b32 v92, 7, v1
  v_lshlrev_b32 v92, 10, v92
  v_lshrrev_b32 v7, 3, v1
  v_lshl_add_u32 v92, v7, 4, v92
  v_and_b32 v93, 31, v1
  v_lshlrev_b32 v93, 3, v93
  v_mov_b32 v122, 0x30003
  v_mov_b32 v125, 0x80000000
  s_mov_b32 s17, 0
  s_mov_b32 s4, 0x10002
  s_mov_b32 s5, 0x20001
  s_mov_b32 s6, 0x20002
  s_mov_b32 s7, 0x10001
  s_mov_b32 s83, 0x20000
  s_lshl_b32 s78, s60, 4
  v_lshl_add_u32 v6, v2, 2, s78
  v_lshrrev_b32 v7, 2, v1
  s_sub_u32 s78, 4094, s78
  v_sub_u32 v7, s78, v7
  s_lshl_b32 s78, s30, 6
  v_add_u32 v98, s78, v1
  s_max_u32 s78, s30, 3
  s_sub_u32 s78, s78, 3
  s_lshl_b32 s78, s78, 10
  s_add_u32 s79, s78, K_BAND - K_PC
  s_add_u32 s48, s48, s79
  s_addc_u32 s49, s49, 0
  s_add_u32 s50, s78, 72704
  s_setprio 3
  s_setprio 3
  s_waitcnt vmcnt(0)
  s_mov_b64 exec, 1
  ds_add_u32 v126, v127 offset:36
  s_mov_b64 exec, -1
  s_branch K_AWB
K_AW:
  s_sleep 1
K_AWB:
  ds_read_b32 v80, v126 offset:36
  s_waitcnt lgkmcnt(0)
  v_cmp_gt_u32 vcc, 8, v80
  s_cbranch_vccnz K_AW
  s_sleep 1
  buffer_load_dwordx4 v[88:91], v92, s[32:35], s63 offen sc1
  buffer_load_dwordx2 v[94:95], v93, s[32:35], s74 offen sc1
  s_mov_b32 m0, s50
  s_nop 0
  global_load_lds_dwordx4 v97, s[48:49]
  s_waitcnt vmcnt(2)
  s_branch K_P1C
K_P1:
  s_sleep 2
  buffer_load_dwordx4 v[88:91], v92, s[32:35], s63 offen sc1
  s_sub_u32 s83, s83, 1
  s_waitcnt vmcnt(0)
  s_cbranch_scc1 K_P1D
K_P1C:
  v_cmp_ne_u32 vcc, s46, v91
  s_cbranch_vccnz K_P1
K_P1D:
  ds_read_b32 v85, v126 offset:4
  s_max_i32 s83, s83, 0
  v_mov_b32_dpp v80, v88 row_newbcast:0 row_mask:0xf bank_mask:0x3
  s_nop 1
  v_mov_b32_dpp v80, v88 row_newbcast:8 row_mask:0xf bank_mask:0xc
  v_sub_f32 v88, v88, v80
  v_mul_f32 v81, 0x43000000, v88
  v_fmac_f32 v89, v81, v88
  v_add_f32_dpp v90, v90, v90 row_half_mirror row_mask:0xf bank_mask:0xf
  v_add_f32_dpp v88, v88, v88 row_half_mirror row_mask:0xf bank_mask:0xf
  v_add_f32_dpp v89, v89, v89 row_half_mirror row_mask:0xf bank_mask:0xf
  v_add_f32_dpp v90, v90, v90 quad_perm:[1,0,3,2] row_mask:0xf bank_mask:0xf
  v_add_f32_dpp v88, v88, v88 quad_perm:[1,0,3,2] row_mask:0xf bank_mask:0xf
  v_add_f32_dpp v89, v89, v89 quad_perm:[1,0,3,2] row_mask:0xf bank_mask:0xf
  v_add_f32_dpp v90, v90, v90 quad_perm:[2,3,0,1] row_mask:0xf bank_mask:0xf
  v_add_f32_dpp v88, v88, v88 quad_perm:[2,3,0,1] row_mask:0xf bank_mask:0xf
  v_add_f32_dpp v89, v89, v89 quad_perm:[2,3,0,1] row_mask:0xf bank_mask:0xf
  v_mul_f32 v81, 0x41800000, v88
  v_fmac_f32 v80, 0x3e000000, v88
  v_fma_f32 v89, -v81, v88, v89
  v_mul_f32 v89, 0x3a800000, v89
  v_max_f32 v89, 0, v89
  v_cvt_pk_bf16_f32 v81, v80, v89
  v_and_b32 v89, v124, v81
  v_lshlrev_b32 v80, 16, v81
  v_add_f32 v89, 0x3727c5ac, v89
  v_cvt_pk_bf16_f32 v89, 0, v89
  v_sub_f32 v86, v86, v80
  v_sqrt_f32 v89, v89
  s_waitcnt vmcnt(1)
  v_cmp_ne_u32 s[78:79], s46, v94
  v_cvt_pk_bf16_f32 v83, v80, v89
  v_and_b32 v89, v124, v83
  v_rcp_f32 v81, v89
  s_waitcnt lgkmcnt(0)
  v_cmp_eq_u32 vcc, 0, v85
  v_mul_f32 v86, v86, v81
  s_or_b64 vcc, vcc, s[78:79]
  s_cbranch_vccnz K_RARE
K_RB:
  v_cmp_ne_u32 vcc, s56, v95
  v_fma_f32 v82, -v80, v85, v90
  v_mov_b32_dpp v28, v81 row_newbcast:0 row_mask:0xf bank_mask:0xf
  v_mul_f32 v82, v82, v81
  v_mov_b32_dpp v29, v81 row_newbcast:8 row_mask:0xf bank_mask:0xf
  v_cvt_pk_bf16_f32 v82, v82, v82
  v_mov_b32_dpp v30, v86 row_newbcast:0 row_mask:0xf bank_mask:0xf
  v_ashrrev_i32 v81, 31, v82
  v_mov_b32_dpp v31, v86 row_newbcast:8 row_mask:0xf bank_mask:0xf
  v_bitop3_b32 v82, v82, v81, v125 bitop3:0x1e
  s_cmp_lg_u64 vcc, 0
  s_cselect_b32 s47, 1, 0
  v_and_or_b32 v82, v82, v124, v7
  v_mov_b32 v80, s47
  s_mov_b32 exec_lo, 0x01010101
  s_mov_b32 exec_hi, 0x01010101
  ds_write_b64 v98, v[82:83] offset:128
  s_mov_b64 exec, 1
  ds_write_b32 v126, v80 offset:8
  ds_add_u32 v126, v127 offset:20
  s_mov_b64 exec, -1
  v_pk_fma_f32 v[48:49], v[32:33], v[28:29], v[30:31] neg_lo:[1,0,0] neg_hi:[1,0,0]
  v_pk_fma_f32 v[50:51], v[34:35], v[28:29], v[30:31] neg_lo:[1,0,0] neg_hi:[1,0,0]
  v_pk_fma_f32 v[52:53], v[36:37], v[28:29], v[30:31] neg_lo:[1,0,0] neg_hi:[1,0,0]
  v_pk_fma_f32 v[54:55], v[38:39], v[28:29], v[30:31] neg_lo:[1,0,0] neg_hi:[1,0,0]
  v_pk_fma_f32 v[56:57], v[40:41], v[28:29], v[30:31] neg_lo:[1,0,0] neg_hi:[1,0,0]
  v_pk_fma_f32 v[58:59], v[42:43], v[28:29], v[30:31] neg_lo:[1,0,0] neg_hi:[1,0,0]
  v_pk_fma_f32 v[60:61], v[44:45], v[28:29], v[30:31] neg_lo:[1,0,0] neg_hi:[1,0,0]
  v_pk_fma_f32 v[62:63], v[46:47], v[28:29], v[30:31] neg_lo:[1,0,0] neg_hi:[1,0,0]
  v_cvt_pk_f16_f32 v64, v48, v49
  v_cvt_pk_f16_f32 v65, v50, v51
  v_cvt_pk_f16_f32 v66, v52, v53
  v_cvt_pk_f16_f32 v67, v54, v55
  v_cvt_pk_f16_f32 v68, v56, v57
  v_cvt_pk_f16_f32 v69, v58, v59
  v_cvt_pk_f16_f32 v70, v60, v61
  v_cvt_pk_f16_f32 v71, v62, v63
  v_permlane32_swap_b32 v64, v66
  v_permlane32_swap_b32 v65, v67
  v_permlane32_swap_b32 v68, v70
  v_permlane32_swap_b32 v69, v71
  v_permlane16_swap_b32 v64, v65
  v_permlane16_swap_b32 v66, v67
  v_permlane16_swap_b32 v68, v69
  v_permlane16_swap_b32 v70, v71
  v_bfi_b32 v64, v122, s4, v64
  v_bfi_b32 v65, v122, s5, v65
  v_bfi_b32 v66, v122, s6, v66
  v_bfi_b32 v67, v122, s7, v67
  v_bfi_b32 v68, v122, s4, v68
  v_bfi_b32 v69, v122, s5, v69
  v_bfi_b32 v70, v122, s6, v70
  v_bfi_b32 v71, v122, s7, v71
  s_cmp_lg_u32 s47, 0
  s_cbranch_scc1 K_US_W
  buffer_store_dwordx4 v[64:67], v4, s[20:23], s61 offen
  buffer_store_dwordx4 v[68:71], v4, s[20:23], s61 offen offset:2048
  s_branch K_US_D
K_US_W:
  buffer_store_dwordx4 v[64:67], v4, s[20:23], s61 offen sc1
  buffer_store_dwordx4 v[68:71], v4, s[20:23], s61 offen offset:2048 sc1
K_US_D:
  s_branch K_P2A
K_P2:
K_P2A:
  buffer_load_dwordx4 v[64:67], v96, s[20:23], s75 offen sc1
  buffer_load_dwordx4 v[68:71], v96, s[20:23], s76 offen sc1
  s_cmp_lg_u32 s17, 0
  s_cbranch_scc1 K_E2
  s_setprio 0
  v_pk_mul_f32 v[8:9], v[48:49], s[58:59] op_sel_hi:[1,0]
  v_pk_mul_f32 v[10:11], v[50:51], s[58:59] op_sel_hi:[1,0]
  v_pk_mul_f32 v[12:13], v[52:53], s[58:59] op_sel_hi:[1,0]
  v_pk_mul_f32 v[14:15], v[54:55], s[58:59] op_sel_hi:[1,0]
  v_exp_f32 v8, -v8
  v_lshlrev_b32 v100, 16, v20
  v_exp_f32 v9, -v9
  v_pk_add_f32 v[32:33], v[26:27], v[32:33] neg_lo:[0,1] neg_hi:[0,1]
  v_exp_f32 v10, -v10
  v_and_b32 v102, 0xffff0000, v20
  v_exp_f32 v11, -v11
  v_pk_add_f32 v[34:35], v[26:27], v[34:35] neg_lo:[0,1] neg_hi:[0,1]
  v_exp_f32 v12, -v12
  v_lshlrev_b32 v104, 16, v21
  v_exp_f32 v13, -v13
  v_pk_add_f32 v[36:37], v[26:27], v[36:37] neg_lo:[0,1] neg_hi:[0,1]
  v_exp_f32 v14, -v14
  v_and_b32 v106, 0xffff0000, v21
  v_exp_f32 v15, -v15
  v_pk_add_f32 v[38:39], v[26:27], v[38:39] neg_lo:[0,1] neg_hi:[0,1]
  v_pk_add_f32 v[8:9], v[8:9], 1.0 op_sel_hi:[1,0]
  v_pk_add_f32 v[10:11], v[10:11], 1.0 op_sel_hi:[1,0]
  v_pk_add_f32 v[12:13], v[12:13], 1.0 op_sel_hi:[1,0]
  v_pk_add_f32 v[14:15], v[14:15], 1.0 op_sel_hi:[1,0]
  v_rcp_f32 v8, v8
  v_pk_mul_f32 v[100:101], v[48:49], v[100:101] op_sel_hi:[1,0]
  v_rcp_f32 v9, v9
  v_rcp_f32 v10, v10
  v_pk_mul_f32 v[102:103], v[50:51], v[102:103] op_sel_hi:[1,0]
  v_rcp_f32 v11, v11
  v_rcp_f32 v12, v12
  v_pk_mul_f32 v[104:105], v[52:53], v[104:105] op_sel_hi:[1,0]
  v_rcp_f32 v13, v13
  v_rcp_f32 v14, v14
  v_pk_mul_f32 v[106:107], v[54:55], v[106:107] op_sel_hi:[1,0]
  v_rcp_f32 v15, v15
  v_pk_mul_f32 v[8:9], v[8:9], v[48:49]
  v_pk_mul_f32 v[10:11], v[10:11], v[50:51]
  v_pk_mul_f32 v[12:13], v[12:13], v[52:53]
  v_pk_mul_f32 v[14:15], v[14:15], v[54:55]
  v_pk_fma_f32 v[32:33], v[100:101], v[8:9], v[32:33]
  v_cvt_pk_bf16_f32 v48, v8, 0
  v_cvt_pk_bf16_f32 v49, 0, v9
  v_pk_fma_f32 v[34:35], v[102:103], v[10:11], v[34:35]
  v_cvt_pk_bf16_f32 v50, v10, 0
  v_cvt_pk_bf16_f32 v51, 0, v11
  v_pk_fma_f32 v[36:37], v[104:105], v[12:13], v[36:37]
  v_cvt_pk_bf16_f32 v52, v12, 0
  v_cvt_pk_bf16_f32 v53, 0, v13
  v_pk_fma_f32 v[38:39], v[106:107], v[14:15], v[38:39]
  v_cvt_pk_bf16_f32 v54, v14, 0
  v_cvt_pk_bf16_f32 v55, 0, v15
  s_mov_b32 s17, 1
  s_setprio 3
K_E2:
  s_sub_u32 s83, s83, 1
  s_waitcnt vmcnt(0)
  v_bitop3_b32 v80, v64, v68, s4 bitop3:0x7e
  v_bitop3_b32 v81, v65, v69, s5 bitop3:0x7e
  v_bitop3_b32 v82, v66, v70, s6 bitop3:0x7e
  v_bitop3_b32 v83, v67, v71, s7 bitop3:0x7e
  s_cbranch_scc1 K_P2D
  v_or3_b32 v80, v80, v81, v82
  v_bitop3_b32 v80, v80, v83, v122 bitop3:0xa8
  v_cmp_ne_u32 vcc, 0, v80
  s_cbranch_vccnz K_P2
K_P2D:
  ds_write_b128 v121, v[64:67] offset:1312
  ds_write_b128 v121, v[68:71] offset:1568
  s_max_i32 s83, s83, 0
  s_mov_b64 exec, 1
  ds_add_u32 v126, v127 offset:16
  s_mov_b64 exec, -1
  s_setprio 0
  s_cmp_ge_u32 s29, 28
  s_cbranch_scc1 K_NOTL
  s_branch K_UGB
K_UG:
  s_sleep 2
K_UGB:
  ds_read_b32 v64, v126 offset:16
  s_waitcnt lgkmcnt(0)
  v_cmp_gt_u32 vcc, 8, v64
  s_cbranch_vccnz K_UG
  s_setprio 3
  s_add_u32 m0, s16, 34816
  s_nop 0
  buffer_load_dwordx4 v25, s[68:71], s14 offen nt lds
  s_add_u32 m0, s16, 3072
  s_nop 0
  buffer_load_dwordx4 v25, s[64:67], s15 offen nt lds
  s_add_u32 m0, s16, 35840
  s_nop 0
  buffer_load_dwordx4 v25, s[68:71], s15 offen nt lds
  s_waitcnt vmcnt(1)
  s_branch K_HGB
K_HG:
  s_sleep 2
K_HGB:
  ds_read_b32 v64, v126 offset:16
  ds_read2_b32 v[66:67], v126 offset0:28 offset1:30
  s_waitcnt lgkmcnt(0)
  v_add3_u32 v64, v64, v66, v67
  v_cmp_gt_u32 vcc, 17, v64
  s_cbranch_vccnz K_HG
  s_add_u32 m0, s19, 19328
  s_nop 0
  buffer_load_dwordx4 v118, s[40:43], s18 offen nt lds
  s_add_u32 s18, s18, 8192
  s_add_u32 m0, s19, 20352
  s_nop 0
  buffer_load_dwordx4 v118, s[40:43], s18 offen nt lds
  s_add_u32 s18, s18, 8192
  s_add_u32 m0, s19, 21376
  s_nop 0
  buffer_load_dwordx4 v119, s[40:43], s18 offen nt lds
  s_add_u32 s18, s18, 8192
  s_add_u32 m0, s19, 22400
  s_nop 0
  buffer_load_dwordx4 v119, s[40:43], s18 offen nt lds
  s_mov_b64 exec, 1
  s_waitcnt vmcnt(4)
  ds_add_u32 v126, v127 offset:24
  s_waitcnt vmcnt(0)
  ds_add_u32 v126, v127 offset:124
  s_mov_b64 exec, -1
  s_setprio 0
  s_branch K_TLD
K_NOTL:
  s_branch K_TLB
K_TL:
  s_sleep 8
K_TLB:
  ds_read_b32 v64, v126 offset:120
  s_waitcnt lgkmcnt(0)
  v_cmp_eq_u32 vcc, 0, v64
  s_cbranch_vccnz K_TL
K_TLD:
  ds_read_b128 v[92:95], v126 offset:96
  s_waitcnt lgkmcnt(0)
  v_readfirstlane_b32 s6, v92
  v_readfirstlane_b32 s7, v94
  s_andn2_b32 s6, 0xffe, s6
  s_andn2_b32 s7, 0xffe, s7
  s_lshr_b32 s77, s6, 4
  s_lshr_b32 s79, s7, 4
  v_cmp_ne_u32 s[52:53], s6, v6
  v_cmp_ne_u32 vcc, s7, v6
  v_add_u32 v6, 2, v6
  s_and_b64 s[52:53], s[52:53], vcc
  v_cmp_ne_u32 s[54:55], s6, v6
  v_cmp_ne_u32 vcc, s7, v6
  s_nop 0
  s_and_b64 s[54:55], s[54:55], vcc
  s_cmp_eq_u32 s77, s60
  s_cselect_b32 s77, 0x55555555, 0
  s_cmp_eq_u32 s79, s60
  s_cselect_b32 s79, 0xaaaaaaaa, 0
  s_or_b32 s77, s77, s79
  v_and_b32 v64, 3, v1
  v_mul_u32_u24 v64, 544, v64
  v_sub_u32 v121, v121, v64
  s_and_b32 s78, s30, 3
  s_lshl_b32 s78, s78, 2
  s_lshr_b32 s78, 0xc480, s78
  s_and_b32 s78, s78, 15
  v_mov_b32 v123, s78
  s_or_b32 s78, s30, 3
  s_add_u32 s78, s78, 1
  s_branch K_HW4B
K_HW4:
  s_sleep 6
K_HW4B:
  ds_read_b32 v64, v123 offset:48
  s_waitcnt lgkmcnt(0)
  v_cmp_gt_u32 vcc, 4, v64
  s_cbranch_vccnz K_HW4
  v_cmp_le_u32 vcc, s78, v64
  s_cbranch_vccnz K_YWB
  s_sleep 6
  s_setprio 3
  s_branch K_YWB
K_YW:
  s_sleep 1
K_YWB:
  ds_read_b128 v[64:67], v126 offset:48
  s_waitcnt lgkmcnt(0)
  v_min_u32 v64, v64, v65
  v_min3_u32 v64, v64, v66, v67
  v_cmp_gt_u32 vcc, s78, v64
  s_cbranch_vccnz K_YW
  ds_read_b128 v[64:67], v121 offset:56320
  ds_read_b128 v[68:71], v121 offset:56576
  s_setprio 3
  s_waitcnt lgkmcnt(1)
  v_xor_b32 v72, 0x10002, v64
  v_bitop3_b32 v72, v72, v65, s5 bitop3:0xf6
  v_and_b32 v72, v122, v72
  v_cmp_eq_u32 vcc, 0, v72
  s_nop 1
  v_addc_co_u32 v64, vcc, 0, v64, vcc
  s_waitcnt lgkmcnt(0)
  v_xor_b32 v72, 0x10002, v68
  v_bitop3_b32 v72, v72, v69, s5 bitop3:0xf6
  v_and_b32 v72, v122, v72
  v_cmp_eq_u32 vcc, 0, v72
  s_nop 1
  v_addc_co_u32 v68, vcc, 0, v68, vcc
  s_cmp_lg_u32 s47, 0
  s_cbranch_scc1 K_YS_W
  buffer_store_dwordx4 v[64:67], v96, s[20:23], s75 offen
  buffer_store_dwordx4 v[68:71], v96, s[20:23], s76 offen
  s_branch K_YS_D
K_YS_W:
  buffer_store_dwordx4 v[64:67], v96, s[20:23], s75 offen sc1
  buffer_store_dwordx4 v[68:71], v96, s[20:23], s76 offen sc1
K_YS_D:
  s_setprio 0
  s_cmp_eq_u32 s77, 0
  s_cbranch_scc1 K_NOOWN
  v_mul_f32 v9, 0x3fb8aa3b, v57
  v_mul_f32 v8, 0x3fb8aa3b, v56
  v_mul_f32 v11, 0x3fb8aa3b, v59
  v_mul_f32 v10, 0x3fb8aa3b, v58
  v_mul_f32 v13, 0x3fb8aa3b, v61
  v_mul_f32 v12, 0x3fb8aa3b, v60
  v_mul_f32 v15, 0x3fb8aa3b, v63
  v_mul_f32 v14, 0x3fb8aa3b, v62
  v_exp_f32 v8, -v8
  v_lshlrev_b32 v100, 16, v22
  v_exp_f32 v9, -v9
  v_sub_f32 v41, v27, v41
  v_sub_f32 v40, v26, v40
  v_exp_f32 v10, -v10
  v_and_b32 v102, 0xffff0000, v22
  v_exp_f32 v11, -v11
  v_sub_f32 v43, v27, v43
  v_sub_f32 v42, v26, v42
  v_exp_f32 v12, -v12
  v_lshlrev_b32 v104, 16, v23
  v_exp_f32 v13, -v13
  v_sub_f32 v45, v27, v45
  v_sub_f32 v44, v26, v44
  v_exp_f32 v14, -v14
  v_and_b32 v106, 0xffff0000, v23
  v_exp_f32 v15, -v15
  v_sub_f32 v47, v27, v47
  v_sub_f32 v46, v26, v46
  v_add_f32 v9, 1.0, v9
  v_add_f32 v8, 1.0, v8
  v_add_f32 v11, 1.0, v11
  v_add_f32 v10, 1.0, v10
  v_add_f32 v13, 1.0, v13
  v_add_f32 v12, 1.0, v12
  v_add_f32 v15, 1.0, v15
  v_add_f32 v14, 1.0, v14
  v_rcp_f32 v8, v8
  v_mul_f32 v101, v57, v100
  v_mul_f32 v100, v56, v100
  v_rcp_f32 v9, v9
  v_rcp_f32 v10, v10
  v_mul_f32 v103, v59, v102
  v_mul_f32 v102, v58, v102
  v_rcp_f32 v11, v11
  v_rcp_f32 v12, v12
  v_mul_f32 v105, v61, v104
  v_mul_f32 v104, v60, v104
  v_rcp_f32 v13, v13
  v_rcp_f32 v14, v14
  v_mul_f32 v107, v63, v106
  v_mul_f32 v106, v62, v106
  v_rcp_f32 v15, v15
  v_mul_f32 v9, v9, v57
  v_mul_f32 v8, v8, v56
  v_mul_f32 v11, v11, v59
  v_mul_f32 v10, v10, v58
  v_mul_f32 v13, v13, v61
  v_mul_f32 v12, v12, v60
  v_mul_f32 v15, v15, v63
  v_mul_f32 v14, v14, v62
  v_fma_f32 v41, v101, v9, v41
  v_fma_f32 v40, v100, v8, v40
  v_cvt_pk_bf16_f32 v56, v8, 0
  v_cvt_pk_bf16_f32 v57, 0, v9
  v_fma_f32 v43, v103, v11, v43
  v_fma_f32 v42, v102, v10, v42
  v_cvt_pk_bf16_f32 v58, v10, 0
  v_cvt_pk_bf16_f32 v59, 0, v11
  v_fma_f32 v45, v105, v13, v45
  v_fma_f32 v44, v104, v12, v44
  v_cvt_pk_bf16_f32 v60, v12, 0
  v_cvt_pk_bf16_f32 v61, 0, v13
  v_fma_f32 v47, v107, v15, v47
  v_fma_f32 v46, v106, v14, v46
  v_cvt_pk_bf16_f32 v62, v14, 0
  v_cvt_pk_bf16_f32 v63, 0, v15
  s_setprio 3
K_PO:
  s_sleep 1
  buffer_load_dwordx4 v[72:75], v4, s[20:23], s61 offen sc1
  buffer_load_dwordx4 v[76:79], v4, s[20:23], s61 offen offset:2048 sc1
  s_sub_u32 s83, s83, 1
  s_waitcnt vmcnt(0)
  s_cbranch_scc1 K_POD
  v_xor_b32 v64, s4, v72
  v_xor_b32 v65, s4, v76
  v_bitop3_b32 v64, v64, v73, s5 bitop3:0xf6
  v_bitop3_b32 v65, v65, v77, s5 bitop3:0xf6
  v_and_b32 v64, v122, v64
  v_and_b32 v65, v122, v65
  v_min_u32 v64, v64, v65
  v_cmp_eq_u32 vcc, 0, v64
  s_cbranch_vccnz K_PO
K_POD:
  v_mov_b32 v64, 0
  v_mov_b32 v65, 0
  v_mov_b32 v66, s46
  v_lshlrev_b32 v67, 5, v1
  s_mov_b32 exec_lo, s77
  s_mov_b32 exec_hi, s77
  s_lshl_b32 s78, s28, 16
  s_add_u32 s78, s78, 0x50e000
  s_cmp_lg_u32 s47, 0
  s_cbranch_scc1 K_OS_W
  buffer_store_dwordx3 v[64:66], v67, s[32:35], s78 offen
  s_branch K_OS_D
K_OS_W:
  buffer_store_dwordx3 v[64:66], v67, s[32:35], s78 offen sc1
K_OS_D:
  s_mov_b64 exec, -1
  s_branch K_PYD
K_NOOWN:
  s_branch K_DWB
K_DW:
  s_sleep 3
K_DWB:
  ds_read_b32 v64, v123 offset:48
  s_waitcnt lgkmcnt(0)
  v_cmp_gt_u32 vcc, 8, v64
  s_cbranch_vccnz K_DW
  s_setprio 2
  buffer_load_dwordx4 v[72:75], v4, s[20:23], s61 offen sc1
  buffer_load_dwordx4 v[76:79], v4, s[20:23], s61 offen offset:2048 sc1
  v_pk_mul_f32 v[8:9], v[56:57], s[58:59] op_sel_hi:[1,0]
  v_pk_mul_f32 v[10:11], v[58:59], s[58:59] op_sel_hi:[1,0]
  v_pk_mul_f32 v[12:13], v[60:61], s[58:59] op_sel_hi:[1,0]
  v_pk_mul_f32 v[14:15], v[62:63], s[58:59] op_sel_hi:[1,0]
  v_exp_f32 v8, -v8
  v_lshlrev_b32 v100, 16, v22
  v_exp_f32 v9, -v9
  v_pk_add_f32 v[40:41], v[26:27], v[40:41] neg_lo:[0,1] neg_hi:[0,1]
  v_exp_f32 v10, -v10
  v_and_b32 v102, 0xffff0000, v22
  v_exp_f32 v11, -v11
  v_pk_add_f32 v[42:43], v[26:27], v[42:43] neg_lo:[0,1] neg_hi:[0,1]
  v_exp_f32 v12, -v12
  v_lshlrev_b32 v104, 16, v23
  v_exp_f32 v13, -v13
  v_pk_add_f32 v[44:45], v[26:27], v[44:45] neg_lo:[0,1] neg_hi:[0,1]
  v_exp_f32 v14, -v14
  v_and_b32 v106, 0xffff0000, v23
  v_exp_f32 v15, -v15
  v_pk_add_f32 v[46:47], v[26:27], v[46:47] neg_lo:[0,1] neg_hi:[0,1]
  v_pk_add_f32 v[8:9], v[8:9], 1.0 op_sel_hi:[1,0]
  v_pk_add_f32 v[10:11], v[10:11], 1.0 op_sel_hi:[1,0]
  v_pk_add_f32 v[12:13], v[12:13], 1.0 op_sel_hi:[1,0]
  v_pk_add_f32 v[14:15], v[14:15], 1.0 op_sel_hi:[1,0]
  v_rcp_f32 v8, v8
  v_pk_mul_f32 v[100:101], v[56:57], v[100:101] op_sel_hi:[1,0]
  v_rcp_f32 v9, v9
  v_rcp_f32 v10, v10
  v_pk_mul_f32 v[102:103], v[58:59], v[102:103] op_sel_hi:[1,0]
  v_rcp_f32 v11, v11
  v_rcp_f32 v12, v12
  v_pk_mul_f32 v[104:105], v[60:61], v[104:105] op_sel_hi:[1,0]
  v_rcp_f32 v13, v13
  v_rcp_f32 v14, v14
  v_pk_mul_f32 v[106:107], v[62:63], v[106:107] op_sel_hi:[1,0]
  v_rcp_f32 v15, v15
  v_pk_mul_f32 v[8:9], v[8:9], v[56:57]
  v_pk_mul_f32 v[10:11], v[10:11], v[58:59]
  v_pk_mul_f32 v[12:13], v[12:13], v[60:61]
  v_pk_mul_f32 v[14:15], v[14:15], v[62:63]
  v_pk_fma_f32 v[40:41], v[100:101], v[8:9], v[40:41]
  v_cvt_pk_bf16_f32 v56, v8, 0
  v_cvt_pk_bf16_f32 v57, 0, v9
  v_pk_fma_f32 v[42:43], v[102:103], v[10:11], v[42:43]
  v_cvt_pk_bf16_f32 v58, v10, 0
  v_cvt_pk_bf16_f32 v59, 0, v11
  v_pk_fma_f32 v[44:45], v[104:105], v[12:13], v[44:45]
  v_cvt_pk_bf16_f32 v60, v12, 0
  v_cvt_pk_bf16_f32 v61, 0, v13
  v_pk_fma_f32 v[46:47], v[106:107], v[14:15], v[46:47]
  v_cvt_pk_bf16_f32 v62, v14, 0
  v_cvt_pk_bf16_f32 v63, 0, v15
  s_waitcnt vmcnt(0)
  s_branch K_PYC
K_PY:
  buffer_load_dwordx4 v[72:75], v4, s[20:23], s61 offen sc1
  buffer_load_dwordx4 v[76:79], v4, s[20:23], s61 offen offset:2048 sc1
  s_sub_u32 s83, s83, 1
  s_waitcnt vmcnt(0)
  s_cbranch_scc1 K_PYD
K_PYC:
  v_xor_b32 v64, s4, v72
  v_xor_b32 v65, s4, v76
  v_bitop3_b32 v64, v64, v73, s5 bitop3:0xf6
  v_bitop3_b32 v65, v65, v77, s5 bitop3:0xf6
  v_and_b32 v64, v122, v64
  v_and_b32 v65, v122, v65
  v_min_u32 v64, v64, v65
  v_cmp_eq_u32 vcc, 0, v64
  s_cbranch_vccnz K_PY
K_PYD:
  v_permlane32_swap_b32 v72, v74
  v_permlane32_swap_b32 v73, v75
  v_permlane32_swap_b32 v76, v78
  v_permlane32_swap_b32 v77, v79
  v_permlane16_swap_b32 v72, v73
  v_permlane16_swap_b32 v74, v75
  v_permlane16_swap_b32 v76, v77
  v_permlane16_swap_b32 v78, v79
  v_dot2c_f32_bf16 v32, v72, v48
  v_dot2c_f32_bf16 v34, v73, v50
  v_dot2c_f32_bf16 v36, v74, v52
  v_dot2c_f32_bf16 v38, v75, v54
  v_dot2c_f32_bf16 v40, v76, v56
  v_dot2c_f32_bf16 v42, v77, v58
  v_dot2c_f32_bf16 v44, v78, v60
  v_dot2c_f32_bf16 v46, v79, v62
  v_dot2c_f32_bf16 v33, v72, v49
  v_dot2c_f32_bf16 v35, v73, v51
  v_dot2c_f32_bf16 v37, v74, v53
  v_dot2c_f32_bf16 v39, v75, v55
  v_dot2c_f32_bf16 v41, v76, v57
  v_dot2c_f32_bf16 v43, v77, v59
  v_dot2c_f32_bf16 v45, v78, v61
  v_dot2c_f32_bf16 v47, v79, v63
  v_cvt_pk_bf16_f32 v8, v32, v34
  v_cvt_pk_bf16_f32 v9, v36, v38
  v_cvt_pk_bf16_f32 v10, v40, v42
  v_cvt_pk_bf16_f32 v11, v44, v46
  s_mov_b64 exec, s[52:53]
  buffer_store_dwordx4 v[8:11], v4, s[20:23], s61 offen offset:0
  s_mov_b64 exec, -1
  v_cvt_pk_bf16_f32 v12, v33, v35
  v_cvt_pk_bf16_f32 v13, v37, v39
  v_cvt_pk_bf16_f32 v14, v41, v43
  v_cvt_pk_bf16_f32 v15, v45, v47
  s_mov_b64 exec, s[54:55]
  buffer_store_dwordx4 v[12:15], v4, s[20:23], s61 offen offset:2048
  s_mov_b64 exec, -1
  s_endpgm
K_RARE:
  s_sleep 2
  buffer_load_dwordx2 v[94:95], v93, s[32:35], s74 offen sc1
  ds_read_b32 v85, v126 offset:4
  s_sub_u32 s83, s83, 1
  s_waitcnt vmcnt(0) lgkmcnt(0)
  s_cbranch_scc1 K_RE
  v_cmp_ne_u32 s[78:79], s46, v94
  v_cmp_eq_u32 vcc, 0, v85
  s_nop 0
  s_or_b64 vcc, vcc, s[78:79]
  s_cbranch_vccnz K_RARE
K_RE:
  s_max_i32 s83, s83, 0
  s_branch K_RB
.p2align 6
K_C:
  s_sub_u32 s30, s30, 8
  s_setprio 2
  s_lshr_b32 s3, s29, 3
  s_lshl_b32 s3, s3, 5
  s_and_b32 s55, s29, 7
  s_add_u32 s3, s3, s55
  s_lshl_b32 s55, s28, 7
  s_add_u32 s3, s3, s55
  s_lshr_b32 s59, s30, 1
  s_lshl_b32 s55, s59, 3
  s_add_u32 s56, s3, s55
  s_lshl_b32 s57, s56, 1
  s_and_b32 s57, s57, -4
  v_lshlrev_b32 v95, 4, v1
  v_and_b32 v96, 15, v1
  v_lshrrev_b32 v97, 4, v1
  v_mov_b32 v20, 0
  v_mov_b32 v21, 0
  v_mov_b32 v22, 0
  v_mov_b32 v23, 0
  s_mov_b32 s34, 0x800000
  s_mov_b32 s35, 0x00020000
  s_waitcnt lgkmcnt(0)
  s_load_dword s47, s[12:13], s57
  s_mov_b32 s32, s42
  s_mov_b32 s33, s43
  s_barrier
  s_mov_b32 m0, 81920
  s_cmp_lg_u32 s30, 2
  s_cbranch_scc1 K_NOT
  s_lshl_b32 s60, s28, 16
  s_lshl_b32 s61, s29, 11
  s_add_u32 s60, s60, s61
  s_add_u32 s60, s60, 0x500000
  s_lshl_b32 s61, s28, 10
  s_add_u32 s61, s61, 0x441000
  buffer_load_dwordx4 v95, s[32:35], s60 offen sc1 lds
  buffer_load_dwordx4 v95, s[32:35], s60 offen offset:1024 sc1 lds
  buffer_load_dwordx4 v95, s[32:35], s61 offen sc1 lds
K_NOT:
  s_mov_b32 s4, s20
  s_mov_b32 s5, s21
  s_mov_b32 s6, 0x700000
  s_mov_b32 s7, 0x00020000
  s_mov_b32 s8, s22
  s_mov_b32 s9, s23
  s_mov_b32 s10, 0x700000
  s_mov_b32 s11, 0x00020000
  s_cmp_ge_u32 s29, 28
  s_cselect_b32 s6, 0, s6
  s_cselect_b32 s10, 0, s10
  v_lshlrev_b32 v88, 1, v97
  v_xor_b32 v88, v88, v96
  v_mul_u32_u24 v18, 7168, v97
  v_lshl_add_u32 v88, v88, 4, v18
  v_xor_b32 v98, 0x80, v88
  s_lshl_b32 s16, s28, 3
  s_add_u32 s16, s16, s30
  s_mul_i32 s16, s16, 114688
  s_lshl_b32 s17, s29, 8
  s_add_u32 s16, s16, s17
  s_add_u32 s17, s16, 28672
  s_add_u32 s18, s16, 57344
  s_add_u32 s19, s16, 86016
  s_lshl_b32 s36, s30, 12
  s_add_u32 s36, s36, 83968
  s_add_u32 m0, s36, 0
  s_nop 0
  buffer_load_dwordx4 v88, s[4:7], s16 offen nt lds
  s_mov_b32 s52, s59
  s_lshr_b32 s53, s30, 2
  s_xor_b32 s53, s53, s30
  s_and_b32 s53, s53, 1
  s_mul_i32 s66, s52, 4640
  s_add_u32 s66, s66, 768
  v_add_u32 v11, s66, v95
  s_mov_b32 exec_hi, 3
  ds_write_b128 v11, v[20:23]
  s_mov_b32 exec_hi, -1
  s_lshl_b32 s68, s52, 12
  s_add_u32 s68, s68, 56320
  s_lshl_b32 s67, s53, 11
  s_add_u32 s67, s67, s68
  v_add_u32 v90, s67, v95
  ds_write_b128 v90, v[20:23]
  ds_write_b128 v90, v[20:23] offset:1024
  s_mov_b32 s67, 0x32a57060
  s_mov_b32 s71, 0x3f317218
  s_lshl_b32 s61, s30, 2
  v_mov_b32 v92, s61
  s_xor_b32 s61, s61, 4
  v_mov_b32 v93, s61
  s_mul_i32 s69, s52, 9216
  s_add_u32 s69, s69, 19328
  s_xor_b32 s70, s53, 1
  s_mul_i32 s70, s70, 4608
  s_add_u32 s70, s70, s69
  s_sub_u32 m0, s70, 16384
  v_mul_u32_u24 v41, 288, v96
  v_lshl_add_u32 v41, v97, 4, v41
  v_add_u32 v41, s70, v41
  v_add_u32 v99, s69, v95
  s_lshl_b32 s60, s52, 8
  s_add_u32 s60, s60, 77824
  v_lshl_add_u32 v17, v1, 2, s60
  s_lshl_b32 s61, s53, 7
  s_add_u32 s60, s60, s61
  v_lshl_add_u32 v16, v1, 1, s60
  v_mov_b32 v2, 0
  v_mov_b32 v3, 0
  v_mov_b32 v4, 0
  v_mov_b32 v5, 0
  v_mov_b32 v42, 0x3c00
  s_mov_b32 s37, m0
  s_mov_b32 s72, -1
  s_mov_b32 s73, 0
  s_cmp_eq_u32 s53, 0
  s_cbranch_scc0 K_HA
  v_lshlrev_b32 v124, 8, v97
  v_lshl_add_u32 v124, v96, 4, v124
  v_sub_u32 v124, 562, v124
  v_add_u32 v124, s68, v124
  v_lshrrev_b32 v125, 1, v97
  v_lshlrev_b32 v125, 8, v125
  v_lshl_add_u32 v125, v96, 4, v125
  v_and_b32 v30, 1, v97
  v_lshl_add_u32 v125, v30, 3, v125
  v_sub_u32 v125, 1080, v125
  v_add_u32 v125, s68, v125
  v_add_u32 v126, 2, v124
  v_add_u32 v127, 1986, v124
  v_lshlrev_b32 v12, 5, v96
  v_lshl_add_u32 v9, v97, 3, v12
  v_lshl_add_u32 v12, v97, 4, v12
  v_add_u32 v12, s66, v12
  v_add_u32 v9, s68, v9
  v_add_u32 v13, 72704, v95
  v_and_b32 v11, 1, v96
  v_xor_b32 v11, 1, v11
  v_mul_u32_u24 v11, 1986, v11
  v_lshlrev_b32 v10, 1, v96
  v_sub_u32 v11, v11, v10
  s_add_u32 s78, s68, 30
  v_add_u32 v11, s78, v11
  v_lshl_add_u32 v10, v97, 4, v11
  v_lshl_add_u32 v14, v97, 3, v11
  v_add_u32 v14, 1120, v14
  v_add_u32 v11, 512, v10
  s_lshl_b32 s79, s52, 2
  v_mov_b32 v15, s79
  v_mov_b32 v8, 0
  s_branch K_AD
K_HA:
  v_and_b32 v28, 1, v96
  v_lshrrev_b32 v29, 1, v96
  v_lshlrev_b32 v124, 8, v28
  v_lshlrev_b32 v30, 1, v29
  v_sub_u32 v124, v124, v30
  v_lshlrev_b32 v125, 5, v97
  v_sub_u32 v124, v124, v125
  v_add_u32 v124, 1390, v124
  v_add_u32 v124, s68, v124
  v_lshlrev_b32 v125, 1, v28
  v_sub_u32 v125, v124, v125
  v_add_u32 v125, -126, v125
  v_mul_u32_u24 v126, 158, v28
  v_sub_u32 v126, v126, v30
  v_lshlrev_b32 v31, 6, v97
  v_sub_u32 v126, v126, v31
  v_add_u32 v126, 1712, v126
  v_add_u32 v126, s68, v126
  v_lshrrev_b32 v28, 2, v96
  v_lshl_add_u32 v11, v97, 3, v28
  v_lshlrev_b32 v11, 8, v11
  v_and_b32 v29, 1, v97
  v_lshl_or_b32 v28, v29, 2, v28
  v_lshl_or_b32 v11, v28, 5, v11
  v_and_b32 v28, 3, v1
  s_lshl_b32 s78, s52, 6
  v_xor_b32 v11, s78, v11
  v_lshlrev_b32 v9, 4, v28
  v_xor_b32 v9, v9, v11
  v_add_u32 v9, 19328, v9
  v_lshl_add_u32 v11, v28, 3, v11
  v_xor_b32 v12, 32, v11
  v_add_u32 v11, 83968, v11
  v_add_u32 v12, 83968, v12
  v_lshlrev_b32 v8, 6, v28
  v_and_b32 v29, 12, v1
  v_lshl_add_u32 v8, v29, 2, v8
  v_mul_u32_u24 v10, 320, v28
  v_lshl_add_u32 v10, v97, 4, v10
  v_add_u32 v10, 149504, v10
  v_lshrrev_b32 v28, 5, v1
  v_and_b32 v29, 31, v1
  v_lshlrev_b32 v14, 4, v29
  v_lshl_add_u32 v14, v28, 11, v14
  v_mul_u32_u24 v13, 320, v28
  v_lshl_add_u32 v13, v29, 1, v13
  s_add_u32 s78, s78, 150784
  v_add_u32 v13, s78, v13
  v_mov_b32 v15, 0
K_AD:
  s_waitcnt lgkmcnt(0)
  s_lshl_b32 s60, s47, 16
  s_and_b32 s61, s47, s31
  s_bitcmp1_b32 s56, 0
  s_cselect_b32 s60, s61, s60
  v_mov_b32 v116, s60
  v_mul_f32 v118, s58, v116
  v_fma_f32 v119, v116, s58, -v118
  v_exp_f32 v117, v118
  v_fmac_f32 v119, s67, v116
  v_mul_f32 v119, s71, v119
  v_fmac_f32 v117, v117, v119
  v_cvt_pk_bf16_f32 v117, 0, v117
  v_mul_f32 v91, s58, v117
  v_mul_f32 v90, 0.15915494, v117
  s_branch K_PWB
K_PW:
  s_sleep 1
K_PWB:
  ds_read_b32 v18, v20 offset:12
  s_waitcnt lgkmcnt(0)
  v_cmp_eq_u32 vcc, 0, v18
  s_cbranch_vccnz K_PW
  s_cmp_lg_u32 s30, 0
  s_cbranch_scc1 K_NOCI
  ds_read_b32 v18, v20 offset:0
  s_getreg_b32 s60, hwreg(HW_REG_XCC_ID)
  v_mov_b32 v19, s60
  s_lshl_b32 s60, s28, 8
  s_lshl_b32 s61, s29, 3
  s_add_u32 s60, s60, s61
  s_add_u32 s60, s60, 0x440000
  s_waitcnt lgkmcnt(0)
  s_mov_b64 exec, 1
  buffer_store_dwordx2 v[18:19], v20, s[32:35], s60 offen sc1
  s_mov_b64 exec, -1
K_NOCI:
  ds_read_u16_d16_hi v2, v16
  ds_read_u16_d16_hi v3, v16 offset:1024
  ds_read_b32 v6, v17 offset:2048
  ds_read_b32 v7, v17 offset:3072
  ds_read_u16_d16_hi v4, v16 offset:2048
  ds_read_u16_d16_hi v5, v16 offset:3072
  s_waitcnt lgkmcnt(5)
  v_mul_f32 v2, 0x3fb8aa3b, v2
  s_waitcnt lgkmcnt(4)
  v_mul_f32 v118, v3, v90
  v_exp_f32 v116, v2
  v_mul_f32 v119, 0x43000000, v118
  v_fract_f32 v118, v118
  v_fract_f32 v119, v119
  s_waitcnt lgkmcnt(2)
  v_and_b32 v6, 0x7fff7fff, v6
  v_and_b32 v7, 0x7fff7fff, v7
  v_cvt_pk_bf16_f32 v116, v116, v116
  v_pk_max_u16 v6, v6, v7
  v_and_b32 v116, 0xffff0000, v116
  v_pk_max_u16 v6, v6, v6 op_sel:[0,1] op_sel_hi:[1,0]
  v_mul_f32 v116, v116, v91
  v_sin_f32 v26, v119
  v_mul_f32 v120, 0x43000000, v116
  v_max_u32_dpp v6, v6, v6 quad_perm:[1,0,3,2] row_mask:0xf bank_mask:0xf
  v_exp_f32 v116, -v116
  v_cos_f32 v27, v119
  v_max_u32_dpp v6, v6, v6 quad_perm:[2,3,0,1] row_mask:0xf bank_mask:0xf
  v_cos_f32 v119, v118
  v_sin_f32 v118, v118
  v_max_u32_dpp v6, v6, v6 row_half_mirror row_mask:0xf bank_mask:0xf
  v_exp_f32 v120, -v120
  v_mul_f32 v119, v119, v116
  v_max_u32_dpp v6, v6, v6 row_mirror row_mask:0xf bank_mask:0xf
  v_mul_f32 v118, v118, v116
  v_mul_f32 v26, v26, v120
  v_max_u32_dpp v6, v6, v6 row_bcast:15 row_mask:0xa bank_mask:0xf
  v_mul_f32 v27, v27, v120
  v_add_f32 v117, v117, v117
  v_max_u32_dpp v6, v6, v6 row_bcast:31 row_mask:0xc bank_mask:0xf
  v_pk_mul_f32 v[24:25], v[118:119], v[118:119] op_sel:[1,0] op_sel_hi:[1,1]
  v_mul_f32 v6, v6, v117
  v_pk_fma_f32 v[24:25], v[118:119], v[118:119], v[24:25] op_sel:[1,0,0] op_sel_hi:[0,0,1] neg_hi:[1,0,0]
  v_readlane_b32 s78, v6, 63
  s_nop 0
  s_lshr_b32 s78, s78, 23
  s_max_u32 s78, s78, 33
  s_min_u32 s78, s78, 233
  s_sub_u32 s70, s78, 6
  s_sub_u32 s78, 260, s78
  s_lshl_b32 s70, s70, 23
  s_lshl_b32 s78, s78, 23
  v_mul_f32 v117, s78, v117
  s_waitcnt lgkmcnt(0)
  v_mul_f32 v33, v4, v117
  v_mul_f32 v32, v5, v117
  v_pk_mul_f32 v[120:121], v[24:25], v[24:25] op_sel:[1,0] op_sel_hi:[1,1]
  s_add_u32 m0, s36, 32768
  s_nop 0
  buffer_load_dwordx4 v88, s[8:11], s16 offen nt lds
  s_mov_b32 m0, s37
  v_cvt_pk_f16_f32 v100, v33, -v32
  v_cvt_pk_f16_f32 v101, v119, -v118
  v_pk_fma_f32 v[120:121], v[24:25], v[24:25], v[120:121] op_sel:[1,0,0] op_sel_hi:[0,0,1] neg_hi:[1,0,0]
  v_cvt_pk_f16_f32 v102, v25, -v24
  v_pk_mul_f16 v103, v100, v101 op_sel:[0,0] op_sel_hi:[0,1]
  v_pk_mul_f32 v[122:123], v[120:121], v[120:121] op_sel:[1,0] op_sel_hi:[1,1]
  v_pk_mul_f16 v104, v100, v102 op_sel:[0,0] op_sel_hi:[0,1]
  v_pk_fma_f16 v103, v100, v101, v103 op_sel:[1,1,0] op_sel_hi:[1,0,1] neg_lo:[1,0,0]
  v_pk_fma_f32 v[122:123], v[120:121], v[120:121], v[122:123] op_sel:[1,0,0] op_sel_hi:[0,0,1] neg_hi:[1,0,0]
  v_pk_fma_f16 v104, v100, v102, v104 op_sel:[1,1,0] op_sel_hi:[1,0,1] neg_lo:[1,0,0]
  v_pk_mul_f32 v[16:17], v[24:25], v[118:119] op_sel:[1,0] op_sel_hi:[1,1]
  v_pk_mul_f32 v[18:19], v[122:123], v[122:123] op_sel:[1,0] op_sel_hi:[1,1]
  v_cvt_pk_f16_f32 v105, v121, -v120
  v_pk_fma_f32 v[16:17], v[118:119], v[24:25], v[16:17] op_sel:[1,0,0] op_sel_hi:[0,0,1] neg_hi:[1,0,0]
  v_pk_fma_f32 v[18:19], v[122:123], v[122:123], v[18:19] op_sel:[1,0,0] op_sel_hi:[0,0,1] neg_hi:[1,0,0]
  v_pk_mul_f16 v106, v100, v105 op_sel:[0,0] op_sel_hi:[0,1]
  v_cvt_pk_f16_f32 v107, v17, -v16
  v_pk_mul_f32 v[20:21], v[18:19], v[18:19] op_sel:[1,0] op_sel_hi:[1,1]
  v_pk_fma_f16 v106, v100, v105, v106 op_sel:[1,1,0] op_sel_hi:[1,0,1] neg_lo:[1,0,0]
  v_pk_mul_f16 v108, v100, v107 op_sel:[0,0] op_sel_hi:[0,1]
  v_pk_fma_f32 v[20:21], v[18:19], v[18:19], v[20:21] op_sel:[1,0,0] op_sel_hi:[0,0,1] neg_hi:[1,0,0]
  v_pk_mul_f16 v109, v105, v101 op_sel:[0,0] op_sel_hi:[0,1]
  v_pk_fma_f16 v108, v100, v107, v108 op_sel:[1,1,0] op_sel_hi:[1,0,1] neg_lo:[1,0,0]
  v_pk_mul_f32 v[22:23], v[20:21], v[20:21] op_sel:[1,0] op_sel_hi:[1,1]
  v_pk_fma_f16 v109, v105, v101, v109 op_sel:[1,1,0] op_sel_hi:[1,0,1] neg_lo:[1,0,0]
  v_pk_mul_f16 v110, v105, v102 op_sel:[0,0] op_sel_hi:[0,1]
  v_pk_fma_f32 v[22:23], v[20:21], v[20:21], v[22:23] op_sel:[1,0,0] op_sel_hi:[0,0,1] neg_hi:[1,0,0]
  v_pk_mul_f16 v111, v100, v109 op_sel:[0,0] op_sel_hi:[0,1]
  v_pk_fma_f16 v110, v105, v102, v110 op_sel:[1,1,0] op_sel_hi:[1,0,1] neg_lo:[1,0,0]
  v_pk_mul_f16 v112, v105, v107 op_sel:[0,0] op_sel_hi:[0,1]
  v_pk_fma_f16 v111, v100, v109, v111 op_sel:[1,1,0] op_sel_hi:[1,0,1] neg_lo:[1,0,0]
  v_pk_mul_f16 v113, v100, v110 op_sel:[0,0] op_sel_hi:[0,1]
  v_pk_fma_f16 v112, v105, v107, v112 op_sel:[1,1,0] op_sel_hi:[1,0,1] neg_lo:[1,0,0]
  v_pk_mul_f32 v[28:29], v[32:33], v[26:27] op_sel:[1,0] op_sel_hi:[1,1]
  v_pk_fma_f16 v113, v100, v110, v113 op_sel:[1,1,0] op_sel_hi:[1,0,1] neg_lo:[1,0,0]
  v_pk_mul_f16 v114, v100, v112 op_sel:[0,0] op_sel_hi:[0,1]
  v_pk_fma_f32 v[28:29], v[26:27], v[32:33], v[28:29] op_sel:[1,0,0] op_sel_hi:[0,0,1] neg_hi:[1,0,0]
  v_cvt_pk_f16_f32 v115, v123, v122
  v_pk_fma_f16 v114, v100, v112, v114 op_sel:[1,1,0] op_sel_hi:[1,0,1] neg_lo:[1,0,0]
  v_cvt_pk_f16_f32 v116, v29, -v28
  v_cvt_pk_f16_f32 v117, v19, v18
  ds_write_addtid_b32 v100 offset:16384
  ds_write_addtid_b32 v103 offset:16672
  ds_write_addtid_b32 v104 offset:16960
  ds_write_addtid_b32 v108 offset:17248
  ds_write_addtid_b32 v106 offset:17536
  ds_write_addtid_b32 v111 offset:17824
  ds_write_addtid_b32 v113 offset:18112
  ds_write_addtid_b32 v114 offset:18400
  s_add_u32 m0, s36, 1024
  s_nop 0
  buffer_load_dwordx4 v88, s[4:7], s17 offen nt lds
  s_mov_b32 m0, s37
  v_pk_mul_f16 v2, v116, v101 op_sel:[0,0] op_sel_hi:[0,1]
  v_pk_mul_f16 v3, v116, v102 op_sel:[0,0] op_sel_hi:[0,1]
  v_pk_mul_f16 v4, v116, v107 op_sel:[0,0] op_sel_hi:[0,1]
  v_pk_fma_f16 v2, v116, v101, v2 op_sel:[1,1,0] op_sel_hi:[1,0,1] neg_lo:[1,0,0]
  v_pk_fma_f16 v3, v116, v102, v3 op_sel:[1,1,0] op_sel_hi:[1,0,1] neg_lo:[1,0,0]
  v_pk_fma_f16 v4, v116, v107, v4 op_sel:[1,1,0] op_sel_hi:[1,0,1] neg_lo:[1,0,0]
  v_pk_mul_f16 v5, v116, v105 op_sel:[0,0] op_sel_hi:[0,1]
  v_pk_mul_f16 v6, v116, v109 op_sel:[0,0] op_sel_hi:[0,1]
  v_pk_mul_f16 v7, v116, v110 op_sel:[0,0] op_sel_hi:[0,1]
  v_pk_fma_f16 v5, v116, v105, v5 op_sel:[1,1,0] op_sel_hi:[1,0,1] neg_lo:[1,0,0]
  v_pk_fma_f16 v6, v116, v109, v6 op_sel:[1,1,0] op_sel_hi:[1,0,1] neg_lo:[1,0,0]
  v_pk_fma_f16 v7, v116, v110, v7 op_sel:[1,1,0] op_sel_hi:[1,0,1] neg_lo:[1,0,0]
  v_pk_mul_f16 v40, v116, v112 op_sel:[0,0] op_sel_hi:[0,1]
  v_cvt_pk_f16_f32 v43, v21, v20
  v_pk_mul_f32 v[30:31], v[18:19], v[122:123] op_sel:[1,0] op_sel_hi:[1,1]
  v_pk_fma_f16 v40, v116, v112, v40 op_sel:[1,1,0] op_sel_hi:[1,0,1] neg_lo:[1,0,0]
  v_cvt_pk_f16_f32 v90, v23, v22
  v_pk_fma_f32 v[30:31], v[122:123], v[18:19], v[30:31] op_sel:[1,0,0] op_sel_hi:[0,0,1] neg_hi:[1,0,0]
  ds_write_addtid_b32 v116 offset:18688
  ds_write_addtid_b32 v2 offset:18976
  ds_write_addtid_b32 v3 offset:19264
  ds_write_addtid_b32 v4 offset:19552
  ds_write_addtid_b32 v5 offset:19840
  ds_write_addtid_b32 v6 offset:20128
  ds_write_addtid_b32 v7 offset:20416
  ds_write_addtid_b32 v40 offset:20704
  ds_read_b128 v[60:63], v41 offset:0
  ds_read_b128 v[64:67], v41 offset:64
  ds_read_b128 v[68:71], v41 offset:128
  ds_read_b128 v[72:75], v41 offset:192
  ds_write_addtid_b32 v42 offset:16384
  v_cvt_pk_f16_f32 v91, v31, v30
  v_pk_mul_f16 v103, v43, v115 op_sel:[0,0] op_sel_hi:[0,1]
  v_pk_mul_f16 v104, v43, v117 op_sel:[0,0] op_sel_hi:[0,1]
  v_pk_mul_f16 v108, v43, v91 op_sel:[0,0] op_sel_hi:[0,1]
  v_pk_fma_f16 v103, v43, v115, v103 op_sel:[1,1,0] op_sel_hi:[1,0,1] neg_lo:[1,0,0]
  v_pk_fma_f16 v104, v43, v117, v104 op_sel:[1,1,0] op_sel_hi:[1,0,1] neg_lo:[1,0,0]
  v_pk_fma_f16 v108, v43, v91, v108 op_sel:[1,1,0] op_sel_hi:[1,0,1] neg_lo:[1,0,0]
  v_pk_mul_f32 v[34:35], v[22:23], v[20:21] op_sel:[1,0] op_sel_hi:[1,1]
  v_pk_mul_f16 v106, v90, v115 op_sel:[0,0] op_sel_hi:[0,1]
  ds_write_addtid_b32 v115 offset:16672
  ds_write_addtid_b32 v117 offset:16960
  ds_write_addtid_b32 v43 offset:17536
  ds_write_addtid_b32 v91 offset:17248
  ds_write_addtid_b32 v90 offset:18688
  ds_write_addtid_b32 v103 offset:17824
  ds_write_addtid_b32 v104 offset:18112
  ds_write_addtid_b32 v108 offset:18400
  v_pk_fma_f32 v[34:35], v[20:21], v[22:23], v[34:35] op_sel:[1,0,0] op_sel_hi:[0,0,1] neg_hi:[1,0,0]
  v_pk_fma_f16 v106, v90, v115, v106 op_sel:[1,1,0] op_sel_hi:[1,0,1] neg_lo:[1,0,0]
  s_add_u32 m0, s36, 33792
  s_nop 0
  buffer_load_dwordx4 v88, s[8:11], s17 offen nt lds
  s_mov_b32 m0, s37
  v_pk_mul_f16 v111, v90, v117 op_sel:[0,0] op_sel_hi:[0,1]
  v_cvt_pk_f16_f32 v113, v35, v34
  v_pk_mul_f16 v114, v90, v91 op_sel:[0,0] op_sel_hi:[0,1]
  v_pk_fma_f16 v111, v90, v117, v111 op_sel:[1,1,0] op_sel_hi:[1,0,1] neg_lo:[1,0,0]
  v_pk_mul_f16 v101, v113, v115 op_sel:[0,0] op_sel_hi:[0,1]
  v_pk_fma_f16 v114, v90, v91, v114 op_sel:[1,1,0] op_sel_hi:[1,0,1] neg_lo:[1,0,0]
  v_pk_mul_f16 v107, v113, v117 op_sel:[0,0] op_sel_hi:[0,1]
  v_pk_fma_f16 v101, v113, v115, v101 op_sel:[1,1,0] op_sel_hi:[1,0,1] neg_lo:[1,0,0]
  v_pk_mul_f16 v109, v113, v91 op_sel:[0,0] op_sel_hi:[0,1]
  v_pk_fma_f16 v107, v113, v117, v107 op_sel:[1,1,0] op_sel_hi:[1,0,1] neg_lo:[1,0,0]
  v_pk_mul_f32 v[36:37], v[26:27], v[26:27] op_sel:[1,0] op_sel_hi:[1,1]
  v_pk_fma_f16 v109, v113, v91, v109 op_sel:[1,1,0] op_sel_hi:[1,0,1] neg_lo:[1,0,0]
  v_cvt_pk_f16_f32 v112, v27, -v26
  v_pk_fma_f32 v[36:37], v[26:27], v[26:27], v[36:37] op_sel:[1,0,0] op_sel_hi:[0,0,1] neg_hi:[1,0,0]
  ds_write_addtid_b32 v113 offset:19840
  ds_write_addtid_b32 v106 offset:18976
  ds_write_addtid_b32 v111 offset:19264
  ds_write_addtid_b32 v114 offset:19552
  ds_write_addtid_b32 v101 offset:20128
  ds_write_addtid_b32 v107 offset:20416
  ds_write_addtid_b32 v109 offset:20704
  ds_read_b128 v[44:47], v41 offset:0
  ds_read_b128 v[48:51], v41 offset:64
  ds_read_b128 v[52:55], v41 offset:128
  ds_read_b128 v[56:59], v41 offset:192
  v_cvt_pk_f16_f32 v116, v37, -v36
  v_pk_mul_f32 v[38:39], v[36:37], v[26:27] op_sel:[1,0] op_sel_hi:[1,1]
  v_pk_mul_f32 v[120:121], v[36:37], v[36:37] op_sel:[1,0] op_sel_hi:[1,1]
  v_pk_mul_f16 v2, v100, v116 op_sel:[0,0] op_sel_hi:[0,1]
  v_pk_fma_f32 v[38:39], v[26:27], v[36:37], v[38:39] op_sel:[1,0,0] op_sel_hi:[0,0,1] neg_hi:[1,0,0]
  v_pk_fma_f32 v[120:121], v[36:37], v[36:37], v[120:121] op_sel:[1,0,0] op_sel_hi:[0,0,1] neg_hi:[1,0,0]
  v_pk_fma_f16 v2, v100, v116, v2 op_sel:[1,1,0] op_sel_hi:[1,0,1] neg_lo:[1,0,0]
  v_cvt_pk_f16_f32 v3, v39, -v38
  v_pk_mul_f32 v[24:25], v[32:33], v[120:121] op_sel:[1,0] op_sel_hi:[1,1]
  v_pk_mul_f16 v4, v2, v102 op_sel:[0,0] op_sel_hi:[0,1]
  v_pk_mul_f16 v5, v2, v105 op_sel:[0,0] op_sel_hi:[0,1]
  v_pk_mul_f16 v6, v2, v110 op_sel:[0,0] op_sel_hi:[0,1]
  v_pk_fma_f16 v4, v2, v102, v4 op_sel:[1,1,0] op_sel_hi:[1,0,1] neg_lo:[1,0,0]
  v_pk_fma_f16 v5, v2, v105, v5 op_sel:[1,1,0] op_sel_hi:[1,0,1] neg_lo:[1,0,0]
  v_pk_fma_f16 v6, v2, v110, v6 op_sel:[1,1,0] op_sel_hi:[1,0,1] neg_lo:[1,0,0]
  v_pk_mul_f16 v7, v100, v3 op_sel:[0,0] op_sel_hi:[0,1]
  v_pk_fma_f32 v[24:25], v[120:121], v[32:33], v[24:25] op_sel:[1,0,0] op_sel_hi:[0,0,1] neg_hi:[1,0,0]
  v_pk_fma_f16 v7, v100, v3, v7 op_sel:[1,1,0] op_sel_hi:[1,0,1] neg_lo:[1,0,0]
  v_cvt_pk_f16_f32 v40, v25, -v24
  v_pk_mul_f32 v[118:119], v[24:25], v[120:121] op_sel:[1,0] op_sel_hi:[1,1]
  v_pk_mul_f16 v43, v7, v102 op_sel:[0,0] op_sel_hi:[0,1]
  v_pk_mul_f16 v103, v7, v105 op_sel:[0,0] op_sel_hi:[0,1]
  v_pk_mul_f16 v104, v7, v110 op_sel:[0,0] op_sel_hi:[0,1]
  s_waitcnt lgkmcnt(0)
  s_add_u32 m0, s36, 2048
  s_nop 0
  buffer_load_dwordx4 v98, s[4:7], s18 offen nt lds
  s_mov_b32 m0, s37
  v_mfma_f32_16x16x32_f16 v[76:79], v[60:63], v[44:47], 0
  v_mfma_f32_16x16x32_f16 v[76:79], v[64:67], v[48:51], v[76:79]
  v_mfma_f32_16x16x32_f16 v[76:79], v[68:71], v[52:55], v[76:79]
  v_mfma_f32_16x16x32_f16 v[76:79], v[72:75], v[56:59], v[76:79]
  v_pk_fma_f16 v43, v7, v102, v43 op_sel:[1,1,0] op_sel_hi:[1,0,1] neg_lo:[1,0,0]
  v_pk_fma_f16 v103, v7, v105, v103 op_sel:[1,1,0] op_sel_hi:[1,0,1] neg_lo:[1,0,0]
  v_pk_fma_f16 v104, v7, v110, v104 op_sel:[1,1,0] op_sel_hi:[1,0,1] neg_lo:[1,0,0]
  v_pk_mul_f16 v108, v40, v105 op_sel:[0,0] op_sel_hi:[0,1]
  ds_write_addtid_b32 v2 offset:16384
  ds_write_addtid_b32 v4 offset:16672
  ds_write_addtid_b32 v5 offset:16960
  ds_write_addtid_b32 v6 offset:17248
  ds_write_addtid_b32 v7 offset:17536
  ds_write_addtid_b32 v43 offset:17824
  ds_write_addtid_b32 v103 offset:18112
  ds_write_addtid_b32 v40 offset:18688
  v_pk_fma_f16 v108, v40, v105, v108 op_sel:[1,1,0] op_sel_hi:[1,0,1] neg_lo:[1,0,0]
  v_pk_mul_f16 v90, v40, v112 op_sel:[0,0] op_sel_hi:[0,1]
  v_pk_mul_f16 v115, v40, v116 op_sel:[0,0] op_sel_hi:[0,1]
  v_pk_mul_f16 v117, v40, v3 op_sel:[0,0] op_sel_hi:[0,1]
  v_pk_fma_f16 v90, v40, v112, v90 op_sel:[1,1,0] op_sel_hi:[1,0,1] neg_lo:[1,0,0]
  v_pk_fma_f16 v115, v40, v116, v115 op_sel:[1,1,0] op_sel_hi:[1,0,1] neg_lo:[1,0,0]
  v_pk_fma_f16 v117, v40, v3, v117 op_sel:[1,1,0] op_sel_hi:[1,0,1] neg_lo:[1,0,0]
  v_pk_mul_f16 v91, v90, v105 op_sel:[0,0] op_sel_hi:[0,1]
  v_pk_mul_f16 v113, v115, v105 op_sel:[0,0] op_sel_hi:[0,1]
  v_pk_mul_f16 v106, v117, v105 op_sel:[0,0] op_sel_hi:[0,1]
  v_pk_fma_f16 v91, v90, v105, v91 op_sel:[1,1,0] op_sel_hi:[1,0,1] neg_lo:[1,0,0]
  v_pk_fma_f16 v113, v115, v105, v113 op_sel:[1,1,0] op_sel_hi:[1,0,1] neg_lo:[1,0,0]
  v_pk_fma_f16 v106, v117, v105, v106 op_sel:[1,1,0] op_sel_hi:[1,0,1] neg_lo:[1,0,0]
  v_pk_fma_f32 v[118:119], v[120:121], v[24:25], v[118:119] op_sel:[1,0,0] op_sel_hi:[0,0,1] neg_hi:[1,0,0]
  ds_write_addtid_b32 v104 offset:18400
  ds_write_addtid_b32 v108 offset:18976
  ds_write_addtid_b32 v90 offset:19264
  ds_write_addtid_b32 v91 offset:19552
  ds_write_addtid_b32 v115 offset:19840
  ds_write_addtid_b32 v113 offset:20128
  ds_write_addtid_b32 v117 offset:20416
  ds_write_addtid_b32 v106 offset:20704
  ds_read_b128 v[60:63], v41 offset:0
  ds_read_b128 v[64:67], v41 offset:64
  ds_read_b128 v[68:71], v41 offset:128
  ds_read_b128 v[72:75], v41 offset:192
  v_cvt_pk_f16_f32 v111, v119, -v118
  v_pk_mul_f32 v[16:17], v[118:119], v[120:121] op_sel:[1,0] op_sel_hi:[1,1]
  v_pk_mul_f16 v114, v111, v112 op_sel:[0,0] op_sel_hi:[0,1]
  v_pk_mul_f16 v101, v111, v116 op_sel:[0,0] op_sel_hi:[0,1]
  v_pk_mul_f16 v107, v111, v3 op_sel:[0,0] op_sel_hi:[0,1]
  v_pk_fma_f16 v114, v111, v112, v114 op_sel:[1,1,0] op_sel_hi:[1,0,1] neg_lo:[1,0,0]
  v_pk_fma_f16 v101, v111, v116, v101 op_sel:[1,1,0] op_sel_hi:[1,0,1] neg_lo:[1,0,0]
  v_pk_fma_f16 v107, v111, v3, v107 op_sel:[1,1,0] op_sel_hi:[1,0,1] neg_lo:[1,0,0]
  v_pk_fma_f32 v[16:17], v[120:121], v[118:119], v[16:17] op_sel:[1,0,0] op_sel_hi:[0,0,1] neg_hi:[1,0,0]
  v_cvt_pk_f16_f32 v109, v17, -v16
  v_pk_mul_f32 v[28:29], v[16:17], v[120:121] op_sel:[1,0] op_sel_hi:[1,1]
  v_pk_mul_f16 v100, v109, v112 op_sel:[0,0] op_sel_hi:[0,1]
  v_pk_mul_f16 v102, v109, v116 op_sel:[0,0] op_sel_hi:[0,1]
  v_pk_mul_f16 v110, v109, v3 op_sel:[0,0] op_sel_hi:[0,1]
  v_pk_fma_f16 v100, v109, v112, v100 op_sel:[1,1,0] op_sel_hi:[1,0,1] neg_lo:[1,0,0]
  v_pk_fma_f16 v102, v109, v116, v102 op_sel:[1,1,0] op_sel_hi:[1,0,1] neg_lo:[1,0,0]
  v_pk_fma_f16 v110, v109, v3, v110 op_sel:[1,1,0] op_sel_hi:[1,0,1] neg_lo:[1,0,0]
  v_pk_fma_f32 v[28:29], v[120:121], v[16:17], v[28:29] op_sel:[1,0,0] op_sel_hi:[0,0,1] neg_hi:[1,0,0]
  ds_write_addtid_b32 v111 offset:16384
  ds_write_addtid_b32 v114 offset:16672
  ds_write_addtid_b32 v101 offset:16960
  ds_write_addtid_b32 v107 offset:17248
  ds_write_addtid_b32 v109 offset:17536
  ds_write_addtid_b32 v100 offset:17824
  ds_write_addtid_b32 v102 offset:18112
  ds_write_addtid_b32 v110 offset:18400
  s_waitcnt lgkmcnt(8)
  v_mfma_f32_16x16x32_f16 v[80:83], v[60:63], v[44:47], 0
  v_mfma_f32_16x16x32_f16 v[80:83], v[64:67], v[48:51], v[80:83]
  v_mfma_f32_16x16x32_f16 v[80:83], v[68:71], v[52:55], v[80:83]
  v_mfma_f32_16x16x32_f16 v[80:83], v[72:75], v[56:59], v[80:83]
  v_cvt_pk_f16_f32 v2, v29, -v28
  ds_write_addtid_b32 v2 offset:18688
  ds_read_b128 v[60:63], v41 offset:0
  ds_read_b128 v[64:67], v41 offset:64
  ds_read_b128 v[68:71], v41 offset:128
  ds_read_b128 v[72:75], v41 offset:192
  s_waitcnt lgkmcnt(0)
  v_mfma_f32_16x16x32_f16 v[84:87], v[60:63], v[44:47], 0
  v_mfma_f32_16x16x32_f16 v[84:87], v[64:67], v[48:51], v[84:87]
  v_mfma_f32_16x16x32_f16 v[84:87], v[68:71], v[52:55], v[84:87]
  v_mfma_f32_16x16x32_f16 v[84:87], v[72:75], v[56:59], v[84:87]
  s_cmp_eq_u32 s53, 0
  s_cbranch_scc0 K_FAR
  ds_write_b128 v99, v[80:83] offset:5120
  s_nop 4
  ds_write_b128 v99, v[84:87] offset:6144
  v_mov_b32 v94, 1
  ds_write_b32 v92, v94 offset:64
  s_branch K_PS1B
K_PS1:
K_PS1B:
  ds_read_b32 v94, v93 offset:64
  s_waitcnt lgkmcnt(0)
  v_cmp_gt_u32 vcc, 1, v94
  s_cbranch_vccnz K_PS1
  ds_read_b128 v[16:19], v99 offset:1024
  ds_read_b128 v[24:27], v99
  s_waitcnt lgkmcnt(1)
  v_pk_add_f32 v[80:81], v[80:81], v[16:17]
  v_pk_add_f32 v[82:83], v[82:83], v[18:19]
  s_waitcnt lgkmcnt(0)
  v_pk_add_f32 v[76:77], v[76:77], v[24:25]
  v_pk_add_f32 v[78:79], v[78:79], v[26:27]
  v_mov_b32_dpp v28, v80 row_shl:1 row_mask:0xf bank_mask:0xf
  v_writelane_b32 v28, 0, 33
  s_mov_b32 exec_hi, 3
  v_cndmask_b32 v29, v80, v81, s[72:73]
  v_cndmask_b32 v30, v81, v82, s[72:73]
  v_cndmask_b32 v28, v28, v83, s[72:73]
  v_cvt_pk_f16_f32 v16, v28, v30
  v_cvt_pk_f16_f32 v17, v30, v30
  v_cvt_pk_f16_f32 v18, v29, v80
  v_cvt_pk_f16_f32 v19, v80, v80
  v_cvt_pk_f16_f32 v20, v30, v29
  ds_write_b16 v124, v16
  ds_write2_b32 v126, v17, v20 offset0:0 offset1:1
  ds_write_b32 v126, v19 offset:8
  ds_write_b16 v124, v19 offset:14
  ds_write2_b32 v127, v16, v17 offset0:0 offset1:1
  ds_write2_b32 v127, v18, v19 offset0:2 offset1:3
  s_mov_b32 exec_hi, -1
  v_cvt_pk_f16_f32 v24, v79, v78
  v_cvt_pk_f16_f32 v25, v77, v76
  v_cvt_pk_f16_f32 v26, v78, v77
  ds_write_b64 v125, v[24:25]
  ds_write_b16 v125, v24 offset:1986
  ds_write_b32 v125, v26 offset:1988
  ds_write_b16_d16_hi v125, v25 offset:1992
  v_mov_b32 v8, s70
  ds_read2_b32 v[96:97], v11 offset0:128 offset1:129
  ds_read2_b32 v[98:99], v11 offset0:130 offset1:131
  ds_read2_b32 v[100:101], v10 offset0:128 offset1:129
  ds_read2_b32 v[102:103], v10 offset0:130 offset1:131
  ds_read2_b32 v[92:93], v10 offset0:0 offset1:1
  ds_read2_b32 v[94:95], v10 offset0:2 offset1:3
  ds_read2_b32 v[104:105], v11 offset0:112 offset1:113
  ds_read2_b32 v[106:107], v11 offset0:114 offset1:115
  ds_read2_b32 v[108:109], v10 offset0:112 offset1:113
  ds_read2_b32 v[110:111], v10 offset0:114 offset1:115
  s_branch K_FWB
K_FW:
  s_sleep 1
K_FWB:
  ds_read_b32 v6, v15 offset:640
  s_waitcnt lgkmcnt(0)
  v_cmp_eq_u32 vcc, 0, v6
  s_cbranch_vccnz K_FW
  v_readfirstlane_b32 s71, v6
  ds_read2_b32 v[48:49], v14 offset0:16 offset1:17
  ds_read2_b32 v[50:51], v14 offset0:112 offset1:113
  ds_read2_b32 v[52:53], v14 offset0:8 offset1:9
  ds_read2_b32 v[54:55], v14 offset0:104 offset1:105
  ds_read2_b32 v[56:57], v14 offset0:0 offset1:1
  ds_read2_b32 v[58:59], v14 offset0:96 offset1:97
  ds_read2_b32 v[60:61], v14 offset0:48 offset1:49
  ds_read2_b32 v[62:63], v14 offset0:80 offset1:81
  ds_read2_b32 v[64:65], v14 offset0:40 offset1:41
  ds_read2_b32 v[66:67], v14 offset0:72 offset1:73
  ds_read2_b32 v[68:69], v14 offset0:32 offset1:33
  s_waitcnt lgkmcnt(4)
  ds_read2_b32 v[70:71], v14 offset0:64 offset1:65
  ds_read2_b32 v[72:73], v14 offset0:152 offset1:153
  ds_read2_b32 v[74:75], v14 offset0:192 offset1:193
  ds_read2_b32 v[76:77], v14 offset0:144 offset1:145
  ds_read2_b32 v[78:79], v14 offset0:184 offset1:185
  ds_read2_b32 v[80:81], v14 offset0:136 offset1:137
  ds_read2_b32 v[82:83], v14 offset0:176 offset1:177
  ds_read2_b32 v[84:85], v14 offset0:128 offset1:129
  ds_read2_b32 v[86:87], v14 offset0:168 offset1:169
  s_setprio 1
  v_mov_b32 v6, 0
  v_mov_b32 v7, 1
  s_waitcnt vmcnt(0)
  s_mov_b64 exec, 1
  ds_add_u32 v6, v7 offset:112
  s_mov_b64 exec, -1
  s_branch K_W1NB
K_W1N:
  s_sleep 1
K_W1NB:
  ds_read_b32 v7, v6 offset:16
  s_waitcnt lgkmcnt(0)
  v_cmp_gt_u32 vcc, 8, v7
  s_cbranch_vccnz K_W1N
  ds_read_b128 v[112:115], v12 offset:512
  ds_read_b128 v[116:119], v12 offset:1024
  ds_read_b128 v[120:123], v12 offset:1536
  ds_read_b128 v[124:127], v12 offset:2048
  ds_read_b128 v[2:5], v12 offset:2560
  s_waitcnt lgkmcnt(4)
  v_mfma_f32_16x16x32_f16 v[16:19], v[96:99], v[112:115], 0
  v_mfma_f32_16x16x32_f16 v[20:23], v[100:103], v[112:115], 0
  v_mfma_f32_16x16x32_f16 v[24:27], v[92:95], v[112:115], 0
  ds_read_b128 v[112:115], v12 offset:3072
  s_waitcnt lgkmcnt(4)
  v_mfma_f32_16x16x32_f16 v[20:23], v[96:99], v[116:119], v[20:23]
  v_mfma_f32_16x16x32_f16 v[24:27], v[100:103], v[116:119], v[24:27]
  v_mfma_f32_16x16x32_f16 v[28:31], v[92:95], v[116:119], 0
  ds_read_b128 v[116:119], v12 offset:3584
  s_waitcnt lgkmcnt(2)
  v_mfma_f32_16x16x32_f16 v[24:27], v[96:99], v[120:123], v[24:27]
  v_mfma_f32_16x16x32_f16 v[28:31], v[100:103], v[120:123], v[28:31]
  v_mfma_f32_16x16x32_f16 v[32:35], v[92:95], v[120:123], 0
  ds_read_b128 v[120:123], v12 offset:4096
  v_mfma_f32_16x16x32_f16 v[28:31], v[96:99], v[124:127], v[28:31]
  v_mfma_f32_16x16x32_f16 v[32:35], v[100:103], v[124:127], v[32:35]
  v_mfma_f32_16x16x32_f16 v[36:39], v[92:95], v[124:127], 0
  ds_read_b128 v[124:127], v12 offset:448
  v_mfma_f32_16x16x32_f16 v[32:35], v[96:99], v[2:5], v[32:35]
  v_mfma_f32_16x16x32_f16 v[36:39], v[100:103], v[2:5], v[36:39]
  v_mfma_f32_16x16x32_f16 v[40:43], v[92:95], v[2:5], 0
  ds_read_b128 v[2:5], v12 offset:960
  s_waitcnt lgkmcnt(2)
  v_mfma_f32_16x16x32_f16 v[36:39], v[96:99], v[112:115], v[36:39]
  v_mfma_f32_16x16x32_f16 v[40:43], v[100:103], v[112:115], v[40:43]
  v_mfma_f32_16x16x32_f16 v[44:47], v[92:95], v[112:115], 0
  ds_read_b128 v[112:115], v12 offset:1472
  v_mfma_f32_16x16x32_f16 v[40:43], v[96:99], v[116:119], v[40:43]
  v_mfma_f32_16x16x32_f16 v[44:47], v[100:103], v[116:119], v[44:47]
  ds_read_b128 v[116:119], v12 offset:1984
  v_mfma_f32_16x16x32_f16 v[44:47], v[96:99], v[120:123], v[44:47]
  ds_read_b128 v[120:123], v12 offset:2496
  s_waitcnt lgkmcnt(3)
  v_mfma_f32_16x16x32_f16 v[16:19], v[104:107], v[124:127], v[16:19]
  ds_read2_b32 v[96:97], v11 offset0:96 offset1:97
  ds_read2_b32 v[98:99], v11 offset0:98 offset1:99
  v_mfma_f32_16x16x32_f16 v[20:23], v[108:111], v[124:127], v[20:23]
  ds_read_b128 v[124:127], v12 offset:3008
  ds_read2_b32 v[100:101], v10 offset0:96 offset1:97
  v_mfma_f32_16x16x32_f16 v[20:23], v[104:107], v[2:5], v[20:23]
  ds_read2_b32 v[102:103], v10 offset0:98 offset1:99
  ds_read_b128 v[88:91], v13 offset:0
  v_mfma_f32_16x16x32_f16 v[24:27], v[108:111], v[2:5], v[24:27]
  ds_read_b128 v[2:5], v12 offset:3520
  s_waitcnt lgkmcnt(8)
  v_mfma_f32_16x16x32_f16 v[24:27], v[104:107], v[112:115], v[24:27]
  ds_read_b128 v[92:95], v13 offset:1024
  v_mfma_f32_16x16x32_f16 v[28:31], v[108:111], v[112:115], v[28:31]
  ds_read_b128 v[112:115], v12 offset:4032
  v_mfma_f32_16x16x32_f16 v[28:31], v[104:107], v[116:119], v[28:31]
  v_mfma_f32_16x16x32_f16 v[32:35], v[108:111], v[116:119], v[32:35]
  ds_read_b128 v[116:119], v12 offset:384
  s_waitcnt lgkmcnt(4)
  v_mfma_f32_16x16x32_f16 v[32:35], v[104:107], v[120:123], v[32:35]
  v_mfma_f32_16x16x32_f16 v[36:39], v[108:111], v[120:123], v[36:39]
  ds_read_b128 v[120:123], v12 offset:896
  v_mfma_f32_16x16x32_f16 v[36:39], v[104:107], v[124:127], v[36:39]
  v_mfma_f32_16x16x32_f16 v[40:43], v[108:111], v[124:127], v[40:43]
  ds_read_b128 v[124:127], v12 offset:1408
  s_waitcnt lgkmcnt(3)
  v_mfma_f32_16x16x32_f16 v[40:43], v[104:107], v[2:5], v[40:43]
  v_mfma_f32_16x16x32_f16 v[44:47], v[108:111], v[2:5], v[44:47]
  ds_read_b128 v[2:5], v12 offset:1920
  v_mfma_f32_16x16x32_f16 v[44:47], v[104:107], v[112:115], v[44:47]
  ds_read_b128 v[112:115], v12 offset:2432
  s_waitcnt lgkmcnt(3)
  v_mfma_f32_16x16x32_f16 v[16:19], v[96:99], v[116:119], v[16:19]
  ds_read2_b32 v[104:105], v11 offset0:80 offset1:81
  ds_read2_b32 v[106:107], v11 offset0:82 offset1:83
  v_mfma_f32_16x16x32_f16 v[20:23], v[100:103], v[116:119], v[20:23]
  ds_read_b128 v[116:119], v12 offset:2944
  ds_read2_b32 v[108:109], v10 offset0:80 offset1:81
  v_mfma_f32_16x16x32_f16 v[20:23], v[96:99], v[120:123], v[20:23]
  ds_read2_b32 v[110:111], v10 offset0:82 offset1:83
  v_mfma_f32_16x16x32_f16 v[24:27], v[100:103], v[120:123], v[24:27]
  ds_read_b128 v[120:123], v12 offset:3456
  s_waitcnt lgkmcnt(7)
  v_mfma_f32_16x16x32_f16 v[24:27], v[96:99], v[124:127], v[24:27]
  v_mfma_f32_16x16x32_f16 v[28:31], v[100:103], v[124:127], v[28:31]
  ds_read_b128 v[124:127], v12 offset:3968
  v_mfma_f32_16x16x32_f16 v[28:31], v[96:99], v[2:5], v[28:31]
  v_mfma_f32_16x16x32_f16 v[32:35], v[100:103], v[2:5], v[32:35]
  ds_read_b128 v[2:5], v12 offset:320
  s_waitcnt lgkmcnt(3)
  v_mfma_f32_16x16x32_f16 v[32:35], v[96:99], v[112:115], v[32:35]
  v_mfma_f32_16x16x32_f16 v[36:39], v[100:103], v[112:115], v[36:39]
  ds_read_b128 v[112:115], v12 offset:832
  v_mfma_f32_16x16x32_f16 v[36:39], v[96:99], v[116:119], v[36:39]
  v_mfma_f32_16x16x32_f16 v[40:43], v[100:103], v[116:119], v[40:43]
  ds_read_b128 v[116:119], v12 offset:1344
  s_waitcnt lgkmcnt(3)
  v_mfma_f32_16x16x32_f16 v[40:43], v[96:99], v[120:123], v[40:43]
  v_mfma_f32_16x16x32_f16 v[44:47], v[100:103], v[120:123], v[44:47]
  ds_read_b128 v[120:123], v12 offset:1856
  v_mfma_f32_16x16x32_f16 v[44:47], v[96:99], v[124:127], v[44:47]
  ds_read_b128 v[124:127], v12 offset:2368
  s_waitcnt lgkmcnt(3)
  v_mfma_f32_16x16x32_f16 v[16:19], v[104:107], v[2:5], v[16:19]
  ds_read2_b32 v[96:97], v11 offset0:64 offset1:65
  ds_read2_b32 v[98:99], v11 offset0:66 offset1:67
  v_mfma_f32_16x16x32_f16 v[20:23], v[108:111], v[2:5], v[20:23]
  ds_read_b128 v[2:5], v12 offset:2880
  ds_read2_b32 v[100:101], v10 offset0:64 offset1:65
  v_mfma_f32_16x16x32_f16 v[20:23], v[104:107], v[112:115], v[20:23]
  ds_read2_b32 v[102:103], v10 offset0:66 offset1:67
  v_mfma_f32_16x16x32_f16 v[24:27], v[108:111], v[112:115], v[24:27]
  ds_read_b128 v[112:115], v12 offset:3392
  s_waitcnt lgkmcnt(7)
  v_mfma_f32_16x16x32_f16 v[24:27], v[104:107], v[116:119], v[24:27]
  v_mfma_f32_16x16x32_f16 v[28:31], v[108:111], v[116:119], v[28:31]
  ds_read_b128 v[116:119], v12 offset:3904
  v_mfma_f32_16x16x32_f16 v[28:31], v[104:107], v[120:123], v[28:31]
  v_mfma_f32_16x16x32_f16 v[32:35], v[108:111], v[120:123], v[32:35]
  ds_read_b128 v[120:123], v12 offset:256
  s_waitcnt lgkmcnt(3)
  v_mfma_f32_16x16x32_f16 v[32:35], v[104:107], v[124:127], v[32:35]
  v_mfma_f32_16x16x32_f16 v[36:39], v[108:111], v[124:127], v[36:39]
  ds_read_b128 v[124:127], v12 offset:768
  v_mfma_f32_16x16x32_f16 v[36:39], v[104:107], v[2:5], v[36:39]
  v_mfma_f32_16x16x32_f16 v[40:43], v[108:111], v[2:5], v[40:43]
  ds_read_b128 v[2:5], v12 offset:1280
  s_waitcnt lgkmcnt(3)
  v_mfma_f32_16x16x32_f16 v[40:43], v[104:107], v[112:115], v[40:43]
  v_mfma_f32_16x16x32_f16 v[44:47], v[108:111], v[112:115], v[44:47]
  ds_read_b128 v[112:115], v12 offset:1792
  v_mfma_f32_16x16x32_f16 v[44:47], v[104:107], v[116:119], v[44:47]
  ds_read_b128 v[116:119], v12 offset:2304
  s_waitcnt lgkmcnt(3)
  v_mfma_f32_16x16x32_f16 v[16:19], v[96:99], v[120:123], v[16:19]
  ds_read2_b32 v[104:105], v11 offset0:48 offset1:49
  ds_read2_b32 v[106:107], v11 offset0:50 offset1:51
  v_mfma_f32_16x16x32_f16 v[20:23], v[100:103], v[120:123], v[20:23]
  ds_read_b128 v[120:123], v12 offset:2816
  ds_read2_b32 v[108:109], v10 offset0:48 offset1:49
  v_mfma_f32_16x16x32_f16 v[20:23], v[96:99], v[124:127], v[20:23]
  ds_read2_b32 v[110:111], v10 offset0:50 offset1:51
  v_mfma_f32_16x16x32_f16 v[24:27], v[100:103], v[124:127], v[24:27]
  ds_read_b128 v[124:127], v12 offset:3328
  s_waitcnt lgkmcnt(7)
  v_mfma_f32_16x16x32_f16 v[24:27], v[96:99], v[2:5], v[24:27]
  v_mfma_f32_16x16x32_f16 v[28:31], v[100:103], v[2:5], v[28:31]
  ds_read_b128 v[2:5], v12 offset:3840
  v_mfma_f32_16x16x32_f16 v[28:31], v[96:99], v[112:115], v[28:31]
  v_mfma_f32_16x16x32_f16 v[32:35], v[100:103], v[112:115], v[32:35]
  ds_read_b128 v[112:115], v12 offset:192
  s_waitcnt lgkmcnt(3)
  v_mfma_f32_16x16x32_f16 v[32:35], v[96:99], v[116:119], v[32:35]
  v_mfma_f32_16x16x32_f16 v[36:39], v[100:103], v[116:119], v[36:39]
  ds_read_b128 v[116:119], v12 offset:704
  v_mfma_f32_16x16x32_f16 v[36:39], v[96:99], v[120:123], v[36:39]
  v_mfma_f32_16x16x32_f16 v[40:43], v[100:103], v[120:123], v[40:43]
  ds_read_b128 v[120:123], v12 offset:1216
  s_waitcnt lgkmcnt(3)
  v_mfma_f32_16x16x32_f16 v[40:43], v[96:99], v[124:127], v[40:43]
  v_mfma_f32_16x16x32_f16 v[44:47], v[100:103], v[124:127], v[44:47]
  ds_read_b128 v[124:127], v12 offset:1728
  v_mfma_f32_16x16x32_f16 v[44:47], v[96:99], v[2:5], v[44:47]
  ds_read_b128 v[2:5], v12 offset:2240
  s_waitcnt lgkmcnt(3)
  v_mfma_f32_16x16x32_f16 v[16:19], v[104:107], v[112:115], v[16:19]
  ds_read2_b32 v[96:97], v11 offset0:32 offset1:33
  ds_read2_b32 v[98:99], v11 offset0:34 offset1:35
  v_mfma_f32_16x16x32_f16 v[20:23], v[108:111], v[112:115], v[20:23]
  ds_read_b128 v[112:115], v12 offset:2752
  ds_read2_b32 v[100:101], v10 offset0:32 offset1:33
  v_mfma_f32_16x16x32_f16 v[20:23], v[104:107], v[116:119], v[20:23]
  ds_read2_b32 v[102:103], v10 offset0:34 offset1:35
  v_mfma_f32_16x16x32_f16 v[24:27], v[108:111], v[116:119], v[24:27]
  ds_read_b128 v[116:119], v12 offset:3264
  s_waitcnt lgkmcnt(7)
  v_mfma_f32_16x16x32_f16 v[24:27], v[104:107], v[120:123], v[24:27]
  v_mfma_f32_16x16x32_f16 v[28:31], v[108:111], v[120:123], v[28:31]
  ds_read_b128 v[120:123], v12 offset:3776
  v_mfma_f32_16x16x32_f16 v[28:31], v[104:107], v[124:127], v[28:31]
  v_mfma_f32_16x16x32_f16 v[32:35], v[108:111], v[124:127], v[32:35]
  ds_read_b128 v[124:127], v12 offset:128
  s_waitcnt lgkmcnt(3)
  v_mfma_f32_16x16x32_f16 v[32:35], v[104:107], v[2:5], v[32:35]
  v_mfma_f32_16x16x32_f16 v[36:39], v[108:111], v[2:5], v[36:39]
  ds_read_b128 v[2:5], v12 offset:640
  v_mfma_f32_16x16x32_f16 v[36:39], v[104:107], v[112:115], v[36:39]
  v_mfma_f32_16x16x32_f16 v[40:43], v[108:111], v[112:115], v[40:43]
  ds_read_b128 v[112:115], v12 offset:1152
  s_waitcnt lgkmcnt(3)
  v_mfma_f32_16x16x32_f16 v[40:43], v[104:107], v[116:119], v[40:43]
  v_mfma_f32_16x16x32_f16 v[44:47], v[108:111], v[116:119], v[44:47]
  ds_read_b128 v[116:119], v12 offset:1664
  v_mfma_f32_16x16x32_f16 v[44:47], v[104:107], v[120:123], v[44:47]
  ds_read_b128 v[120:123], v12 offset:2176
  s_waitcnt lgkmcnt(3)
  v_mfma_f32_16x16x32_f16 v[16:19], v[96:99], v[124:127], v[16:19]
  ds_read2_b32 v[104:105], v11 offset0:16 offset1:17
  ds_read2_b32 v[106:107], v11 offset0:18 offset1:19
  v_mfma_f32_16x16x32_f16 v[20:23], v[100:103], v[124:127], v[20:23]
  ds_read_b128 v[124:127], v12 offset:2688
  ds_read2_b32 v[108:109], v10 offset0:16 offset1:17
  v_mfma_f32_16x16x32_f16 v[20:23], v[96:99], v[2:5], v[20:23]
  ds_read2_b32 v[110:111], v10 offset0:18 offset1:19
  v_mfma_f32_16x16x32_f16 v[24:27], v[100:103], v[2:5], v[24:27]
  ds_read_b128 v[2:5], v12 offset:3200
  s_waitcnt lgkmcnt(7)
  v_mfma_f32_16x16x32_f16 v[24:27], v[96:99], v[112:115], v[24:27]
  v_mfma_f32_16x16x32_f16 v[28:31], v[100:103], v[112:115], v[28:31]
  ds_read_b128 v[112:115], v12 offset:3712
  v_mfma_f32_16x16x32_f16 v[28:31], v[96:99], v[116:119], v[28:31]
  v_mfma_f32_16x16x32_f16 v[32:35], v[100:103], v[116:119], v[32:35]
  ds_read_b128 v[116:119], v12 offset:64
  s_waitcnt lgkmcnt(3)
  v_mfma_f32_16x16x32_f16 v[32:35], v[96:99], v[120:123], v[32:35]
  v_mfma_f32_16x16x32_f16 v[36:39], v[100:103], v[120:123], v[36:39]
  ds_read_b128 v[120:123], v12 offset:576
  v_mfma_f32_16x16x32_f16 v[36:39], v[96:99], v[124:127], v[36:39]
  v_mfma_f32_16x16x32_f16 v[40:43], v[100:103], v[124:127], v[40:43]
  ds_read_b128 v[124:127], v12 offset:1088
  s_waitcnt lgkmcnt(3)
  v_mfma_f32_16x16x32_f16 v[40:43], v[96:99], v[2:5], v[40:43]
  v_mfma_f32_16x16x32_f16 v[44:47], v[100:103], v[2:5], v[44:47]
  ds_read_b128 v[2:5], v12 offset:1600
  v_mfma_f32_16x16x32_f16 v[44:47], v[96:99], v[112:115], v[44:47]
  ds_read_b128 v[112:115], v12 offset:2112
  s_waitcnt lgkmcnt(3)
  v_mfma_f32_16x16x32_f16 v[16:19], v[104:107], v[116:119], v[16:19]
  v_mfma_f32_16x16x32_f16 v[20:23], v[108:111], v[116:119], v[20:23]
  ds_read_b128 v[116:119], v12 offset:2624
  v_mfma_f32_16x16x32_f16 v[20:23], v[104:107], v[120:123], v[20:23]
  v_mfma_f32_16x16x32_f16 v[24:27], v[108:111], v[120:123], v[24:27]
  ds_read_b128 v[120:123], v12 offset:3136
  s_waitcnt lgkmcnt(3)
  v_mfma_f32_16x16x32_f16 v[24:27], v[104:107], v[124:127], v[24:27]
  v_mul_f32 v16, v16, v8
  v_mul_f32 v17, v17, v8
  v_mfma_f32_16x16x32_f16 v[28:31], v[108:111], v[124:127], v[28:31]
  ds_read_b128 v[124:127], v12 offset:3648
  v_mul_f32 v18, v18, v8
  v_mfma_f32_16x16x32_f16 v[28:31], v[104:107], v[2:5], v[28:31]
  v_mul_f32 v19, v19, v8
  v_cvt_pk_bf16_f32 v16, v16, v17
  v_mfma_f32_16x16x32_f16 v[32:35], v[108:111], v[2:5], v[32:35]
  v_cvt_pk_bf16_f32 v17, v18, v19
  s_waitcnt lgkmcnt(2)
  v_mfma_f32_16x16x32_f16 v[32:35], v[104:107], v[112:115], v[32:35]
  ds_write_b64 v9, v[16:17] offset:0
  v_mfma_f32_16x16x32_f16 v[36:39], v[108:111], v[112:115], v[36:39]
  ds_read_b128 v[112:115], v12 offset:496
  v_mul_f32 v20, v20, v8
  v_mfma_f32_16x16x32_f16 v[36:39], v[104:107], v[116:119], v[36:39]
  v_mul_f32 v21, v21, v8
  v_mul_f32 v22, v22, v8
  v_mfma_f32_16x16x32_f16 v[40:43], v[108:111], v[116:119], v[40:43]
  v_mul_f32 v23, v23, v8
  s_waitcnt lgkmcnt(2)
  v_mfma_f32_16x16x32_f16 v[40:43], v[104:107], v[120:123], v[40:43]
  v_cvt_pk_bf16_f32 v20, v20, v21
  v_cvt_pk_bf16_f32 v21, v22, v23
  v_mfma_f32_16x16x32_f16 v[44:47], v[108:111], v[120:123], v[44:47]
  ds_write_b64 v9, v[20:21] offset:512
  v_mfma_f32_16x16x32_f16 v[44:47], v[104:107], v[124:127], v[44:47]
  ds_read_b128 v[16:19], v13 offset:2048
  s_waitcnt lgkmcnt(2)
  v_mfma_f32_16x16x32_f16 v[96:99], v[112:115], v[88:91], 0
  ds_read_b128 v[116:119], v12 offset:512
  ds_read_b128 v[20:23], v13 offset:3072
  v_mfma_f32_16x16x32_f16 v[100:103], v[112:115], v[92:95], 0
  ds_read_b128 v[2:5], v13 offset:4096
  s_waitcnt lgkmcnt(3)
  v_mfma_f32_16x16x32_f16 v[104:107], v[112:115], v[16:19], 0
  ds_read_b128 v[120:123], v12 offset:16
  s_waitcnt lgkmcnt(2)
  v_mfma_f32_16x16x32_f16 v[108:111], v[116:119], v[20:23], 0
  v_cvt_pk_f16_f32 v96, v96, v97
  v_cvt_pk_f16_f32 v97, v98, v99
  v_cvt_pk_f16_f32 v98, v100, v101
  v_cvt_pk_f16_f32 v99, v102, v103
  s_nop 1
  v_mfma_f32_16x16x32_f16 v[24:27], v[96:99], v[48:51], v[24:27]
  ds_read_b128 v[124:127], v12 offset:1008
  ds_read_b128 v[112:115], v12 offset:1024
  v_mfma_f32_16x16x32_f16 v[28:31], v[96:99], v[52:55], v[28:31]
  v_cvt_pk_f16_f32 v104, v104, v105
  v_cvt_pk_f16_f32 v105, v106, v107
  v_mfma_f32_16x16x32_f16 v[32:35], v[96:99], v[56:59], v[32:35]
  v_cvt_pk_f16_f32 v106, v108, v109
  v_cvt_pk_f16_f32 v107, v110, v111
  v_mfma_f32_16x16x32_f16 v[96:99], v[116:119], v[92:95], 0
  s_waitcnt lgkmcnt(2)
  v_pk_mul_f16 v2, v2, s71 op_sel_hi:[1,0]
  v_mfma_f32_16x16x32_f16 v[100:103], v[116:119], v[88:91], 0
  v_pk_mul_f16 v3, v3, s71 op_sel_hi:[1,0]
  v_pk_mul_f16 v4, v4, s71 op_sel_hi:[1,0]
  v_mfma_f32_16x16x32_f16 v[32:35], v[104:107], v[72:75], v[32:35]
  v_pk_mul_f16 v5, v5, s71 op_sel_hi:[1,0]
  ds_read_b128 v[116:119], v12 offset:528
  v_mfma_f32_16x16x32_f16 v[36:39], v[104:107], v[76:79], v[36:39]
  v_cvt_pk_f16_f32 v96, v96, v97
  v_cvt_pk_f16_f32 v97, v98, v99
  v_mfma_f32_16x16x32_f16 v[40:43], v[104:107], v[80:83], v[40:43]
  v_cvt_pk_f16_f32 v98, v100, v101
  v_cvt_pk_f16_f32 v99, v102, v103
  v_mfma_f32_16x16x32_f16 v[44:47], v[104:107], v[84:87], v[44:47]
  v_mfma_f32_16x16x32_f16 v[28:31], v[2:5], v[120:123], v[28:31]
  ds_read_b128 v[120:123], v12 offset:1520
  s_waitcnt lgkmcnt(2)
  v_mfma_f32_16x16x32_f16 v[104:107], v[124:127], v[88:91], 0
  v_mfma_f32_16x16x32_f16 v[108:111], v[124:127], v[92:95], 0
  v_mfma_f32_16x16x32_f16 v[24:27], v[96:99], v[60:63], v[24:27]
  v_mfma_f32_16x16x32_f16 v[28:31], v[96:99], v[64:67], v[28:31]
  v_cvt_pk_f16_f32 v104, v104, v105
  v_cvt_pk_f16_f32 v105, v106, v107
  v_mfma_f32_16x16x32_f16 v[32:35], v[96:99], v[68:71], v[32:35]
  v_cvt_pk_f16_f32 v106, v108, v109
  v_cvt_pk_f16_f32 v107, v110, v111
  v_mfma_f32_16x16x32_f16 v[96:99], v[124:127], v[16:19], 0
  v_mul_f32 v24, v24, v8
  v_mul_f32 v25, v25, v8
  v_mfma_f32_16x16x32_f16 v[100:103], v[112:115], v[20:23], 0
  v_mul_f32 v26, v26, v8
  v_mul_f32 v27, v27, v8
  v_mfma_f32_16x16x32_f16 v[28:31], v[104:107], v[48:51], v[28:31]
  v_cvt_pk_bf16_f32 v24, v24, v25
  v_cvt_pk_bf16_f32 v25, v26, v27
  v_mfma_f32_16x16x32_f16 v[32:35], v[104:107], v[52:55], v[32:35]
  ds_write_b64 v9, v[24:25] offset:1024
  v_mfma_f32_16x16x32_f16 v[36:39], v[104:107], v[56:59], v[36:39]
  v_cvt_pk_f16_f32 v96, v96, v97
  v_cvt_pk_f16_f32 v97, v98, v99
  v_mfma_f32_16x16x32_f16 v[104:107], v[112:115], v[92:95], 0
  v_cvt_pk_f16_f32 v98, v100, v101
  v_cvt_pk_f16_f32 v99, v102, v103
  v_mfma_f32_16x16x32_f16 v[108:111], v[112:115], v[88:91], 0
  ds_read_b128 v[124:127], v12 offset:1536
  ds_read_b128 v[112:115], v12 offset:1040
  v_mfma_f32_16x16x32_f16 v[36:39], v[96:99], v[72:75], v[36:39]
  v_mfma_f32_16x16x32_f16 v[40:43], v[96:99], v[76:79], v[40:43]
  v_cvt_pk_f16_f32 v104, v104, v105
  v_cvt_pk_f16_f32 v105, v106, v107
  v_mfma_f32_16x16x32_f16 v[44:47], v[96:99], v[80:83], v[44:47]
  v_cvt_pk_f16_f32 v106, v108, v109
  s_waitcnt lgkmcnt(2)
  v_mfma_f32_16x16x32_f16 v[32:35], v[2:5], v[116:119], v[32:35]
  v_cvt_pk_f16_f32 v107, v110, v111
  ds_read_b128 v[116:119], v12 offset:2032
  v_mfma_f32_16x16x32_f16 v[96:99], v[120:123], v[88:91], 0
  v_mfma_f32_16x16x32_f16 v[100:103], v[120:123], v[92:95], 0
  v_mfma_f32_16x16x32_f16 v[28:31], v[104:107], v[60:63], v[28:31]
  v_mov_b32 v7, 4
  v_mfma_f32_16x16x32_f16 v[32:35], v[104:107], v[64:67], v[32:35]
  v_cvt_pk_f16_f32 v96, v96, v97
  v_cvt_pk_f16_f32 v97, v98, v99
  v_mfma_f32_16x16x32_f16 v[36:39], v[104:107], v[68:71], v[36:39]
  v_cvt_pk_f16_f32 v98, v100, v101
  v_cvt_pk_f16_f32 v99, v102, v103
  v_mfma_f32_16x16x32_f16 v[104:107], v[120:123], v[16:19], 0
  v_mul_f32 v28, v28, v8
  s_waitcnt lgkmcnt(0)
  v_mfma_f32_16x16x32_f16 v[108:111], v[124:127], v[20:23], 0
  v_mul_f32 v29, v29, v8
  v_mul_f32 v30, v30, v8
  v_mfma_f32_16x16x32_f16 v[32:35], v[96:99], v[48:51], v[32:35]
  v_mul_f32 v31, v31, v8
  v_cvt_pk_bf16_f32 v28, v28, v29
  v_mfma_f32_16x16x32_f16 v[36:39], v[96:99], v[52:55], v[36:39]
  v_cvt_pk_f16_f32 v104, v104, v105
  v_cvt_pk_f16_f32 v105, v106, v107
  v_mfma_f32_16x16x32_f16 v[40:43], v[96:99], v[56:59], v[40:43]
  v_cvt_pk_f16_f32 v106, v108, v109
  v_cvt_pk_f16_f32 v107, v110, v111
  v_mfma_f32_16x16x32_f16 v[96:99], v[124:127], v[92:95], 0
  v_cvt_pk_bf16_f32 v29, v30, v31
  ds_read_b128 v[120:123], v12 offset:2048
  v_mfma_f32_16x16x32_f16 v[100:103], v[124:127], v[88:91], 0
  ds_write_b64 v9, v[28:29] offset:1536
  v_mfma_f32_16x16x32_f16 v[40:43], v[104:107], v[72:75], v[40:43]
  ds_write_b32 v15, v7 offset:48
  v_mfma_f32_16x16x32_f16 v[44:47], v[104:107], v[76:79], v[44:47]
  v_cvt_pk_f16_f32 v96, v96, v97
  v_cvt_pk_f16_f32 v97, v98, v99
  v_mfma_f32_16x16x32_f16 v[36:39], v[2:5], v[112:115], v[36:39]
  v_cvt_pk_f16_f32 v98, v100, v101
  v_cvt_pk_f16_f32 v99, v102, v103
  v_mfma_f32_16x16x32_f16 v[104:107], v[116:119], v[88:91], 0
  ds_read_b128 v[124:127], v12 offset:1552
  ds_read_b128 v[112:115], v12 offset:2544
  v_mfma_f32_16x16x32_f16 v[108:111], v[116:119], v[92:95], 0
  v_mfma_f32_16x16x32_f16 v[32:35], v[96:99], v[60:63], v[32:35]
  v_mfma_f32_16x16x32_f16 v[36:39], v[96:99], v[64:67], v[36:39]
  v_cvt_pk_f16_f32 v104, v104, v105
  v_cvt_pk_f16_f32 v105, v106, v107
  v_mfma_f32_16x16x32_f16 v[40:43], v[96:99], v[68:71], v[40:43]
  v_cvt_pk_f16_f32 v106, v108, v109
  v_cvt_pk_f16_f32 v107, v110, v111
  v_mfma_f32_16x16x32_f16 v[96:99], v[116:119], v[16:19], 0
  v_mul_f32 v32, v32, v8
  s_waitcnt lgkmcnt(0)
  v_mfma_f32_16x16x32_f16 v[100:103], v[120:123], v[20:23], 0
  v_mul_f32 v33, v33, v8
  v_mul_f32 v34, v34, v8
  v_mfma_f32_16x16x32_f16 v[36:39], v[104:107], v[48:51], v[36:39]
  v_mul_f32 v35, v35, v8
  v_cvt_pk_bf16_f32 v32, v32, v33
  v_mfma_f32_16x16x32_f16 v[40:43], v[104:107], v[52:55], v[40:43]
  v_cvt_pk_f16_f32 v96, v96, v97
  v_cvt_pk_f16_f32 v97, v98, v99
  v_mfma_f32_16x16x32_f16 v[44:47], v[104:107], v[56:59], v[44:47]
  v_cvt_pk_f16_f32 v98, v100, v101
  v_cvt_pk_f16_f32 v99, v102, v103
  v_mfma_f32_16x16x32_f16 v[104:107], v[120:123], v[92:95], 0
  v_cvt_pk_bf16_f32 v33, v34, v35
  ds_read_b128 v[116:119], v12 offset:2560
  v_mfma_f32_16x16x32_f16 v[108:111], v[120:123], v[88:91], 0
  ds_write_b64 v9, v[32:33] offset:2048
  v_mfma_f32_16x16x32_f16 v[44:47], v[96:99], v[72:75], v[44:47]
  ds_read_b128 v[120:123], v12 offset:2064
  v_mfma_f32_16x16x32_f16 v[40:43], v[2:5], v[124:127], v[40:43]
  v_cvt_pk_f16_f32 v104, v104, v105
  v_cvt_pk_f16_f32 v105, v106, v107
  v_mfma_f32_16x16x32_f16 v[96:99], v[112:115], v[88:91], 0
  v_cvt_pk_f16_f32 v106, v108, v109
  v_cvt_pk_f16_f32 v107, v110, v111
  v_mfma_f32_16x16x32_f16 v[100:103], v[112:115], v[92:95], 0
  ds_read_b128 v[124:127], v12 offset:3056
  ds_read_b128 v[112:115], v12 offset:3072
  v_mfma_f32_16x16x32_f16 v[36:39], v[104:107], v[60:63], v[36:39]
  v_mfma_f32_16x16x32_f16 v[40:43], v[104:107], v[64:67], v[40:43]
  v_cvt_pk_f16_f32 v96, v96, v97
  v_cvt_pk_f16_f32 v97, v98, v99
  v_mfma_f32_16x16x32_f16 v[44:47], v[104:107], v[68:71], v[44:47]
  v_cvt_pk_f16_f32 v98, v100, v101
  s_waitcnt lgkmcnt(2)
  v_mfma_f32_16x16x32_f16 v[104:107], v[116:119], v[92:95], 0
  v_cvt_pk_f16_f32 v99, v102, v103
  v_mul_f32 v36, v36, v8
  v_mfma_f32_16x16x32_f16 v[108:111], v[116:119], v[88:91], 0
  v_mul_f32 v37, v37, v8
  v_mul_f32 v38, v38, v8
  v_mfma_f32_16x16x32_f16 v[40:43], v[96:99], v[48:51], v[40:43]
  v_mul_f32 v39, v39, v8
  v_cvt_pk_bf16_f32 v36, v36, v37
  v_mfma_f32_16x16x32_f16 v[44:47], v[96:99], v[52:55], v[44:47]
  v_cvt_pk_f16_f32 v104, v104, v105
  v_cvt_pk_f16_f32 v105, v106, v107
  v_mfma_f32_16x16x32_f16 v[44:47], v[2:5], v[120:123], v[44:47]
  v_cvt_pk_f16_f32 v106, v108, v109
  s_waitcnt lgkmcnt(0)
  v_mfma_f32_16x16x32_f16 v[96:99], v[124:127], v[88:91], 0
  v_cvt_pk_f16_f32 v107, v110, v111
  v_cvt_pk_bf16_f32 v37, v38, v39
  v_mfma_f32_16x16x32_f16 v[100:103], v[124:127], v[92:95], 0
  ds_write_b64 v9, v[36:37] offset:2560
  v_mfma_f32_16x16x32_f16 v[40:43], v[104:107], v[60:63], v[40:43]
  v_mfma_f32_16x16x32_f16 v[44:47], v[104:107], v[64:67], v[44:47]
  v_cvt_pk_f16_f32 v96, v96, v97
  v_cvt_pk_f16_f32 v97, v98, v99
  v_mfma_f32_16x16x32_f16 v[104:107], v[112:115], v[92:95], 0
  v_cvt_pk_f16_f32 v98, v100, v101
  v_cvt_pk_f16_f32 v99, v102, v103
  v_mfma_f32_16x16x32_f16 v[108:111], v[112:115], v[88:91], 0
  v_mul_f32 v40, v40, v8
  v_mul_f32 v41, v41, v8
  v_mfma_f32_16x16x32_f16 v[44:47], v[96:99], v[48:51], v[44:47]
  s_nop 1
  v_cvt_pk_f16_f32 v104, v104, v105
  v_cvt_pk_f16_f32 v105, v106, v107
  s_nop 0
  v_cvt_pk_f16_f32 v106, v108, v109
  v_cvt_pk_f16_f32 v107, v110, v111
  s_nop 1
  v_mfma_f32_16x16x32_f16 v[44:47], v[104:107], v[60:63], v[44:47]
  v_mul_f32 v42, v42, v8
  v_mul_f32 v43, v43, v8
  v_cvt_pk_bf16_f32 v40, v40, v41
  v_cvt_pk_bf16_f32 v41, v42, v43
  ds_write_b64 v9, v[40:41] offset:3072
  s_nop 2
  v_mul_f32 v44, v44, v8
  v_mul_f32 v45, v45, v8
  v_mul_f32 v46, v46, v8
  v_mul_f32 v47, v47, v8
  v_cvt_pk_bf16_f32 v44, v44, v45
  v_cvt_pk_bf16_f32 v45, v46, v47
  ds_write_b64 v9, v[44:45] offset:3584
  v_mov_b32 v7, 8
  ds_write_b32 v15, v7 offset:48
  s_endpgm
.p2align 6
K_FAR:
  ds_write_b128 v99, v[76:79]
  ds_write_b128 v99, v[80:83] offset:1024
  s_nop 0
  v_mov_b32 v94, 1
  ds_write_b32 v92, v94 offset:64
  s_branch K_PS2B
K_PS2:
K_PS2B:
  ds_read_b32 v94, v93 offset:64
  s_waitcnt lgkmcnt(0)
  v_cmp_gt_u32 vcc, 1, v94
  s_cbranch_vccnz K_PS2
  ds_read_b128 v[16:19], v99 offset:5120
  ds_read_b128 v[20:23], v99 offset:6144
  s_waitcnt lgkmcnt(1)
  v_pk_add_f32 v[80:81], v[80:81], v[16:17]
  v_pk_add_f32 v[82:83], v[82:83], v[18:19]
  s_waitcnt lgkmcnt(0)
  v_pk_add_f32 v[84:85], v[84:85], v[20:21]
  v_pk_add_f32 v[86:87], v[86:87], v[22:23]
  v_cvt_pk_f16_f32 v16, v80, v81
  v_cvt_pk_f16_f32 v17, v82, v83
  v_cvt_pk_f16_f32 v18, v84, v85
  v_cvt_pk_f16_f32 v19, v86, v87
  v_cvt_pk_f16_f32 v89, v84, v84
  s_mov_b32 exec_lo, 0
  ds_write_b16 v125, v17
  ds_write_b16 v125, v17 offset:1986
  ds_write_b16_d16_hi v124, v17
  ds_write_b16_d16_hi v124, v17 offset:1986
  s_mov_b32 exec_hi, -4
  ds_write_b16 v125, v16 offset:16
  ds_write_b16 v125, v16 offset:2002
  ds_write_b16_d16_hi v124, v16 offset:16
  ds_write_b16_d16_hi v124, v16 offset:2002
  s_mov_b32 exec_hi, 1
  s_mov_b32 exec_lo, -2
  ds_write_b16 v126, v18 offset:48
  ds_write_b16 v126, v18 offset:2034
  s_mov_b32 exec_hi, 0
  s_mov_b32 exec_lo, -1
  ds_write_b16_d16_hi v126, v18 offset:32
  ds_write_b16_d16_hi v126, v18 offset:2018
  ds_write_b16 v126, v19 offset:16
  ds_write_b16 v126, v19 offset:2002
  ds_write_b16_d16_hi v126, v19
  ds_write_b16_d16_hi v126, v19 offset:1986
  s_mov_b64 exec, -1
  v_or_b32 v127, 0x10000, v89
  s_lshl_b32 s79, s52, 2
  v_mov_b32 v4, s79
  v_mov_b32 v93, 1
  s_mov_b64 exec, 1
  ds_write_b32 v4, v127 offset:640
  s_waitcnt vmcnt(0)
  ds_add_u32 v15, v93 offset:112
  s_mov_b64 exec, -1
  s_setprio 1
  s_lshl_b32 s62, s29, 14
  s_lshl_b32 s79, s52, 9
  s_add_u32 s62, s62, s79
  s_add_u32 s62, s62, 0x450000
  s_add_u32 s63, s62, 4096
  s_add_u32 s64, s62, 8192
  s_add_u32 s65, s62, 12288
  s_lshl_b32 s73, s28, 11
  s_add_u32 s73, s73, s62
  s_lshl_b32 s77, s28, 16
  s_add_u32 s77, s77, 0x500000
  s_lshl_b32 s57, s29, 11
  s_add_u32 s57, s57, s79
  s_add_u32 s57, s57, s77
  s_mov_b64 s[54:55], s[14:15]
  s_mov_b32 s12, 0x07060503
  s_mov_b32 s13, 0x07060502
  s_mov_b32 s14, 0x07060501
  s_mov_b32 s15, 0x04000c0c
  s_mov_b32 s16, 0x0706000c
  s_lshl_b32 s18, s28, 8
  s_cmp_lg_u32 s30, 1
  s_cbranch_scc1 K_NOKP
  ds_read_b32 v90, v15 offset:0
  v_mov_b32 v92, 0x3f803f80
  v_mov_b32 v93, v92
  v_lshlrev_b32 v3, 3, v1
  v_add_u32 v3, 150144, v3
  ds_write_b64 v3, v[92:93]
  ds_write_b64 v3, v[92:93] offset:64
  v_lshlrev_b32 v2, 3, v1
  s_setprio 3
  s_lshl_b32 s60, s28, 10
  s_add_u32 s60, s60, 0x441000
  s_mov_b32 s83, 0x20000
  v_add_u32 v3, s18, v95
  s_mov_b32 m0, 149504
  s_branch K_KWB
K_KW:
  s_sleep 1
K_KWB:
  ds_read_b32 v93, v15 offset:20
  s_waitcnt lgkmcnt(0)
  v_cmp_gt_u32 vcc, 8, v93
  s_cbranch_vccnz K_KW
  ds_read_b64 v[72:73], v2 offset:128
  ds_read_b32 v5, v15 offset:8
  v_readfirstlane_b32 s46, v90
  v_mov_b32 v74, v90
  v_mov_b32 v75, v90
  s_lshl_b32 s61, s29, 5
  s_add_u32 s61, s61, s60
  s_waitcnt lgkmcnt(0)
  v_readfirstlane_b32 s47, v5
  v_mov_b32 v80, v72
  s_nop 1
  v_max_u32_dpp v80, v80, v80 quad_perm:[1,0,3,2] row_mask:0xf bank_mask:0xf
  s_nop 1
  v_max_u32_dpp v80, v80, v80 quad_perm:[2,3,0,1] row_mask:0xf bank_mask:0xf
  s_nop 1
  v_max_u32_dpp v80, v80, v80 row_half_mirror row_mask:0xf bank_mask:0xf
  s_nop 1
  v_max_u32_dpp v80, v80, v80 row_mirror row_mask:0xf bank_mask:0xf
  s_nop 1
  v_max_u32_dpp v80, v80, v80 row_bcast:15 row_mask:0xa bank_mask:0xf
  s_nop 1
  v_max_u32_dpp v80, v80, v80 row_bcast:31 row_mask:0xc bank_mask:0xf
  s_nop 0
  v_readlane_b32 s78, v80, 63
  s_nop 1
  v_cmp_ne_u32 s[66:67], s78, v72
  s_nop 1
  v_cndmask_b32 v80, 0, v72, s[66:67]
  s_nop 1
  v_max_u32_dpp v80, v80, v80 quad_perm:[1,0,3,2] row_mask:0xf bank_mask:0xf
  s_nop 1
  v_max_u32_dpp v80, v80, v80 quad_perm:[2,3,0,1] row_mask:0xf bank_mask:0xf
  s_nop 1
  v_max_u32_dpp v80, v80, v80 row_half_mirror row_mask:0xf bank_mask:0xf
  s_nop 1
  v_max_u32_dpp v80, v80, v80 row_mirror row_mask:0xf bank_mask:0xf
  s_nop 1
  v_max_u32_dpp v80, v80, v80 row_bcast:15 row_mask:0xa bank_mask:0xf
  s_nop 1
  v_max_u32_dpp v80, v80, v80 row_bcast:31 row_mask:0xc bank_mask:0xf
  s_nop 0
  v_readlane_b32 s79, v80, 63
  v_cndmask_b32 v80, 0, 16, s[66:67]
  s_nop 0
  v_cmp_le_u32 vcc, s79, v72
  s_nop 0
  s_mov_b64 exec, vcc
  s_cmp_lg_u32 s47, 0
  s_cbranch_scc1 K_KS_W
  buffer_store_dwordx4 v[72:75], v80, s[32:35], s61 offen
  s_branch K_KS_D
K_KS_W:
  buffer_store_dwordx4 v[72:75], v80, s[32:35], s61 offen sc1
K_KS_D:
  s_mov_b64 exec, -1
K_P3:
  s_nop 0
  buffer_load_dwordx4 v[72:75], v95, s[32:35], s60 offen sc1
  s_sub_u32 s83, s83, 1
  s_waitcnt vmcnt(0)
  s_cbranch_scc1 K_P3D
  v_cmp_ne_u32 vcc, s46, v74
  s_cbranch_vccnz K_P3
K_P3D:
  v_mov_b32 v80, v72
  s_nop 1
  v_max_u32_dpp v80, v80, v80 quad_perm:[1,0,3,2] row_mask:0xf bank_mask:0xf
  s_nop 1
  v_max_u32_dpp v80, v80, v80 quad_perm:[2,3,0,1] row_mask:0xf bank_mask:0xf
  s_nop 1
  v_max_u32_dpp v80, v80, v80 row_half_mirror row_mask:0xf bank_mask:0xf
  s_nop 1
  v_max_u32_dpp v80, v80, v80 row_mirror row_mask:0xf bank_mask:0xf
  s_nop 1
  v_max_u32_dpp v80, v80, v80 row_bcast:15 row_mask:0xa bank_mask:0xf
  s_nop 1
  v_max_u32_dpp v80, v80, v80 row_bcast:31 row_mask:0xc bank_mask:0xf
  s_nop 0
  v_readlane_b32 s78, v80, 63
  s_nop 1
  v_cmp_ne_u32 s[66:67], s78, v72
  s_nop 1
  v_cndmask_b32 v80, 0, v72, s[66:67]
  s_nop 1
  v_max_u32_dpp v80, v80, v80 quad_perm:[1,0,3,2] row_mask:0xf bank_mask:0xf
  s_nop 1
  v_max_u32_dpp v80, v80, v80 quad_perm:[2,3,0,1] row_mask:0xf bank_mask:0xf
  s_nop 1
  v_max_u32_dpp v80, v80, v80 row_half_mirror row_mask:0xf bank_mask:0xf
  s_nop 1
  v_max_u32_dpp v80, v80, v80 row_mirror row_mask:0xf bank_mask:0xf
  s_nop 1
  v_max_u32_dpp v80, v80, v80 row_bcast:15 row_mask:0xa bank_mask:0xf
  s_nop 1
  v_max_u32_dpp v80, v80, v80 row_bcast:31 row_mask:0xc bank_mask:0xf
  s_nop 0
  v_readlane_b32 s79, v80, 63
  s_andn2_b32 s78, 0xffe, s78
  s_andn2_b32 s61, 0xffe, s79
  v_cndmask_b32 v80, 0, 8, s[66:67]
  v_cmp_le_u32 vcc, s79, v72
  v_mov_b32 v92, s78
  s_mov_b32 exec_lo, 0xfff00000
  s_mov_b32 exec_hi, 15
  v_mov_b32 v92, s61
  v_add_u32 v3, -320, v3
  s_mov_b32 exec_lo, 0xfff0ffff
  v_lshl_add_u32 v3, v92, 10, v3
  global_load_lds_dwordx4 v3, s[44:45]
  s_mov_b64 exec, vcc
  ds_write_b64 v80, v[72:73] offset:96
  v_mov_b32 v93, 1
  s_waitcnt vmcnt(0)
  ds_write_b32 v15, v93 offset:120
  s_cmp_lg_u32 s2, 0
  s_cbranch_scc1 K_NOZ
  s_mov_b32 s78, 0x0
  buffer_store_dword v74, v15, s[32:35], s78 offen sc1
K_NOZ:
  s_mov_b64 exec, -1
  s_setprio 1
K_NOKP:
  s_branch K_XWB
K_XW:
  s_sleep 4
K_XWB:
  ds_read_b32 v92, v15 offset:120
  s_waitcnt lgkmcnt(0)
  v_cmp_eq_u32 vcc, 0, v92
  s_cbranch_vccnz K_XW
  ds_read_b32 v5, v15 offset:8
  ds_read_b128 v[40:43], v15 offset:96
  ds_read_b32 v90, v15 offset:0
  ds_read_b128 v[48:51], v10 offset:0
  ds_read_b128 v[52:55], v10 offset:64
  ds_read_b128 v[56:59], v10 offset:128
  ds_read_b128 v[60:63], v10 offset:192
  v_mov_b32 v93, 1
  s_waitcnt lgkmcnt(4)
  v_and_b32 v44, 0xffff0000, v41
  v_and_b32 v45, 0xffff0000, v43
  v_lshlrev_b32 v46, 16, v41
  v_lshlrev_b32 v47, 16, v43
  v_rcp_f32 v44, v44
  v_rcp_f32 v45, v45
  v_readfirstlane_b32 s47, v5
  s_cmp_ge_u32 s29, 28
  s_cbranch_scc1 K_NOFFN
  s_setprio 3
  s_branch K_GWB
K_GW:
  s_sleep 2
K_GWB:
  ds_read_b32 v92, v15 offset:24
  s_waitcnt lgkmcnt(0)
  v_cmp_gt_u32 vcc, 8, v92
  s_cbranch_vccnz K_GW
  ds_read_b64_tr_b16 v[64:65], v11 offset:0
  ds_read_b64_tr_b16 v[66:67], v11 offset:1024
  ds_read_b64_tr_b16 v[68:69], v11 offset:32768
  ds_read_b64_tr_b16 v[70:71], v11 offset:33792
  ds_read_b64_tr_b16 v[72:73], v12 offset:0
  ds_read_b64_tr_b16 v[74:75], v12 offset:1024
  ds_read_b64_tr_b16 v[76:77], v12 offset:32768
  ds_read_b64_tr_b16 v[78:79], v12 offset:33792
  ds_read_b64_tr_b16 v[80:81], v11 offset:8192
  ds_read_b64_tr_b16 v[82:83], v11 offset:9216
  ds_read_b64_tr_b16 v[84:85], v11 offset:40960
  ds_read_b64_tr_b16 v[86:87], v11 offset:41984
  s_waitcnt lgkmcnt(10)
  v_mfma_f32_16x16x32_bf16 v[16:19], v[48:51], v[64:67], 0
  ds_read_b64_tr_b16 v[64:65], v12 offset:8192
  ds_read_b64_tr_b16 v[66:67], v12 offset:9216
  s_waitcnt lgkmcnt(10)
  v_mfma_f32_16x16x32_bf16 v[20:23], v[48:51], v[68:71], 0
  ds_read_b64_tr_b16 v[68:69], v12 offset:40960
  ds_read_b64_tr_b16 v[70:71], v12 offset:41984
  s_waitcnt lgkmcnt(10)
  v_mfma_f32_16x16x32_bf16 v[24:27], v[48:51], v[72:75], 0
  ds_read_b64_tr_b16 v[72:73], v11 offset:16384
  ds_read_b64_tr_b16 v[74:75], v11 offset:17408
  s_waitcnt lgkmcnt(10)
  v_mfma_f32_16x16x32_bf16 v[28:31], v[48:51], v[76:79], 0
  ds_read_b64_tr_b16 v[76:77], v11 offset:49152
  ds_read_b64_tr_b16 v[78:79], v11 offset:50176
  s_waitcnt lgkmcnt(10)
  v_mfma_f32_16x16x32_bf16 v[16:19], v[52:55], v[80:83], v[16:19]
  ds_read_b64_tr_b16 v[80:81], v12 offset:16384
  ds_read_b64_tr_b16 v[82:83], v12 offset:17408
  s_waitcnt lgkmcnt(10)
  v_mfma_f32_16x16x32_bf16 v[20:23], v[52:55], v[84:87], v[20:23]
  ds_read_b64_tr_b16 v[84:85], v12 offset:49152
  ds_read_b64_tr_b16 v[86:87], v12 offset:50176
  s_waitcnt lgkmcnt(10)
  v_mfma_f32_16x16x32_bf16 v[24:27], v[52:55], v[64:67], v[24:27]
  ds_read_b64_tr_b16 v[64:65], v11 offset:24576
  ds_read_b64_tr_b16 v[66:67], v11 offset:25600
  s_waitcnt lgkmcnt(10)
  v_mfma_f32_16x16x32_bf16 v[28:31], v[52:55], v[68:71], v[28:31]
  ds_read_b64_tr_b16 v[68:69], v11 offset:57344
  ds_read_b64_tr_b16 v[70:71], v11 offset:58368
  s_waitcnt lgkmcnt(10)
  v_mfma_f32_16x16x32_bf16 v[16:19], v[56:59], v[72:75], v[16:19]
  ds_read_b64_tr_b16 v[72:73], v12 offset:24576
  ds_read_b64_tr_b16 v[74:75], v12 offset:25600
  s_waitcnt lgkmcnt(10)
  v_mfma_f32_16x16x32_bf16 v[20:23], v[56:59], v[76:79], v[20:23]
  ds_read_b64_tr_b16 v[76:77], v12 offset:57344
  ds_read_b64_tr_b16 v[78:79], v12 offset:58368
  s_waitcnt lgkmcnt(10)
  v_mfma_f32_16x16x32_bf16 v[24:27], v[56:59], v[80:83], v[24:27]
  s_waitcnt lgkmcnt(8)
  v_mfma_f32_16x16x32_bf16 v[28:31], v[56:59], v[84:87], v[28:31]
  s_waitcnt lgkmcnt(6)
  v_mfma_f32_16x16x32_bf16 v[16:19], v[60:63], v[64:67], v[16:19]
  s_waitcnt lgkmcnt(4)
  v_mfma_f32_16x16x32_bf16 v[20:23], v[60:63], v[68:71], v[20:23]
  s_waitcnt lgkmcnt(2)
  v_mfma_f32_16x16x32_bf16 v[24:27], v[60:63], v[72:75], v[24:27]
  s_waitcnt lgkmcnt(0)
  v_mfma_f32_16x16x32_bf16 v[28:31], v[60:63], v[76:79], v[28:31]
  s_mov_b32 exec_lo, 0xffff0000
  s_mov_b32 exec_hi, 0
  s_nop 3
  v_mov_b32 v16, v24
  v_mov_b32 v17, v25
  v_mov_b32 v18, v26
  v_mov_b32 v20, v28
  v_mov_b32 v21, v29
  v_mov_b32 v22, v30
  s_mov_b32 exec_lo, -1
  v_fma_f32 v16, -v46, v18, v16
  v_fma_f32 v17, -v47, v18, v17
  v_fma_f32 v18, -v46, v22, v20
  v_fma_f32 v19, -v47, v22, v21
  v_mul_f32 v16, v16, v44
  v_mul_f32 v17, v17, v45
  v_mul_f32 v18, v18, v44
  v_mul_f32 v19, v19, v45
  v_add_u32 v16, 0x80, v16
  v_add_u32 v17, 0x80, v17
  v_add_u32 v18, 0x80, v18
  v_add_u32 v19, 0x80, v19
  v_perm_b32 v16, v16, v19, s12
  v_perm_b32 v17, v17, v19, s13
  v_perm_b32 v18, v18, v19, s14
  v_mov_b32 v19, v90
  buffer_store_dwordx4 v[16:19], v95, s[32:35], s73 offen sc1
  s_mov_b32 exec_hi, -1
K_NOFFN:
  s_cmp_lg_u32 s30, 1
  s_cbranch_scc1 K_NOFP
  s_setprio 0
  v_and_b32 v3, 16, v1
  v_lshrrev_b32 v3, 1, v3
  ds_read_b64 v[100:101], v3 offset:96
  v_and_b32 v7, 3, v1
  v_lshl_add_u32 v5, v7, 3, s3
  v_lshlrev_b32 v5, 1, v5
  global_load_ushort v102, v5, s[54:55]
  v_lshrrev_b32 v106, 2, v1
  v_lshlrev_b32 v106, 11, v106
  v_lshl_add_u32 v106, v7, 4, v106
  s_lshl_b32 s61, s29, 6
  s_add_u32 s60, s77, s61
  s_add_u32 s61, s60, 0x8000
  s_waitcnt lgkmcnt(0)
  v_not_b32 v6, v100
  v_and_b32 v6, 0xffe, v6
  v_lshl_add_u32 v104, v7, 12, v6
  v_lshl_add_u32 v107, v6, 10, v5
  global_load_ushort v103, v107, s[44:45]
  v_and_b32 v5, s31, v100
  v_ashrrev_i32 v3, 31, v5
  v_not_b32 v3, v3
  v_or_b32 v3, 0x80000000, v3
  v_xor_b32 v5, v5, v3
  v_and_b32 v5, s31, v5
  v_mul_f32 v105, s58, v5
  v_exp_f32 v105, -v105
  v_and_b32 v108, s31, v101
  v_lshlrev_b32 v101, 16, v101
  v_add_f32 v105, 1.0, v105
  v_rcp_f32 v105, v105
  v_rcp_f32 v109, v108
  s_nop 0
  v_fma_f32 v108, -v108, v109, 1.0
  v_fmac_f32 v109, v108, v109
  v_cvt_pk_bf16_f32 v105, 0, v105
  s_setprio 3
  s_branch K_FPD
K_NOFP:
  s_sleep 8
K_FPD:
  s_cmp_ge_u32 s29, 28
  s_cbranch_scc1 K_NOG2
  s_mov_b32 s83, 0x20000
  buffer_load_dwordx4 v[64:67], v14, s[32:35], s62 offen sc1
  buffer_load_dwordx4 v[68:71], v14, s[32:35], s63 offen sc1
  buffer_load_dwordx4 v[72:75], v14, s[32:35], s64 offen sc1
  buffer_load_dwordx4 v[76:79], v14, s[32:35], s65 offen sc1
  s_waitcnt vmcnt(0)
  s_branch K_WWB
K_WW:
  s_sleep 1
K_WWB:
  ds_read_b32 v92, v15 offset:124
  s_waitcnt lgkmcnt(0)
  v_cmp_gt_u32 vcc, 8, v92
  s_cbranch_vccnz K_WW
  ds_read_b64_tr_b16 v[24:25], v9 offset:0
  ds_read_b64_tr_b16 v[26:27], v9 offset:1024
  ds_read_b64_tr_b16 v[28:29], v9 offset:8
  ds_read_b64_tr_b16 v[30:31], v9 offset:1032
  ds_read_b64_tr_b16 v[32:33], v9 offset:8192
  ds_read_b64_tr_b16 v[34:35], v9 offset:9216
  ds_read_b64_tr_b16 v[36:37], v9 offset:8200
  ds_read_b64_tr_b16 v[38:39], v9 offset:9224
  ds_read_b64_tr_b16 v[112:113], v9 offset:16384
  ds_read_b64_tr_b16 v[114:115], v9 offset:17408
  ds_read_b64_tr_b16 v[116:117], v9 offset:16392
  ds_read_b64_tr_b16 v[118:119], v9 offset:17416
  s_waitcnt lgkmcnt(8)
  ds_read_b64_tr_b16 v[120:121], v9 offset:24576
  ds_read_b64_tr_b16 v[122:123], v9 offset:25600
  ds_read_b64_tr_b16 v[124:125], v9 offset:24584
  ds_read_b64_tr_b16 v[126:127], v9 offset:25608
  s_branch K_P4B
K_P4:
  s_sleep 2
  buffer_load_dwordx4 v[64:67], v14, s[32:35], s62 offen sc1
  buffer_load_dwordx4 v[68:71], v14, s[32:35], s63 offen sc1
  buffer_load_dwordx4 v[72:75], v14, s[32:35], s64 offen sc1
  buffer_load_dwordx4 v[76:79], v14, s[32:35], s65 offen sc1
K_P4B:
  s_sub_u32 s83, s83, 1
  s_waitcnt vmcnt(0)
  v_bitop3_b32 v92, v67, v71, v90 bitop3:0x7e
  v_bitop3_b32 v80, v75, v79, v90 bitop3:0x7e
  s_cbranch_scc1 K_P4D
  v_or_b32 v92, v92, v80
  v_cmp_ne_u32 vcc, 0, v92
  s_cbranch_vccnz K_P4
K_P4D:
  v_perm_b32 v67, v64, v65, s15
  v_perm_b32 v71, v68, v69, s15
  v_perm_b32 v75, v72, v73, s15
  v_perm_b32 v79, v76, v77, s15
  v_perm_b32 v67, v67, v66, s16
  v_perm_b32 v71, v71, v70, s16
  v_perm_b32 v75, v75, v74, s16
  v_perm_b32 v79, v79, v78, s16
  v_add_f32 v64, v64, v72
  v_add_f32 v65, v65, v73
  v_add_f32 v66, v66, v74
  v_add_f32 v67, v67, v75
  v_add_f32 v68, v68, v76
  v_add_f32 v69, v69, v77
  v_add_f32 v70, v70, v78
  v_add_f32 v71, v71, v79
  v_add_f32 v64, v64, v68
  v_add_f32 v65, v65, v69
  v_add_f32 v66, v66, v70
  v_add_f32 v67, v67, v71
  v_permlane32_swap_b32 v64, v65
  s_nop 0
  v_permlane32_swap_b32 v66, v67
  v_add_f32 v64, v64, v65
  v_add_f32 v66, v66, v67
  v_cvt_pk_bf16_f32 v64, 0, v64
  v_cvt_pk_bf16_f32 v66, 0, v66
  v_mul_f32 v65, 0xbfb8aa3b, v64
  v_exp_f32 v65, v65
  s_nop 0
  v_add_f32 v65, 1.0, v65
  v_rcp_f32 v65, v65
  s_nop 0
  v_mul_f32 v65, v65, v64
  v_cvt_pk_bf16_f32 v65, 0, v65
  v_mul_f32 v65, v65, v66
  v_cvt_pk_bf16_f32 v65, v65, v65
  ds_write_b16 v13, v65
  s_mov_b64 exec, 1
  ds_add_u32 v15, v93 offset:116
  s_mov_b64 exec, -1
  s_branch K_HWB
K_HW:
K_HWB:
  ds_read_b32 v92, v15 offset:116
  s_waitcnt lgkmcnt(0)
  v_cmp_gt_u32 vcc, 4, v92
  s_cbranch_vccnz K_HW
  ds_read_b128 v[48:51], v10 offset:1280
  ds_read_b128 v[52:55], v10 offset:1344
  ds_read_b128 v[56:59], v10 offset:1408
  ds_read_b128 v[60:63], v10 offset:1472
  s_waitcnt lgkmcnt(3)
  v_mfma_f32_16x16x32_bf16 v[16:19], v[48:51], v[24:27], 0
  v_mfma_f32_16x16x32_bf16 v[20:23], v[48:51], v[28:31], 0
  s_waitcnt lgkmcnt(2)
  v_mfma_f32_16x16x32_bf16 v[16:19], v[52:55], v[32:35], v[16:19]
  v_mfma_f32_16x16x32_bf16 v[20:23], v[52:55], v[36:39], v[20:23]
  s_waitcnt lgkmcnt(1)
  v_mfma_f32_16x16x32_bf16 v[16:19], v[56:59], v[112:115], v[16:19]
  v_mfma_f32_16x16x32_bf16 v[20:23], v[56:59], v[116:119], v[20:23]
  s_waitcnt lgkmcnt(0)
  v_mfma_f32_16x16x32_bf16 v[16:19], v[60:63], v[120:123], v[16:19]
  v_mfma_f32_16x16x32_bf16 v[20:23], v[60:63], v[124:127], v[20:23]
  s_mov_b64 exec, 0xffff
  s_nop 5
  v_mov_b32 v18, v90
  v_mov_b32 v22, v90
  s_cmp_lg_u32 s47, 0
  s_cbranch_scc1 K_DS_W
  buffer_store_dwordx3 v[16:18], v8, s[32:35], s57 offen
  buffer_store_dwordx3 v[20:22], v8, s[32:35], s57 offen offset:256
  s_branch K_DS_D
K_DS_W:
  buffer_store_dwordx3 v[16:18], v8, s[32:35], s57 offen sc1
  buffer_store_dwordx3 v[20:22], v8, s[32:35], s57 offen offset:256 sc1
K_DS_D:
  s_mov_b64 exec, -1
K_NOG2:
  s_cmp_lg_u32 s30, 1
  s_cbranch_scc1 K_CDONE
  s_branch K_YAB
K_YA:
  s_sleep 2
K_YAB:
  ds_read_b128 v[32:35], v15 offset:48
  ds_read_u16 v40, v104 offset:56320
  s_waitcnt lgkmcnt(1)
  v_and_b32 v92, v32, v33
  v_bitop3_b32 v92, v92, v34, v35 bitop3:0x80
  v_cmp_ne_u32 vcc, 8, v92
  s_cbranch_vccnz K_YA
  v_mov_b32 v52, 0
  v_mov_b32 v53, 0
  v_mov_b32 v54, v90
  buffer_load_dwordx3 v[48:50], v106, s[32:35], s60 offen sc1
  s_mov_b32 exec_hi, 0x5ffff
  buffer_load_dwordx3 v[52:54], v106, s[32:35], s61 offen sc1
  s_mov_b32 exec_hi, -1
  s_mov_b32 s83, 0x20000
  s_waitcnt vmcnt(2) lgkmcnt(0)
  v_lshlrev_b32 v103, 16, v103
  v_lshlrev_b32 v102, 16, v102
  v_lshlrev_b32 v40, 16, v40
  v_sub_f32 v25, v103, v101
  v_cvt_pk_bf16_f32 v25, 0, v25
  v_mul_f32 v25, v25, v109
  v_cvt_pk_bf16_f32 v25, 0, v25
  v_mul_f32 v26, v25, v102
  v_cvt_pk_bf16_f32 v26, 0, v26
  v_add_f32 v26, v26, v40
  v_cvt_pk_bf16_f32 v26, 0, v26
  s_waitcnt vmcnt(0)
  s_branch K_DC
K_DP:
  buffer_load_dwordx3 v[48:50], v106, s[32:35], s60 offen sc1
  s_mov_b32 exec_hi, 0x5ffff
  buffer_load_dwordx3 v[52:54], v106, s[32:35], s61 offen sc1
  s_mov_b32 exec_hi, -1
  s_sub_u32 s83, s83, 1
  s_waitcnt vmcnt(0)
  s_cbranch_scc1 K_DD
K_DC:
  v_bitop3_b32 v92, v50, v54, v90 bitop3:0x7e
  v_cmp_ne_u32 vcc, 0, v92
  s_cbranch_vccnz K_DP
K_DD:
  v_pk_add_f32 v[48:49], v[48:49], v[52:53]
  s_nop 1
  v_permlane16_swap_b32 v48, v49
  v_add_f32 v48, v48, v49
  v_mov_b32 v49, v48
  s_nop 1
  v_permlane32_swap_b32 v48, v49
  v_add_f32 v48, v48, v49
  s_nop 1
  v_add_f32_dpp v48, v48, v48 row_ror:4 row_mask:0xf bank_mask:0xf
  s_nop 1
  v_add_f32_dpp v48, v48, v48 row_ror:8 row_mask:0xf bank_mask:0xf
  v_cvt_pk_bf16_f32 v48, 0, v48
  v_mul_f32 v20, v48, v105
  v_cvt_pk_bf16_f32 v20, 0, v20
  v_add_f32 v20, v20, v25
  v_cvt_pk_bf16_f32 v20, 0, v20
  v_mul_f32 v23, 0xbfb8aa3b, v20
  v_exp_f32 v23, v23
  s_nop 0
  v_add_f32 v23, 1.0, v23
  v_rcp_f32 v23, v23
  s_nop 0
  v_mul_f32 v23, v23, v20
  v_cvt_pk_bf16_f32 v23, 0, v23
  v_mul_f32 v23, v23, v26
  v_cvt_pk_bf16_f32 v23, 0, v23
  v_add_f32 v23, v23, v103
  v_cvt_pk_bf16_f32 v23, v23, v23
  s_mov_b64 exec, 0x000f000f
  global_store_short v107, v23, s[26:27]
K_CDONE:
  s_endpgm
K_END:
  s_endpgm
.p2align 4
.type K_BAND,@object
.size K_BAND, 5120
K_BAND:
.long 0x0, 0x0, 0x0, 0x3c003c00
.long 0x0, 0x0, 0x0, 0x3c000000
.long 0x0, 0x0, 0x0, 0x0
.long 0x0, 0x0, 0x0, 0x0
.long 0x0, 0x0, 0x0, 0x0
.long 0x0, 0x0, 0x0, 0x0
.long 0x0, 0x0, 0x0, 0x0
.long 0x0, 0x0, 0x0, 0x0
.long 0x0, 0x0, 0x0, 0x0
.long 0x0, 0x0, 0x0, 0x0
.long 0x0, 0x0, 0x0, 0x0
.long 0x0, 0x0, 0x0, 0x0
.long 0x0, 0x0, 0x0, 0x0
.long 0x0, 0x0, 0x0, 0x0
.long 0x0, 0x0, 0x0, 0x0
.long 0x0, 0x0, 0x0, 0x0
.long 0x3c003c00, 0x3c00, 0x0, 0x0
.long 0x3c003c00, 0x3c003c00, 0x0, 0x0
.long 0x3c003c00, 0x3c003c00, 0x3c00, 0x0
.long 0x3c000000, 0x3c003c00, 0x3c003c00, 0x0
.long 0x0, 0x3c003c00, 0x3c003c00, 0x3c00
.long 0x0, 0x3c000000, 0x3c003c00, 0x3c003c00
.long 0x0, 0x0, 0x3c003c00, 0x3c003c00
.long 0x0, 0x0, 0x3c000000, 0x3c003c00
.long 0x0, 0x0, 0x0, 0x3c003c00
.long 0x0, 0x0, 0x0, 0x3c000000
.long 0x0, 0x0, 0x0, 0x0
.long 0x0, 0x0, 0x0, 0x0
.long 0x0, 0x0, 0x0, 0x0
.long 0x0, 0x0, 0x0, 0x0
.long 0x0, 0x0, 0x0, 0x0
.long 0x0, 0x0, 0x0, 0x0
.long 0x0, 0x0, 0x0, 0x0
.long 0x0, 0x0, 0x0, 0x0
.long 0x0, 0x0, 0x0, 0x0
.long 0x0, 0x0, 0x0, 0x0
.long 0x0, 0x0, 0x0, 0x0
.long 0x0, 0x0, 0x0, 0x0
.long 0x3c00, 0x0, 0x0, 0x0
.long 0x3c003c00, 0x0, 0x0, 0x0
.long 0x3c003c00, 0x3c00, 0x0, 0x0
.long 0x3c003c00, 0x3c003c00, 0x0, 0x0
.long 0x3c003c00, 0x3c003c00, 0x3c00, 0x0
.long 0x3c000000, 0x3c003c00, 0x3c003c00, 0x0
.long 0x0, 0x3c003c00, 0x3c003c00, 0x3c00
.long 0x0, 0x3c000000, 0x3c003c00, 0x3c003c00
.long 0x0, 0x0, 0x3c003c00, 0x3c003c00
.long 0x0, 0x0, 0x3c000000, 0x3c003c00
.long 0x0, 0x0, 0x0, 0x0
.long 0x0, 0x0, 0x0, 0x0
.long 0x0, 0x0, 0x0, 0x0
.long 0x0, 0x0, 0x0, 0x0
.long 0x0, 0x0, 0x0, 0x0
.long 0x0, 0x0, 0x0, 0x0
.long 0x0, 0x0, 0x0, 0x0
.long 0x0, 0x0, 0x0, 0x0
.long 0x0, 0x0, 0x0, 0x0
.long 0x0, 0x0, 0x0, 0x0
.long 0x0, 0x0, 0x0, 0x0
.long 0x0, 0x0, 0x0, 0x0
.long 0x0, 0x0, 0x0, 0x0
.long 0x0, 0x0, 0x0, 0x0
.long 0x3c00, 0x0, 0x0, 0x0
.long 0x3c003c00, 0x0, 0x0, 0x0
.long 0x0, 0x0, 0x0, 0x0
.long 0x0, 0x0, 0x0, 0x0
.long 0x0, 0x0, 0x0, 0x0
.long 0x0, 0x0, 0x0, 0x0
.long 0x0, 0x0, 0x0, 0x0
.long 0x0, 0x0, 0x0, 0x0
.long 0x0, 0x0, 0x0, 0x0
.long 0x0, 0x0, 0x0, 0x0
.long 0x0, 0x0, 0x0, 0x0
.long 0x0, 0x0, 0x0, 0x0
.long 0x0, 0x0, 0x0, 0x0
.long 0x0, 0x0, 0x0, 0x0
.long 0x0, 0x0, 0x0, 0x0
.long 0x0, 0x0, 0x0, 0x0
.long 0x0, 0x0, 0x0, 0x0
.long 0x0, 0x0, 0x0, 0x0
.long 0x0, 0x3c000000, 0x3c003c00, 0x0
.long 0x0, 0x0, 0x3c003c00, 0x3c00
.long 0x0, 0x0, 0x3c000000, 0x3c003c00
.long 0x0, 0x0, 0x0, 0x3c003c00
.long 0x0, 0x0, 0x0, 0x3c000000
.long 0x0, 0x0, 0x0, 0x0
.long 0x0, 0x0, 0x0, 0x0
.long 0x0, 0x0, 0x0, 0x0
.long 0x0, 0x0, 0x0, 0x0
.long 0x0, 0x0, 0x0, 0x0
.long 0x0, 0x0, 0x0, 0x0
.long 0x0, 0x0, 0x0, 0x0
.long 0x0, 0x0, 0x0, 0x0
.long 0x0, 0x0, 0x0, 0x0
.long 0x0, 0x0, 0x0, 0x0
.long 0x0, 0x0, 0x0, 0x0
.long 0x0, 0x0, 0x0, 0x0
.long 0x0, 0x0, 0x0, 0x0
.long 0x0, 0x0, 0x0, 0x0
.long 0x3c00, 0x0, 0x0, 0x0
.long 0x3c003c00, 0x0, 0x0, 0x0
.long 0x3c003c00, 0x3c00, 0x0, 0x0
.long 0x3c000000, 0x3c003c00, 0x0, 0x0
.long 0x0, 0x3c003c00, 0x3c00, 0x0
.long 0x0, 0x3c000000, 0x3c003c00, 0x0
.long 0x0, 0x0, 0x3c003c00, 0x3c00
.long 0x0, 0x0, 0x3c000000, 0x3c003c00
.long 0x0, 0x0, 0x0, 0x3c003c00
.long 0x0, 0x0, 0x0, 0x3c000000
.long 0x0, 0x0, 0x0, 0x0
.long 0x0, 0x0, 0x0, 0x0
.long 0x0, 0x0, 0x0, 0x0
.long 0x0, 0x0, 0x0, 0x0
.long 0x0, 0x0, 0x0, 0x0
.long 0x0, 0x0, 0x0, 0x0
.long 0x0, 0x0, 0x0, 0x0
.long 0x0, 0x0, 0x0, 0x0
.long 0x0, 0x0, 0x0, 0x0
.long 0x0, 0x0, 0x0, 0x0
.long 0x0, 0x0, 0x0, 0x0
.long 0x0, 0x0, 0x0, 0x0
.long 0x0, 0x0, 0x0, 0x0
.long 0x0, 0x0, 0x0, 0x0
.long 0x3c00, 0x0, 0x0, 0x0
.long 0x3c003c00, 0x0, 0x0, 0x0
.long 0x3c003c00, 0x3c00, 0x0, 0x0
.long 0x3c000000, 0x3c003c00, 0x0, 0x0
.long 0x0, 0x3c003c00, 0x3c00, 0x0
.long 0x0, 0x0, 0x3c003c00, 0x3c003c00
.long 0x0, 0x0, 0x3c000000, 0x3c003c00
.long 0x0, 0x0, 0x0, 0x3c003c00
.long 0x0, 0x0, 0x0, 0x3c000000
.long 0x0, 0x0, 0x0, 0x0
.long 0x0, 0x0, 0x0, 0x0
.long 0x0, 0x0, 0x0, 0x0
.long 0x0, 0x0, 0x0, 0x0
.long 0x0, 0x0, 0x0, 0x0
.long 0x0, 0x0, 0x0, 0x0
.long 0x0, 0x0, 0x0, 0x0
.long 0x0, 0x0, 0x0, 0x0
.long 0x0, 0x0, 0x0, 0x0
.long 0x0, 0x0, 0x0, 0x0
.long 0x0, 0x0, 0x0, 0x0
.long 0x0, 0x0, 0x0, 0x0
.long 0x3c003c00, 0x3c003c00, 0x3c00, 0x0
.long 0x3c003c00, 0x3c003c00, 0x3c003c00, 0x0
.long 0x3c003c00, 0x3c003c00, 0x3c003c00, 0x3c00
.long 0x3c003c00, 0x3c003c00, 0x3c003c00, 0x3c003c00
.long 0x3c003c00, 0x3c003c00, 0x3c003c00, 0x3c003c00
.long 0x3c000000, 0x3c003c00, 0x3c003c00, 0x3c003c00
.long 0x0, 0x3c003c00, 0x3c003c00, 0x3c003c00
.long 0x0, 0x3c000000, 0x3c003c00, 0x3c003c00
.long 0x0, 0x0, 0x3c003c00, 0x3c003c00
.long 0x0, 0x0, 0x3c000000, 0x3c003c00
.long 0x0, 0x0, 0x0, 0x3c003c00
.long 0x0, 0x0, 0x0, 0x3c000000
.long 0x0, 0x0, 0x0, 0x0
.long 0x0, 0x0, 0x0, 0x0
.long 0x0, 0x0, 0x0, 0x0
.long 0x0, 0x0, 0x0, 0x0
.long 0x0, 0x0, 0x0, 0x0
.long 0x0, 0x0, 0x0, 0x0
.long 0x0, 0x0, 0x0, 0x0
.long 0x0, 0x0, 0x0, 0x0
.long 0x3c00, 0x0, 0x0, 0x0
.long 0x3c003c00, 0x0, 0x0, 0x0
.long 0x3c003c00, 0x3c00, 0x0, 0x0
.long 0x3c003c00, 0x3c003c00, 0x0, 0x0
.long 0x3c003c00, 0x3c003c00, 0x3c00, 0x0
.long 0x3c003c00, 0x3c003c00, 0x3c003c00, 0x0
.long 0x3c003c00, 0x3c003c00, 0x3c003c00, 0x3c00
.long 0x3c003c00, 0x3c003c00, 0x3c003c00, 0x3c003c00
.long 0x3c003c00, 0x3c003c00, 0x3c003c00, 0x3c003c00
.long 0x3c000000, 0x3c003c00, 0x3c003c00, 0x3c003c00
.long 0x0, 0x3c003c00, 0x3c003c00, 0x3c003c00
.long 0x0, 0x3c000000, 0x3c003c00, 0x3c003c00
.long 0x0, 0x0, 0x0, 0x0
.long 0x0, 0x0, 0x0, 0x0
.long 0x0, 0x0, 0x0, 0x0
.long 0x0, 0x0, 0x0, 0x0
.long 0x0, 0x0, 0x0, 0x0
.long 0x0, 0x0, 0x0, 0x0
.long 0x0, 0x0, 0x0, 0x0
.long 0x0, 0x0, 0x0, 0x0
.long 0x0, 0x0, 0x0, 0x0
.long 0x0, 0x0, 0x0, 0x0
.long 0x0, 0x0, 0x0, 0x0
.long 0x0, 0x0, 0x0, 0x0
.long 0x3c00, 0x0, 0x0, 0x0
.long 0x3c003c00, 0x0, 0x0, 0x0
.long 0x3c003c00, 0x3c00, 0x0, 0x0
.long 0x3c003c00, 0x3c003c00, 0x0, 0x0
.long 0x0, 0x0, 0x3c000000, 0x3c003c00
.long 0x0, 0x0, 0x0, 0x3c003c00
.long 0x0, 0x0, 0x0, 0x3c000000
.long 0x0, 0x0, 0x0, 0x0
.long 0x0, 0x0, 0x0, 0x0
.long 0x0, 0x0, 0x0, 0x0
.long 0x0, 0x0, 0x0, 0x0
.long 0x0, 0x0, 0x0, 0x0
.long 0x0, 0x0, 0x0, 0x0
.long 0x0, 0x0, 0x0, 0x0
.long 0x0, 0x0, 0x0, 0x0
.long 0x0, 0x0, 0x0, 0x0
.long 0x0, 0x0, 0x0, 0x0
.long 0x0, 0x0, 0x0, 0x0
.long 0x0, 0x0, 0x0, 0x0
.long 0x0, 0x0, 0x0, 0x0
.long 0x3c003c00, 0x3c003c00, 0x0, 0x0
.long 0x3c003c00, 0x3c003c00, 0x3c00, 0x0
.long 0x3c003c00, 0x3c003c00, 0x3c003c00, 0x0
.long 0x3c003c00, 0x3c003c00, 0x3c003c00, 0x3c00
.long 0x3c000000, 0x3c003c00, 0x3c003c00, 0x3c003c00
.long 0x0, 0x3c003c00, 0x3c003c00, 0x3c003c00
.long 0x0, 0x3c000000, 0x3c003c00, 0x3c003c00
.long 0x0, 0x0, 0x3c003c00, 0x3c003c00
.long 0x0, 0x0, 0x3c000000, 0x3c003c00
.long 0x0, 0x0, 0x0, 0x3c003c00
.long 0x0, 0x0, 0x0, 0x3c000000
.long 0x0, 0x0, 0x0, 0x0
.long 0x0, 0x0, 0x0, 0x0
.long 0x0, 0x0, 0x0, 0x0
.long 0x0, 0x0, 0x0, 0x0
.long 0x0, 0x0, 0x0, 0x0
.long 0x0, 0x0, 0x0, 0x0
.long 0x0, 0x0, 0x0, 0x0
.long 0x0, 0x0, 0x0, 0x0
.long 0x0, 0x0, 0x0, 0x0
.long 0x0, 0x0, 0x0, 0x0
.long 0x3c00, 0x0, 0x0, 0x0
.long 0x3c003c00, 0x0, 0x0, 0x0
.long 0x3c003c00, 0x3c00, 0x0, 0x0
.long 0x3c003c00, 0x3c003c00, 0x0, 0x0
.long 0x3c003c00, 0x3c003c00, 0x3c00, 0x0
.long 0x3c003c00, 0x3c003c00, 0x3c003c00, 0x0
.long 0x3c003c00, 0x3c003c00, 0x3c003c00, 0x3c00
.long 0x3c000000, 0x3c003c00, 0x3c003c00, 0x3c003c00
.long 0x0, 0x3c003c00, 0x3c003c00, 0x3c003c00
.long 0x0, 0x3c000000, 0x3c003c00, 0x3c003c00
.long 0x0, 0x0, 0x3c003c00, 0x3c003c00
.long 0x0, 0x0, 0x0, 0x0
.long 0x0, 0x0, 0x0, 0x0
.long 0x0, 0x0, 0x0, 0x0
.long 0x0, 0x0, 0x0, 0x0
.long 0x0, 0x0, 0x0, 0x0
.long 0x0, 0x0, 0x0, 0x0
.long 0x0, 0x0, 0x0, 0x0
.long 0x0, 0x0, 0x0, 0x0
.long 0x0, 0x0, 0x0, 0x0
.long 0x0, 0x0, 0x0, 0x0
.long 0x0, 0x0, 0x0, 0x0
.long 0x0, 0x0, 0x0, 0x0
.long 0x0, 0x0, 0x0, 0x0
.long 0x3c00, 0x0, 0x0, 0x0
.long 0x3c003c00, 0x0, 0x0, 0x0
.long 0x3c003c00, 0x3c00, 0x0, 0x0
.long 0x0, 0x0, 0x3c003c00, 0x3c003c00
.long 0x0, 0x0, 0x3c000000, 0x3c003c00
.long 0x0, 0x0, 0x0, 0x3c003c00
.long 0x0, 0x0, 0x0, 0x3c000000
.long 0x0, 0x0, 0x0, 0x0
.long 0x0, 0x0, 0x0, 0x0
.long 0x0, 0x0, 0x0, 0x0
.long 0x0, 0x0, 0x0, 0x0
.long 0x0, 0x0, 0x0, 0x0
.long 0x0, 0x0, 0x0, 0x0
.long 0x0, 0x0, 0x0, 0x0
.long 0x0, 0x0, 0x0, 0x0
.long 0x0, 0x0, 0x0, 0x0
.long 0x0, 0x0, 0x0, 0x0
.long 0x0, 0x0, 0x0, 0x0
.long 0x0, 0x0, 0x0, 0x0
.long 0x3c003c00, 0x3c00, 0x0, 0x0
.long 0x3c003c00, 0x3c003c00, 0x0, 0x0
.long 0x3c003c00, 0x3c003c00, 0x3c00, 0x0
.long 0x3c003c00, 0x3c003c00, 0x3c003c00, 0x0
.long 0x3c003c00, 0x3c003c00, 0x3c003c00, 0x3c00
.long 0x3c000000, 0x3c003c00, 0x3c003c00, 0x3c003c00
.long 0x0, 0x3c003c00, 0x3c003c00, 0x3c003c00
.long 0x0, 0x3c000000, 0x3c003c00, 0x3c003c00
.long 0x0, 0x0, 0x3c003c00, 0x3c003c00
.long 0x0, 0x0, 0x3c000000, 0x3c003c00
.long 0x0, 0x0, 0x0, 0x3c003c00
.long 0x0, 0x0, 0x0, 0x3c000000
.long 0x0, 0x0, 0x0, 0x0
.long 0x0, 0x0, 0x0, 0x0
.long 0x0, 0x0, 0x0, 0x0
.long 0x0, 0x0, 0x0, 0x0
.long 0x0, 0x0, 0x0, 0x0
.long 0x0, 0x0, 0x0, 0x0
.long 0x0, 0x0, 0x0, 0x0
.long 0x0, 0x0, 0x0, 0x0
.long 0x0, 0x0, 0x0, 0x0
.long 0x0, 0x0, 0x0, 0x0
.long 0x3c00, 0x0, 0x0, 0x0
.long 0x3c003c00, 0x0, 0x0, 0x0
.long 0x3c003c00, 0x3c00, 0x0, 0x0
.long 0x3c003c00, 0x3c003c00, 0x0, 0x0
.long 0x3c003c00, 0x3c003c00, 0x3c00, 0x0
.long 0x3c003c00, 0x3c003c00, 0x3c003c00, 0x0
.long 0x3c003c00, 0x3c003c00, 0x3c003c00, 0x3c00
.long 0x3c000000, 0x3c003c00, 0x3c003c00, 0x3c003c00
.long 0x0, 0x3c003c00, 0x3c003c00, 0x3c003c00
.long 0x0, 0x3c000000, 0x3c003c00, 0x3c003c00
.long 0x0, 0x0, 0x0, 0x0
.long 0x0, 0x0, 0x0, 0x0
.long 0x0, 0x0, 0x0, 0x0
.long 0x0, 0x0, 0x0, 0x0
.long 0x0, 0x0, 0x0, 0x0
.long 0x0, 0x0, 0x0, 0x0
.long 0x0, 0x0, 0x0, 0x0
.long 0x0, 0x0, 0x0, 0x0
.long 0x0, 0x0, 0x0, 0x0
.long 0x0, 0x0, 0x0, 0x0
.long 0x0, 0x0, 0x0, 0x0
.long 0x0, 0x0, 0x0, 0x0
.long 0x0, 0x0, 0x0, 0x0
.long 0x0, 0x0, 0x0, 0x0
.long 0x3c00, 0x0, 0x0, 0x0
.long 0x3c003c00, 0x0, 0x0, 0x0

.section .rodata,"a"
.p2align 6
.amdhsa_kernel recurrent_scan__ssm_conv_s4d__moe_arch_mod__prompt_kernel
  .amdhsa_next_free_vgpr 128
  .amdhsa_next_free_sgpr 96
  .amdhsa_accum_offset 128
  .amdhsa_group_segment_fixed_size 0
  .amdhsa_kernarg_size 120
  .amdhsa_user_sgpr_count 2
  .amdhsa_user_sgpr_kernarg_segment_ptr 1
  .amdhsa_system_sgpr_workgroup_id_x 1
.end_amdhsa_kernel
```

```asm
; @launch grid=(256,1,1) block=(1024,1,1) lds=152064
.amdgcn_target "amdgcn-amd-amdhsa--gfx950"
.text
.p2align 8
.globl recurrent_scan__ssm_conv_s4d__moe_arch_mod__prompt_kernel
.type recurrent_scan__ssm_conv_s4d__moe_arch_mod__prompt_kernel,@function
recurrent_scan__ssm_conv_s4d__moe_arch_mod__prompt_kernel:
  s_cmp_ge_u32 s2, 256
  s_cbranch_scc1 K_END
  s_load_dwordx2 s[44:45], s[0:1], 0
  s_load_dwordx16 s[4:19], s[0:1], 8
  s_load_dwordx8 s[20:27], s[0:1], 72
  s_load_dwordx4 s[40:43], s[0:1], 104
  v_readfirstlane_b32 s30, v0
  v_and_b32 v1, 63, v0
  s_and_b32 s28, s2, 7
  s_lshr_b32 s29, s2, 3
  s_mov_b32 s31, 0xffff0000
  s_mov_b32 s58, 0x3fb8aa3b
  s_lshr_b32 s30, s30, 6
  s_cmp_ge_u32 s30, 8
  s_cbranch_scc1 K_C
  v_lshlrev_b32 v97, 4, v1
  v_lshrrev_b32 v2, 4, v1
  v_and_b32 v3, 15, v1
  v_lshlrev_b32 v5, 4, v3
  s_setprio 3
  s_getpc_b64 s[48:49]
K_PC:
  s_cmp_lg_u32 s30, 0
  s_cbranch_scc1 K_NOPF
  s_lshl_b32 s50, s29, 10
  s_min_u32 s50, s50, K_END - K_PC - 1024
  s_add_u32 s50, s50, s48
  s_addc_u32 s51, s49, 0
  global_load_dwordx4 v[32:35], v97, s[50:51]
K_NOPF:
  s_lshr_b32 s3, s29, 3
  s_lshl_b32 s3, s3, 5
  s_and_b32 s63, s29, 7
  s_add_u32 s3, s3, s63
  s_lshl_b32 s63, s28, 7
  s_add_u32 s3, s3, s63
  v_lshl_add_u32 v4, v2, 12, v5
  v_lshl_add_u32 v120, v2, 11, v5
  s_lshl_b32 s60, s29, 3
  s_add_u32 s60, s60, s30
  s_lshl_b32 s61, s60, 14
  s_lshl_b32 s62, s28, 8
  s_add_u32 s61, s61, s62
  v_add_u32 v6, s62, v5
  v_mov_b32 v126, 0
  v_mov_b32 v127, 1
  v_lshlrev_b32 v7, 2, v1
  ds_write2st64_b32 v7, v126, v126 offset0:0 offset1:2
  s_mov_b32 s38, 0x400000
  s_mov_b32 s39, 0x00020000
  s_lshl_b32 s63, s3, 8
  v_add_u32 v7, s63, v120
  s_lshl_b32 s3, s3, 1
  s_and_b32 s3, s3, -64
  s_mov_b32 m0, 77824
  s_cmp_lg_u32 s30, 0
  s_waitcnt lgkmcnt(0)
  s_load_dword s46, s[42:43], 0x0
  s_mov_b32 s36, s44
  s_mov_b32 s37, s45
  s_cbranch_scc1 K_NOPRM
  global_load_lds_dwordx4 v7, s[4:5]
  s_mov_b32 m0, 78848
  s_load_dword s47, s[12:13], s3
  global_load_lds_dwordx4 v7, s[6:7]
  s_mov_b32 m0, 79872
  s_nop 0
  global_load_lds_dwordx4 v7, s[8:9]
  s_mov_b32 m0, 80896
  s_nop 0
  global_load_lds_dwordx4 v7, s[10:11]
K_NOPRM:
  s_cmp_lg_u32 s30, 1
  s_cbranch_scc1 K_NOSM
  global_load_dwordx4 v[48:51], v97, s[18:19]
  global_load_dwordx4 v[52:55], v97, s[18:19] offset:1024
K_NOSM:
  buffer_load_dwordx4 v[8:11], v4, s[36:39], s61 offen
  buffer_load_dwordx4 v[12:15], v4, s[36:39], s61 offen offset:2048
  global_load_dwordx4 v[16:19], v6, s[18:19]
  global_load_dwordx4 v[20:23], v6, s[14:15]
  s_barrier
  s_mov_b32 s32, s42
  s_mov_b32 s33, s43
  s_mov_b32 s34, 0x800000
  s_mov_b32 s35, 0x00020000
  s_lshl_b32 s63, s29, 13
  s_lshl_b32 s73, s30, 7
  s_add_u32 s63, s63, s73
  s_add_u32 s63, s63, 0x100000
  s_lshl_b32 s73, s28, 10
  s_add_u32 s57, s73, 0x441000
  s_add_u32 s73, s73, s63
  s_lshl_b32 s74, s28, 12
  s_add_u32 s74, s74, 0x400000
  s_getreg_b32 s56, hwreg(HW_REG_XCC_ID, 0, 4)
  v_mov_b32 v124, 0xffff0000
  s_mov_b32 s8, 0x0000bf80
  s_mov_b32 s9, 0xbf800000
  v_mov_b32 v84, 0
  v_mov_b32 v85, 0
  v_and_b32 v92, 7, v1
  v_lshrrev_b32 v94, 3, v1
  v_lshlrev_b32 v95, 18, v92
  v_lshl_add_u32 v95, v94, 4, v95
  v_lshlrev_b32 v92, 10, v92
  s_lshl_b32 s10, 0x01010101, s28
  s_not_b32 s10, s10
  s_mov_b32 s11, s10
  s_add_u32 s72, s63, 0x80000
  v_lshl_add_u32 v92, v94, 4, v92
  v_and_b32 v93, 31, v1
  v_lshlrev_b32 v93, 2, v93
  s_waitcnt lgkmcnt(0)
  s_add_u32 s46, s46, 0x9e3779b9
  v_mov_b32 v91, s46
  s_cmp_lg_u32 s30, 3
  s_cbranch_scc1 K_NOCI
  v_add_u32 v80, s56, v91
  s_lshl_b32 s78, s29, 7
  s_add_u32 s78, s78, s74
  s_mov_b32 exec_hi, 0
  buffer_store_dword v80, v93, s[32:35], s78 offen sc1
  s_mov_b32 exec_hi, -1
K_NOCI:
  s_cmp_lg_u32 s30, 0
  s_cbranch_scc1 K_NOPS
  s_mov_b64 exec, 1
  ds_write_b32 v126, v91 offset:0
  s_waitcnt vmcnt(4)
  ds_add_u32 v126, v127 offset:12
  s_mov_b64 exec, -1
K_NOPS:
  s_waitcnt vmcnt(3)
  v_and_b32_dpp v26, v8, v124 row_newbcast:0 row_mask:0xf bank_mask:0xf
  v_dot2_f32_bf16 v32, v8, s8, v26
  v_dot2_f32_bf16 v34, v8, s9, v26
  v_dot2_f32_bf16 v36, v9, s8, v26
  v_dot2_f32_bf16 v38, v9, s9, v26
  v_dot2_f32_bf16 v40, v10, s8, v26
  v_dot2_f32_bf16 v42, v10, s9, v26
  v_dot2_f32_bf16 v44, v11, s8, v26
  v_dot2_f32_bf16 v46, v11, s9, v26
  s_waitcnt vmcnt(2)
  v_and_b32_dpp v27, v12, v124 row_newbcast:0 row_mask:0xf bank_mask:0xf
  v_dot2_f32_bf16 v33, v12, s8, v27
  v_dot2_f32_bf16 v35, v12, s9, v27
  v_dot2_f32_bf16 v37, v13, s8, v27
  v_dot2_f32_bf16 v39, v13, s9, v27
  v_dot2_f32_bf16 v41, v14, s8, v27
  v_dot2_f32_bf16 v43, v14, s9, v27
  v_dot2_f32_bf16 v45, v15, s8, v27
  v_dot2_f32_bf16 v47, v15, s9, v27
  v_pk_add_f32 v[28:29], v[32:33], v[34:35]
  v_pk_mul_f32 v[30:31], v[32:33], v[32:33]
  v_pk_add_f32 v[80:81], v[36:37], v[38:39]
  v_pk_mul_f32 v[82:83], v[34:35], v[34:35]
  v_pk_fma_f32 v[30:31], v[36:37], v[36:37], v[30:31]
  v_pk_fma_f32 v[82:83], v[38:39], v[38:39], v[82:83]
  v_pk_fma_f32 v[30:31], v[40:41], v[40:41], v[30:31]
  v_pk_add_f32 v[28:29], v[28:29], v[40:41]
  v_pk_fma_f32 v[82:83], v[42:43], v[42:43], v[82:83]
  v_pk_add_f32 v[80:81], v[80:81], v[42:43]
  v_pk_fma_f32 v[30:31], v[44:45], v[44:45], v[30:31]
  v_pk_add_f32 v[28:29], v[28:29], v[44:45]
  v_pk_fma_f32 v[82:83], v[46:47], v[46:47], v[82:83]
  v_pk_add_f32 v[80:81], v[80:81], v[46:47]
  s_waitcnt vmcnt(1)
  v_dot2c_f32_bf16 v84, v8, v16
  v_dot2c_f32_bf16 v85, v12, v16
  v_dot2c_f32_bf16 v84, v9, v17
  v_dot2c_f32_bf16 v85, v13, v17
  v_dot2c_f32_bf16 v84, v10, v18
  v_dot2c_f32_bf16 v85, v14, v18
  v_dot2c_f32_bf16 v84, v11, v19
  v_dot2c_f32_bf16 v85, v15, v19
  v_pk_add_f32 v[30:31], v[30:31], v[82:83]
  v_mov_b32 v86, v26
  v_pk_add_f32 v[28:29], v[28:29], v[80:81]
  v_add_f32_dpp v90, v84, v84 row_ror:8 row_mask:0xf bank_mask:0x3
  v_add_f32_dpp v89, v30, v30 row_ror:8 row_mask:0xf bank_mask:0x3
  v_add_f32_dpp v88, v28, v28 row_ror:8 row_mask:0xf bank_mask:0x3
  v_add_f32_dpp v90, v85, v85 row_ror:8 row_mask:0xf bank_mask:0xc
  v_add_f32_dpp v89, v31, v31 row_ror:8 row_mask:0xf bank_mask:0xc
  v_add_f32_dpp v88, v29, v29 row_ror:8 row_mask:0xf bank_mask:0xc
  v_mov_b32_dpp v86, v27 quad_perm:[0,1,2,3] row_mask:0xf bank_mask:0xc
  s_nop 0
  v_add_f32_dpp v88, v88, v88 row_half_mirror row_mask:0xf bank_mask:0xf
  v_add_f32_dpp v90, v90, v90 row_half_mirror row_mask:0xf bank_mask:0xf
  v_add_f32_dpp v89, v89, v89 row_half_mirror row_mask:0xf bank_mask:0xf
  v_add_f32_dpp v88, v88, v88 quad_perm:[1,0,3,2] row_mask:0xf bank_mask:0xf
  v_add_f32_dpp v90, v90, v90 quad_perm:[1,0,3,2] row_mask:0xf bank_mask:0xf
  v_add_f32_dpp v89, v89, v89 quad_perm:[1,0,3,2] row_mask:0xf bank_mask:0xf
  v_add_f32_dpp v88, v88, v88 quad_perm:[2,3,0,1] row_mask:0xf bank_mask:0xf
  v_add_f32_dpp v90, v90, v90 quad_perm:[2,3,0,1] row_mask:0xf bank_mask:0xf
  v_add_f32_dpp v89, v89, v89 quad_perm:[2,3,0,1] row_mask:0xf bank_mask:0xf
  v_mul_f32 v87, 0x3c000000, v88
  v_fma_f32 v89, -v87, v88, v89
  v_sub_f32 v88, v86, v87
  s_mov_b32 exec_lo, 0x7070707
  s_mov_b32 exec_hi, exec_lo
  buffer_store_dwordx4 v[88:91], v95, s[32:35], s73 offen sc1
  s_mov_b64 exec, -1
  s_setprio 0
  s_cmp_lg_u32 s30, 1
  s_cbranch_scc1 K_NOSW
  v_mov_b32 v56, 0
  v_dot2c_f32_bf16 v56, 0x3f803f80, v48
  v_dot2c_f32_bf16 v56, 0x3f803f80, v49
  v_dot2c_f32_bf16 v56, 0x3f803f80, v50
  v_dot2c_f32_bf16 v56, 0x3f803f80, v51
  v_dot2c_f32_bf16 v56, 0x3f803f80, v52
  v_dot2c_f32_bf16 v56, 0x3f803f80, v53
  v_dot2c_f32_bf16 v56, 0x3f803f80, v54
  v_dot2c_f32_bf16 v56, 0x3f803f80, v55
  s_nop 2
  v_add_f32_dpp v56, v56, v56 quad_perm:[1,0,3,2] row_mask:0xf bank_mask:0xf
  s_nop 1
  v_add_f32_dpp v56, v56, v56 quad_perm:[2,3,0,1] row_mask:0xf bank_mask:0xf
  s_nop 1
  v_add_f32_dpp v56, v56, v56 row_half_mirror row_mask:0xf bank_mask:0xf
  s_nop 1
  v_add_f32_dpp v56, v56, v56 row_mirror row_mask:0xf bank_mask:0xf
  s_nop 1
  v_add_f32_dpp v56, v56, v56 row_bcast:15 row_mask:0xa bank_mask:0xf
  s_nop 1
  v_add_f32_dpp v56, v56, v56 row_bcast:31 row_mask:0xc bank_mask:0xf
  v_or_b32 v56, 1, v56
  s_mov_b32 exec_lo, 0
  s_mov_b32 exec_hi, 0x80000000
  ds_write_b32 v126, v56 offset:4
  s_mov_b64 exec, -1
K_NOSW:
  s_setprio 0
  s_mov_b32 s64, s20
  s_mov_b32 s65, s21
  s_mov_b32 s66, 0x700000
  s_mov_b32 s67, 0x00020000
  s_mov_b32 s68, s22
  s_mov_b32 s69, s23
  s_mov_b32 s70, 0x700000
  s_mov_b32 s71, 0x00020000
  s_cmp_ge_u32 s29, 28
  s_cselect_b32 s66, 0, s66
  s_cselect_b32 s70, 0, s70
  s_and_b32 s12, s30, 2
  s_lshl_b32 s12, s12, 2
  v_lshl_or_b32 v24, v2, 1, s12
  v_xor_b32 v24, v24, v3
  v_mul_u32_u24 v7, 7168, v2
  v_lshl_add_u32 v24, v24, 4, v7
  s_lshl_b32 s12, s28, 5
  s_add_u32 s12, s12, s30
  s_mul_i32 s12, s12, 28672
  s_lshl_b32 s13, s29, 8
  s_add_u32 s12, s12, s13
  s_add_u32 s13, s12, 229376
  s_add_u32 s14, s12, 458752
  s_add_u32 s15, s12, 688128
  s_lshl_b32 s16, s30, 10
  s_add_u32 s16, s16, 83968
  s_mov_b32 s40, s24
  s_mov_b32 s41, s25
  s_mov_b32 s42, 0x700000
  s_mov_b32 s43, 0x00020000
  s_mov_b32 s42, s66
  v_mul_u32_u24 v7, 5120, v2
  v_sub_u32 v118, v24, v7
  s_lshl_b32 s18, s29, 5
  s_add_u32 s18, s18, s30
  s_lshl_b32 s18, s18, 13
  s_add_u32 s18, s18, s62
  s_lshl_b32 s19, s30, 10
  s_mov_b32 s20, s26
  s_mov_b32 s21, s27
  s_mov_b32 s22, 0x400000
  s_mov_b32 s23, 0x00020000
  v_and_b32 v7, 3, v1
  v_mul_u32_u24 v121, 4640, v7
  v_lshlrev_b32 v96, 4, v7
  v_lshrrev_b32 v7, 2, v1
  v_lshl_add_u32 v121, v7, 4, v121
  v_lshl_add_u32 v96, v7, 14, v96
  s_lshl_b32 s78, s30, 9
  v_add_u32 v121, s78, v121
  s_lshl_b32 s75, s30, 19
  s_lshl_b32 s78, s28, 8
  s_add_u32 s75, s75, s78
  s_and_b32 s78, s29, 3
  s_lshl_b32 s78, s78, 12
  s_add_u32 s75, s75, s78
  s_and_b32 s78, s29, 4
  s_lshl_b32 s78, s78, 9
  s_add_u32 s75, s75, s78
  s_lshr_b32 s78, s29, 3
  s_lshl_b32 s78, s78, 6
  s_add_u32 s75, s75, s78
  s_add_u32 s76, s75, 0x40000
  v_mov_b32 v122, 0x30003
  v_mov_b32 v125, 0x80000000
  s_mov_b32 s17, 0
  v_mov_b32 v123, 0xfffcfffc
  s_mov_b32 s83, 0x20000
  s_lshl_b32 s78, s60, 4
  v_lshl_add_u32 v6, v2, 2, s78
  v_lshrrev_b32 v7, 2, v1
  s_sub_u32 s78, 4094, s78
  v_sub_u32 v7, s78, v7
  s_lshl_b32 s78, s30, 6
  v_add_u32 v98, s78, v1
  s_max_u32 s78, s30, 3
  s_sub_u32 s78, s78, 3
  s_lshl_b32 s78, s78, 10
  s_add_u32 s79, s78, K_BAND - K_PC
  s_add_u32 s48, s48, s79
  s_addc_u32 s49, s49, 0
  s_add_u32 s50, s78, 72704
  s_setprio 3
  s_setprio 3
  s_mov_b64 exec, s[10:11]
  buffer_load_dwordx4 v[88:91], v92, s[32:35], s63 offen sc1
  s_mov_b64 exec, -1
  s_cmp_lg_u32 s30, 2
  s_cbranch_scc1 K_NOCR
  v_lshlrev_b32 v93, 5, v93
  s_mov_b32 s83, 0x20000
K_CR:
  buffer_load_dword v94, v93, s[32:35], s74 offen sc1
  s_sub_u32 s83, s83, 1
  s_waitcnt vmcnt(0)
  v_subrev_u32 v94, s46, v94
  s_cbranch_scc1 K_CRD
  v_cmp_lt_u32 vcc, 15, v94
  s_cbranch_vccnz K_CR
K_CRD:
  v_cmp_ne_u32 vcc, s56, v94
  s_nop 0
  s_cmp_lg_u64 vcc, 0
  s_cselect_b32 s78, 2, 1
  v_mov_b32 v94, s78
  ds_write_b32 v126, v94 offset:8
K_NOCR:
  s_mov_b32 m0, s50
  s_nop 0
  global_load_lds_dwordx4 v97, s[48:49]
  s_waitcnt vmcnt(1)
  s_branch K_P1C
K_P1:
  s_mov_b64 s[10:11], vcc
  s_add_u32 s63, s63, 0x40000
  s_min_u32 s63, s63, s72
  s_mov_b64 exec, s[10:11]
  buffer_load_dwordx4 v[88:91], v92, s[32:35], s63 offen sc1
  s_mov_b64 exec, -1
  s_sub_u32 s83, s83, 1
  s_waitcnt vmcnt(0)
  s_cbranch_scc1 K_P1D
K_P1C:
  v_cmp_ne_u32 vcc, s46, v91
  s_cbranch_vccnz K_P1
K_P1D:
  ds_read2_b32 v[84:85], v126 offset0:2 offset1:1
  s_max_i32 s83, s83, 0
  v_mov_b32_dpp v80, v88 row_newbcast:0 row_mask:0xf bank_mask:0x3
  s_nop 1
  v_mov_b32_dpp v80, v88 row_newbcast:8 row_mask:0xf bank_mask:0xc
  v_sub_f32 v88, v88, v80
  v_mul_f32 v81, 0x43000000, v88
  v_fmac_f32 v89, v81, v88
  v_add_f32_dpp v90, v90, v90 row_half_mirror row_mask:0xf bank_mask:0xf
  v_add_f32_dpp v88, v88, v88 row_half_mirror row_mask:0xf bank_mask:0xf
  v_add_f32_dpp v89, v89, v89 row_half_mirror row_mask:0xf bank_mask:0xf
  v_add_f32_dpp v90, v90, v90 quad_perm:[1,0,3,2] row_mask:0xf bank_mask:0xf
  v_add_f32_dpp v88, v88, v88 quad_perm:[1,0,3,2] row_mask:0xf bank_mask:0xf
  v_add_f32_dpp v89, v89, v89 quad_perm:[1,0,3,2] row_mask:0xf bank_mask:0xf
  v_add_f32_dpp v90, v90, v90 quad_perm:[2,3,0,1] row_mask:0xf bank_mask:0xf
  v_add_f32_dpp v88, v88, v88 quad_perm:[2,3,0,1] row_mask:0xf bank_mask:0xf
  v_add_f32_dpp v89, v89, v89 quad_perm:[2,3,0,1] row_mask:0xf bank_mask:0xf
  v_mul_f32 v81, 0x41800000, v88
  v_fmac_f32 v80, 0x3e000000, v88
  v_fma_f32 v89, -v81, v88, v89
  v_mul_f32 v89, 0x3a800000, v89
  v_max_f32 v89, 0, v89
  v_cvt_pk_bf16_f32 v81, v80, v89
  v_and_b32 v89, v124, v81
  v_lshlrev_b32 v80, 16, v81
  v_add_f32 v89, 0x3727c5ac, v89
  v_cvt_pk_bf16_f32 v89, 0, v89
  v_sub_f32 v86, v86, v80
  v_sqrt_f32 v89, v89
  s_nop 0
  v_cvt_pk_bf16_f32 v83, v80, v89
  v_and_b32 v89, v124, v83
  v_rcp_f32 v81, v89
  s_waitcnt lgkmcnt(0)
  v_readfirstlane_b32 s47, v84
  v_readfirstlane_b32 s78, v85
  v_mul_f32 v86, v86, v81
  s_min_u32 s78, s78, s47
  s_cmp_eq_u32 s78, 0
  s_cbranch_scc1 K_RARE
K_RB:
  s_sub_u32 s47, s47, 1
  v_mov_b32_dpp v28, v81 row_newbcast:0 row_mask:0xf bank_mask:0xf
  v_mov_b32_dpp v29, v81 row_newbcast:8 row_mask:0xf bank_mask:0xf
  v_mov_b32_dpp v30, v86 row_newbcast:0 row_mask:0xf bank_mask:0xf
  v_mov_b32_dpp v31, v86 row_newbcast:8 row_mask:0xf bank_mask:0xf
  v_fma_f32 v82, -v80, v85, v90
  v_mul_f32 v82, v82, v81
  v_cvt_pk_bf16_f32 v82, v82, v82
  v_ashrrev_i32 v81, 31, v82
  v_bitop3_b32 v82, v82, v81, v125 bitop3:0x1e
  v_and_or_b32 v82, v82, v124, v7
  s_mov_b32 exec_lo, 0x01010101
  s_mov_b32 exec_hi, 0x01010101
  ds_write_b64 v98, v[82:83] offset:128
  s_mov_b64 exec, 1
  ds_add_u32 v126, v127 offset:20
  s_mov_b64 exec, -1
  s_setprio 3
  v_pk_fma_f32 v[48:49], v[32:33], v[28:29], v[30:31] neg_lo:[1,0,0] neg_hi:[1,0,0]
  v_pk_fma_f32 v[50:51], v[34:35], v[28:29], v[30:31] neg_lo:[1,0,0] neg_hi:[1,0,0]
  v_pk_fma_f32 v[52:53], v[36:37], v[28:29], v[30:31] neg_lo:[1,0,0] neg_hi:[1,0,0]
  v_pk_fma_f32 v[54:55], v[38:39], v[28:29], v[30:31] neg_lo:[1,0,0] neg_hi:[1,0,0]
  v_pk_fma_f32 v[56:57], v[40:41], v[28:29], v[30:31] neg_lo:[1,0,0] neg_hi:[1,0,0]
  v_pk_fma_f32 v[58:59], v[42:43], v[28:29], v[30:31] neg_lo:[1,0,0] neg_hi:[1,0,0]
  v_pk_fma_f32 v[60:61], v[44:45], v[28:29], v[30:31] neg_lo:[1,0,0] neg_hi:[1,0,0]
  v_pk_fma_f32 v[62:63], v[46:47], v[28:29], v[30:31] neg_lo:[1,0,0] neg_hi:[1,0,0]
  v_cvt_pk_f16_f32 v64, v48, v49
  v_cvt_pk_f16_f32 v65, v50, v51
  v_cvt_pk_f16_f32 v66, v52, v53
  v_cvt_pk_f16_f32 v67, v54, v55
  v_cvt_pk_f16_f32 v68, v56, v57
  v_cvt_pk_f16_f32 v69, v58, v59
  v_cvt_pk_f16_f32 v70, v60, v61
  v_cvt_pk_f16_f32 v71, v62, v63
  v_permlane32_swap_b32 v64, v66
  v_permlane32_swap_b32 v65, v67
  v_permlane32_swap_b32 v68, v70
  v_permlane32_swap_b32 v69, v71
  v_permlane16_swap_b32 v64, v65
  v_permlane16_swap_b32 v66, v67
  v_permlane16_swap_b32 v68, v69
  v_permlane16_swap_b32 v70, v71
  v_and_b32 v64, v123, v64
  v_or_b32 v65, v122, v65
  v_or_b32 v66, v122, v66
  v_and_b32 v67, v123, v67
  v_and_b32 v68, v123, v68
  v_or_b32 v69, v122, v69
  v_or_b32 v70, v122, v70
  v_and_b32 v71, v123, v71
  s_cmp_lg_u32 s47, 0
  s_cbranch_scc1 K_US_W
  buffer_store_dwordx4 v[64:67], v4, s[20:23], s61 offen
  buffer_store_dwordx4 v[68:71], v4, s[20:23], s61 offen offset:2048
  s_branch K_US_D
K_US_W:
  buffer_store_dwordx4 v[64:67], v4, s[20:23], s61 offen sc1
  buffer_store_dwordx4 v[68:71], v4, s[20:23], s61 offen offset:2048 sc1
K_US_D:
  s_nop 0
  buffer_load_dwordx4 v[64:67], v96, s[20:23], s75 offen sc1
  buffer_load_dwordx4 v[68:71], v96, s[20:23], s76 offen sc1
  s_branch K_P2A
K_P2:
  buffer_load_dwordx4 v[64:67], v96, s[20:23], s75 offen sc1
  buffer_load_dwordx4 v[68:71], v96, s[20:23], s76 offen sc1
K_P2A:
  s_cmp_lg_u32 s17, 0
  s_cbranch_scc1 K_E2
  s_setprio 0
  v_pk_mul_f32 v[8:9], v[48:49], s[58:59] op_sel_hi:[1,0]
  v_pk_mul_f32 v[10:11], v[50:51], s[58:59] op_sel_hi:[1,0]
  v_pk_mul_f32 v[12:13], v[52:53], s[58:59] op_sel_hi:[1,0]
  v_pk_mul_f32 v[14:15], v[54:55], s[58:59] op_sel_hi:[1,0]
  v_exp_f32 v8, -v8
  v_lshlrev_b32 v100, 16, v20
  v_exp_f32 v9, -v9
  v_pk_add_f32 v[32:33], v[26:27], v[32:33] neg_lo:[0,1] neg_hi:[0,1]
  v_exp_f32 v10, -v10
  v_and_b32 v102, 0xffff0000, v20
  v_exp_f32 v11, -v11
  v_pk_add_f32 v[34:35], v[26:27], v[34:35] neg_lo:[0,1] neg_hi:[0,1]
  v_exp_f32 v12, -v12
  v_lshlrev_b32 v104, 16, v21
  v_exp_f32 v13, -v13
  v_pk_add_f32 v[36:37], v[26:27], v[36:37] neg_lo:[0,1] neg_hi:[0,1]
  v_exp_f32 v14, -v14
  v_and_b32 v106, 0xffff0000, v21
  v_exp_f32 v15, -v15
  v_pk_add_f32 v[38:39], v[26:27], v[38:39] neg_lo:[0,1] neg_hi:[0,1]
  v_pk_add_f32 v[8:9], v[8:9], 1.0 op_sel_hi:[1,0]
  v_pk_add_f32 v[10:11], v[10:11], 1.0 op_sel_hi:[1,0]
  v_pk_add_f32 v[12:13], v[12:13], 1.0 op_sel_hi:[1,0]
  v_pk_add_f32 v[14:15], v[14:15], 1.0 op_sel_hi:[1,0]
  v_rcp_f32 v8, v8
  v_pk_mul_f32 v[100:101], v[48:49], v[100:101] op_sel_hi:[1,0]
  v_rcp_f32 v9, v9
  v_rcp_f32 v10, v10
  v_pk_mul_f32 v[102:103], v[50:51], v[102:103] op_sel_hi:[1,0]
  v_rcp_f32 v11, v11
  v_rcp_f32 v12, v12
  v_pk_mul_f32 v[104:105], v[52:53], v[104:105] op_sel_hi:[1,0]
  v_rcp_f32 v13, v13
  v_rcp_f32 v14, v14
  v_pk_mul_f32 v[106:107], v[54:55], v[106:107] op_sel_hi:[1,0]
  v_rcp_f32 v15, v15
  v_pk_mul_f32 v[8:9], v[8:9], v[48:49]
  v_pk_mul_f32 v[10:11], v[10:11], v[50:51]
  v_pk_mul_f32 v[12:13], v[12:13], v[52:53]
  v_pk_mul_f32 v[14:15], v[14:15], v[54:55]
  v_pk_fma_f32 v[32:33], v[100:101], v[8:9], v[32:33]
  v_cvt_pk_bf16_f32 v48, v8, 0
  v_cvt_pk_bf16_f32 v49, 0, v9
  v_pk_fma_f32 v[34:35], v[102:103], v[10:11], v[34:35]
  v_cvt_pk_bf16_f32 v50, v10, 0
  v_cvt_pk_bf16_f32 v51, 0, v11
  v_pk_fma_f32 v[36:37], v[104:105], v[12:13], v[36:37]
  v_cvt_pk_bf16_f32 v52, v12, 0
  v_cvt_pk_bf16_f32 v53, 0, v13
  v_pk_fma_f32 v[38:39], v[106:107], v[14:15], v[38:39]
  v_cvt_pk_bf16_f32 v54, v14, 0
  v_cvt_pk_bf16_f32 v55, 0, v15
  s_mov_b32 s17, 1
  s_setprio 3
K_E2:
  s_sub_u32 s83, s83, 1
  s_waitcnt vmcnt(0)
  v_or3_b32 v80, v64, v67, v68
  v_bitop3_b32 v81, v65, v66, v69 bitop3:0x80
  v_bitop3_b32 v80, v80, v71, v70 bitop3:0xfd
  s_cbranch_scc1 K_P2D
  v_bitop3_b32 v80, v80, v81, v122 bitop3:0xa2
  v_cmp_ne_u32 vcc, 0, v80
  s_cbranch_vccnz K_P2
K_P2D:
  ds_write_b128 v121, v[64:67] offset:1312
  ds_write_b128 v121, v[68:71] offset:1568
  s_max_i32 s83, s83, 0
  s_mov_b64 exec, 1
  ds_add_u32 v126, v127 offset:16
  s_mov_b64 exec, -1
  s_setprio 0
  s_cmp_ge_u32 s29, 28
  s_cbranch_scc1 K_NOTL
  s_branch K_UGB
K_UG:
  s_sleep 1
K_UGB:
  ds_read_b32 v64, v126 offset:16
  s_waitcnt lgkmcnt(0)
  v_cmp_gt_u32 vcc, 8, v64
  s_cbranch_vccnz K_UG
  s_setprio 3
  s_add_u32 m0, s16, 49152
  s_nop 0
  buffer_load_dwordx4 v24, s[68:71], s14 offen nt lds
  s_add_u32 m0, s16, 24576
  s_nop 0
  buffer_load_dwordx4 v24, s[64:67], s15 offen nt lds
  s_add_u32 m0, s16, 57344
  s_nop 0
  buffer_load_dwordx4 v24, s[68:71], s15 offen nt lds
  s_cmp_ge_u32 s30, 4
  s_cbranch_scc1 K_NOWD
  s_waitcnt vmcnt(1)
  s_branch K_HGB
K_HG:
  s_sleep 1
K_HGB:
  ds_read_b32 v64, v126 offset:16
  ds_read2_b32 v[66:67], v126 offset0:28 offset1:30
  s_waitcnt lgkmcnt(0)
  v_add3_u32 v64, v64, v66, v67
  v_cmp_gt_u32 vcc, 17, v64
  s_cbranch_vccnz K_HG
  s_add_u32 m0, s19, 19328
  s_nop 0
  buffer_load_dwordx4 v118, s[40:43], s18 offen nt lds
  s_add_u32 s18, s18, 32768
  s_add_u32 m0, s19, 23424
  s_nop 0
  buffer_load_dwordx4 v118, s[40:43], s18 offen nt lds
  s_add_u32 s18, s18, 32768
  s_mov_b64 exec, 1
  s_waitcnt vmcnt(2)
  ds_add_u32 v126, v127 offset:24
  s_mov_b64 exec, -1
  s_add_u32 m0, s19, 27520
  s_nop 0
  buffer_load_dwordx4 v118, s[40:43], s18 offen nt lds
  s_add_u32 s18, s18, 32768
  s_add_u32 m0, s19, 31616
  s_nop 0
  buffer_load_dwordx4 v118, s[40:43], s18 offen nt lds
  s_add_u32 s18, s18, 32768
  s_add_u32 m0, s19, 35712
  s_nop 0
  buffer_load_dwordx4 v118, s[40:43], s18 offen nt lds
  s_add_u32 s18, s18, 32768
  s_add_u32 m0, s19, 39808
  s_nop 0
  buffer_load_dwordx4 v118, s[40:43], s18 offen nt lds
  s_add_u32 s18, s18, 32768
  s_add_u32 m0, s19, 43904
  s_nop 0
  buffer_load_dwordx4 v118, s[40:43], s18 offen nt lds
  s_add_u32 s18, s18, 32768
  s_add_u32 m0, s19, 48000
  s_nop 0
  buffer_load_dwordx4 v118, s[40:43], s18 offen nt lds
  s_mov_b64 exec, 1
  s_waitcnt vmcnt(0)
  ds_add_u32 v126, v127 offset:124
  s_mov_b64 exec, -1
  s_setprio 0
  s_branch K_TLD
K_NOWD:
  s_mov_b64 exec, 1
  s_waitcnt vmcnt(0)
  ds_add_u32 v126, v127 offset:24
  s_mov_b64 exec, -1
  s_setprio 0
K_NOTL:
  s_branch K_TLB
K_TL:
  s_sleep 8
K_TLB:
  ds_read_b32 v64, v126 offset:120
  s_waitcnt lgkmcnt(0)
  v_cmp_eq_u32 vcc, 0, v64
  s_cbranch_vccnz K_TL
K_TLD:
  ds_read_b128 v[92:95], v126 offset:96
  s_waitcnt lgkmcnt(0)
  v_readfirstlane_b32 s6, v92
  v_readfirstlane_b32 s7, v94
  s_andn2_b32 s6, 0xffe, s6
  s_andn2_b32 s7, 0xffe, s7
  s_lshr_b32 s77, s6, 4
  s_lshr_b32 s79, s7, 4
  v_cmp_ne_u32 s[52:53], s6, v6
  v_cmp_ne_u32 vcc, s7, v6
  v_add_u32 v6, 2, v6
  s_and_b64 s[52:53], s[52:53], vcc
  v_cmp_ne_u32 s[54:55], s6, v6
  v_cmp_ne_u32 vcc, s7, v6
  s_nop 0
  s_and_b64 s[54:55], s[54:55], vcc
  s_cmp_eq_u32 s77, s60
  s_cselect_b32 s77, 0x55555555, 0
  s_cmp_eq_u32 s79, s60
  s_cselect_b32 s79, 0xaaaaaaaa, 0
  s_or_b32 s77, s77, s79
  v_and_b32 v64, 3, v1
  v_mul_u32_u24 v64, 544, v64
  v_sub_u32 v121, v121, v64
  s_and_b32 s78, s30, 3
  s_lshl_b32 s78, s78, 2
  s_lshr_b32 s78, 0xc480, s78
  s_and_b32 s78, s78, 15
  v_mov_b32 v123, s78
  s_mov_b32 s78, 4
  s_sub_u32 s75, s75, 0x200000
  s_sub_u32 s76, s76, 0x200000
  s_cmp_eq_u32 s77, 0
  s_cbranch_scc1 K_NOOW1
  v_mul_f32 v9, 0x3fb8aa3b, v57
  v_mul_f32 v8, 0x3fb8aa3b, v56
  v_mul_f32 v11, 0x3fb8aa3b, v59
  v_mul_f32 v10, 0x3fb8aa3b, v58
  v_mul_f32 v13, 0x3fb8aa3b, v61
  v_mul_f32 v12, 0x3fb8aa3b, v60
  v_mul_f32 v15, 0x3fb8aa3b, v63
  v_mul_f32 v14, 0x3fb8aa3b, v62
  v_exp_f32 v8, -v8
  v_lshlrev_b32 v100, 16, v22
  v_exp_f32 v9, -v9
  v_sub_f32 v41, v27, v41
  v_sub_f32 v40, v26, v40
  v_exp_f32 v10, -v10
  v_and_b32 v102, 0xffff0000, v22
  v_exp_f32 v11, -v11
  v_sub_f32 v43, v27, v43
  v_sub_f32 v42, v26, v42
  v_exp_f32 v12, -v12
  v_lshlrev_b32 v104, 16, v23
  v_exp_f32 v13, -v13
  v_sub_f32 v45, v27, v45
  v_sub_f32 v44, v26, v44
  v_exp_f32 v14, -v14
  v_and_b32 v106, 0xffff0000, v23
  v_exp_f32 v15, -v15
  v_sub_f32 v47, v27, v47
  v_sub_f32 v46, v26, v46
  v_add_f32 v9, 1.0, v9
  v_add_f32 v8, 1.0, v8
  v_add_f32 v11, 1.0, v11
  v_add_f32 v10, 1.0, v10
  v_add_f32 v13, 1.0, v13
  v_add_f32 v12, 1.0, v12
  v_add_f32 v15, 1.0, v15
  v_add_f32 v14, 1.0, v14
  v_rcp_f32 v8, v8
  v_mul_f32 v101, v57, v100
  v_mul_f32 v100, v56, v100
  v_rcp_f32 v9, v9
  v_rcp_f32 v10, v10
  v_mul_f32 v103, v59, v102
  v_mul_f32 v102, v58, v102
  v_rcp_f32 v11, v11
  v_rcp_f32 v12, v12
  v_mul_f32 v105, v61, v104
  v_mul_f32 v104, v60, v104
  v_rcp_f32 v13, v13
  v_rcp_f32 v14, v14
  v_mul_f32 v107, v63, v106
  v_mul_f32 v106, v62, v106
  v_rcp_f32 v15, v15
  v_mul_f32 v9, v9, v57
  v_mul_f32 v8, v8, v56
  v_mul_f32 v11, v11, v59
  v_mul_f32 v10, v10, v58
  v_mul_f32 v13, v13, v61
  v_mul_f32 v12, v12, v60
  v_mul_f32 v15, v15, v63
  v_mul_f32 v14, v14, v62
  v_fma_f32 v41, v101, v9, v41
  v_fma_f32 v40, v100, v8, v40
  v_cvt_pk_bf16_f32 v56, v8, 0
  v_cvt_pk_bf16_f32 v57, 0, v9
  v_fma_f32 v43, v103, v11, v43
  v_fma_f32 v42, v102, v10, v42
  v_cvt_pk_bf16_f32 v58, v10, 0
  v_cvt_pk_bf16_f32 v59, 0, v11
  v_fma_f32 v45, v105, v13, v45
  v_fma_f32 v44, v104, v12, v44
  v_cvt_pk_bf16_f32 v60, v12, 0
  v_cvt_pk_bf16_f32 v61, 0, v13
  v_fma_f32 v47, v107, v15, v47
  v_fma_f32 v46, v106, v14, v46
  v_cvt_pk_bf16_f32 v62, v14, 0
  v_cvt_pk_bf16_f32 v63, 0, v15
K_NOOW1:
  s_branch K_HW4B
K_HW4:
  s_sleep 6
K_HW4B:
  ds_read_b32 v64, v123 offset:48
  s_waitcnt lgkmcnt(0)
  v_cmp_gt_u32 vcc, 4, v64
  s_cbranch_vccnz K_HW4
  s_cmp_lt_u32 s30, 4
  s_cbranch_scc1 K_NOSEND
  s_branch K_YWB
K_YW:
  s_sleep 1
K_YWB:
  ds_read_b128 v[64:67], v126 offset:48
  s_waitcnt lgkmcnt(0)
  v_min_u32 v64, v64, v65
  v_min3_u32 v64, v64, v66, v67
  v_cmp_gt_u32 vcc, s78, v64
  s_cbranch_vccnz K_YW
  ds_read_b128 v[64:67], v121 offset:54272
  ds_read_b128 v[68:71], v121 offset:54528
  s_setprio 3
  s_waitcnt lgkmcnt(1)
  v_bitop3_b32 v72, v64, v65, v122 bitop3:0xa2
  v_cmp_eq_u32 vcc, 0, v72
  s_nop 1
  v_addc_co_u32 v64, vcc, 0, v64, vcc
  s_waitcnt lgkmcnt(0)
  v_bitop3_b32 v72, v68, v69, v122 bitop3:0xa2
  v_cmp_eq_u32 vcc, 0, v72
  s_nop 1
  v_addc_co_u32 v68, vcc, 0, v68, vcc
  s_cmp_lg_u32 s47, 0
  s_cbranch_scc1 K_YS_W
  buffer_store_dwordx4 v[64:67], v96, s[20:23], s75 offen
  buffer_store_dwordx4 v[68:71], v96, s[20:23], s76 offen
  s_branch K_YS_D
K_YS_W:
  buffer_store_dwordx4 v[64:67], v96, s[20:23], s75 offen sc1
  buffer_store_dwordx4 v[68:71], v96, s[20:23], s76 offen sc1
K_YS_D:
  s_add_u32 s75, s75, 0x200000
  s_add_u32 s76, s76, 0x200000
  v_add_u32 v121, 2048, v121
  s_add_u32 s78, s78, 4
  s_cmp_gt_u32 s78, 8
  s_cbranch_scc1 K_SENT
  s_branch K_YWB
K_SENT:
  s_setprio 0
K_NOSEND:
  s_cmp_eq_u32 s77, 0
  s_cbranch_scc1 K_NOOWN
  s_setprio 3
K_PO:
  buffer_load_dwordx4 v[72:75], v4, s[20:23], s61 offen sc1
  buffer_load_dwordx4 v[76:79], v4, s[20:23], s61 offen offset:2048 sc1
  s_sub_u32 s83, s83, 1
  s_waitcnt vmcnt(0)
  s_cbranch_scc1 K_POD
  v_bitop3_b32 v64, v72, v73, v122 bitop3:0xa2
  v_bitop3_b32 v65, v76, v77, v122 bitop3:0xa2
  v_cmp_eq_u32 s[8:9], 0, v64
  v_cmp_eq_u32 s[10:11], 0, v65
  s_andn2_b64 s[8:9], s[8:9], s[52:53]
  s_andn2_b64 s[10:11], s[10:11], s[54:55]
  s_or_b64 s[8:9], s[8:9], s[10:11]
  s_cbranch_scc1 K_PO
K_POD:
  s_max_i32 s83, s83, 0
  v_mov_b32 v64, 0
  v_mov_b32 v65, 0
  v_mov_b32 v66, s46
  v_lshlrev_b32 v67, 5, v1
  s_mov_b32 exec_lo, s77
  s_mov_b32 exec_hi, s77
  s_lshl_b32 s78, s28, 16
  s_add_u32 s78, s78, 0x50e000
  s_cmp_lg_u32 s47, 0
  s_cbranch_scc1 K_OS_W
  buffer_store_dwordx3 v[64:66], v67, s[32:35], s78 offen
  s_branch K_OS_D
K_OS_W:
  buffer_store_dwordx3 v[64:66], v67, s[32:35], s78 offen sc1
K_OS_D:
  s_mov_b64 exec, -1
  s_branch K_PYC
K_NOOWN:
  s_branch K_DWB
K_DW:
  s_sleep 2
K_DWB:
  ds_read_b32 v64, v123 offset:48
  s_waitcnt lgkmcnt(0)
  v_cmp_gt_u32 vcc, 8, v64
  s_cbranch_vccnz K_DW
  s_setprio 2
  buffer_load_dwordx4 v[72:75], v4, s[20:23], s61 offen sc1
  buffer_load_dwordx4 v[76:79], v4, s[20:23], s61 offen offset:2048 sc1
  v_pk_mul_f32 v[8:9], v[56:57], s[58:59] op_sel_hi:[1,0]
  v_pk_mul_f32 v[10:11], v[58:59], s[58:59] op_sel_hi:[1,0]
  v_pk_mul_f32 v[12:13], v[60:61], s[58:59] op_sel_hi:[1,0]
  v_pk_mul_f32 v[14:15], v[62:63], s[58:59] op_sel_hi:[1,0]
  v_exp_f32 v8, -v8
  v_lshlrev_b32 v100, 16, v22
  v_exp_f32 v9, -v9
  v_pk_add_f32 v[40:41], v[26:27], v[40:41] neg_lo:[0,1] neg_hi:[0,1]
  v_exp_f32 v10, -v10
  v_and_b32 v102, 0xffff0000, v22
  v_exp_f32 v11, -v11
  v_pk_add_f32 v[42:43], v[26:27], v[42:43] neg_lo:[0,1] neg_hi:[0,1]
  v_exp_f32 v12, -v12
  v_lshlrev_b32 v104, 16, v23
  v_exp_f32 v13, -v13
  v_pk_add_f32 v[44:45], v[26:27], v[44:45] neg_lo:[0,1] neg_hi:[0,1]
  v_exp_f32 v14, -v14
  v_and_b32 v106, 0xffff0000, v23
  v_exp_f32 v15, -v15
  v_pk_add_f32 v[46:47], v[26:27], v[46:47] neg_lo:[0,1] neg_hi:[0,1]
  v_pk_add_f32 v[8:9], v[8:9], 1.0 op_sel_hi:[1,0]
  v_pk_add_f32 v[10:11], v[10:11], 1.0 op_sel_hi:[1,0]
  v_pk_add_f32 v[12:13], v[12:13], 1.0 op_sel_hi:[1,0]
  v_pk_add_f32 v[14:15], v[14:15], 1.0 op_sel_hi:[1,0]
  v_rcp_f32 v8, v8
  v_pk_mul_f32 v[100:101], v[56:57], v[100:101] op_sel_hi:[1,0]
  v_rcp_f32 v9, v9
  v_rcp_f32 v10, v10
  v_pk_mul_f32 v[102:103], v[58:59], v[102:103] op_sel_hi:[1,0]
  v_rcp_f32 v11, v11
  v_rcp_f32 v12, v12
  v_pk_mul_f32 v[104:105], v[60:61], v[104:105] op_sel_hi:[1,0]
  v_rcp_f32 v13, v13
  v_rcp_f32 v14, v14
  v_pk_mul_f32 v[106:107], v[62:63], v[106:107] op_sel_hi:[1,0]
  v_rcp_f32 v15, v15
  v_pk_mul_f32 v[8:9], v[8:9], v[56:57]
  v_pk_mul_f32 v[10:11], v[10:11], v[58:59]
  v_pk_mul_f32 v[12:13], v[12:13], v[60:61]
  v_pk_mul_f32 v[14:15], v[14:15], v[62:63]
  v_pk_fma_f32 v[40:41], v[100:101], v[8:9], v[40:41]
  v_cvt_pk_bf16_f32 v56, v8, 0
  v_cvt_pk_bf16_f32 v57, 0, v9
  v_pk_fma_f32 v[42:43], v[102:103], v[10:11], v[42:43]
  v_cvt_pk_bf16_f32 v58, v10, 0
  v_cvt_pk_bf16_f32 v59, 0, v11
  v_pk_fma_f32 v[44:45], v[104:105], v[12:13], v[44:45]
  v_cvt_pk_bf16_f32 v60, v12, 0
  v_cvt_pk_bf16_f32 v61, 0, v13
  v_pk_fma_f32 v[46:47], v[106:107], v[14:15], v[46:47]
  v_cvt_pk_bf16_f32 v62, v14, 0
  v_cvt_pk_bf16_f32 v63, 0, v15
  s_waitcnt vmcnt(0)
  s_branch K_PYC
K_PY:
  s_mov_b64 exec, s[52:53]
  buffer_load_dwordx4 v[72:75], v4, s[20:23], s61 offen sc1
  s_mov_b64 exec, s[54:55]
  buffer_load_dwordx4 v[76:79], v4, s[20:23], s61 offen offset:2048 sc1
  s_mov_b64 exec, -1
  s_sub_u32 s83, s83, 1
  s_waitcnt vmcnt(0)
  s_cbranch_scc1 K_PYD
K_PYC:
  v_bitop3_b32 v64, v72, v73, v122 bitop3:0xa2
  v_bitop3_b32 v65, v76, v77, v122 bitop3:0xa2
  v_min_u32 v64, v64, v65
  v_cmp_eq_u32 vcc, 0, v64
  s_cbranch_vccnz K_PY
K_PYD:
  v_permlane32_swap_b32 v72, v74
  v_permlane32_swap_b32 v73, v75
  v_permlane32_swap_b32 v76, v78
  v_permlane32_swap_b32 v77, v79
  v_permlane16_swap_b32 v72, v73
  v_permlane16_swap_b32 v74, v75
  v_permlane16_swap_b32 v76, v77
  v_permlane16_swap_b32 v78, v79
  v_dot2c_f32_bf16 v32, v72, v48
  v_dot2c_f32_bf16 v34, v73, v50
  v_dot2c_f32_bf16 v36, v74, v52
  v_dot2c_f32_bf16 v38, v75, v54
  v_dot2c_f32_bf16 v40, v76, v56
  v_dot2c_f32_bf16 v42, v77, v58
  v_dot2c_f32_bf16 v44, v78, v60
  v_dot2c_f32_bf16 v46, v79, v62
  v_dot2c_f32_bf16 v33, v72, v49
  v_dot2c_f32_bf16 v35, v73, v51
  v_dot2c_f32_bf16 v37, v74, v53
  v_dot2c_f32_bf16 v39, v75, v55
  v_dot2c_f32_bf16 v41, v76, v57
  v_dot2c_f32_bf16 v43, v77, v59
  v_dot2c_f32_bf16 v45, v78, v61
  v_dot2c_f32_bf16 v47, v79, v63
  v_cvt_pk_bf16_f32 v8, v32, v34
  v_cvt_pk_bf16_f32 v9, v36, v38
  v_cvt_pk_bf16_f32 v10, v40, v42
  v_cvt_pk_bf16_f32 v11, v44, v46
  s_mov_b64 exec, s[52:53]
  buffer_store_dwordx4 v[8:11], v4, s[20:23], s61 offen offset:0
  s_mov_b64 exec, -1
  v_cvt_pk_bf16_f32 v12, v33, v35
  v_cvt_pk_bf16_f32 v13, v37, v39
  v_cvt_pk_bf16_f32 v14, v41, v43
  v_cvt_pk_bf16_f32 v15, v45, v47
  s_mov_b64 exec, s[54:55]
  buffer_store_dwordx4 v[12:15], v4, s[20:23], s61 offen offset:2048
  s_mov_b64 exec, -1
  s_endpgm
K_RARE:
  s_sleep 1
  ds_read2_b32 v[84:85], v126 offset0:2 offset1:1
  s_waitcnt lgkmcnt(0)
  v_readfirstlane_b32 s47, v84
  v_readfirstlane_b32 s78, v85
  s_nop 0
  s_min_u32 s78, s78, s47
  s_cmp_eq_u32 s78, 0
  s_cbranch_scc1 K_RARE
  s_branch K_RB
.p2align 6
K_C:
  s_sub_u32 s30, s30, 8
  s_setprio 2
  s_lshr_b32 s3, s29, 3
  s_lshl_b32 s3, s3, 5
  s_and_b32 s55, s29, 7
  s_add_u32 s3, s3, s55
  s_lshl_b32 s55, s28, 7
  s_add_u32 s3, s3, s55
  s_lshr_b32 s59, s30, 1
  s_lshl_b32 s55, s59, 3
  s_add_u32 s56, s3, s55
  s_lshl_b32 s57, s56, 1
  s_and_b32 s57, s57, -4
  v_lshlrev_b32 v95, 4, v1
  v_and_b32 v96, 15, v1
  v_lshrrev_b32 v97, 4, v1
  v_mov_b32 v20, 0
  v_mov_b32 v21, 0
  v_mov_b32 v22, 0
  v_mov_b32 v23, 0
  s_mov_b32 s34, 0x800000
  s_mov_b32 s35, 0x00020000
  s_waitcnt lgkmcnt(0)
  s_load_dword s47, s[12:13], s57
  s_mov_b32 s32, s42
  s_mov_b32 s33, s43
  s_barrier
  s_mov_b32 m0, 81920
  s_cmp_lg_u32 s30, 2
  s_cbranch_scc1 K_NOT
  s_lshl_b32 s60, s28, 16
  s_lshl_b32 s61, s29, 11
  s_add_u32 s60, s60, s61
  s_add_u32 s60, s60, 0x500000
  s_lshl_b32 s61, s28, 10
  s_add_u32 s61, s61, 0x441000
  buffer_load_dwordx4 v95, s[32:35], s60 offen sc1 lds
  buffer_load_dwordx4 v95, s[32:35], s60 offen offset:1024 sc1 lds
  buffer_load_dwordx4 v95, s[32:35], s61 offen sc1 lds
K_NOT:
  s_mov_b32 s4, s20
  s_mov_b32 s5, s21
  s_mov_b32 s6, 0x700000
  s_mov_b32 s7, 0x00020000
  s_mov_b32 s8, s22
  s_mov_b32 s9, s23
  s_mov_b32 s10, 0x700000
  s_mov_b32 s11, 0x00020000
  s_cmp_ge_u32 s29, 28
  s_cselect_b32 s6, 0, s6
  s_cselect_b32 s10, 0, s10
  s_and_b32 s16, s30, 2
  s_lshl_b32 s16, s16, 2
  v_lshl_or_b32 v88, v97, 1, s16
  v_xor_b32 v88, v88, v96
  v_mul_u32_u24 v18, 7168, v97
  v_lshl_add_u32 v88, v88, 4, v18
  s_lshl_b32 s16, s28, 5
  s_add_u32 s16, s16, s30
  s_mul_i32 s16, s16, 28672
  s_lshl_b32 s17, s29, 8
  s_add_u32 s16, s16, s17
  s_add_u32 s17, s16, 229376
  s_add_u32 s18, s16, 458752
  s_add_u32 s19, s16, 688128
  s_lshl_b32 s36, s30, 10
  s_add_u32 s36, s36, 83968
  s_add_u32 m0, s36, 0
  s_nop 0
  buffer_load_dwordx4 v88, s[4:7], s16 offen nt lds
  s_mov_b32 s52, s59
  s_lshr_b32 s53, s30, 2
  s_xor_b32 s53, s53, s30
  s_and_b32 s53, s53, 1
  s_mul_i32 s66, s52, 4640
  s_add_u32 s66, s66, 768
  v_add_u32 v11, s66, v95
  s_mov_b32 exec_hi, 3
  ds_write_b128 v11, v[20:23]
  s_mov_b32 exec_hi, -1
  s_lshl_b32 s68, s52, 12
  s_add_u32 s68, s68, 56320
  s_lshl_b32 s67, s53, 11
  s_add_u32 s67, s67, s68
  v_add_u32 v90, s67, v95
  ds_write_b128 v90, v[20:23]
  ds_write_b128 v90, v[20:23] offset:1024
  s_mov_b32 s67, 0x32a57060
  s_mov_b32 s71, 0x3f317218
  s_lshl_b32 s61, s30, 2
  v_mov_b32 v92, s61
  s_xor_b32 s61, s61, 4
  v_mov_b32 v93, s61
  s_mul_i32 s69, s52, 9216
  s_add_u32 s69, s69, 19328
  s_xor_b32 s70, s53, 1
  s_mul_i32 s70, s70, 4608
  s_add_u32 s70, s70, s69
  s_sub_u32 m0, s70, 16384
  v_mul_u32_u24 v41, 288, v96
  v_lshl_add_u32 v41, v97, 4, v41
  v_add_u32 v41, s70, v41
  v_add_u32 v99, s69, v95
  s_lshl_b32 s60, s52, 8
  s_add_u32 s60, s60, 77824
  v_lshl_add_u32 v17, v1, 2, s60
  s_lshl_b32 s61, s53, 7
  s_add_u32 s60, s60, s61
  v_lshl_add_u32 v16, v1, 1, s60
  v_mov_b32 v2, 0
  v_mov_b32 v3, 0
  v_mov_b32 v4, 0
  v_mov_b32 v5, 0
  v_mov_b32 v42, 0x3c00
  s_mov_b32 s37, m0
  s_mov_b32 s72, -1
  s_mov_b32 s73, 0
  s_cmp_eq_u32 s53, 0
  s_cbranch_scc0 K_HA
  v_lshlrev_b32 v124, 8, v97
  v_lshl_add_u32 v124, v96, 4, v124
  v_sub_u32 v124, 562, v124
  v_add_u32 v124, s68, v124
  v_lshrrev_b32 v125, 1, v97
  v_lshlrev_b32 v125, 8, v125
  v_lshl_add_u32 v125, v96, 4, v125
  v_and_b32 v30, 1, v97
  v_lshl_add_u32 v125, v30, 3, v125
  v_sub_u32 v125, 1080, v125
  v_add_u32 v125, s68, v125
  v_add_u32 v126, 2, v124
  v_add_u32 v127, 1986, v124
  v_lshlrev_b32 v12, 5, v96
  v_lshl_add_u32 v9, v97, 3, v12
  v_lshl_add_u32 v12, v97, 4, v12
  v_add_u32 v12, s66, v12
  v_add_u32 v9, s68, v9
  v_add_u32 v13, 72704, v95
  v_and_b32 v11, 1, v96
  v_xor_b32 v11, 1, v11
  v_mul_u32_u24 v11, 1986, v11
  v_lshlrev_b32 v10, 1, v96
  v_sub_u32 v11, v11, v10
  s_add_u32 s78, s68, 30
  v_add_u32 v11, s78, v11
  v_lshl_add_u32 v10, v97, 4, v11
  v_lshl_add_u32 v14, v97, 3, v11
  v_add_u32 v14, 1120, v14
  v_add_u32 v11, 512, v10
  s_lshl_b32 s79, s52, 2
  v_mov_b32 v15, s79
  v_mov_b32 v8, 0
  s_branch K_AD
K_HA:
  v_and_b32 v28, 1, v96
  v_lshrrev_b32 v29, 1, v96
  v_lshlrev_b32 v124, 8, v28
  v_lshlrev_b32 v30, 1, v29
  v_sub_u32 v124, v124, v30
  v_lshlrev_b32 v125, 5, v97
  v_sub_u32 v124, v124, v125
  v_add_u32 v124, 1390, v124
  v_add_u32 v124, s68, v124
  v_lshlrev_b32 v125, 1, v28
  v_sub_u32 v125, v124, v125
  v_add_u32 v125, -126, v125
  v_mul_u32_u24 v126, 158, v28
  v_sub_u32 v126, v126, v30
  v_lshlrev_b32 v31, 6, v97
  v_sub_u32 v126, v126, v31
  v_add_u32 v126, 1712, v126
  v_add_u32 v126, s68, v126
  v_lshrrev_b32 v28, 2, v96
  v_lshl_add_u32 v11, v97, 3, v28
  v_lshlrev_b32 v11, 8, v11
  v_and_b32 v29, 1, v97
  v_lshl_or_b32 v28, v29, 2, v28
  v_lshl_or_b32 v11, v28, 5, v11
  v_and_b32 v28, 3, v1
  s_lshl_b32 s78, s52, 6
  v_xor_b32 v11, s78, v11
  v_lshlrev_b32 v9, 4, v28
  v_xor_b32 v9, v9, v11
  v_add_u32 v9, 19328, v9
  v_lshl_add_u32 v11, v28, 3, v11
  v_xor_b32 v12, 32, v11
  v_add_u32 v11, 83968, v11
  v_add_u32 v12, 83968, v12
  v_lshlrev_b32 v8, 6, v28
  v_and_b32 v29, 12, v1
  v_lshl_add_u32 v8, v29, 2, v8
  v_mul_u32_u24 v10, 320, v28
  v_lshl_add_u32 v10, v97, 4, v10
  v_add_u32 v10, 149504, v10
  v_lshrrev_b32 v28, 5, v1
  v_and_b32 v29, 31, v1
  v_lshlrev_b32 v14, 4, v29
  v_lshl_add_u32 v14, v28, 11, v14
  v_mul_u32_u24 v13, 320, v28
  v_lshl_add_u32 v13, v29, 1, v13
  s_add_u32 s78, s78, 150784
  v_add_u32 v13, s78, v13
  v_mov_b32 v15, 0
K_AD:
  s_waitcnt lgkmcnt(0)
  s_lshl_b32 s60, s47, 16
  s_and_b32 s61, s47, s31
  s_bitcmp1_b32 s56, 0
  s_cselect_b32 s60, s61, s60
  v_mov_b32 v116, s60
  v_mul_f32 v118, s58, v116
  v_fma_f32 v119, v116, s58, -v118
  v_exp_f32 v117, v118
  v_fmac_f32 v119, s67, v116
  v_mul_f32 v119, s71, v119
  v_fmac_f32 v117, v117, v119
  v_cvt_pk_bf16_f32 v117, 0, v117
  v_mul_f32 v91, s58, v117
  v_mul_f32 v90, 0.15915494, v117
  s_branch K_PWB
K_PW:
  s_sleep 1
K_PWB:
  ds_read_b32 v18, v20 offset:12
  s_waitcnt lgkmcnt(0)
  v_cmp_eq_u32 vcc, 0, v18
  s_cbranch_vccnz K_PW
  ds_read_u16_d16_hi v2, v16
  ds_read_u16_d16_hi v3, v16 offset:1024
  ds_read_b32 v6, v17 offset:2048
  ds_read_b32 v7, v17 offset:3072
  ds_read_u16_d16_hi v4, v16 offset:2048
  ds_read_u16_d16_hi v5, v16 offset:3072
  s_waitcnt lgkmcnt(5)
  v_mul_f32 v2, 0x3fb8aa3b, v2
  s_waitcnt lgkmcnt(4)
  v_mul_f32 v118, v3, v90
  v_exp_f32 v116, v2
  v_mul_f32 v119, 0x43000000, v118
  v_fract_f32 v118, v118
  v_fract_f32 v119, v119
  s_waitcnt lgkmcnt(2)
  v_and_b32 v6, 0x7fff7fff, v6
  v_and_b32 v7, 0x7fff7fff, v7
  v_cvt_pk_bf16_f32 v116, v116, v116
  v_pk_max_u16 v6, v6, v7
  v_and_b32 v116, 0xffff0000, v116
  v_pk_max_u16 v6, v6, v6 op_sel:[0,1] op_sel_hi:[1,0]
  v_mul_f32 v116, v116, v91
  v_sin_f32 v26, v119
  v_mul_f32 v120, 0x43000000, v116
  v_max_u32_dpp v6, v6, v6 quad_perm:[1,0,3,2] row_mask:0xf bank_mask:0xf
  v_exp_f32 v116, -v116
  v_cos_f32 v27, v119
  v_max_u32_dpp v6, v6, v6 quad_perm:[2,3,0,1] row_mask:0xf bank_mask:0xf
  v_cos_f32 v119, v118
  v_sin_f32 v118, v118
  v_max_u32_dpp v6, v6, v6 row_half_mirror row_mask:0xf bank_mask:0xf
  v_exp_f32 v120, -v120
  v_mul_f32 v119, v119, v116
  v_max_u32_dpp v6, v6, v6 row_mirror row_mask:0xf bank_mask:0xf
  v_mul_f32 v118, v118, v116
  v_mul_f32 v26, v26, v120
  v_max_u32_dpp v6, v6, v6 row_bcast:15 row_mask:0xa bank_mask:0xf
  v_mul_f32 v27, v27, v120
  v_add_f32 v117, v117, v117
  v_max_u32_dpp v6, v6, v6 row_bcast:31 row_mask:0xc bank_mask:0xf
  v_pk_mul_f32 v[24:25], v[118:119], v[118:119] op_sel:[1,0] op_sel_hi:[1,1]
  v_mul_f32 v6, v6, v117
  v_pk_fma_f32 v[24:25], v[118:119], v[118:119], v[24:25] op_sel:[1,0,0] op_sel_hi:[0,0,1] neg_hi:[1,0,0]
  v_readlane_b32 s78, v6, 63
  s_nop 0
  s_lshr_b32 s78, s78, 23
  s_max_u32 s78, s78, 33
  s_min_u32 s78, s78, 233
  s_sub_u32 s70, s78, 6
  s_sub_u32 s78, 260, s78
  s_lshl_b32 s70, s70, 23
  s_lshl_b32 s78, s78, 23
  v_mul_f32 v117, s78, v117
  s_waitcnt lgkmcnt(0)
  v_mul_f32 v33, v4, v117
  v_mul_f32 v32, v5, v117
  v_pk_mul_f32 v[120:121], v[24:25], v[24:25] op_sel:[1,0] op_sel_hi:[1,1]
  s_add_u32 m0, s36, 32768
  s_nop 0
  buffer_load_dwordx4 v88, s[8:11], s16 offen nt lds
  s_mov_b32 m0, s37
  v_cvt_pk_f16_f32 v100, v33, -v32
  v_cvt_pk_f16_f32 v101, v119, -v118
  v_pk_fma_f32 v[120:121], v[24:25], v[24:25], v[120:121] op_sel:[1,0,0] op_sel_hi:[0,0,1] neg_hi:[1,0,0]
  v_cvt_pk_f16_f32 v102, v25, -v24
  v_pk_mul_f16 v103, v100, v101 op_sel:[0,0] op_sel_hi:[0,1]
  v_pk_mul_f32 v[122:123], v[120:121], v[120:121] op_sel:[1,0] op_sel_hi:[1,1]
  v_pk_mul_f16 v104, v100, v102 op_sel:[0,0] op_sel_hi:[0,1]
  v_pk_fma_f16 v103, v100, v101, v103 op_sel:[1,1,0] op_sel_hi:[1,0,1] neg_lo:[1,0,0]
  v_pk_fma_f32 v[122:123], v[120:121], v[120:121], v[122:123] op_sel:[1,0,0] op_sel_hi:[0,0,1] neg_hi:[1,0,0]
  v_pk_fma_f16 v104, v100, v102, v104 op_sel:[1,1,0] op_sel_hi:[1,0,1] neg_lo:[1,0,0]
  v_pk_mul_f32 v[16:17], v[24:25], v[118:119] op_sel:[1,0] op_sel_hi:[1,1]
  v_pk_mul_f32 v[18:19], v[122:123], v[122:123] op_sel:[1,0] op_sel_hi:[1,1]
  v_cvt_pk_f16_f32 v105, v121, -v120
  v_pk_fma_f32 v[16:17], v[118:119], v[24:25], v[16:17] op_sel:[1,0,0] op_sel_hi:[0,0,1] neg_hi:[1,0,0]
  v_pk_fma_f32 v[18:19], v[122:123], v[122:123], v[18:19] op_sel:[1,0,0] op_sel_hi:[0,0,1] neg_hi:[1,0,0]
  v_pk_mul_f16 v106, v100, v105 op_sel:[0,0] op_sel_hi:[0,1]
  v_cvt_pk_f16_f32 v107, v17, -v16
  v_pk_mul_f32 v[20:21], v[18:19], v[18:19] op_sel:[1,0] op_sel_hi:[1,1]
  v_pk_fma_f16 v106, v100, v105, v106 op_sel:[1,1,0] op_sel_hi:[1,0,1] neg_lo:[1,0,0]
  v_pk_mul_f16 v108, v100, v107 op_sel:[0,0] op_sel_hi:[0,1]
  v_pk_fma_f32 v[20:21], v[18:19], v[18:19], v[20:21] op_sel:[1,0,0] op_sel_hi:[0,0,1] neg_hi:[1,0,0]
  v_pk_mul_f16 v109, v105, v101 op_sel:[0,0] op_sel_hi:[0,1]
  v_pk_fma_f16 v108, v100, v107, v108 op_sel:[1,1,0] op_sel_hi:[1,0,1] neg_lo:[1,0,0]
  v_pk_mul_f32 v[22:23], v[20:21], v[20:21] op_sel:[1,0] op_sel_hi:[1,1]
  v_pk_fma_f16 v109, v105, v101, v109 op_sel:[1,1,0] op_sel_hi:[1,0,1] neg_lo:[1,0,0]
  v_pk_mul_f16 v110, v105, v102 op_sel:[0,0] op_sel_hi:[0,1]
  v_pk_fma_f32 v[22:23], v[20:21], v[20:21], v[22:23] op_sel:[1,0,0] op_sel_hi:[0,0,1] neg_hi:[1,0,0]
  v_pk_mul_f16 v111, v100, v109 op_sel:[0,0] op_sel_hi:[0,1]
  v_pk_fma_f16 v110, v105, v102, v110 op_sel:[1,1,0] op_sel_hi:[1,0,1] neg_lo:[1,0,0]
  v_pk_mul_f16 v112, v105, v107 op_sel:[0,0] op_sel_hi:[0,1]
  v_pk_fma_f16 v111, v100, v109, v111 op_sel:[1,1,0] op_sel_hi:[1,0,1] neg_lo:[1,0,0]
  v_pk_mul_f16 v113, v100, v110 op_sel:[0,0] op_sel_hi:[0,1]
  v_pk_fma_f16 v112, v105, v107, v112 op_sel:[1,1,0] op_sel_hi:[1,0,1] neg_lo:[1,0,0]
  v_pk_mul_f32 v[28:29], v[32:33], v[26:27] op_sel:[1,0] op_sel_hi:[1,1]
  v_pk_fma_f16 v113, v100, v110, v113 op_sel:[1,1,0] op_sel_hi:[1,0,1] neg_lo:[1,0,0]
  v_pk_mul_f16 v114, v100, v112 op_sel:[0,0] op_sel_hi:[0,1]
  v_pk_fma_f32 v[28:29], v[26:27], v[32:33], v[28:29] op_sel:[1,0,0] op_sel_hi:[0,0,1] neg_hi:[1,0,0]
  v_cvt_pk_f16_f32 v115, v123, v122
  v_pk_fma_f16 v114, v100, v112, v114 op_sel:[1,1,0] op_sel_hi:[1,0,1] neg_lo:[1,0,0]
  v_cvt_pk_f16_f32 v116, v29, -v28
  v_cvt_pk_f16_f32 v117, v19, v18
  ds_write_addtid_b32 v100 offset:16384
  ds_write_addtid_b32 v103 offset:16672
  ds_write_addtid_b32 v104 offset:16960
  ds_write_addtid_b32 v108 offset:17248
  ds_write_addtid_b32 v106 offset:17536
  ds_write_addtid_b32 v111 offset:17824
  ds_write_addtid_b32 v113 offset:18112
  ds_write_addtid_b32 v114 offset:18400
  s_add_u32 m0, s36, 8192
  s_nop 0
  buffer_load_dwordx4 v88, s[4:7], s17 offen nt lds
  s_mov_b32 m0, s37
  v_pk_mul_f16 v2, v116, v101 op_sel:[0,0] op_sel_hi:[0,1]
  v_pk_mul_f16 v3, v116, v102 op_sel:[0,0] op_sel_hi:[0,1]
  v_pk_mul_f16 v4, v116, v107 op_sel:[0,0] op_sel_hi:[0,1]
  v_pk_fma_f16 v2, v116, v101, v2 op_sel:[1,1,0] op_sel_hi:[1,0,1] neg_lo:[1,0,0]
  v_pk_fma_f16 v3, v116, v102, v3 op_sel:[1,1,0] op_sel_hi:[1,0,1] neg_lo:[1,0,0]
  v_pk_fma_f16 v4, v116, v107, v4 op_sel:[1,1,0] op_sel_hi:[1,0,1] neg_lo:[1,0,0]
  v_pk_mul_f16 v5, v116, v105 op_sel:[0,0] op_sel_hi:[0,1]
  v_pk_mul_f16 v6, v116, v109 op_sel:[0,0] op_sel_hi:[0,1]
  v_pk_mul_f16 v7, v116, v110 op_sel:[0,0] op_sel_hi:[0,1]
  v_pk_fma_f16 v5, v116, v105, v5 op_sel:[1,1,0] op_sel_hi:[1,0,1] neg_lo:[1,0,0]
  v_pk_fma_f16 v6, v116, v109, v6 op_sel:[1,1,0] op_sel_hi:[1,0,1] neg_lo:[1,0,0]
  v_pk_fma_f16 v7, v116, v110, v7 op_sel:[1,1,0] op_sel_hi:[1,0,1] neg_lo:[1,0,0]
  v_pk_mul_f16 v40, v116, v112 op_sel:[0,0] op_sel_hi:[0,1]
  v_cvt_pk_f16_f32 v43, v21, v20
  v_pk_mul_f32 v[30:31], v[18:19], v[122:123] op_sel:[1,0] op_sel_hi:[1,1]
  v_pk_fma_f16 v40, v116, v112, v40 op_sel:[1,1,0] op_sel_hi:[1,0,1] neg_lo:[1,0,0]
  v_cvt_pk_f16_f32 v90, v23, v22
  v_pk_fma_f32 v[30:31], v[122:123], v[18:19], v[30:31] op_sel:[1,0,0] op_sel_hi:[0,0,1] neg_hi:[1,0,0]
  ds_write_addtid_b32 v116 offset:18688
  ds_write_addtid_b32 v2 offset:18976
  ds_write_addtid_b32 v3 offset:19264
  ds_write_addtid_b32 v4 offset:19552
  ds_write_addtid_b32 v5 offset:19840
  ds_write_addtid_b32 v6 offset:20128
  ds_write_addtid_b32 v7 offset:20416
  ds_write_addtid_b32 v40 offset:20704
  ds_read_b128 v[60:63], v41 offset:0
  ds_read_b128 v[64:67], v41 offset:64
  ds_read_b128 v[68:71], v41 offset:128
  ds_read_b128 v[72:75], v41 offset:192
  ds_write_addtid_b32 v42 offset:16384
  v_cvt_pk_f16_f32 v91, v31, v30
  v_pk_mul_f16 v103, v43, v115 op_sel:[0,0] op_sel_hi:[0,1]
  v_pk_mul_f16 v104, v43, v117 op_sel:[0,0] op_sel_hi:[0,1]
  v_pk_mul_f16 v108, v43, v91 op_sel:[0,0] op_sel_hi:[0,1]
  v_pk_fma_f16 v103, v43, v115, v103 op_sel:[1,1,0] op_sel_hi:[1,0,1] neg_lo:[1,0,0]
  v_pk_fma_f16 v104, v43, v117, v104 op_sel:[1,1,0] op_sel_hi:[1,0,1] neg_lo:[1,0,0]
  v_pk_fma_f16 v108, v43, v91, v108 op_sel:[1,1,0] op_sel_hi:[1,0,1] neg_lo:[1,0,0]
  v_pk_mul_f32 v[34:35], v[22:23], v[20:21] op_sel:[1,0] op_sel_hi:[1,1]
  v_pk_mul_f16 v106, v90, v115 op_sel:[0,0] op_sel_hi:[0,1]
  ds_write_addtid_b32 v115 offset:16672
  ds_write_addtid_b32 v117 offset:16960
  ds_write_addtid_b32 v43 offset:17536
  ds_write_addtid_b32 v91 offset:17248
  ds_write_addtid_b32 v90 offset:18688
  ds_write_addtid_b32 v103 offset:17824
  ds_write_addtid_b32 v104 offset:18112
  ds_write_addtid_b32 v108 offset:18400
  v_pk_fma_f32 v[34:35], v[20:21], v[22:23], v[34:35] op_sel:[1,0,0] op_sel_hi:[0,0,1] neg_hi:[1,0,0]
  v_pk_fma_f16 v106, v90, v115, v106 op_sel:[1,1,0] op_sel_hi:[1,0,1] neg_lo:[1,0,0]
  s_add_u32 m0, s36, 40960
  s_nop 0
  buffer_load_dwordx4 v88, s[8:11], s17 offen nt lds
  s_mov_b32 m0, s37
  v_pk_mul_f16 v111, v90, v117 op_sel:[0,0] op_sel_hi:[0,1]
  v_cvt_pk_f16_f32 v113, v35, v34
  v_pk_mul_f16 v114, v90, v91 op_sel:[0,0] op_sel_hi:[0,1]
  v_pk_fma_f16 v111, v90, v117, v111 op_sel:[1,1,0] op_sel_hi:[1,0,1] neg_lo:[1,0,0]
  v_pk_mul_f16 v101, v113, v115 op_sel:[0,0] op_sel_hi:[0,1]
  v_pk_fma_f16 v114, v90, v91, v114 op_sel:[1,1,0] op_sel_hi:[1,0,1] neg_lo:[1,0,0]
  v_pk_mul_f16 v107, v113, v117 op_sel:[0,0] op_sel_hi:[0,1]
  v_pk_fma_f16 v101, v113, v115, v101 op_sel:[1,1,0] op_sel_hi:[1,0,1] neg_lo:[1,0,0]
  v_pk_mul_f16 v109, v113, v91 op_sel:[0,0] op_sel_hi:[0,1]
  v_pk_fma_f16 v107, v113, v117, v107 op_sel:[1,1,0] op_sel_hi:[1,0,1] neg_lo:[1,0,0]
  v_pk_mul_f32 v[36:37], v[26:27], v[26:27] op_sel:[1,0] op_sel_hi:[1,1]
  v_pk_fma_f16 v109, v113, v91, v109 op_sel:[1,1,0] op_sel_hi:[1,0,1] neg_lo:[1,0,0]
  v_cvt_pk_f16_f32 v112, v27, -v26
  v_pk_fma_f32 v[36:37], v[26:27], v[26:27], v[36:37] op_sel:[1,0,0] op_sel_hi:[0,0,1] neg_hi:[1,0,0]
  ds_write_addtid_b32 v113 offset:19840
  ds_write_addtid_b32 v106 offset:18976
  ds_write_addtid_b32 v111 offset:19264
  ds_write_addtid_b32 v114 offset:19552
  ds_write_addtid_b32 v101 offset:20128
  ds_write_addtid_b32 v107 offset:20416
  ds_write_addtid_b32 v109 offset:20704
  ds_read_b128 v[44:47], v41 offset:0
  ds_read_b128 v[48:51], v41 offset:64
  ds_read_b128 v[52:55], v41 offset:128
  ds_read_b128 v[56:59], v41 offset:192
  v_cvt_pk_f16_f32 v116, v37, -v36
  v_pk_mul_f32 v[38:39], v[36:37], v[26:27] op_sel:[1,0] op_sel_hi:[1,1]
  v_pk_mul_f32 v[120:121], v[36:37], v[36:37] op_sel:[1,0] op_sel_hi:[1,1]
  v_pk_mul_f16 v2, v100, v116 op_sel:[0,0] op_sel_hi:[0,1]
  v_pk_fma_f32 v[38:39], v[26:27], v[36:37], v[38:39] op_sel:[1,0,0] op_sel_hi:[0,0,1] neg_hi:[1,0,0]
  v_pk_fma_f32 v[120:121], v[36:37], v[36:37], v[120:121] op_sel:[1,0,0] op_sel_hi:[0,0,1] neg_hi:[1,0,0]
  v_pk_fma_f16 v2, v100, v116, v2 op_sel:[1,1,0] op_sel_hi:[1,0,1] neg_lo:[1,0,0]
  v_cvt_pk_f16_f32 v3, v39, -v38
  v_pk_mul_f32 v[24:25], v[32:33], v[120:121] op_sel:[1,0] op_sel_hi:[1,1]
  v_pk_mul_f16 v4, v2, v102 op_sel:[0,0] op_sel_hi:[0,1]
  v_pk_mul_f16 v5, v2, v105 op_sel:[0,0] op_sel_hi:[0,1]
  v_pk_mul_f16 v6, v2, v110 op_sel:[0,0] op_sel_hi:[0,1]
  v_pk_fma_f16 v4, v2, v102, v4 op_sel:[1,1,0] op_sel_hi:[1,0,1] neg_lo:[1,0,0]
  v_pk_fma_f16 v5, v2, v105, v5 op_sel:[1,1,0] op_sel_hi:[1,0,1] neg_lo:[1,0,0]
  v_pk_fma_f16 v6, v2, v110, v6 op_sel:[1,1,0] op_sel_hi:[1,0,1] neg_lo:[1,0,0]
  v_pk_mul_f16 v7, v100, v3 op_sel:[0,0] op_sel_hi:[0,1]
  v_pk_fma_f32 v[24:25], v[120:121], v[32:33], v[24:25] op_sel:[1,0,0] op_sel_hi:[0,0,1] neg_hi:[1,0,0]
  v_pk_fma_f16 v7, v100, v3, v7 op_sel:[1,1,0] op_sel_hi:[1,0,1] neg_lo:[1,0,0]
  v_cvt_pk_f16_f32 v40, v25, -v24
  v_pk_mul_f32 v[118:119], v[24:25], v[120:121] op_sel:[1,0] op_sel_hi:[1,1]
  v_pk_mul_f16 v43, v7, v102 op_sel:[0,0] op_sel_hi:[0,1]
  v_pk_mul_f16 v103, v7, v105 op_sel:[0,0] op_sel_hi:[0,1]
  v_pk_mul_f16 v104, v7, v110 op_sel:[0,0] op_sel_hi:[0,1]
  s_waitcnt lgkmcnt(0)
  s_add_u32 m0, s36, 16384
  s_nop 0
  buffer_load_dwordx4 v88, s[4:7], s18 offen nt lds
  s_mov_b32 m0, s37
  v_mfma_f32_16x16x32_f16 v[76:79], v[60:63], v[44:47], 0
  v_mfma_f32_16x16x32_f16 v[76:79], v[64:67], v[48:51], v[76:79]
  v_mfma_f32_16x16x32_f16 v[76:79], v[68:71], v[52:55], v[76:79]
  v_mfma_f32_16x16x32_f16 v[76:79], v[72:75], v[56:59], v[76:79]
  v_pk_fma_f16 v43, v7, v102, v43 op_sel:[1,1,0] op_sel_hi:[1,0,1] neg_lo:[1,0,0]
  v_pk_fma_f16 v103, v7, v105, v103 op_sel:[1,1,0] op_sel_hi:[1,0,1] neg_lo:[1,0,0]
  v_pk_fma_f16 v104, v7, v110, v104 op_sel:[1,1,0] op_sel_hi:[1,0,1] neg_lo:[1,0,0]
  v_pk_mul_f16 v108, v40, v105 op_sel:[0,0] op_sel_hi:[0,1]
  ds_write_addtid_b32 v2 offset:16384
  ds_write_addtid_b32 v4 offset:16672
  ds_write_addtid_b32 v5 offset:16960
  ds_write_addtid_b32 v6 offset:17248
  ds_write_addtid_b32 v7 offset:17536
  ds_write_addtid_b32 v43 offset:17824
  ds_write_addtid_b32 v103 offset:18112
  ds_write_addtid_b32 v40 offset:18688
  v_pk_fma_f16 v108, v40, v105, v108 op_sel:[1,1,0] op_sel_hi:[1,0,1] neg_lo:[1,0,0]
  v_pk_mul_f16 v90, v40, v112 op_sel:[0,0] op_sel_hi:[0,1]
  v_pk_mul_f16 v115, v40, v116 op_sel:[0,0] op_sel_hi:[0,1]
  v_pk_mul_f16 v117, v40, v3 op_sel:[0,0] op_sel_hi:[0,1]
  v_pk_fma_f16 v90, v40, v112, v90 op_sel:[1,1,0] op_sel_hi:[1,0,1] neg_lo:[1,0,0]
  v_pk_fma_f16 v115, v40, v116, v115 op_sel:[1,1,0] op_sel_hi:[1,0,1] neg_lo:[1,0,0]
  v_pk_fma_f16 v117, v40, v3, v117 op_sel:[1,1,0] op_sel_hi:[1,0,1] neg_lo:[1,0,0]
  v_pk_mul_f16 v91, v90, v105 op_sel:[0,0] op_sel_hi:[0,1]
  v_pk_mul_f16 v113, v115, v105 op_sel:[0,0] op_sel_hi:[0,1]
  v_pk_mul_f16 v106, v117, v105 op_sel:[0,0] op_sel_hi:[0,1]
  v_pk_fma_f16 v91, v90, v105, v91 op_sel:[1,1,0] op_sel_hi:[1,0,1] neg_lo:[1,0,0]
  v_pk_fma_f16 v113, v115, v105, v113 op_sel:[1,1,0] op_sel_hi:[1,0,1] neg_lo:[1,0,0]
  v_pk_fma_f16 v106, v117, v105, v106 op_sel:[1,1,0] op_sel_hi:[1,0,1] neg_lo:[1,0,0]
  v_pk_fma_f32 v[118:119], v[120:121], v[24:25], v[118:119] op_sel:[1,0,0] op_sel_hi:[0,0,1] neg_hi:[1,0,0]
  ds_write_addtid_b32 v104 offset:18400
  ds_write_addtid_b32 v108 offset:18976
  ds_write_addtid_b32 v90 offset:19264
  ds_write_addtid_b32 v91 offset:19552
  ds_write_addtid_b32 v115 offset:19840
  ds_write_addtid_b32 v113 offset:20128
  ds_write_addtid_b32 v117 offset:20416
  ds_write_addtid_b32 v106 offset:20704
  ds_read_b128 v[60:63], v41 offset:0
  ds_read_b128 v[64:67], v41 offset:64
  ds_read_b128 v[68:71], v41 offset:128
  ds_read_b128 v[72:75], v41 offset:192
  v_cvt_pk_f16_f32 v111, v119, -v118
  v_pk_mul_f32 v[16:17], v[118:119], v[120:121] op_sel:[1,0] op_sel_hi:[1,1]
  v_pk_mul_f16 v114, v111, v112 op_sel:[0,0] op_sel_hi:[0,1]
  v_pk_mul_f16 v101, v111, v116 op_sel:[0,0] op_sel_hi:[0,1]
  v_pk_mul_f16 v107, v111, v3 op_sel:[0,0] op_sel_hi:[0,1]
  v_pk_fma_f16 v114, v111, v112, v114 op_sel:[1,1,0] op_sel_hi:[1,0,1] neg_lo:[1,0,0]
  v_pk_fma_f16 v101, v111, v116, v101 op_sel:[1,1,0] op_sel_hi:[1,0,1] neg_lo:[1,0,0]
  v_pk_fma_f16 v107, v111, v3, v107 op_sel:[1,1,0] op_sel_hi:[1,0,1] neg_lo:[1,0,0]
  v_pk_fma_f32 v[16:17], v[120:121], v[118:119], v[16:17] op_sel:[1,0,0] op_sel_hi:[0,0,1] neg_hi:[1,0,0]
  v_cvt_pk_f16_f32 v109, v17, -v16
  v_pk_mul_f32 v[28:29], v[16:17], v[120:121] op_sel:[1,0] op_sel_hi:[1,1]
  v_pk_mul_f16 v100, v109, v112 op_sel:[0,0] op_sel_hi:[0,1]
  v_pk_mul_f16 v102, v109, v116 op_sel:[0,0] op_sel_hi:[0,1]
  v_pk_mul_f16 v110, v109, v3 op_sel:[0,0] op_sel_hi:[0,1]
  v_pk_fma_f16 v100, v109, v112, v100 op_sel:[1,1,0] op_sel_hi:[1,0,1] neg_lo:[1,0,0]
  v_pk_fma_f16 v102, v109, v116, v102 op_sel:[1,1,0] op_sel_hi:[1,0,1] neg_lo:[1,0,0]
  v_pk_fma_f16 v110, v109, v3, v110 op_sel:[1,1,0] op_sel_hi:[1,0,1] neg_lo:[1,0,0]
  v_pk_fma_f32 v[28:29], v[120:121], v[16:17], v[28:29] op_sel:[1,0,0] op_sel_hi:[0,0,1] neg_hi:[1,0,0]
  ds_write_addtid_b32 v111 offset:16384
  ds_write_addtid_b32 v114 offset:16672
  ds_write_addtid_b32 v101 offset:16960
  ds_write_addtid_b32 v107 offset:17248
  ds_write_addtid_b32 v109 offset:17536
  ds_write_addtid_b32 v100 offset:17824
  ds_write_addtid_b32 v102 offset:18112
  ds_write_addtid_b32 v110 offset:18400
  s_waitcnt lgkmcnt(8)
  v_mfma_f32_16x16x32_f16 v[80:83], v[60:63], v[44:47], 0
  v_mfma_f32_16x16x32_f16 v[80:83], v[64:67], v[48:51], v[80:83]
  v_mfma_f32_16x16x32_f16 v[80:83], v[68:71], v[52:55], v[80:83]
  v_mfma_f32_16x16x32_f16 v[80:83], v[72:75], v[56:59], v[80:83]
  v_cvt_pk_f16_f32 v2, v29, -v28
  ds_write_addtid_b32 v2 offset:18688
  ds_read_b128 v[60:63], v41 offset:0
  ds_read_b128 v[64:67], v41 offset:64
  ds_read_b128 v[68:71], v41 offset:128
  ds_read_b128 v[72:75], v41 offset:192
  s_waitcnt lgkmcnt(0)
  v_mfma_f32_16x16x32_f16 v[84:87], v[60:63], v[44:47], 0
  v_mfma_f32_16x16x32_f16 v[84:87], v[64:67], v[48:51], v[84:87]
  v_mfma_f32_16x16x32_f16 v[84:87], v[68:71], v[52:55], v[84:87]
  v_mfma_f32_16x16x32_f16 v[84:87], v[72:75], v[56:59], v[84:87]
  s_cmp_eq_u32 s53, 0
  s_cbranch_scc0 K_FAR
  ds_write_b128 v99, v[80:83] offset:5120
  s_nop 4
  ds_write_b128 v99, v[84:87] offset:6144
  v_mov_b32 v94, 1
  ds_write_b32 v92, v94 offset:64
  s_branch K_PS1B
K_PS1:
K_PS1B:
  ds_read_b32 v94, v93 offset:64
  s_waitcnt lgkmcnt(0)
  v_cmp_gt_u32 vcc, 1, v94
  s_cbranch_vccnz K_PS1
  ds_read_b128 v[16:19], v99 offset:1024
  ds_read_b128 v[24:27], v99
  s_waitcnt lgkmcnt(1)
  v_pk_add_f32 v[80:81], v[80:81], v[16:17]
  v_pk_add_f32 v[82:83], v[82:83], v[18:19]
  s_waitcnt lgkmcnt(0)
  v_pk_add_f32 v[76:77], v[76:77], v[24:25]
  v_pk_add_f32 v[78:79], v[78:79], v[26:27]
  v_mov_b32_dpp v28, v80 row_shl:1 row_mask:0xf bank_mask:0xf
  v_writelane_b32 v28, 0, 33
  s_mov_b32 exec_hi, 3
  v_cndmask_b32 v29, v80, v81, s[72:73]
  v_cndmask_b32 v30, v81, v82, s[72:73]
  v_cndmask_b32 v28, v28, v83, s[72:73]
  v_cvt_pk_f16_f32 v16, v28, v30
  v_cvt_pk_f16_f32 v17, v30, v30
  v_cvt_pk_f16_f32 v18, v29, v80
  v_cvt_pk_f16_f32 v19, v80, v80
  v_cvt_pk_f16_f32 v20, v30, v29
  ds_write_b16 v124, v16
  ds_write2_b32 v126, v17, v20 offset0:0 offset1:1
  ds_write_b32 v126, v19 offset:8
  ds_write_b16 v124, v19 offset:14
  ds_write2_b32 v127, v16, v17 offset0:0 offset1:1
  ds_write2_b32 v127, v18, v19 offset0:2 offset1:3
  s_mov_b32 exec_hi, -1
  v_cvt_pk_f16_f32 v24, v79, v78
  v_cvt_pk_f16_f32 v25, v77, v76
  v_cvt_pk_f16_f32 v26, v78, v77
  ds_write_b64 v125, v[24:25]
  ds_write_b16 v125, v24 offset:1986
  ds_write_b32 v125, v26 offset:1988
  ds_write_b16_d16_hi v125, v25 offset:1992
  v_mov_b32 v8, s70
  ds_read2_b32 v[96:97], v11 offset0:128 offset1:129
  ds_read2_b32 v[98:99], v11 offset0:130 offset1:131
  ds_read2_b32 v[100:101], v10 offset0:128 offset1:129
  ds_read2_b32 v[102:103], v10 offset0:130 offset1:131
  ds_read2_b32 v[92:93], v10 offset0:0 offset1:1
  ds_read2_b32 v[94:95], v10 offset0:2 offset1:3
  ds_read2_b32 v[104:105], v11 offset0:112 offset1:113
  ds_read2_b32 v[106:107], v11 offset0:114 offset1:115
  ds_read2_b32 v[108:109], v10 offset0:112 offset1:113
  ds_read2_b32 v[110:111], v10 offset0:114 offset1:115
  s_branch K_FWB
K_FW:
  s_sleep 1
K_FWB:
  ds_read_b32 v6, v15 offset:640
  s_waitcnt lgkmcnt(0)
  v_cmp_eq_u32 vcc, 0, v6
  s_cbranch_vccnz K_FW
  v_readfirstlane_b32 s71, v6
  ds_read2_b32 v[48:49], v14 offset0:16 offset1:17
  ds_read2_b32 v[50:51], v14 offset0:112 offset1:113
  ds_read2_b32 v[52:53], v14 offset0:8 offset1:9
  ds_read2_b32 v[54:55], v14 offset0:104 offset1:105
  ds_read2_b32 v[56:57], v14 offset0:0 offset1:1
  ds_read2_b32 v[58:59], v14 offset0:96 offset1:97
  ds_read2_b32 v[60:61], v14 offset0:48 offset1:49
  ds_read2_b32 v[62:63], v14 offset0:80 offset1:81
  ds_read2_b32 v[64:65], v14 offset0:40 offset1:41
  ds_read2_b32 v[66:67], v14 offset0:72 offset1:73
  ds_read2_b32 v[68:69], v14 offset0:32 offset1:33
  s_waitcnt lgkmcnt(4)
  ds_read2_b32 v[70:71], v14 offset0:64 offset1:65
  ds_read2_b32 v[72:73], v14 offset0:152 offset1:153
  ds_read2_b32 v[74:75], v14 offset0:192 offset1:193
  ds_read2_b32 v[76:77], v14 offset0:144 offset1:145
  ds_read2_b32 v[78:79], v14 offset0:184 offset1:185
  ds_read2_b32 v[80:81], v14 offset0:136 offset1:137
  ds_read2_b32 v[82:83], v14 offset0:176 offset1:177
  ds_read2_b32 v[84:85], v14 offset0:128 offset1:129
  ds_read2_b32 v[86:87], v14 offset0:168 offset1:169
  s_setprio 1
  v_mov_b32 v6, 0
  v_mov_b32 v7, 1
  s_waitcnt vmcnt(0)
  s_mov_b64 exec, 1
  ds_add_u32 v6, v7 offset:112
  s_mov_b64 exec, -1
  s_branch K_W1NB
K_W1N:
  s_sleep 1
K_W1NB:
  ds_read_b32 v7, v6 offset:16
  s_waitcnt lgkmcnt(0)
  v_cmp_gt_u32 vcc, 8, v7
  s_cbranch_vccnz K_W1N
  ds_read_b128 v[112:115], v12 offset:512
  ds_read_b128 v[116:119], v12 offset:1024
  ds_read_b128 v[120:123], v12 offset:1536
  ds_read_b128 v[124:127], v12 offset:2048
  ds_read_b128 v[2:5], v12 offset:2560
  s_waitcnt lgkmcnt(4)
  v_mfma_f32_16x16x32_f16 v[16:19], v[96:99], v[112:115], 0
  v_mfma_f32_16x16x32_f16 v[20:23], v[100:103], v[112:115], 0
  v_mfma_f32_16x16x32_f16 v[24:27], v[92:95], v[112:115], 0
  ds_read_b128 v[112:115], v12 offset:3072
  s_waitcnt lgkmcnt(4)
  v_mfma_f32_16x16x32_f16 v[20:23], v[96:99], v[116:119], v[20:23]
  v_mfma_f32_16x16x32_f16 v[24:27], v[100:103], v[116:119], v[24:27]
  v_mfma_f32_16x16x32_f16 v[28:31], v[92:95], v[116:119], 0
  ds_read_b128 v[116:119], v12 offset:3584
  s_waitcnt lgkmcnt(2)
  v_mfma_f32_16x16x32_f16 v[24:27], v[96:99], v[120:123], v[24:27]
  v_mfma_f32_16x16x32_f16 v[28:31], v[100:103], v[120:123], v[28:31]
  v_mfma_f32_16x16x32_f16 v[32:35], v[92:95], v[120:123], 0
  ds_read_b128 v[120:123], v12 offset:4096
  v_mfma_f32_16x16x32_f16 v[28:31], v[96:99], v[124:127], v[28:31]
  v_mfma_f32_16x16x32_f16 v[32:35], v[100:103], v[124:127], v[32:35]
  v_mfma_f32_16x16x32_f16 v[36:39], v[92:95], v[124:127], 0
  ds_read_b128 v[124:127], v12 offset:448
  v_mfma_f32_16x16x32_f16 v[32:35], v[96:99], v[2:5], v[32:35]
  v_mfma_f32_16x16x32_f16 v[36:39], v[100:103], v[2:5], v[36:39]
  v_mfma_f32_16x16x32_f16 v[40:43], v[92:95], v[2:5], 0
  ds_read_b128 v[2:5], v12 offset:960
  s_waitcnt lgkmcnt(2)
  v_mfma_f32_16x16x32_f16 v[36:39], v[96:99], v[112:115], v[36:39]
  v_mfma_f32_16x16x32_f16 v[40:43], v[100:103], v[112:115], v[40:43]
  v_mfma_f32_16x16x32_f16 v[44:47], v[92:95], v[112:115], 0
  ds_read_b128 v[112:115], v12 offset:1472
  v_mfma_f32_16x16x32_f16 v[40:43], v[96:99], v[116:119], v[40:43]
  v_mfma_f32_16x16x32_f16 v[44:47], v[100:103], v[116:119], v[44:47]
  ds_read_b128 v[116:119], v12 offset:1984
  v_mfma_f32_16x16x32_f16 v[44:47], v[96:99], v[120:123], v[44:47]
  ds_read_b128 v[120:123], v12 offset:2496
  s_waitcnt lgkmcnt(3)
  v_mfma_f32_16x16x32_f16 v[16:19], v[104:107], v[124:127], v[16:19]
  ds_read2_b32 v[96:97], v11 offset0:96 offset1:97
  ds_read2_b32 v[98:99], v11 offset0:98 offset1:99
  v_mfma_f32_16x16x32_f16 v[20:23], v[108:111], v[124:127], v[20:23]
  ds_read_b128 v[124:127], v12 offset:3008
  ds_read2_b32 v[100:101], v10 offset0:96 offset1:97
  v_mfma_f32_16x16x32_f16 v[20:23], v[104:107], v[2:5], v[20:23]
  ds_read2_b32 v[102:103], v10 offset0:98 offset1:99
  ds_read_b128 v[88:91], v13 offset:0
  v_mfma_f32_16x16x32_f16 v[24:27], v[108:111], v[2:5], v[24:27]
  ds_read_b128 v[2:5], v12 offset:3520
  s_waitcnt lgkmcnt(8)
  v_mfma_f32_16x16x32_f16 v[24:27], v[104:107], v[112:115], v[24:27]
  ds_read_b128 v[92:95], v13 offset:1024
  v_mfma_f32_16x16x32_f16 v[28:31], v[108:111], v[112:115], v[28:31]
  ds_read_b128 v[112:115], v12 offset:4032
  v_mfma_f32_16x16x32_f16 v[28:31], v[104:107], v[116:119], v[28:31]
  v_mfma_f32_16x16x32_f16 v[32:35], v[108:111], v[116:119], v[32:35]
  ds_read_b128 v[116:119], v12 offset:384
  s_waitcnt lgkmcnt(4)
  v_mfma_f32_16x16x32_f16 v[32:35], v[104:107], v[120:123], v[32:35]
  v_mfma_f32_16x16x32_f16 v[36:39], v[108:111], v[120:123], v[36:39]
  ds_read_b128 v[120:123], v12 offset:896
  v_mfma_f32_16x16x32_f16 v[36:39], v[104:107], v[124:127], v[36:39]
  v_mfma_f32_16x16x32_f16 v[40:43], v[108:111], v[124:127], v[40:43]
  ds_read_b128 v[124:127], v12 offset:1408
  s_waitcnt lgkmcnt(3)
  v_mfma_f32_16x16x32_f16 v[40:43], v[104:107], v[2:5], v[40:43]
  v_mfma_f32_16x16x32_f16 v[44:47], v[108:111], v[2:5], v[44:47]
  ds_read_b128 v[2:5], v12 offset:1920
  v_mfma_f32_16x16x32_f16 v[44:47], v[104:107], v[112:115], v[44:47]
  ds_read_b128 v[112:115], v12 offset:2432
  s_waitcnt lgkmcnt(3)
  v_mfma_f32_16x16x32_f16 v[16:19], v[96:99], v[116:119], v[16:19]
  ds_read2_b32 v[104:105], v11 offset0:80 offset1:81
  ds_read2_b32 v[106:107], v11 offset0:82 offset1:83
  v_mfma_f32_16x16x32_f16 v[20:23], v[100:103], v[116:119], v[20:23]
  ds_read_b128 v[116:119], v12 offset:2944
  ds_read2_b32 v[108:109], v10 offset0:80 offset1:81
  v_mfma_f32_16x16x32_f16 v[20:23], v[96:99], v[120:123], v[20:23]
  ds_read2_b32 v[110:111], v10 offset0:82 offset1:83
  v_mfma_f32_16x16x32_f16 v[24:27], v[100:103], v[120:123], v[24:27]
  ds_read_b128 v[120:123], v12 offset:3456
  s_waitcnt lgkmcnt(7)
  v_mfma_f32_16x16x32_f16 v[24:27], v[96:99], v[124:127], v[24:27]
  v_mfma_f32_16x16x32_f16 v[28:31], v[100:103], v[124:127], v[28:31]
  ds_read_b128 v[124:127], v12 offset:3968
  v_mfma_f32_16x16x32_f16 v[28:31], v[96:99], v[2:5], v[28:31]
  v_mfma_f32_16x16x32_f16 v[32:35], v[100:103], v[2:5], v[32:35]
  ds_read_b128 v[2:5], v12 offset:320
  s_waitcnt lgkmcnt(3)
  v_mfma_f32_16x16x32_f16 v[32:35], v[96:99], v[112:115], v[32:35]
  v_mfma_f32_16x16x32_f16 v[36:39], v[100:103], v[112:115], v[36:39]
  ds_read_b128 v[112:115], v12 offset:832
  v_mfma_f32_16x16x32_f16 v[36:39], v[96:99], v[116:119], v[36:39]
  v_mfma_f32_16x16x32_f16 v[40:43], v[100:103], v[116:119], v[40:43]
  ds_read_b128 v[116:119], v12 offset:1344
  s_waitcnt lgkmcnt(3)
  v_mfma_f32_16x16x32_f16 v[40:43], v[96:99], v[120:123], v[40:43]
  v_mfma_f32_16x16x32_f16 v[44:47], v[100:103], v[120:123], v[44:47]
  ds_read_b128 v[120:123], v12 offset:1856
  v_mfma_f32_16x16x32_f16 v[44:47], v[96:99], v[124:127], v[44:47]
  ds_read_b128 v[124:127], v12 offset:2368
  s_waitcnt lgkmcnt(3)
  v_mfma_f32_16x16x32_f16 v[16:19], v[104:107], v[2:5], v[16:19]
  ds_read2_b32 v[96:97], v11 offset0:64 offset1:65
  ds_read2_b32 v[98:99], v11 offset0:66 offset1:67
  v_mfma_f32_16x16x32_f16 v[20:23], v[108:111], v[2:5], v[20:23]
  ds_read_b128 v[2:5], v12 offset:2880
  ds_read2_b32 v[100:101], v10 offset0:64 offset1:65
  v_mfma_f32_16x16x32_f16 v[20:23], v[104:107], v[112:115], v[20:23]
  ds_read2_b32 v[102:103], v10 offset0:66 offset1:67
  v_mfma_f32_16x16x32_f16 v[24:27], v[108:111], v[112:115], v[24:27]
  ds_read_b128 v[112:115], v12 offset:3392
  s_waitcnt lgkmcnt(7)
  v_mfma_f32_16x16x32_f16 v[24:27], v[104:107], v[116:119], v[24:27]
  v_mfma_f32_16x16x32_f16 v[28:31], v[108:111], v[116:119], v[28:31]
  ds_read_b128 v[116:119], v12 offset:3904
  v_mfma_f32_16x16x32_f16 v[28:31], v[104:107], v[120:123], v[28:31]
  v_mfma_f32_16x16x32_f16 v[32:35], v[108:111], v[120:123], v[32:35]
  ds_read_b128 v[120:123], v12 offset:256
  s_waitcnt lgkmcnt(3)
  v_mfma_f32_16x16x32_f16 v[32:35], v[104:107], v[124:127], v[32:35]
  v_mfma_f32_16x16x32_f16 v[36:39], v[108:111], v[124:127], v[36:39]
  ds_read_b128 v[124:127], v12 offset:768
  v_mfma_f32_16x16x32_f16 v[36:39], v[104:107], v[2:5], v[36:39]
  v_mfma_f32_16x16x32_f16 v[40:43], v[108:111], v[2:5], v[40:43]
  ds_read_b128 v[2:5], v12 offset:1280
  s_waitcnt lgkmcnt(3)
  v_mfma_f32_16x16x32_f16 v[40:43], v[104:107], v[112:115], v[40:43]
  v_mfma_f32_16x16x32_f16 v[44:47], v[108:111], v[112:115], v[44:47]
  ds_read_b128 v[112:115], v12 offset:1792
  v_mfma_f32_16x16x32_f16 v[44:47], v[104:107], v[116:119], v[44:47]
  ds_read_b128 v[116:119], v12 offset:2304
  s_waitcnt lgkmcnt(3)
  v_mfma_f32_16x16x32_f16 v[16:19], v[96:99], v[120:123], v[16:19]
  ds_read2_b32 v[104:105], v11 offset0:48 offset1:49
  ds_read2_b32 v[106:107], v11 offset0:50 offset1:51
  v_mfma_f32_16x16x32_f16 v[20:23], v[100:103], v[120:123], v[20:23]
  ds_read_b128 v[120:123], v12 offset:2816
  ds_read2_b32 v[108:109], v10 offset0:48 offset1:49
  v_mfma_f32_16x16x32_f16 v[20:23], v[96:99], v[124:127], v[20:23]
  ds_read2_b32 v[110:111], v10 offset0:50 offset1:51
  v_mfma_f32_16x16x32_f16 v[24:27], v[100:103], v[124:127], v[24:27]
  ds_read_b128 v[124:127], v12 offset:3328
  s_waitcnt lgkmcnt(7)
  v_mfma_f32_16x16x32_f16 v[24:27], v[96:99], v[2:5], v[24:27]
  v_mfma_f32_16x16x32_f16 v[28:31], v[100:103], v[2:5], v[28:31]
  ds_read_b128 v[2:5], v12 offset:3840
  v_mfma_f32_16x16x32_f16 v[28:31], v[96:99], v[112:115], v[28:31]
  v_mfma_f32_16x16x32_f16 v[32:35], v[100:103], v[112:115], v[32:35]
  ds_read_b128 v[112:115], v12 offset:192
  s_waitcnt lgkmcnt(3)
  v_mfma_f32_16x16x32_f16 v[32:35], v[96:99], v[116:119], v[32:35]
  v_mfma_f32_16x16x32_f16 v[36:39], v[100:103], v[116:119], v[36:39]
  ds_read_b128 v[116:119], v12 offset:704
  v_mfma_f32_16x16x32_f16 v[36:39], v[96:99], v[120:123], v[36:39]
  v_mfma_f32_16x16x32_f16 v[40:43], v[100:103], v[120:123], v[40:43]
  ds_read_b128 v[120:123], v12 offset:1216
  s_waitcnt lgkmcnt(3)
  v_mfma_f32_16x16x32_f16 v[40:43], v[96:99], v[124:127], v[40:43]
  v_mfma_f32_16x16x32_f16 v[44:47], v[100:103], v[124:127], v[44:47]
  ds_read_b128 v[124:127], v12 offset:1728
  v_mfma_f32_16x16x32_f16 v[44:47], v[96:99], v[2:5], v[44:47]
  ds_read_b128 v[2:5], v12 offset:2240
  s_waitcnt lgkmcnt(3)
  v_mfma_f32_16x16x32_f16 v[16:19], v[104:107], v[112:115], v[16:19]
  ds_read2_b32 v[96:97], v11 offset0:32 offset1:33
  ds_read2_b32 v[98:99], v11 offset0:34 offset1:35
  v_mfma_f32_16x16x32_f16 v[20:23], v[108:111], v[112:115], v[20:23]
  ds_read_b128 v[112:115], v12 offset:2752
  ds_read2_b32 v[100:101], v10 offset0:32 offset1:33
  v_mfma_f32_16x16x32_f16 v[20:23], v[104:107], v[116:119], v[20:23]
  ds_read2_b32 v[102:103], v10 offset0:34 offset1:35
  v_mfma_f32_16x16x32_f16 v[24:27], v[108:111], v[116:119], v[24:27]
  ds_read_b128 v[116:119], v12 offset:3264
  s_waitcnt lgkmcnt(7)
  v_mfma_f32_16x16x32_f16 v[24:27], v[104:107], v[120:123], v[24:27]
  v_mfma_f32_16x16x32_f16 v[28:31], v[108:111], v[120:123], v[28:31]
  ds_read_b128 v[120:123], v12 offset:3776
  v_mfma_f32_16x16x32_f16 v[28:31], v[104:107], v[124:127], v[28:31]
  v_mfma_f32_16x16x32_f16 v[32:35], v[108:111], v[124:127], v[32:35]
  ds_read_b128 v[124:127], v12 offset:128
  s_waitcnt lgkmcnt(3)
  v_mfma_f32_16x16x32_f16 v[32:35], v[104:107], v[2:5], v[32:35]
  v_mfma_f32_16x16x32_f16 v[36:39], v[108:111], v[2:5], v[36:39]
  ds_read_b128 v[2:5], v12 offset:640
  v_mfma_f32_16x16x32_f16 v[36:39], v[104:107], v[112:115], v[36:39]
  v_mfma_f32_16x16x32_f16 v[40:43], v[108:111], v[112:115], v[40:43]
  ds_read_b128 v[112:115], v12 offset:1152
  s_waitcnt lgkmcnt(3)
  v_mfma_f32_16x16x32_f16 v[40:43], v[104:107], v[116:119], v[40:43]
  v_mfma_f32_16x16x32_f16 v[44:47], v[108:111], v[116:119], v[44:47]
  ds_read_b128 v[116:119], v12 offset:1664
  v_mfma_f32_16x16x32_f16 v[44:47], v[104:107], v[120:123], v[44:47]
  ds_read_b128 v[120:123], v12 offset:2176
  s_waitcnt lgkmcnt(3)
  v_mfma_f32_16x16x32_f16 v[16:19], v[96:99], v[124:127], v[16:19]
  ds_read2_b32 v[104:105], v11 offset0:16 offset1:17
  ds_read2_b32 v[106:107], v11 offset0:18 offset1:19
  v_mfma_f32_16x16x32_f16 v[20:23], v[100:103], v[124:127], v[20:23]
  ds_read_b128 v[124:127], v12 offset:2688
  ds_read2_b32 v[108:109], v10 offset0:16 offset1:17
  v_mfma_f32_16x16x32_f16 v[20:23], v[96:99], v[2:5], v[20:23]
  ds_read2_b32 v[110:111], v10 offset0:18 offset1:19
  v_mfma_f32_16x16x32_f16 v[24:27], v[100:103], v[2:5], v[24:27]
  ds_read_b128 v[2:5], v12 offset:3200
  s_waitcnt lgkmcnt(7)
  v_mfma_f32_16x16x32_f16 v[24:27], v[96:99], v[112:115], v[24:27]
  v_mfma_f32_16x16x32_f16 v[28:31], v[100:103], v[112:115], v[28:31]
  ds_read_b128 v[112:115], v12 offset:3712
  v_mfma_f32_16x16x32_f16 v[28:31], v[96:99], v[116:119], v[28:31]
  v_mfma_f32_16x16x32_f16 v[32:35], v[100:103], v[116:119], v[32:35]
  ds_read_b128 v[116:119], v12 offset:64
  s_waitcnt lgkmcnt(3)
  v_mfma_f32_16x16x32_f16 v[32:35], v[96:99], v[120:123], v[32:35]
  v_mfma_f32_16x16x32_f16 v[36:39], v[100:103], v[120:123], v[36:39]
  ds_read_b128 v[120:123], v12 offset:576
  v_mfma_f32_16x16x32_f16 v[36:39], v[96:99], v[124:127], v[36:39]
  v_mfma_f32_16x16x32_f16 v[40:43], v[100:103], v[124:127], v[40:43]
  ds_read_b128 v[124:127], v12 offset:1088
  s_waitcnt lgkmcnt(3)
  v_mfma_f32_16x16x32_f16 v[40:43], v[96:99], v[2:5], v[40:43]
  v_mfma_f32_16x16x32_f16 v[44:47], v[100:103], v[2:5], v[44:47]
  ds_read_b128 v[2:5], v12 offset:1600
  v_mfma_f32_16x16x32_f16 v[44:47], v[96:99], v[112:115], v[44:47]
  ds_read_b128 v[112:115], v12 offset:2112
  s_waitcnt lgkmcnt(3)
  v_mfma_f32_16x16x32_f16 v[16:19], v[104:107], v[116:119], v[16:19]
  v_mfma_f32_16x16x32_f16 v[20:23], v[108:111], v[116:119], v[20:23]
  ds_read_b128 v[116:119], v12 offset:2624
  v_mfma_f32_16x16x32_f16 v[20:23], v[104:107], v[120:123], v[20:23]
  v_mfma_f32_16x16x32_f16 v[24:27], v[108:111], v[120:123], v[24:27]
  ds_read_b128 v[120:123], v12 offset:3136
  s_waitcnt lgkmcnt(3)
  v_mfma_f32_16x16x32_f16 v[24:27], v[104:107], v[124:127], v[24:27]
  v_mul_f32 v16, v16, v8
  v_mul_f32 v17, v17, v8
  v_mfma_f32_16x16x32_f16 v[28:31], v[108:111], v[124:127], v[28:31]
  ds_read_b128 v[124:127], v12 offset:3648
  v_mul_f32 v18, v18, v8
  v_mfma_f32_16x16x32_f16 v[28:31], v[104:107], v[2:5], v[28:31]
  v_mul_f32 v19, v19, v8
  v_cvt_pk_bf16_f32 v16, v16, v17
  v_mfma_f32_16x16x32_f16 v[32:35], v[108:111], v[2:5], v[32:35]
  v_cvt_pk_bf16_f32 v17, v18, v19
  s_waitcnt lgkmcnt(2)
  v_mfma_f32_16x16x32_f16 v[32:35], v[104:107], v[112:115], v[32:35]
  ds_write_b64 v9, v[16:17] offset:0
  v_mfma_f32_16x16x32_f16 v[36:39], v[108:111], v[112:115], v[36:39]
  ds_read_b128 v[112:115], v12 offset:496
  v_mul_f32 v20, v20, v8
  v_mfma_f32_16x16x32_f16 v[36:39], v[104:107], v[116:119], v[36:39]
  v_mul_f32 v21, v21, v8
  v_mul_f32 v22, v22, v8
  v_mfma_f32_16x16x32_f16 v[40:43], v[108:111], v[116:119], v[40:43]
  v_mul_f32 v23, v23, v8
  s_waitcnt lgkmcnt(2)
  v_mfma_f32_16x16x32_f16 v[40:43], v[104:107], v[120:123], v[40:43]
  v_cvt_pk_bf16_f32 v20, v20, v21
  v_cvt_pk_bf16_f32 v21, v22, v23
  v_mfma_f32_16x16x32_f16 v[44:47], v[108:111], v[120:123], v[44:47]
  ds_write_b64 v9, v[20:21] offset:512
  v_mfma_f32_16x16x32_f16 v[44:47], v[104:107], v[124:127], v[44:47]
  ds_read_b128 v[16:19], v13 offset:2048
  s_waitcnt lgkmcnt(2)
  v_mfma_f32_16x16x32_f16 v[96:99], v[112:115], v[88:91], 0
  ds_read_b128 v[116:119], v12 offset:512
  ds_read_b128 v[20:23], v13 offset:3072
  v_mfma_f32_16x16x32_f16 v[100:103], v[112:115], v[92:95], 0
  ds_read_b128 v[2:5], v13 offset:4096
  s_waitcnt lgkmcnt(3)
  v_mfma_f32_16x16x32_f16 v[104:107], v[112:115], v[16:19], 0
  ds_read_b128 v[120:123], v12 offset:16
  s_waitcnt lgkmcnt(2)
  v_mfma_f32_16x16x32_f16 v[108:111], v[116:119], v[20:23], 0
  v_cvt_pk_f16_f32 v96, v96, v97
  v_cvt_pk_f16_f32 v97, v98, v99
  v_cvt_pk_f16_f32 v98, v100, v101
  v_cvt_pk_f16_f32 v99, v102, v103
  s_nop 1
  v_mfma_f32_16x16x32_f16 v[24:27], v[96:99], v[48:51], v[24:27]
  ds_read_b128 v[124:127], v12 offset:1008
  ds_read_b128 v[112:115], v12 offset:1024
  v_mfma_f32_16x16x32_f16 v[28:31], v[96:99], v[52:55], v[28:31]
  v_cvt_pk_f16_f32 v104, v104, v105
  v_cvt_pk_f16_f32 v105, v106, v107
  v_mfma_f32_16x16x32_f16 v[32:35], v[96:99], v[56:59], v[32:35]
  v_cvt_pk_f16_f32 v106, v108, v109
  v_cvt_pk_f16_f32 v107, v110, v111
  v_mfma_f32_16x16x32_f16 v[96:99], v[116:119], v[92:95], 0
  s_waitcnt lgkmcnt(2)
  v_pk_mul_f16 v2, v2, s71 op_sel_hi:[1,0]
  v_mfma_f32_16x16x32_f16 v[100:103], v[116:119], v[88:91], 0
  v_pk_mul_f16 v3, v3, s71 op_sel_hi:[1,0]
  v_pk_mul_f16 v4, v4, s71 op_sel_hi:[1,0]
  v_mfma_f32_16x16x32_f16 v[32:35], v[104:107], v[72:75], v[32:35]
  v_pk_mul_f16 v5, v5, s71 op_sel_hi:[1,0]
  ds_read_b128 v[116:119], v12 offset:528
  v_mfma_f32_16x16x32_f16 v[36:39], v[104:107], v[76:79], v[36:39]
  v_cvt_pk_f16_f32 v96, v96, v97
  v_cvt_pk_f16_f32 v97, v98, v99
  v_mfma_f32_16x16x32_f16 v[40:43], v[104:107], v[80:83], v[40:43]
  v_cvt_pk_f16_f32 v98, v100, v101
  v_cvt_pk_f16_f32 v99, v102, v103
  v_mfma_f32_16x16x32_f16 v[44:47], v[104:107], v[84:87], v[44:47]
  v_mfma_f32_16x16x32_f16 v[28:31], v[2:5], v[120:123], v[28:31]
  ds_read_b128 v[120:123], v12 offset:1520
  s_waitcnt lgkmcnt(2)
  v_mfma_f32_16x16x32_f16 v[104:107], v[124:127], v[88:91], 0
  v_mfma_f32_16x16x32_f16 v[108:111], v[124:127], v[92:95], 0
  v_mfma_f32_16x16x32_f16 v[24:27], v[96:99], v[60:63], v[24:27]
  v_mfma_f32_16x16x32_f16 v[28:31], v[96:99], v[64:67], v[28:31]
  v_cvt_pk_f16_f32 v104, v104, v105
  v_cvt_pk_f16_f32 v105, v106, v107
  v_mfma_f32_16x16x32_f16 v[32:35], v[96:99], v[68:71], v[32:35]
  v_cvt_pk_f16_f32 v106, v108, v109
  v_cvt_pk_f16_f32 v107, v110, v111
  v_mfma_f32_16x16x32_f16 v[96:99], v[124:127], v[16:19], 0
  v_mul_f32 v24, v24, v8
  v_mul_f32 v25, v25, v8
  v_mfma_f32_16x16x32_f16 v[100:103], v[112:115], v[20:23], 0
  v_mul_f32 v26, v26, v8
  v_mul_f32 v27, v27, v8
  v_mfma_f32_16x16x32_f16 v[28:31], v[104:107], v[48:51], v[28:31]
  v_cvt_pk_bf16_f32 v24, v24, v25
  v_cvt_pk_bf16_f32 v25, v26, v27
  v_mfma_f32_16x16x32_f16 v[32:35], v[104:107], v[52:55], v[32:35]
  ds_write_b64 v9, v[24:25] offset:1024
  v_mfma_f32_16x16x32_f16 v[36:39], v[104:107], v[56:59], v[36:39]
  v_cvt_pk_f16_f32 v96, v96, v97
  v_cvt_pk_f16_f32 v97, v98, v99
  v_mfma_f32_16x16x32_f16 v[104:107], v[112:115], v[92:95], 0
  v_cvt_pk_f16_f32 v98, v100, v101
  v_cvt_pk_f16_f32 v99, v102, v103
  v_mfma_f32_16x16x32_f16 v[108:111], v[112:115], v[88:91], 0
  ds_read_b128 v[124:127], v12 offset:1536
  ds_read_b128 v[112:115], v12 offset:1040
  v_mfma_f32_16x16x32_f16 v[36:39], v[96:99], v[72:75], v[36:39]
  v_mfma_f32_16x16x32_f16 v[40:43], v[96:99], v[76:79], v[40:43]
  v_cvt_pk_f16_f32 v104, v104, v105
  v_cvt_pk_f16_f32 v105, v106, v107
  v_mfma_f32_16x16x32_f16 v[44:47], v[96:99], v[80:83], v[44:47]
  v_cvt_pk_f16_f32 v106, v108, v109
  s_waitcnt lgkmcnt(2)
  v_mfma_f32_16x16x32_f16 v[32:35], v[2:5], v[116:119], v[32:35]
  v_cvt_pk_f16_f32 v107, v110, v111
  ds_read_b128 v[116:119], v12 offset:2032
  v_mfma_f32_16x16x32_f16 v[96:99], v[120:123], v[88:91], 0
  v_mfma_f32_16x16x32_f16 v[100:103], v[120:123], v[92:95], 0
  v_mfma_f32_16x16x32_f16 v[28:31], v[104:107], v[60:63], v[28:31]
  v_mov_b32 v7, 4
  v_mfma_f32_16x16x32_f16 v[32:35], v[104:107], v[64:67], v[32:35]
  v_cvt_pk_f16_f32 v96, v96, v97
  v_cvt_pk_f16_f32 v97, v98, v99
  v_mfma_f32_16x16x32_f16 v[36:39], v[104:107], v[68:71], v[36:39]
  v_cvt_pk_f16_f32 v98, v100, v101
  v_cvt_pk_f16_f32 v99, v102, v103
  v_mfma_f32_16x16x32_f16 v[104:107], v[120:123], v[16:19], 0
  v_mul_f32 v28, v28, v8
  s_waitcnt lgkmcnt(0)
  v_mfma_f32_16x16x32_f16 v[108:111], v[124:127], v[20:23], 0
  v_mul_f32 v29, v29, v8
  v_mul_f32 v30, v30, v8
  v_mfma_f32_16x16x32_f16 v[32:35], v[96:99], v[48:51], v[32:35]
  v_mul_f32 v31, v31, v8
  v_cvt_pk_bf16_f32 v28, v28, v29
  v_mfma_f32_16x16x32_f16 v[36:39], v[96:99], v[52:55], v[36:39]
  v_cvt_pk_f16_f32 v104, v104, v105
  v_cvt_pk_f16_f32 v105, v106, v107
  v_mfma_f32_16x16x32_f16 v[40:43], v[96:99], v[56:59], v[40:43]
  v_cvt_pk_f16_f32 v106, v108, v109
  v_cvt_pk_f16_f32 v107, v110, v111
  v_mfma_f32_16x16x32_f16 v[96:99], v[124:127], v[92:95], 0
  v_cvt_pk_bf16_f32 v29, v30, v31
  ds_read_b128 v[120:123], v12 offset:2048
  v_mfma_f32_16x16x32_f16 v[100:103], v[124:127], v[88:91], 0
  ds_write_b64 v9, v[28:29] offset:1536
  v_mfma_f32_16x16x32_f16 v[40:43], v[104:107], v[72:75], v[40:43]
  ds_write_b32 v15, v7 offset:48
  v_mfma_f32_16x16x32_f16 v[44:47], v[104:107], v[76:79], v[44:47]
  v_cvt_pk_f16_f32 v96, v96, v97
  v_cvt_pk_f16_f32 v97, v98, v99
  v_mfma_f32_16x16x32_f16 v[36:39], v[2:5], v[112:115], v[36:39]
  v_cvt_pk_f16_f32 v98, v100, v101
  v_cvt_pk_f16_f32 v99, v102, v103
  v_mfma_f32_16x16x32_f16 v[104:107], v[116:119], v[88:91], 0
  ds_read_b128 v[124:127], v12 offset:1552
  ds_read_b128 v[112:115], v12 offset:2544
  v_mfma_f32_16x16x32_f16 v[108:111], v[116:119], v[92:95], 0
  v_mfma_f32_16x16x32_f16 v[32:35], v[96:99], v[60:63], v[32:35]
  v_mfma_f32_16x16x32_f16 v[36:39], v[96:99], v[64:67], v[36:39]
  v_cvt_pk_f16_f32 v104, v104, v105
  v_cvt_pk_f16_f32 v105, v106, v107
  v_mfma_f32_16x16x32_f16 v[40:43], v[96:99], v[68:71], v[40:43]
  v_cvt_pk_f16_f32 v106, v108, v109
  v_cvt_pk_f16_f32 v107, v110, v111
  v_mfma_f32_16x16x32_f16 v[96:99], v[116:119], v[16:19], 0
  v_mul_f32 v32, v32, v8
  s_waitcnt lgkmcnt(0)
  v_mfma_f32_16x16x32_f16 v[100:103], v[120:123], v[20:23], 0
  v_mul_f32 v33, v33, v8
  v_mul_f32 v34, v34, v8
  v_mfma_f32_16x16x32_f16 v[36:39], v[104:107], v[48:51], v[36:39]
  v_mul_f32 v35, v35, v8
  v_cvt_pk_bf16_f32 v32, v32, v33
  v_mfma_f32_16x16x32_f16 v[40:43], v[104:107], v[52:55], v[40:43]
  v_cvt_pk_f16_f32 v96, v96, v97
  v_cvt_pk_f16_f32 v97, v98, v99
  v_mfma_f32_16x16x32_f16 v[44:47], v[104:107], v[56:59], v[44:47]
  v_cvt_pk_f16_f32 v98, v100, v101
  v_cvt_pk_f16_f32 v99, v102, v103
  v_mfma_f32_16x16x32_f16 v[104:107], v[120:123], v[92:95], 0
  v_cvt_pk_bf16_f32 v33, v34, v35
  ds_read_b128 v[116:119], v12 offset:2560
  v_mfma_f32_16x16x32_f16 v[108:111], v[120:123], v[88:91], 0
  ds_write_b64 v9, v[32:33] offset:2048
  v_mfma_f32_16x16x32_f16 v[44:47], v[96:99], v[72:75], v[44:47]
  ds_read_b128 v[120:123], v12 offset:2064
  v_mfma_f32_16x16x32_f16 v[40:43], v[2:5], v[124:127], v[40:43]
  v_cvt_pk_f16_f32 v104, v104, v105
  v_cvt_pk_f16_f32 v105, v106, v107
  v_mfma_f32_16x16x32_f16 v[96:99], v[112:115], v[88:91], 0
  v_cvt_pk_f16_f32 v106, v108, v109
  v_cvt_pk_f16_f32 v107, v110, v111
  v_mfma_f32_16x16x32_f16 v[100:103], v[112:115], v[92:95], 0
  ds_read_b128 v[124:127], v12 offset:3056
  ds_read_b128 v[112:115], v12 offset:3072
  v_mfma_f32_16x16x32_f16 v[36:39], v[104:107], v[60:63], v[36:39]
  v_mfma_f32_16x16x32_f16 v[40:43], v[104:107], v[64:67], v[40:43]
  v_cvt_pk_f16_f32 v96, v96, v97
  v_cvt_pk_f16_f32 v97, v98, v99
  v_mfma_f32_16x16x32_f16 v[44:47], v[104:107], v[68:71], v[44:47]
  v_cvt_pk_f16_f32 v98, v100, v101
  s_waitcnt lgkmcnt(2)
  v_mfma_f32_16x16x32_f16 v[104:107], v[116:119], v[92:95], 0
  v_cvt_pk_f16_f32 v99, v102, v103
  v_mul_f32 v36, v36, v8
  v_mfma_f32_16x16x32_f16 v[108:111], v[116:119], v[88:91], 0
  v_mul_f32 v37, v37, v8
  v_mul_f32 v38, v38, v8
  v_mfma_f32_16x16x32_f16 v[40:43], v[96:99], v[48:51], v[40:43]
  v_mul_f32 v39, v39, v8
  v_cvt_pk_bf16_f32 v36, v36, v37
  v_mfma_f32_16x16x32_f16 v[44:47], v[96:99], v[52:55], v[44:47]
  v_cvt_pk_f16_f32 v104, v104, v105
  v_cvt_pk_f16_f32 v105, v106, v107
  v_mfma_f32_16x16x32_f16 v[44:47], v[2:5], v[120:123], v[44:47]
  v_cvt_pk_f16_f32 v106, v108, v109
  s_waitcnt lgkmcnt(0)
  v_mfma_f32_16x16x32_f16 v[96:99], v[124:127], v[88:91], 0
  v_cvt_pk_f16_f32 v107, v110, v111
  v_cvt_pk_bf16_f32 v37, v38, v39
  v_mfma_f32_16x16x32_f16 v[100:103], v[124:127], v[92:95], 0
  ds_write_b64 v9, v[36:37] offset:2560
  v_mfma_f32_16x16x32_f16 v[40:43], v[104:107], v[60:63], v[40:43]
  v_mfma_f32_16x16x32_f16 v[44:47], v[104:107], v[64:67], v[44:47]
  v_cvt_pk_f16_f32 v96, v96, v97
  v_cvt_pk_f16_f32 v97, v98, v99
  v_mfma_f32_16x16x32_f16 v[104:107], v[112:115], v[92:95], 0
  v_cvt_pk_f16_f32 v98, v100, v101
  v_cvt_pk_f16_f32 v99, v102, v103
  v_mfma_f32_16x16x32_f16 v[108:111], v[112:115], v[88:91], 0
  v_mul_f32 v40, v40, v8
  v_mul_f32 v41, v41, v8
  v_mfma_f32_16x16x32_f16 v[44:47], v[96:99], v[48:51], v[44:47]
  s_nop 1
  v_cvt_pk_f16_f32 v104, v104, v105
  v_cvt_pk_f16_f32 v105, v106, v107
  s_nop 0
  v_cvt_pk_f16_f32 v106, v108, v109
  v_cvt_pk_f16_f32 v107, v110, v111
  s_nop 1
  v_mfma_f32_16x16x32_f16 v[44:47], v[104:107], v[60:63], v[44:47]
  v_mul_f32 v42, v42, v8
  v_mul_f32 v43, v43, v8
  v_cvt_pk_bf16_f32 v40, v40, v41
  v_cvt_pk_bf16_f32 v41, v42, v43
  ds_write_b64 v9, v[40:41] offset:3072
  s_nop 2
  v_mul_f32 v44, v44, v8
  v_mul_f32 v45, v45, v8
  v_mul_f32 v46, v46, v8
  v_mul_f32 v47, v47, v8
  v_cvt_pk_bf16_f32 v44, v44, v45
  v_cvt_pk_bf16_f32 v45, v46, v47
  ds_write_b64 v9, v[44:45] offset:3584
  v_mov_b32 v7, 8
  ds_write_b32 v15, v7 offset:48
  s_endpgm
.p2align 6
K_FAR:
  ds_write_b128 v99, v[76:79]
  ds_write_b128 v99, v[80:83] offset:1024
  s_nop 0
  v_mov_b32 v94, 1
  ds_write_b32 v92, v94 offset:64
  s_branch K_PS2B
K_PS2:
K_PS2B:
  ds_read_b32 v94, v93 offset:64
  s_waitcnt lgkmcnt(0)
  v_cmp_gt_u32 vcc, 1, v94
  s_cbranch_vccnz K_PS2
  ds_read_b128 v[16:19], v99 offset:5120
  ds_read_b128 v[20:23], v99 offset:6144
  s_waitcnt lgkmcnt(1)
  v_pk_add_f32 v[80:81], v[80:81], v[16:17]
  v_pk_add_f32 v[82:83], v[82:83], v[18:19]
  s_waitcnt lgkmcnt(0)
  v_pk_add_f32 v[84:85], v[84:85], v[20:21]
  v_pk_add_f32 v[86:87], v[86:87], v[22:23]
  v_cvt_pk_f16_f32 v16, v80, v81
  v_cvt_pk_f16_f32 v17, v82, v83
  v_cvt_pk_f16_f32 v18, v84, v85
  v_cvt_pk_f16_f32 v19, v86, v87
  v_cvt_pk_f16_f32 v89, v84, v84
  s_mov_b32 exec_lo, 0
  ds_write_b16 v125, v17
  ds_write_b16 v125, v17 offset:1986
  ds_write_b16_d16_hi v124, v17
  ds_write_b16_d16_hi v124, v17 offset:1986
  s_mov_b32 exec_hi, -4
  ds_write_b16 v125, v16 offset:16
  ds_write_b16 v125, v16 offset:2002
  ds_write_b16_d16_hi v124, v16 offset:16
  ds_write_b16_d16_hi v124, v16 offset:2002
  s_mov_b32 exec_hi, 1
  s_mov_b32 exec_lo, -2
  ds_write_b16 v126, v18 offset:48
  ds_write_b16 v126, v18 offset:2034
  s_mov_b32 exec_hi, 0
  s_mov_b32 exec_lo, -1
  ds_write_b16_d16_hi v126, v18 offset:32
  ds_write_b16_d16_hi v126, v18 offset:2018
  ds_write_b16 v126, v19 offset:16
  ds_write_b16 v126, v19 offset:2002
  ds_write_b16_d16_hi v126, v19
  ds_write_b16_d16_hi v126, v19 offset:1986
  s_mov_b64 exec, -1
  v_or_b32 v127, 0x10000, v89
  s_lshl_b32 s79, s52, 2
  v_mov_b32 v4, s79
  v_mov_b32 v93, 1
  s_mov_b64 exec, 1
  ds_write_b32 v4, v127 offset:640
  s_mov_b64 exec, -1
  s_cmp_eq_u32 s30, 1
  s_cbranch_scc1 K_LATER
  s_mov_b64 exec, 1
  s_waitcnt vmcnt(0)
  ds_add_u32 v15, v93 offset:112
  s_mov_b64 exec, -1
K_LATER:
  s_setprio 3
  s_lshl_b32 s62, s29, 14
  s_lshl_b32 s79, s52, 9
  s_add_u32 s62, s62, s79
  s_add_u32 s62, s62, 0x450000
  s_add_u32 s63, s62, 4096
  s_add_u32 s64, s62, 8192
  s_add_u32 s65, s62, 12288
  s_lshl_b32 s73, s28, 11
  s_add_u32 s73, s73, s62
  s_lshl_b32 s77, s28, 16
  s_add_u32 s77, s77, 0x500000
  s_lshl_b32 s57, s29, 11
  s_add_u32 s57, s57, s79
  s_add_u32 s57, s57, s77
  s_mov_b64 s[54:55], s[14:15]
  s_mov_b32 s12, 0x07060503
  s_mov_b32 s13, 0x07060502
  s_mov_b32 s14, 0x07060501
  s_mov_b32 s15, 0x04000c0c
  s_mov_b32 s16, 0x0706000c
  s_lshl_b32 s18, s28, 8
  s_cmp_lg_u32 s30, 1
  s_cbranch_scc1 K_NOKP
  ds_read_b32 v90, v15 offset:0
  v_mov_b32 v92, 0x3f803f80
  v_mov_b32 v93, v92
  v_lshlrev_b32 v3, 3, v1
  v_add_u32 v3, 150144, v3
  ds_write_b64 v3, v[92:93]
  ds_write_b64 v3, v[92:93] offset:64
  v_lshlrev_b32 v2, 3, v1
  s_setprio 3
  s_lshl_b32 s60, s28, 10
  s_add_u32 s60, s60, 0x441000
  s_mov_b32 s83, 0x20000
  v_add_u32 v3, s18, v95
  s_mov_b32 m0, 149504
  s_branch K_KWB
K_KW:
  s_sleep 1
K_KWB:
  ds_read_b32 v93, v15 offset:20
  s_waitcnt lgkmcnt(0)
  v_cmp_gt_u32 vcc, 8, v93
  s_cbranch_vccnz K_KW
  ds_read_b64 v[72:73], v2 offset:128
  ds_read_b32 v5, v15 offset:8
  v_readfirstlane_b32 s46, v90
  v_mov_b32 v74, v90
  v_mov_b32 v75, v90
  s_lshl_b32 s61, s29, 5
  s_add_u32 s61, s61, s60
  s_waitcnt lgkmcnt(0)
  v_readfirstlane_b32 s47, v5
  s_nop 0
  s_sub_u32 s47, s47, 1
  v_mov_b32 v80, v72
  s_nop 1
  v_max_u32_dpp v80, v80, v80 quad_perm:[1,0,3,2] row_mask:0xf bank_mask:0xf
  s_nop 1
  v_max_u32_dpp v80, v80, v80 quad_perm:[2,3,0,1] row_mask:0xf bank_mask:0xf
  s_nop 1
  v_max_u32_dpp v80, v80, v80 row_half_mirror row_mask:0xf bank_mask:0xf
  s_nop 1
  v_max_u32_dpp v80, v80, v80 row_mirror row_mask:0xf bank_mask:0xf
  s_nop 1
  v_max_u32_dpp v80, v80, v80 row_bcast:15 row_mask:0xa bank_mask:0xf
  s_nop 1
  v_max_u32_dpp v80, v80, v80 row_bcast:31 row_mask:0xc bank_mask:0xf
  s_nop 0
  v_readlane_b32 s78, v80, 63
  s_nop 1
  v_cmp_ne_u32 s[66:67], s78, v72
  s_nop 1
  v_cndmask_b32 v80, 0, v72, s[66:67]
  s_nop 1
  v_max_u32_dpp v80, v80, v80 quad_perm:[1,0,3,2] row_mask:0xf bank_mask:0xf
  s_nop 1
  v_max_u32_dpp v80, v80, v80 quad_perm:[2,3,0,1] row_mask:0xf bank_mask:0xf
  s_nop 1
  v_max_u32_dpp v80, v80, v80 row_half_mirror row_mask:0xf bank_mask:0xf
  s_nop 1
  v_max_u32_dpp v80, v80, v80 row_mirror row_mask:0xf bank_mask:0xf
  s_nop 1
  v_max_u32_dpp v80, v80, v80 row_bcast:15 row_mask:0xa bank_mask:0xf
  s_nop 1
  v_max_u32_dpp v80, v80, v80 row_bcast:31 row_mask:0xc bank_mask:0xf
  s_nop 0
  v_readlane_b32 s79, v80, 63
  v_cndmask_b32 v80, 0, 16, s[66:67]
  s_nop 0
  v_cmp_le_u32 vcc, s79, v72
  s_nop 0
  s_mov_b64 exec, vcc
  s_cmp_lg_u32 s47, 0
  s_cbranch_scc1 K_KS_W
  buffer_store_dwordx4 v[72:75], v80, s[32:35], s61 offen
  s_branch K_KS_D
K_KS_W:
  buffer_store_dwordx4 v[72:75], v80, s[32:35], s61 offen sc1
K_KS_D:
  s_mov_b64 exec, -1
  s_mov_b32 exec_lo, 0xfff00000
  v_add_u32 v3, -320, v3
  s_mov_b32 exec_lo, -1
  s_mov_b64 s[70:71], 0
K_P3:
  buffer_load_dwordx4 v[72:75], v95, s[32:35], s60 offen sc1
  s_waitcnt vmcnt(0)
  v_cmp_eq_u32 s[68:69], s46, v74
  s_nop 1
  v_cndmask_b32 v72, 0, v72, s[68:69]
  v_mov_b32 v80, v72
  s_nop 1
  v_max_u32_dpp v80, v80, v80 quad_perm:[1,0,3,2] row_mask:0xf bank_mask:0xf
  s_nop 1
  v_max_u32_dpp v80, v80, v80 quad_perm:[2,3,0,1] row_mask:0xf bank_mask:0xf
  s_nop 1
  v_max_u32_dpp v80, v80, v80 row_half_mirror row_mask:0xf bank_mask:0xf
  s_nop 1
  v_max_u32_dpp v80, v80, v80 row_mirror row_mask:0xf bank_mask:0xf
  s_nop 1
  v_max_u32_dpp v80, v80, v80 row_bcast:15 row_mask:0xa bank_mask:0xf
  s_nop 1
  v_max_u32_dpp v80, v80, v80 row_bcast:31 row_mask:0xc bank_mask:0xf
  s_nop 0
  v_readlane_b32 s78, v80, 63
  s_nop 1
  v_cmp_ne_u32 s[66:67], s78, v72
  s_nop 1
  v_cndmask_b32 v80, 0, v72, s[66:67]
  s_nop 1
  v_max_u32_dpp v80, v80, v80 quad_perm:[1,0,3,2] row_mask:0xf bank_mask:0xf
  s_nop 1
  v_max_u32_dpp v80, v80, v80 quad_perm:[2,3,0,1] row_mask:0xf bank_mask:0xf
  s_nop 1
  v_max_u32_dpp v80, v80, v80 row_half_mirror row_mask:0xf bank_mask:0xf
  s_nop 1
  v_max_u32_dpp v80, v80, v80 row_mirror row_mask:0xf bank_mask:0xf
  s_nop 1
  v_max_u32_dpp v80, v80, v80 row_bcast:15 row_mask:0xa bank_mask:0xf
  s_nop 1
  v_max_u32_dpp v80, v80, v80 row_bcast:31 row_mask:0xc bank_mask:0xf
  s_nop 0
  v_readlane_b32 s79, v80, 63
  s_nop 0
  s_cmp_eq_u64 s[78:79], s[70:71]
  s_cbranch_scc1 K_P3S
  s_mov_b64 s[70:71], s[78:79]
  s_andn2_b32 s78, 0xffe, s78
  s_andn2_b32 s61, 0xffe, s79
  v_mov_b32 v92, s78
  s_mov_b32 exec_lo, 0xfff00000
  s_mov_b32 exec_hi, 15
  v_mov_b32 v92, s61
  s_mov_b32 exec_lo, 0xfff0ffff
  v_lshl_add_u32 v92, v92, 10, v3
  global_load_lds_dwordx4 v92, s[44:45]
  s_mov_b64 exec, -1
K_P3S:
  s_sub_u32 s83, s83, 1
  s_cbranch_scc1 K_P3D
  s_cmp_lg_u64 s[68:69], -1
  s_cbranch_scc1 K_P3
K_P3D:
  v_cndmask_b32 v80, 0, 8, s[66:67]
  v_cmp_le_u32 vcc, s79, v72
  s_nop 0
  s_mov_b64 exec, vcc
  v_mov_b32 v93, 1
  ds_write_b32 v15, v93 offset:40
  ds_write_b64 v80, v[72:73] offset:96
  s_waitcnt vmcnt(0)
  ds_write_b32 v15, v93 offset:120
  s_mov_b64 exec, 1
  v_mov_b32 v93, 1
  ds_add_u32 v15, v93 offset:112
  s_cmp_lg_u32 s2, 0
  s_cbranch_scc1 K_NOZ
  s_mov_b32 s78, 0x0
  buffer_store_dword v74, v15, s[32:35], s78 offen sc1
K_NOZ:
  s_mov_b64 exec, -1
  s_setprio 3
K_NOKP:
  s_branch K_XWB
K_XW:
  s_sleep 4
K_XWB:
  ds_read_b32 v92, v15 offset:120
  s_waitcnt lgkmcnt(0)
  v_cmp_eq_u32 vcc, 0, v92
  s_cbranch_vccnz K_XW
  ds_read_b32 v5, v15 offset:8
  ds_read_b128 v[40:43], v15 offset:96
  ds_read_b32 v90, v15 offset:0
  ds_read_b128 v[48:51], v10 offset:0
  ds_read_b128 v[52:55], v10 offset:64
  ds_read_b128 v[56:59], v10 offset:128
  ds_read_b128 v[60:63], v10 offset:192
  s_waitcnt lgkmcnt(4)
  v_mov_b32 v93, 1
  v_mov_b32 v35, v90
  v_and_b32 v44, 0xffff0000, v41
  v_and_b32 v45, 0xffff0000, v43
  v_lshlrev_b32 v46, 16, v41
  v_lshlrev_b32 v47, 16, v43
  v_rcp_f32 v44, v44
  v_rcp_f32 v45, v45
  v_readfirstlane_b32 s47, v5
  s_nop 0
  s_sub_u32 s47, s47, 1
  s_cmp_ge_u32 s29, 28
  s_cbranch_scc1 K_NOFFN
  s_setprio 3
  s_branch K_EWB
K_EW:
  s_sleep 1
K_EWB:
  ds_read_b32 v92, v15 offset:112
  s_waitcnt lgkmcnt(0)
  v_cmp_gt_u32 vcc, 8, v92
  s_cbranch_vccnz K_EW
  ds_read_b64_tr_b16 v[64:65], v11 offset:0
  ds_read_b64_tr_b16 v[66:67], v11 offset:1024
  ds_read_b64_tr_b16 v[68:69], v12 offset:0
  ds_read_b64_tr_b16 v[70:71], v12 offset:1024
  ds_read_b64_tr_b16 v[72:73], v11 offset:32768
  ds_read_b64_tr_b16 v[74:75], v11 offset:33792
  ds_read_b64_tr_b16 v[76:77], v12 offset:32768
  ds_read_b64_tr_b16 v[78:79], v12 offset:33792
  ds_read_b64_tr_b16 v[80:81], v11 offset:8192
  ds_read_b64_tr_b16 v[82:83], v11 offset:9216
  ds_read_b64_tr_b16 v[84:85], v12 offset:8192
  ds_read_b64_tr_b16 v[86:87], v12 offset:9216
  s_waitcnt lgkmcnt(10)
  v_mfma_f32_16x16x32_bf16 v[16:19], v[48:51], v[64:67], 0
  ds_read_b64_tr_b16 v[64:65], v11 offset:40960
  ds_read_b64_tr_b16 v[66:67], v11 offset:41984
  s_waitcnt lgkmcnt(10)
  v_mfma_f32_16x16x32_bf16 v[24:27], v[48:51], v[68:71], 0
  ds_read_b64_tr_b16 v[68:69], v12 offset:40960
  ds_read_b64_tr_b16 v[70:71], v12 offset:41984
  s_waitcnt lgkmcnt(10)
  v_mfma_f32_16x16x32_bf16 v[20:23], v[48:51], v[72:75], 0
  ds_read_b64_tr_b16 v[72:73], v11 offset:16384
  ds_read_b64_tr_b16 v[74:75], v11 offset:17408
  s_waitcnt lgkmcnt(10)
  v_mfma_f32_16x16x32_bf16 v[28:31], v[48:51], v[76:79], 0
  ds_read_b64_tr_b16 v[76:77], v12 offset:16384
  ds_read_b64_tr_b16 v[78:79], v12 offset:17408
  s_waitcnt lgkmcnt(10)
  v_mfma_f32_16x16x32_bf16 v[16:19], v[52:55], v[80:83], v[16:19]
  s_waitcnt lgkmcnt(8)
  v_mfma_f32_16x16x32_bf16 v[24:27], v[52:55], v[84:87], v[24:27]
  s_waitcnt lgkmcnt(6)
  v_mfma_f32_16x16x32_bf16 v[20:23], v[52:55], v[64:67], v[20:23]
  s_waitcnt lgkmcnt(4)
  v_mfma_f32_16x16x32_bf16 v[28:31], v[52:55], v[68:71], v[28:31]
  s_waitcnt lgkmcnt(2)
  v_mfma_f32_16x16x32_bf16 v[16:19], v[56:59], v[72:75], v[16:19]
  s_waitcnt lgkmcnt(0)
  v_mfma_f32_16x16x32_bf16 v[24:27], v[56:59], v[76:79], v[24:27]
  s_branch K_GWB
K_GW:
  s_sleep 1
K_GWB:
  ds_read_b32 v92, v15 offset:24
  s_waitcnt lgkmcnt(0)
  v_cmp_gt_u32 vcc, 8, v92
  s_cbranch_vccnz K_GW
  ds_read_b64_tr_b16 v[64:65], v11 offset:49152
  ds_read_b64_tr_b16 v[66:67], v11 offset:50176
  ds_read_b64_tr_b16 v[68:69], v12 offset:49152
  ds_read_b64_tr_b16 v[70:71], v12 offset:50176
  ds_read_b64_tr_b16 v[72:73], v11 offset:24576
  ds_read_b64_tr_b16 v[74:75], v11 offset:25600
  ds_read_b64_tr_b16 v[76:77], v12 offset:24576
  ds_read_b64_tr_b16 v[78:79], v12 offset:25600
  ds_read_b64_tr_b16 v[80:81], v11 offset:57344
  ds_read_b64_tr_b16 v[82:83], v11 offset:58368
  ds_read_b64_tr_b16 v[84:85], v12 offset:57344
  ds_read_b64_tr_b16 v[86:87], v12 offset:58368
  s_waitcnt lgkmcnt(10)
  v_mfma_f32_16x16x32_bf16 v[20:23], v[56:59], v[64:67], v[20:23]
  s_waitcnt lgkmcnt(8)
  v_mfma_f32_16x16x32_bf16 v[28:31], v[56:59], v[68:71], v[28:31]
  s_waitcnt lgkmcnt(6)
  v_mfma_f32_16x16x32_bf16 v[16:19], v[60:63], v[72:75], v[16:19]
  s_waitcnt lgkmcnt(4)
  v_mfma_f32_16x16x32_bf16 v[24:27], v[60:63], v[76:79], v[24:27]
  s_waitcnt lgkmcnt(2)
  v_mfma_f32_16x16x32_bf16 v[20:23], v[60:63], v[80:83], v[20:23]
  s_waitcnt lgkmcnt(0)
  v_mfma_f32_16x16x32_bf16 v[28:31], v[60:63], v[84:87], v[28:31]
  s_mov_b32 exec_lo, 0xffff0000
  s_mov_b32 exec_hi, 0
  s_nop 1
  v_mov_b32 v16, v24
  v_mov_b32 v17, v25
  v_mov_b32 v18, v26
  s_nop 0
  v_mov_b32 v20, v28
  v_mov_b32 v21, v29
  v_mov_b32 v22, v30
  s_mov_b32 exec_lo, -1
  v_fma_f32 v16, -v46, v18, v16
  v_fma_f32 v17, -v47, v18, v17
  v_fma_f32 v18, -v46, v22, v20
  v_fma_f32 v19, -v47, v22, v21
  v_mul_f32 v16, v16, v44
  v_mul_f32 v17, v17, v45
  v_mul_f32 v19, v19, v45
  v_mul_f32 v18, v18, v44
  v_perm_b32 v32, v16, v19, s12
  v_perm_b32 v33, v17, v19, s13
  v_perm_b32 v34, v18, v19, s14
  buffer_store_dwordx4 v[32:35], v95, s[32:35], s73 offen sc1
  s_mov_b32 exec_hi, -1
K_NOFFN:
  s_cmp_lg_u32 s30, 1
  s_cbranch_scc1 K_NOFP
  s_setprio 0
  v_and_b32 v3, 16, v1
  v_lshrrev_b32 v3, 1, v3
  ds_read_b64 v[100:101], v3 offset:96
  v_and_b32 v7, 3, v1
  v_lshl_add_u32 v5, v7, 3, s3
  v_lshlrev_b32 v5, 1, v5
  global_load_ushort v102, v5, s[54:55]
  v_lshrrev_b32 v106, 2, v1
  v_lshlrev_b32 v106, 11, v106
  v_lshl_add_u32 v106, v7, 4, v106
  s_lshl_b32 s61, s29, 6
  s_add_u32 s60, s77, s61
  s_add_u32 s61, s60, 0x8000
  s_waitcnt lgkmcnt(0)
  v_not_b32 v6, v100
  v_and_b32 v6, 0xffe, v6
  v_lshl_add_u32 v104, v7, 12, v6
  v_lshl_add_u32 v107, v6, 10, v5
  global_load_ushort v103, v107, s[44:45]
  v_and_b32 v5, s31, v100
  v_ashrrev_i32 v3, 31, v5
  v_not_b32 v3, v3
  v_or_b32 v3, 0x80000000, v3
  v_xor_b32 v5, v5, v3
  v_and_b32 v5, s31, v5
  v_mul_f32 v105, s58, v5
  v_exp_f32 v105, -v105
  v_and_b32 v108, s31, v101
  v_lshlrev_b32 v101, 16, v101
  v_add_f32 v105, 1.0, v105
  v_rcp_f32 v105, v105
  v_rcp_f32 v109, v108
  s_nop 0
  v_fma_f32 v108, -v108, v109, 1.0
  v_fmac_f32 v109, v108, v109
  v_cvt_pk_bf16_f32 v105, 0, v105
  s_setprio 3
  s_branch K_FPD
K_NOFP:
  s_sleep 8
K_FPD:
  s_cmp_ge_u32 s29, 28
  s_cbranch_scc1 K_NOG2
  s_mov_b32 s83, 0x20000
  buffer_load_dwordx4 v[64:67], v14, s[32:35], s62 offen sc1
  buffer_load_dwordx4 v[68:71], v14, s[32:35], s63 offen sc1
  buffer_load_dwordx4 v[72:75], v14, s[32:35], s64 offen sc1
  buffer_load_dwordx4 v[76:79], v14, s[32:35], s65 offen sc1
  s_waitcnt vmcnt(0)
  s_branch K_WWB
K_WW:
  s_sleep 1
K_WWB:
  ds_read_b32 v92, v15 offset:124
  s_waitcnt lgkmcnt(0)
  v_cmp_gt_u32 vcc, 4, v92
  s_cbranch_vccnz K_WW
  ds_read_b64_tr_b16 v[40:41], v9 offset:0
  ds_read_b64_tr_b16 v[42:43], v9 offset:1024
  ds_read_b64_tr_b16 v[44:45], v9 offset:8
  ds_read_b64_tr_b16 v[46:47], v9 offset:1032
  ds_read_b64_tr_b16 v[80:81], v9 offset:8192
  ds_read_b64_tr_b16 v[82:83], v9 offset:9216
  ds_read_b64_tr_b16 v[84:85], v9 offset:8200
  ds_read_b64_tr_b16 v[86:87], v9 offset:9224
  ds_read_b64_tr_b16 v[112:113], v9 offset:16384
  ds_read_b64_tr_b16 v[114:115], v9 offset:17408
  ds_read_b64_tr_b16 v[116:117], v9 offset:16392
  ds_read_b64_tr_b16 v[118:119], v9 offset:17416
  s_waitcnt lgkmcnt(8)
  ds_read_b64_tr_b16 v[120:121], v9 offset:24576
  ds_read_b64_tr_b16 v[122:123], v9 offset:25600
  ds_read_b64_tr_b16 v[124:125], v9 offset:24584
  ds_read_b64_tr_b16 v[126:127], v9 offset:25608
  v_bitop3_b32 v92, v67, v71, v90 bitop3:0x7e
  v_bitop3_b32 v88, v75, v79, v90 bitop3:0x7e
  v_or_b32 v92, v92, v88
  v_cmp_ne_u32 vcc, 0, v92
  s_cbranch_vccnz K_P4
K_P4D:
  v_perm_b32 v67, v64, v65, s15
  v_perm_b32 v71, v68, v69, s15
  v_perm_b32 v75, v72, v73, s15
  v_perm_b32 v79, v76, v77, s15
  v_perm_b32 v67, v67, v66, s16
  v_perm_b32 v71, v71, v70, s16
  v_perm_b32 v75, v75, v74, s16
  v_perm_b32 v79, v79, v78, s16
  v_add_f32 v64, v64, v72
  v_add_f32 v65, v65, v73
  v_add_f32 v66, v66, v74
  v_add_f32 v67, v67, v75
  v_add_f32 v68, v68, v76
  v_add_f32 v69, v69, v77
  v_add_f32 v70, v70, v78
  v_add_f32 v71, v71, v79
  v_add_f32 v64, v64, v68
  v_add_f32 v65, v65, v69
  v_add_f32 v66, v66, v70
  v_add_f32 v67, v67, v71
  v_permlane32_swap_b32 v64, v65
  s_nop 0
  v_permlane32_swap_b32 v66, v67
  v_add_f32 v64, v64, v65
  v_add_f32 v66, v66, v67
  v_cvt_pk_bf16_f32 v64, 0, v64
  v_cvt_pk_bf16_f32 v66, 0, v66
  v_mul_f32 v65, 0xbfb8aa3b, v64
  v_exp_f32 v65, v65
  s_nop 0
  v_add_f32 v65, 1.0, v65
  v_rcp_f32 v65, v65
  s_nop 0
  v_mul_f32 v65, v65, v64
  v_cvt_pk_bf16_f32 v65, 0, v65
  v_mul_f32 v65, v65, v66
  v_cvt_pk_bf16_f32 v65, v65, v65
  ds_write_b16 v13, v65
  s_mov_b64 exec, 1
  ds_add_u32 v15, v93 offset:116
  s_mov_b64 exec, -1
  s_branch K_HWB
K_HW:
K_HWB:
  ds_read_b32 v92, v15 offset:116
  s_waitcnt lgkmcnt(0)
  v_cmp_gt_u32 vcc, 4, v92
  s_cbranch_vccnz K_HW
  ds_read_b128 v[48:51], v10 offset:1280
  ds_read_b128 v[52:55], v10 offset:1344
  ds_read_b128 v[56:59], v10 offset:1408
  ds_read_b128 v[60:63], v10 offset:1472
  s_waitcnt lgkmcnt(3)
  v_mfma_f32_16x16x32_bf16 v[16:19], v[48:51], v[40:43], 0
  v_mfma_f32_16x16x32_bf16 v[20:23], v[48:51], v[44:47], 0
  s_waitcnt lgkmcnt(2)
  v_mfma_f32_16x16x32_bf16 v[16:19], v[52:55], v[80:83], v[16:19]
  v_mfma_f32_16x16x32_bf16 v[20:23], v[52:55], v[84:87], v[20:23]
  s_waitcnt lgkmcnt(1)
  v_mfma_f32_16x16x32_bf16 v[16:19], v[56:59], v[112:115], v[16:19]
  v_mfma_f32_16x16x32_bf16 v[20:23], v[56:59], v[116:119], v[20:23]
  s_waitcnt lgkmcnt(0)
  v_mfma_f32_16x16x32_bf16 v[16:19], v[60:63], v[120:123], v[16:19]
  v_mfma_f32_16x16x32_bf16 v[20:23], v[60:63], v[124:127], v[20:23]
  s_mov_b64 exec, 0xffff
  s_nop 5
  v_mov_b32 v18, v90
  v_mov_b32 v22, v90
  s_cmp_lg_u32 s47, 0
  s_cbranch_scc1 K_DS_W
  buffer_store_dwordx3 v[16:18], v8, s[32:35], s57 offen
  buffer_store_dwordx3 v[20:22], v8, s[32:35], s57 offen offset:256
  s_branch K_DS_D
K_DS_W:
  buffer_store_dwordx3 v[16:18], v8, s[32:35], s57 offen sc1
  buffer_store_dwordx3 v[20:22], v8, s[32:35], s57 offen offset:256 sc1
K_DS_D:
  s_mov_b64 exec, -1
K_NOG2:
  s_cmp_lg_u32 s30, 1
  s_cbranch_scc1 K_CDONE
  s_branch K_YAB
K_YA:
  s_sleep 2
K_YAB:
  ds_read_b128 v[32:35], v15 offset:48
  ds_read_u16 v40, v104 offset:56320
  s_waitcnt lgkmcnt(1)
  v_and_b32 v92, v32, v33
  v_bitop3_b32 v92, v92, v34, v35 bitop3:0x80
  v_cmp_ne_u32 vcc, 8, v92
  s_cbranch_vccnz K_YA
  v_mov_b32 v52, 0
  v_mov_b32 v53, 0
  v_mov_b32 v54, v90
  buffer_load_dwordx3 v[48:50], v106, s[32:35], s60 offen sc1
  s_mov_b32 exec_hi, 0x5ffff
  buffer_load_dwordx3 v[52:54], v106, s[32:35], s61 offen sc1
  s_mov_b32 exec_hi, -1
  s_mov_b32 s83, 0x20000
  s_waitcnt vmcnt(2) lgkmcnt(0)
  v_lshlrev_b32 v103, 16, v103
  v_lshlrev_b32 v102, 16, v102
  v_lshlrev_b32 v40, 16, v40
  v_sub_f32 v25, v103, v101
  v_cvt_pk_bf16_f32 v25, 0, v25
  v_mul_f32 v25, v25, v109
  v_cvt_pk_bf16_f32 v25, 0, v25
  v_mul_f32 v26, v25, v102
  v_cvt_pk_bf16_f32 v26, 0, v26
  v_add_f32 v26, v26, v40
  v_cvt_pk_bf16_f32 v26, 0, v26
  s_waitcnt vmcnt(0)
  s_branch K_DC
K_DP:
  buffer_load_dwordx3 v[48:50], v106, s[32:35], s60 offen sc1
  s_mov_b32 exec_hi, 0x5ffff
  buffer_load_dwordx3 v[52:54], v106, s[32:35], s61 offen sc1
  s_mov_b32 exec_hi, -1
  s_sub_u32 s83, s83, 1
  s_waitcnt vmcnt(0)
  s_cbranch_scc1 K_DD
K_DC:
  v_bitop3_b32 v92, v50, v54, v90 bitop3:0x7e
  v_cmp_ne_u32 vcc, 0, v92
  s_cbranch_vccnz K_DP
K_DD:
  v_pk_add_f32 v[48:49], v[48:49], v[52:53]
  s_nop 1
  v_permlane16_swap_b32 v48, v49
  v_add_f32 v48, v48, v49
  v_mov_b32 v49, v48
  s_nop 1
  v_permlane32_swap_b32 v48, v49
  v_add_f32 v48, v48, v49
  s_nop 1
  v_add_f32_dpp v48, v48, v48 row_ror:4 row_mask:0xf bank_mask:0xf
  s_nop 1
  v_add_f32_dpp v48, v48, v48 row_ror:8 row_mask:0xf bank_mask:0xf
  v_cvt_pk_bf16_f32 v48, 0, v48
  v_mul_f32 v20, v48, v105
  v_cvt_pk_bf16_f32 v20, 0, v20
  v_add_f32 v20, v20, v25
  v_cvt_pk_bf16_f32 v20, 0, v20
  v_mul_f32 v23, 0xbfb8aa3b, v20
  v_exp_f32 v23, v23
  s_nop 0
  v_add_f32 v23, 1.0, v23
  v_rcp_f32 v23, v23
  s_nop 0
  v_mul_f32 v23, v23, v20
  v_cvt_pk_bf16_f32 v23, 0, v23
  v_mul_f32 v23, v23, v26
  v_cvt_pk_bf16_f32 v23, 0, v23
  v_add_f32 v23, v23, v103
  v_cvt_pk_bf16_f32 v23, v23, v23
  s_mov_b64 exec, 0x000f000f
  global_store_short v107, v23, s[26:27]
K_CDONE:
  s_endpgm
K_P4:
  s_sleep 2
  v_cmp_ne_u32 vcc, v67, v90
  s_cbranch_vccz K_P4_0
  s_mov_b64 exec, vcc
  buffer_load_dwordx4 v[64:67], v14, s[32:35], s62 offen sc1
  s_mov_b64 exec, -1
K_P4_0:
  v_cmp_ne_u32 vcc, v71, v90
  s_cbranch_vccz K_P4_1
  s_mov_b64 exec, vcc
  buffer_load_dwordx4 v[68:71], v14, s[32:35], s63 offen sc1
  s_mov_b64 exec, -1
K_P4_1:
  v_cmp_ne_u32 vcc, v75, v90
  s_cbranch_vccz K_P4_2
  s_mov_b64 exec, vcc
  buffer_load_dwordx4 v[72:75], v14, s[32:35], s64 offen sc1
  s_mov_b64 exec, -1
K_P4_2:
  v_cmp_ne_u32 vcc, v79, v90
  s_cbranch_vccz K_P4_3
  s_mov_b64 exec, vcc
  buffer_load_dwordx4 v[76:79], v14, s[32:35], s65 offen sc1
  s_mov_b64 exec, -1
K_P4_3:
  s_sub_u32 s83, s83, 1
  s_waitcnt vmcnt(0)
  v_bitop3_b32 v92, v67, v71, v90 bitop3:0x7e
  v_bitop3_b32 v88, v75, v79, v90 bitop3:0x7e
  s_cbranch_scc1 K_P4D
  v_or_b32 v92, v92, v88
  v_cmp_ne_u32 vcc, 0, v92
  s_cbranch_vccnz K_P4
  s_branch K_P4D
K_END:
  s_endpgm
.p2align 4
.type K_BAND,@object
.size K_BAND, 5120
K_BAND:
.long 0x0, 0x0, 0x0, 0x3c003c00
.long 0x0, 0x0, 0x0, 0x3c000000
.long 0x0, 0x0, 0x0, 0x0
.long 0x0, 0x0, 0x0, 0x0
.long 0x0, 0x0, 0x0, 0x0
.long 0x0, 0x0, 0x0, 0x0
.long 0x0, 0x0, 0x0, 0x0
.long 0x0, 0x0, 0x0, 0x0
.long 0x0, 0x0, 0x0, 0x0
.long 0x0, 0x0, 0x0, 0x0
.long 0x0, 0x0, 0x0, 0x0
.long 0x0, 0x0, 0x0, 0x0
.long 0x0, 0x0, 0x0, 0x0
.long 0x0, 0x0, 0x0, 0x0
.long 0x0, 0x0, 0x0, 0x0
.long 0x0, 0x0, 0x0, 0x0
.long 0x3c003c00, 0x3c00, 0x0, 0x0
.long 0x3c003c00, 0x3c003c00, 0x0, 0x0
.long 0x3c003c00, 0x3c003c00, 0x3c00, 0x0
.long 0x3c000000, 0x3c003c00, 0x3c003c00, 0x0
.long 0x0, 0x3c003c00, 0x3c003c00, 0x3c00
.long 0x0, 0x3c000000, 0x3c003c00, 0x3c003c00
.long 0x0, 0x0, 0x3c003c00, 0x3c003c00
.long 0x0, 0x0, 0x3c000000, 0x3c003c00
.long 0x0, 0x0, 0x0, 0x3c003c00
.long 0x0, 0x0, 0x0, 0x3c000000
.long 0x0, 0x0, 0x0, 0x0
.long 0x0, 0x0, 0x0, 0x0
.long 0x0, 0x0, 0x0, 0x0
.long 0x0, 0x0, 0x0, 0x0
.long 0x0, 0x0, 0x0, 0x0
.long 0x0, 0x0, 0x0, 0x0
.long 0x0, 0x0, 0x0, 0x0
.long 0x0, 0x0, 0x0, 0x0
.long 0x0, 0x0, 0x0, 0x0
.long 0x0, 0x0, 0x0, 0x0
.long 0x0, 0x0, 0x0, 0x0
.long 0x0, 0x0, 0x0, 0x0
.long 0x3c00, 0x0, 0x0, 0x0
.long 0x3c003c00, 0x0, 0x0, 0x0
.long 0x3c003c00, 0x3c00, 0x0, 0x0
.long 0x3c003c00, 0x3c003c00, 0x0, 0x0
.long 0x3c003c00, 0x3c003c00, 0x3c00, 0x0
.long 0x3c000000, 0x3c003c00, 0x3c003c00, 0x0
.long 0x0, 0x3c003c00, 0x3c003c00, 0x3c00
.long 0x0, 0x3c000000, 0x3c003c00, 0x3c003c00
.long 0x0, 0x0, 0x3c003c00, 0x3c003c00
.long 0x0, 0x0, 0x3c000000, 0x3c003c00
.long 0x0, 0x0, 0x0, 0x0
.long 0x0, 0x0, 0x0, 0x0
.long 0x0, 0x0, 0x0, 0x0
.long 0x0, 0x0, 0x0, 0x0
.long 0x0, 0x0, 0x0, 0x0
.long 0x0, 0x0, 0x0, 0x0
.long 0x0, 0x0, 0x0, 0x0
.long 0x0, 0x0, 0x0, 0x0
.long 0x0, 0x0, 0x0, 0x0
.long 0x0, 0x0, 0x0, 0x0
.long 0x0, 0x0, 0x0, 0x0
.long 0x0, 0x0, 0x0, 0x0
.long 0x0, 0x0, 0x0, 0x0
.long 0x0, 0x0, 0x0, 0x0
.long 0x3c00, 0x0, 0x0, 0x0
.long 0x3c003c00, 0x0, 0x0, 0x0
.long 0x0, 0x0, 0x0, 0x0
.long 0x0, 0x0, 0x0, 0x0
.long 0x0, 0x0, 0x0, 0x0
.long 0x0, 0x0, 0x0, 0x0
.long 0x0, 0x0, 0x0, 0x0
.long 0x0, 0x0, 0x0, 0x0
.long 0x0, 0x0, 0x0, 0x0
.long 0x0, 0x0, 0x0, 0x0
.long 0x0, 0x0, 0x0, 0x0
.long 0x0, 0x0, 0x0, 0x0
.long 0x0, 0x0, 0x0, 0x0
.long 0x0, 0x0, 0x0, 0x0
.long 0x0, 0x0, 0x0, 0x0
.long 0x0, 0x0, 0x0, 0x0
.long 0x0, 0x0, 0x0, 0x0
.long 0x0, 0x0, 0x0, 0x0
.long 0x0, 0x3c000000, 0x3c003c00, 0x0
.long 0x0, 0x0, 0x3c003c00, 0x3c00
.long 0x0, 0x0, 0x3c000000, 0x3c003c00
.long 0x0, 0x0, 0x0, 0x3c003c00
.long 0x0, 0x0, 0x0, 0x3c000000
.long 0x0, 0x0, 0x0, 0x0
.long 0x0, 0x0, 0x0, 0x0
.long 0x0, 0x0, 0x0, 0x0
.long 0x0, 0x0, 0x0, 0x0
.long 0x0, 0x0, 0x0, 0x0
.long 0x0, 0x0, 0x0, 0x0
.long 0x0, 0x0, 0x0, 0x0
.long 0x0, 0x0, 0x0, 0x0
.long 0x0, 0x0, 0x0, 0x0
.long 0x0, 0x0, 0x0, 0x0
.long 0x0, 0x0, 0x0, 0x0
.long 0x0, 0x0, 0x0, 0x0
.long 0x0, 0x0, 0x0, 0x0
.long 0x0, 0x0, 0x0, 0x0
.long 0x3c00, 0x0, 0x0, 0x0
.long 0x3c003c00, 0x0, 0x0, 0x0
.long 0x3c003c00, 0x3c00, 0x0, 0x0
.long 0x3c000000, 0x3c003c00, 0x0, 0x0
.long 0x0, 0x3c003c00, 0x3c00, 0x0
.long 0x0, 0x3c000000, 0x3c003c00, 0x0
.long 0x0, 0x0, 0x3c003c00, 0x3c00
.long 0x0, 0x0, 0x3c000000, 0x3c003c00
.long 0x0, 0x0, 0x0, 0x3c003c00
.long 0x0, 0x0, 0x0, 0x3c000000
.long 0x0, 0x0, 0x0, 0x0
.long 0x0, 0x0, 0x0, 0x0
.long 0x0, 0x0, 0x0, 0x0
.long 0x0, 0x0, 0x0, 0x0
.long 0x0, 0x0, 0x0, 0x0
.long 0x0, 0x0, 0x0, 0x0
.long 0x0, 0x0, 0x0, 0x0
.long 0x0, 0x0, 0x0, 0x0
.long 0x0, 0x0, 0x0, 0x0
.long 0x0, 0x0, 0x0, 0x0
.long 0x0, 0x0, 0x0, 0x0
.long 0x0, 0x0, 0x0, 0x0
.long 0x0, 0x0, 0x0, 0x0
.long 0x0, 0x0, 0x0, 0x0
.long 0x3c00, 0x0, 0x0, 0x0
.long 0x3c003c00, 0x0, 0x0, 0x0
.long 0x3c003c00, 0x3c00, 0x0, 0x0
.long 0x3c000000, 0x3c003c00, 0x0, 0x0
.long 0x0, 0x3c003c00, 0x3c00, 0x0
.long 0x0, 0x0, 0x3c003c00, 0x3c003c00
.long 0x0, 0x0, 0x3c000000, 0x3c003c00
.long 0x0, 0x0, 0x0, 0x3c003c00
.long 0x0, 0x0, 0x0, 0x3c000000
.long 0x0, 0x0, 0x0, 0x0
.long 0x0, 0x0, 0x0, 0x0
.long 0x0, 0x0, 0x0, 0x0
.long 0x0, 0x0, 0x0, 0x0
.long 0x0, 0x0, 0x0, 0x0
.long 0x0, 0x0, 0x0, 0x0
.long 0x0, 0x0, 0x0, 0x0
.long 0x0, 0x0, 0x0, 0x0
.long 0x0, 0x0, 0x0, 0x0
.long 0x0, 0x0, 0x0, 0x0
.long 0x0, 0x0, 0x0, 0x0
.long 0x0, 0x0, 0x0, 0x0
.long 0x3c003c00, 0x3c003c00, 0x3c00, 0x0
.long 0x3c003c00, 0x3c003c00, 0x3c003c00, 0x0
.long 0x3c003c00, 0x3c003c00, 0x3c003c00, 0x3c00
.long 0x3c003c00, 0x3c003c00, 0x3c003c00, 0x3c003c00
.long 0x3c003c00, 0x3c003c00, 0x3c003c00, 0x3c003c00
.long 0x3c000000, 0x3c003c00, 0x3c003c00, 0x3c003c00
.long 0x0, 0x3c003c00, 0x3c003c00, 0x3c003c00
.long 0x0, 0x3c000000, 0x3c003c00, 0x3c003c00
.long 0x0, 0x0, 0x3c003c00, 0x3c003c00
.long 0x0, 0x0, 0x3c000000, 0x3c003c00
.long 0x0, 0x0, 0x0, 0x3c003c00
.long 0x0, 0x0, 0x0, 0x3c000000
.long 0x0, 0x0, 0x0, 0x0
.long 0x0, 0x0, 0x0, 0x0
.long 0x0, 0x0, 0x0, 0x0
.long 0x0, 0x0, 0x0, 0x0
.long 0x0, 0x0, 0x0, 0x0
.long 0x0, 0x0, 0x0, 0x0
.long 0x0, 0x0, 0x0, 0x0
.long 0x0, 0x0, 0x0, 0x0
.long 0x3c00, 0x0, 0x0, 0x0
.long 0x3c003c00, 0x0, 0x0, 0x0
.long 0x3c003c00, 0x3c00, 0x0, 0x0
.long 0x3c003c00, 0x3c003c00, 0x0, 0x0
.long 0x3c003c00, 0x3c003c00, 0x3c00, 0x0
.long 0x3c003c00, 0x3c003c00, 0x3c003c00, 0x0
.long 0x3c003c00, 0x3c003c00, 0x3c003c00, 0x3c00
.long 0x3c003c00, 0x3c003c00, 0x3c003c00, 0x3c003c00
.long 0x3c003c00, 0x3c003c00, 0x3c003c00, 0x3c003c00
.long 0x3c000000, 0x3c003c00, 0x3c003c00, 0x3c003c00
.long 0x0, 0x3c003c00, 0x3c003c00, 0x3c003c00
.long 0x0, 0x3c000000, 0x3c003c00, 0x3c003c00
.long 0x0, 0x0, 0x0, 0x0
.long 0x0, 0x0, 0x0, 0x0
.long 0x0, 0x0, 0x0, 0x0
.long 0x0, 0x0, 0x0, 0x0
.long 0x0, 0x0, 0x0, 0x0
.long 0x0, 0x0, 0x0, 0x0
.long 0x0, 0x0, 0x0, 0x0
.long 0x0, 0x0, 0x0, 0x0
.long 0x0, 0x0, 0x0, 0x0
.long 0x0, 0x0, 0x0, 0x0
.long 0x0, 0x0, 0x0, 0x0
.long 0x0, 0x0, 0x0, 0x0
.long 0x3c00, 0x0, 0x0, 0x0
.long 0x3c003c00, 0x0, 0x0, 0x0
.long 0x3c003c00, 0x3c00, 0x0, 0x0
.long 0x3c003c00, 0x3c003c00, 0x0, 0x0
.long 0x0, 0x0, 0x3c000000, 0x3c003c00
.long 0x0, 0x0, 0x0, 0x3c003c00
.long 0x0, 0x0, 0x0, 0x3c000000
.long 0x0, 0x0, 0x0, 0x0
.long 0x0, 0x0, 0x0, 0x0
.long 0x0, 0x0, 0x0, 0x0
.long 0x0, 0x0, 0x0, 0x0
.long 0x0, 0x0, 0x0, 0x0
.long 0x0, 0x0, 0x0, 0x0
.long 0x0, 0x0, 0x0, 0x0
.long 0x0, 0x0, 0x0, 0x0
.long 0x0, 0x0, 0x0, 0x0
.long 0x0, 0x0, 0x0, 0x0
.long 0x0, 0x0, 0x0, 0x0
.long 0x0, 0x0, 0x0, 0x0
.long 0x0, 0x0, 0x0, 0x0
.long 0x3c003c00, 0x3c003c00, 0x0, 0x0
.long 0x3c003c00, 0x3c003c00, 0x3c00, 0x0
.long 0x3c003c00, 0x3c003c00, 0x3c003c00, 0x0
.long 0x3c003c00, 0x3c003c00, 0x3c003c00, 0x3c00
.long 0x3c000000, 0x3c003c00, 0x3c003c00, 0x3c003c00
.long 0x0, 0x3c003c00, 0x3c003c00, 0x3c003c00
.long 0x0, 0x3c000000, 0x3c003c00, 0x3c003c00
.long 0x0, 0x0, 0x3c003c00, 0x3c003c00
.long 0x0, 0x0, 0x3c000000, 0x3c003c00
.long 0x0, 0x0, 0x0, 0x3c003c00
.long 0x0, 0x0, 0x0, 0x3c000000
.long 0x0, 0x0, 0x0, 0x0
.long 0x0, 0x0, 0x0, 0x0
.long 0x0, 0x0, 0x0, 0x0
.long 0x0, 0x0, 0x0, 0x0
.long 0x0, 0x0, 0x0, 0x0
.long 0x0, 0x0, 0x0, 0x0
.long 0x0, 0x0, 0x0, 0x0
.long 0x0, 0x0, 0x0, 0x0
.long 0x0, 0x0, 0x0, 0x0
.long 0x0, 0x0, 0x0, 0x0
.long 0x3c00, 0x0, 0x0, 0x0
.long 0x3c003c00, 0x0, 0x0, 0x0
.long 0x3c003c00, 0x3c00, 0x0, 0x0
.long 0x3c003c00, 0x3c003c00, 0x0, 0x0
.long 0x3c003c00, 0x3c003c00, 0x3c00, 0x0
.long 0x3c003c00, 0x3c003c00, 0x3c003c00, 0x0
.long 0x3c003c00, 0x3c003c00, 0x3c003c00, 0x3c00
.long 0x3c000000, 0x3c003c00, 0x3c003c00, 0x3c003c00
.long 0x0, 0x3c003c00, 0x3c003c00, 0x3c003c00
.long 0x0, 0x3c000000, 0x3c003c00, 0x3c003c00
.long 0x0, 0x0, 0x3c003c00, 0x3c003c00
.long 0x0, 0x0, 0x0, 0x0
.long 0x0, 0x0, 0x0, 0x0
.long 0x0, 0x0, 0x0, 0x0
.long 0x0, 0x0, 0x0, 0x0
.long 0x0, 0x0, 0x0, 0x0
.long 0x0, 0x0, 0x0, 0x0
.long 0x0, 0x0, 0x0, 0x0
.long 0x0, 0x0, 0x0, 0x0
.long 0x0, 0x0, 0x0, 0x0
.long 0x0, 0x0, 0x0, 0x0
.long 0x0, 0x0, 0x0, 0x0
.long 0x0, 0x0, 0x0, 0x0
.long 0x0, 0x0, 0x0, 0x0
.long 0x3c00, 0x0, 0x0, 0x0
.long 0x3c003c00, 0x0, 0x0, 0x0
.long 0x3c003c00, 0x3c00, 0x0, 0x0
.long 0x0, 0x0, 0x3c003c00, 0x3c003c00
.long 0x0, 0x0, 0x3c000000, 0x3c003c00
.long 0x0, 0x0, 0x0, 0x3c003c00
.long 0x0, 0x0, 0x0, 0x3c000000
.long 0x0, 0x0, 0x0, 0x0
.long 0x0, 0x0, 0x0, 0x0
.long 0x0, 0x0, 0x0, 0x0
.long 0x0, 0x0, 0x0, 0x0
.long 0x0, 0x0, 0x0, 0x0
.long 0x0, 0x0, 0x0, 0x0
.long 0x0, 0x0, 0x0, 0x0
.long 0x0, 0x0, 0x0, 0x0
.long 0x0, 0x0, 0x0, 0x0
.long 0x0, 0x0, 0x0, 0x0
.long 0x0, 0x0, 0x0, 0x0
.long 0x0, 0x0, 0x0, 0x0
.long 0x3c003c00, 0x3c00, 0x0, 0x0
.long 0x3c003c00, 0x3c003c00, 0x0, 0x0
.long 0x3c003c00, 0x3c003c00, 0x3c00, 0x0
.long 0x3c003c00, 0x3c003c00, 0x3c003c00, 0x0
.long 0x3c003c00, 0x3c003c00, 0x3c003c00, 0x3c00
.long 0x3c000000, 0x3c003c00, 0x3c003c00, 0x3c003c00
.long 0x0, 0x3c003c00, 0x3c003c00, 0x3c003c00
.long 0x0, 0x3c000000, 0x3c003c00, 0x3c003c00
.long 0x0, 0x0, 0x3c003c00, 0x3c003c00
.long 0x0, 0x0, 0x3c000000, 0x3c003c00
.long 0x0, 0x0, 0x0, 0x3c003c00
.long 0x0, 0x0, 0x0, 0x3c000000
.long 0x0, 0x0, 0x0, 0x0
.long 0x0, 0x0, 0x0, 0x0
.long 0x0, 0x0, 0x0, 0x0
.long 0x0, 0x0, 0x0, 0x0
.long 0x0, 0x0, 0x0, 0x0
.long 0x0, 0x0, 0x0, 0x0
.long 0x0, 0x0, 0x0, 0x0
.long 0x0, 0x0, 0x0, 0x0
.long 0x0, 0x0, 0x0, 0x0
.long 0x0, 0x0, 0x0, 0x0
.long 0x3c00, 0x0, 0x0, 0x0
.long 0x3c003c00, 0x0, 0x0, 0x0
.long 0x3c003c00, 0x3c00, 0x0, 0x0
.long 0x3c003c00, 0x3c003c00, 0x0, 0x0
.long 0x3c003c00, 0x3c003c00, 0x3c00, 0x0
.long 0x3c003c00, 0x3c003c00, 0x3c003c00, 0x0
.long 0x3c003c00, 0x3c003c00, 0x3c003c00, 0x3c00
.long 0x3c000000, 0x3c003c00, 0x3c003c00, 0x3c003c00
.long 0x0, 0x3c003c00, 0x3c003c00, 0x3c003c00
.long 0x0, 0x3c000000, 0x3c003c00, 0x3c003c00
.long 0x0, 0x0, 0x0, 0x0
.long 0x0, 0x0, 0x0, 0x0
.long 0x0, 0x0, 0x0, 0x0
.long 0x0, 0x0, 0x0, 0x0
.long 0x0, 0x0, 0x0, 0x0
.long 0x0, 0x0, 0x0, 0x0
.long 0x0, 0x0, 0x0, 0x0
.long 0x0, 0x0, 0x0, 0x0
.long 0x0, 0x0, 0x0, 0x0
.long 0x0, 0x0, 0x0, 0x0
.long 0x0, 0x0, 0x0, 0x0
.long 0x0, 0x0, 0x0, 0x0
.long 0x0, 0x0, 0x0, 0x0
.long 0x0, 0x0, 0x0, 0x0
.long 0x3c00, 0x0, 0x0, 0x0
.long 0x3c003c00, 0x0, 0x0, 0x0

.section .rodata,"a"
.p2align 6
.amdhsa_kernel recurrent_scan__ssm_conv_s4d__moe_arch_mod__prompt_kernel
  .amdhsa_next_free_vgpr 128
  .amdhsa_next_free_sgpr 96
  .amdhsa_accum_offset 128
  .amdhsa_group_segment_fixed_size 0
  .amdhsa_kernarg_size 120
  .amdhsa_user_sgpr_count 2
  .amdhsa_user_sgpr_kernarg_segment_ptr 1
  .amdhsa_system_sgpr_workgroup_id_x 1
.end_amdhsa_kernel
```

```asm
; @launch grid=(256,1,1) block=(768,1,1) lds=152320
.amdgcn_target "amdgcn-amd-amdhsa--gfx950"
.text
.p2align 8
.globl recurrent_scan__ssm_conv_s4d__moe_arch_mod__prompt_kernel
.type recurrent_scan__ssm_conv_s4d__moe_arch_mod__prompt_kernel,@function
recurrent_scan__ssm_conv_s4d__moe_arch_mod__prompt_kernel:
  s_cmp_ge_u32 s2, 256
  s_cbranch_scc1 K_END
  s_load_dwordx2 s[44:45], s[0:1], 0
  s_load_dwordx16 s[4:19], s[0:1], 8
  s_load_dwordx8 s[20:27], s[0:1], 72
  s_load_dwordx4 s[40:43], s[0:1], 104
  v_readfirstlane_b32 s30, v0
  v_and_b32 v1, 63, v0
  s_and_b32 s28, s2, 7
  s_lshr_b32 s29, s2, 3
  s_mov_b32 s31, 0xffff0000
  s_mov_b32 s58, 0x3fb8aa3b
  s_lshr_b32 s30, s30, 6
  s_cmp_ge_u32 s30, 4
  s_cbranch_scc1 K_C
  v_lshlrev_b32 v148, 4, v1
  v_lshrrev_b32 v2, 4, v1
  v_and_b32 v3, 15, v1
  v_lshlrev_b32 v5, 4, v3
  v_lshl_add_u32 v7, v2, 11, v5
  s_lshl3_add_u32 s63, s30, 8
  s_load_dwordx2 s[64:65], s[0:1], s63
  s_setprio 3
  s_cmp_lg_u32 s30, 0
  s_cbranch_scc1 K_NOPF
  s_getpc_b64 s[48:49]
K_PC:
  s_lshl_b32 s50, s29, 10
  s_min_u32 s50, s50, K_BAND - K_PC + 4096
  s_add_u32 s50, s50, s48
  s_addc_u32 s51, s49, 0
  global_load_dwordx4 v[32:35], v148, s[50:51]
K_NOPF:
  s_lshr_b32 s3, s29, 3
  s_lshl_b32 s3, s3, 5
  s_and_b32 s63, s29, 7
  s_add_u32 s3, s3, s63
  s_lshl_b32 s63, s28, 7
  s_add_u32 s3, s3, s63
  s_lshl_b32 s63, s3, 8
  v_add_u32 v7, s63, v7
  s_lshl_b32 s3, s3, 1
  s_and_b32 s3, s3, -64
  s_lshl_b32 s63, s30, 10
  s_add_u32 m0, s63, 78080
  s_lshl2_add_u32 s60, s29, s30
  s_lshl_b32 s61, s60, 15
  s_lshl_b32 s62, s28, 8
  s_add_u32 s61, s61, s62
  v_lshl_add_u32 v149, v2, 12, v5
  v_add_u32 v6, s62, v5
  v_add_u32 v4, s61, v149
  v_add_u32 v96, 0x4000, v4
  v_mov_b32 v166, 0
  v_lshlrev_b32 v97, 2, v1
  s_mov_b32 s38, 0x580000
  ds_write2st64_b32 v97, v166, v166 offset0:0 offset1:2
  s_waitcnt lgkmcnt(0)
  global_load_lds_dwordx4 v7, s[64:65]
  s_load_dword s46, s[42:43], 0x0
  s_load_dword s39, s[42:43], s38
  s_load_dword s47, s[12:13], s3
  s_sleep 1
  global_load_dwordx4 v[8:11], v4, s[44:45]
  global_load_dwordx4 v[12:15], v4, s[44:45] offset:2048
  global_load_dwordx4 v[16:19], v96, s[44:45]
  global_load_dwordx4 v[20:23], v96, s[44:45] offset:2048
  global_load_dwordx4 v[24:27], v6, s[18:19]
  global_load_dwordx4 v[28:31], v6, s[14:15]
  s_barrier
  s_mov_b32 s32, s42
  s_mov_b32 s33, s43
  s_mov_b32 s34, 0x800000
  s_mov_b32 s35, 0x00020000
  s_lshl_b32 s63, s29, 13
  s_lshl_b32 s73, s30, 8
  s_add_u32 s63, s63, s73
  s_add_u32 s63, s63, 0x100000
  s_lshl_b32 s73, s28, 10
  s_add_u32 s73, s73, s63
  s_lshl_b32 s74, s28, 12
  s_add_u32 s74, s74, 0x400000
  s_getreg_b32 s56, hwreg(HW_REG_XCC_ID, 0, 4)
  v_mov_b32 v167, 1
  v_mov_b32 v160, 0xffff0000
  s_mov_b32 s8, 0x0000bf80
  s_mov_b32 s9, 0xbf800000
  v_mov_b32 v132, 0
  v_mov_b32 v133, 0
  v_mov_b32 v134, 0
  v_mov_b32 v135, 0
  v_and_b32 v7, 3, v1
  v_and_b32 v151, 0xf0, v97
  v_lshl_add_u32 v150, v7, 18, v151
  v_lshl_add_u32 v151, v7, 10, v151
  v_and_b32 v152, 0x7c, v97
  s_and_b32 s10, s28, 3
  s_lshl_b32 s10, 0x11111111, s10
  s_not_b32 s10, s10
  s_cmp_lt_u32 s28, 4
  s_cselect_b32 s4, s10, -1
  s_cselect_b32 s6, -1, s10
  s_mov_b32 s5, s4
  s_mov_b32 s7, s6
  s_add_u32 s72, s63, 0x80000
  s_mov_b64 exec, 1
  s_waitcnt vmcnt(6)
  ds_add_u32 v166, v167 offset:12
  s_mov_b64 exec, -1
  s_waitcnt lgkmcnt(0)
  s_add_u32 s46, s46, s39
  s_add_u32 s46, s46, 0x9e3779b9
  v_mov_b32 v115, s46
  v_mov_b32 v119, s46
  s_cmp_lg_u32 s30, 3
  s_cbranch_scc1 K_NOCI
  v_add_u32 v7, s56, v115
  s_lshl_b32 s78, s29, 7
  s_add_u32 s78, s78, s74
  s_mov_b32 exec_hi, 0
  buffer_store_dword v7, v152, s[32:35], s78 offen sc1
  ds_write_b32 v166, v115 offset:0
  s_mov_b32 exec_hi, -1
K_NOCI:
  s_waitcnt vmcnt(5)
  v_and_b32_dpp v140, v8, v160 row_newbcast:0 row_mask:0xf bank_mask:0xf
  v_dot2_f32_bf16 v32, v8, s8, v140
  v_dot2_f32_bf16 v34, v8, s9, v140
  v_dot2_f32_bf16 v36, v9, s8, v140
  v_dot2_f32_bf16 v38, v9, s9, v140
  v_dot2_f32_bf16 v40, v10, s8, v140
  v_dot2_f32_bf16 v42, v10, s9, v140
  v_dot2_f32_bf16 v44, v11, s8, v140
  v_dot2_f32_bf16 v46, v11, s9, v140
  s_waitcnt vmcnt(4)
  v_and_b32_dpp v141, v12, v160 row_newbcast:0 row_mask:0xf bank_mask:0xf
  v_dot2_f32_bf16 v33, v12, s8, v141
  v_dot2_f32_bf16 v35, v12, s9, v141
  v_dot2_f32_bf16 v37, v13, s8, v141
  v_dot2_f32_bf16 v39, v13, s9, v141
  v_dot2_f32_bf16 v41, v14, s8, v141
  v_dot2_f32_bf16 v43, v14, s9, v141
  v_dot2_f32_bf16 v45, v15, s8, v141
  v_dot2_f32_bf16 v47, v15, s9, v141
  v_pk_add_f32 v[120:121], v[32:33], v[34:35]
  v_pk_mul_f32 v[124:125], v[32:33], v[32:33]
  v_pk_add_f32 v[128:129], v[36:37], v[38:39]
  v_pk_mul_f32 v[130:131], v[34:35], v[34:35]
  v_pk_fma_f32 v[124:125], v[36:37], v[36:37], v[124:125]
  v_pk_fma_f32 v[130:131], v[38:39], v[38:39], v[130:131]
  v_pk_fma_f32 v[124:125], v[40:41], v[40:41], v[124:125]
  v_pk_add_f32 v[120:121], v[120:121], v[40:41]
  v_pk_fma_f32 v[130:131], v[42:43], v[42:43], v[130:131]
  v_pk_add_f32 v[128:129], v[128:129], v[42:43]
  v_pk_fma_f32 v[124:125], v[44:45], v[44:45], v[124:125]
  v_pk_add_f32 v[120:121], v[120:121], v[44:45]
  v_pk_fma_f32 v[130:131], v[46:47], v[46:47], v[130:131]
  v_pk_add_f32 v[128:129], v[128:129], v[46:47]
  v_pk_add_f32 v[124:125], v[124:125], v[130:131]
  v_pk_add_f32 v[120:121], v[120:121], v[128:129]
  s_waitcnt vmcnt(3)
  v_and_b32_dpp v142, v16, v160 row_newbcast:0 row_mask:0xf bank_mask:0xf
  v_dot2_f32_bf16 v48, v16, s8, v142
  v_dot2_f32_bf16 v50, v16, s9, v142
  v_dot2_f32_bf16 v52, v17, s8, v142
  v_dot2_f32_bf16 v54, v17, s9, v142
  v_dot2_f32_bf16 v56, v18, s8, v142
  v_dot2_f32_bf16 v58, v18, s9, v142
  v_dot2_f32_bf16 v60, v19, s8, v142
  v_dot2_f32_bf16 v62, v19, s9, v142
  s_waitcnt vmcnt(2)
  v_and_b32_dpp v143, v20, v160 row_newbcast:0 row_mask:0xf bank_mask:0xf
  v_dot2_f32_bf16 v49, v20, s8, v143
  v_dot2_f32_bf16 v51, v20, s9, v143
  v_dot2_f32_bf16 v53, v21, s8, v143
  v_dot2_f32_bf16 v55, v21, s9, v143
  v_dot2_f32_bf16 v57, v22, s8, v143
  v_dot2_f32_bf16 v59, v22, s9, v143
  v_dot2_f32_bf16 v61, v23, s8, v143
  v_dot2_f32_bf16 v63, v23, s9, v143
  v_pk_add_f32 v[122:123], v[48:49], v[50:51]
  v_pk_mul_f32 v[126:127], v[48:49], v[48:49]
  v_pk_add_f32 v[128:129], v[52:53], v[54:55]
  v_pk_mul_f32 v[130:131], v[50:51], v[50:51]
  v_pk_fma_f32 v[126:127], v[52:53], v[52:53], v[126:127]
  v_pk_fma_f32 v[130:131], v[54:55], v[54:55], v[130:131]
  v_pk_fma_f32 v[126:127], v[56:57], v[56:57], v[126:127]
  v_pk_add_f32 v[122:123], v[122:123], v[56:57]
  v_pk_fma_f32 v[130:131], v[58:59], v[58:59], v[130:131]
  v_pk_add_f32 v[128:129], v[128:129], v[58:59]
  v_pk_fma_f32 v[126:127], v[60:61], v[60:61], v[126:127]
  v_pk_add_f32 v[122:123], v[122:123], v[60:61]
  v_pk_fma_f32 v[130:131], v[62:63], v[62:63], v[130:131]
  v_pk_add_f32 v[128:129], v[128:129], v[62:63]
  v_pk_add_f32 v[126:127], v[126:127], v[130:131]
  v_pk_add_f32 v[122:123], v[122:123], v[128:129]
  s_waitcnt vmcnt(1)
  v_dot2c_f32_bf16 v132, v8, v24
  v_dot2c_f32_bf16 v133, v12, v24
  v_dot2c_f32_bf16 v134, v16, v24
  v_dot2c_f32_bf16 v135, v20, v24
  v_dot2c_f32_bf16 v132, v9, v25
  v_dot2c_f32_bf16 v133, v13, v25
  v_dot2c_f32_bf16 v134, v17, v25
  v_dot2c_f32_bf16 v135, v21, v25
  v_dot2c_f32_bf16 v132, v10, v26
  v_dot2c_f32_bf16 v133, v14, v26
  v_dot2c_f32_bf16 v134, v18, v26
  v_dot2c_f32_bf16 v135, v22, v26
  v_dot2c_f32_bf16 v132, v11, v27
  v_dot2c_f32_bf16 v133, v15, v27
  v_dot2c_f32_bf16 v134, v19, v27
  v_dot2c_f32_bf16 v135, v23, v27
  v_mov_b32 v136, v140
  v_add_f32_dpp v120, v120, v120 row_ror:8 row_mask:0xf bank_mask:0x3
  v_add_f32_dpp v122, v122, v122 row_ror:8 row_mask:0xf bank_mask:0x3
  v_add_f32_dpp v124, v124, v124 row_ror:8 row_mask:0xf bank_mask:0x3
  v_add_f32_dpp v126, v126, v126 row_ror:8 row_mask:0xf bank_mask:0x3
  v_mov_b32_dpp v136, v142 quad_perm:[0,1,2,3] row_mask:0xf bank_mask:0x2
  v_add_f32_dpp v120, v121, v121 row_ror:8 row_mask:0xf bank_mask:0xc
  v_add_f32_dpp v122, v123, v123 row_ror:8 row_mask:0xf bank_mask:0xc
  v_add_f32_dpp v124, v125, v125 row_ror:8 row_mask:0xf bank_mask:0xc
  v_add_f32_dpp v126, v127, v127 row_ror:8 row_mask:0xf bank_mask:0xc
  v_add_f32_dpp v132, v132, v132 row_ror:8 row_mask:0xf bank_mask:0x3
  v_add_f32_dpp v134, v134, v134 row_ror:8 row_mask:0xf bank_mask:0x3
  v_mov_b32_dpp v136, v141 quad_perm:[0,1,2,3] row_mask:0xf bank_mask:0x4
  v_add_f32_dpp v132, v133, v133 row_ror:8 row_mask:0xf bank_mask:0xc
  v_add_f32_dpp v134, v135, v135 row_ror:8 row_mask:0xf bank_mask:0xc
  v_add_f32_dpp v112, v120, v120 row_half_mirror row_mask:0xf bank_mask:0x5
  v_add_f32_dpp v113, v124, v124 row_half_mirror row_mask:0xf bank_mask:0x5
  v_add_f32_dpp v114, v132, v132 row_half_mirror row_mask:0xf bank_mask:0x5
  v_add_f32_dpp v112, v122, v122 row_half_mirror row_mask:0xf bank_mask:0xa
  v_add_f32_dpp v113, v126, v126 row_half_mirror row_mask:0xf bank_mask:0xa
  v_add_f32_dpp v114, v134, v134 row_half_mirror row_mask:0xf bank_mask:0xa
  v_mov_b32_dpp v136, v143 quad_perm:[0,1,2,3] row_mask:0xf bank_mask:0x8
  v_add_f32_dpp v112, v112, v112 quad_perm:[1,0,3,2] row_mask:0xf bank_mask:0xf
  v_add_f32_dpp v113, v113, v113 quad_perm:[1,0,3,2] row_mask:0xf bank_mask:0xf
  v_add_f32_dpp v114, v114, v114 quad_perm:[1,0,3,2] row_mask:0xf bank_mask:0xf
  v_add_f32_dpp v112, v112, v112 quad_perm:[2,3,0,1] row_mask:0xf bank_mask:0xf
  v_add_f32_dpp v113, v113, v113 quad_perm:[2,3,0,1] row_mask:0xf bank_mask:0xf
  v_add_f32_dpp v114, v114, v114 quad_perm:[2,3,0,1] row_mask:0xf bank_mask:0xf
  v_mul_f32 v137, 0x3c000000, v112
  v_fma_f32 v113, -v137, v112, v113
  v_sub_f32 v112, v136, v137
  s_mov_b32 exec_lo, 0x77777777
  s_mov_b32 exec_hi, exec_lo
  buffer_store_dwordx4 v[112:115], v150, s[32:35], s73 offen sc1
  s_mov_b64 exec, 1
  ds_add_u32 v166, v167 offset:36
  s_mov_b64 exec, -1
  s_setprio 0
  v_mov_b32 v116, v112
  v_mov_b32 v117, v113
  v_mov_b32 v118, v114
  s_mov_b32 s64, s20
  s_mov_b32 s65, s21
  s_mov_b32 s66, 0x700000
  s_mov_b32 s67, 0x00020000
  s_mov_b32 s68, s22
  s_mov_b32 s69, s23
  s_mov_b32 s70, 0x700000
  s_mov_b32 s71, 0x00020000
  s_cmp_ge_u32 s29, 28
  s_cselect_b32 s66, 0, s66
  s_cselect_b32 s70, 0, s70
  s_and_b32 s12, s30, 2
  s_lshl_b32 s12, s12, 2
  v_lshl_or_b32 v162, v2, 1, s12
  v_xor_b32 v162, v162, v3
  v_mul_u32_u24 v7, 7168, v2
  v_lshl_add_u32 v162, v162, 4, v7
  s_lshl_b32 s12, s28, 5
  s_add_u32 s12, s12, s30
  s_mul_i32 s12, s12, 28672
  s_lshl_b32 s13, s29, 8
  s_add_u32 s12, s12, s13
  s_add_u32 s13, s12, 229376
  s_add_u32 s14, s12, 458752
  s_add_u32 s15, s12, 688128
  s_lshl_b32 s16, s30, 10
  s_add_u32 s16, s16, 84224
  s_mov_b32 s40, s24
  s_mov_b32 s41, s25
  s_mov_b32 s42, 0x700000
  s_mov_b32 s43, 0x00020000
  s_mov_b32 s42, s66
  s_mov_b32 s20, s26
  s_mov_b32 s21, s27
  s_mov_b32 s22, 0x400000
  s_mov_b32 s23, 0x00020000
  s_lshl_b32 s79, s30, 1
  v_and_b32 v7, 3, v1
  v_mul_u32_u24 v154, 4640, v7
  v_lshlrev_b32 v153, 4, v7
  v_lshrrev_b32 v7, 2, v1
  v_lshl_add_u32 v154, v7, 4, v154
  v_lshl_add_u32 v153, v7, 14, v153
  s_lshl_b32 s78, s79, 9
  v_add_u32 v154, s78, v154
  s_lshl_b32 s75, s79, 19
  s_lshl_b32 s78, s28, 8
  s_add_u32 s75, s75, s78
  s_and_b32 s78, s29, 3
  s_lshl_b32 s78, s78, 12
  s_add_u32 s75, s75, s78
  s_and_b32 s78, s29, 4
  s_lshl_b32 s78, s78, 9
  s_add_u32 s75, s75, s78
  s_lshr_b32 s78, s29, 3
  s_lshl_b32 s78, s78, 6
  s_add_u32 s75, s75, s78
  s_add_u32 s76, s75, 0x40000
  s_add_u32 s36, s75, 0x80000
  s_add_u32 s37, s75, 0xc0000
  s_add_u32 s77, s61, 0x4000
  v_mul_u32_u24 v7, 5120, v2
  v_sub_u32 v163, v162, v7
  s_lshl_b32 s18, s29, 5
  s_add_u32 s18, s18, s30
  s_lshl_b32 s18, s18, 13
  s_add_u32 s18, s18, s62
  s_lshl_b32 s19, s30, 10
  v_mov_b32 v158, 0x30003
  v_mov_b32 v159, 0xfffcfffc
  v_mov_b32 v161, 0x80000000
  s_cmp_ge_u32 s29, 28
  s_cselect_b32 s17, 1, 0
  s_mov_b32 s83, 0x20000
  s_lshl_b32 s78, s60, 5
  v_lshl_add_u32 v157, v2, 2, s78
  v_and_b32 v7, 4, v1
  v_lshl_add_u32 v155, v7, 2, v157
  v_bfe_u32 v7, v1, 3, 1
  v_lshl_add_u32 v155, v7, 1, v155
  v_sub_u32 v155, 4094, v155
  s_lshl_b32 s78, s30, 7
  v_lshl_add_u32 v156, v1, 1, s78
  v_lshlrev_b32 v152, 5, v152
  s_setprio 3
  s_branch K_AWB
K_AW:
  s_sleep 1
K_AWB:
  ds_read_b32 v7, v166 offset:36
  s_waitcnt lgkmcnt(0)
  v_cmp_gt_u32 vcc, 4, v7
  s_cbranch_vccnz K_AW
  s_sleep 3
  s_add_u32 s78, s63, 4096
  s_mov_b64 exec, s[4:5]
  s_cbranch_execz K_GA0
  buffer_load_dwordx4 v[112:115], v151, s[32:35], s63 offen sc1
K_GA0:
  s_mov_b64 exec, s[6:7]
  s_cbranch_execz K_GA1
  buffer_load_dwordx4 v[116:119], v151, s[32:35], s78 offen sc1
K_GA1:
  s_mov_b64 exec, -1
  s_cmp_lg_u32 s30, 2
  s_cbranch_scc1 K_NOCR
K_CR:
  buffer_load_dword v7, v152, s[32:35], s74 offen sc1
  s_sub_u32 s83, s83, 1
  s_waitcnt vmcnt(0)
  v_subrev_u32 v7, s46, v7
  s_cbranch_scc1 K_CRD
  v_cmp_lt_u32 vcc, 15, v7
  s_cbranch_vccnz K_CR
K_CRD:
  v_cmp_ne_u32 vcc, s56, v7
  s_max_i32 s83, s83, 0
  s_cmp_lg_u64 vcc, 0
  s_cselect_b32 s78, 2, 1
  v_mov_b32 v7, s78
  ds_write_b32 v166, v7 offset:8
K_NOCR:
  s_waitcnt vmcnt(0)
  s_branch K_P1C
K_P1:
  s_add_u32 s63, s63, 0x40000
  s_min_u32 s63, s63, s72
  s_add_u32 s78, s63, 4096
  s_mov_b64 exec, s[4:5]
  s_cbranch_execz K_GB0
  buffer_load_dwordx4 v[112:115], v151, s[32:35], s63 offen sc1
K_GB0:
  s_mov_b64 exec, s[6:7]
  s_cbranch_execz K_GB1
  buffer_load_dwordx4 v[116:119], v151, s[32:35], s78 offen sc1
K_GB1:
  s_mov_b64 exec, -1
  s_sub_u32 s83, s83, 1
  s_waitcnt vmcnt(0)
  s_cbranch_scc1 K_P1D
K_P1C:
  v_cmp_ne_u32 s[4:5], s46, v115
  v_cmp_ne_u32 s[6:7], s46, v119
  s_nop 0
  s_or_b64 s[78:79], s[4:5], s[6:7]
  s_cbranch_scc1 K_P1
K_P1D:
  s_max_i32 s83, s83, 0
  v_mov_b32_dpp v128, v112 quad_perm:[0,0,0,0] row_mask:0xf bank_mask:0xf
  v_add_f32 v113, v113, v117
  v_add_f32 v114, v114, v118
  v_sub_f32 v112, v112, v128
  v_sub_f32 v116, v116, v128
  v_mul_f32 v129, v112, v112
  v_add_f32 v112, v112, v116
  v_fmac_f32 v129, v116, v116
  v_fmac_f32 v113, 0x43000000, v129
  v_add_f32_dpp v114, v114, v114 quad_perm:[1,0,3,2] row_mask:0xf bank_mask:0xf
  v_add_f32_dpp v112, v112, v112 quad_perm:[1,0,3,2] row_mask:0xf bank_mask:0xf
  v_add_f32_dpp v113, v113, v113 quad_perm:[1,0,3,2] row_mask:0xf bank_mask:0xf
  v_add_f32_dpp v114, v114, v114 quad_perm:[2,3,0,1] row_mask:0xf bank_mask:0xf
  v_add_f32_dpp v112, v112, v112 quad_perm:[2,3,0,1] row_mask:0xf bank_mask:0xf
  v_add_f32_dpp v113, v113, v113 quad_perm:[2,3,0,1] row_mask:0xf bank_mask:0xf
  v_mul_f32 v129, 0x41800000, v112
  v_fmac_f32 v128, 0x3e000000, v112
  v_fma_f32 v113, -v129, v112, v113
  v_mul_f32 v113, 0x3a800000, v113
  v_max_f32 v113, 0, v113
  v_cvt_pk_bf16_f32 v129, v128, v113
  v_and_b32 v113, v160, v129
  v_lshlrev_b32 v128, 16, v129
  v_add_f32 v113, 0x3727c5ac, v113
  v_cvt_pk_bf16_f32 v113, 0, v113
  v_sub_f32 v136, v136, v128
  v_sqrt_f32 v113, v113
  s_nop 0
  v_cvt_pk_bf16_f32 v131, v128, v113
  v_and_b32 v113, v160, v131
  v_rcp_f32 v129, v113
  s_nop 0
  v_mul_f32 v136, v136, v129
  v_mov_b32_dpp v120, v129 row_newbcast:0 row_mask:0xf bank_mask:0xf
  s_nop 0
  v_mov_b32_dpp v122, v136 row_newbcast:0 row_mask:0xf bank_mask:0xf
  v_mov_b32_dpp v121, v129 row_newbcast:8 row_mask:0xf bank_mask:0xf
  v_mov_b32_dpp v123, v136 row_newbcast:8 row_mask:0xf bank_mask:0xf
  v_pk_fma_f32 v[64:65], v[32:33], v[120:121], v[122:123] neg_lo:[1,0,0] neg_hi:[1,0,0]
  v_pk_fma_f32 v[66:67], v[34:35], v[120:121], v[122:123] neg_lo:[1,0,0] neg_hi:[1,0,0]
  v_pk_fma_f32 v[68:69], v[36:37], v[120:121], v[122:123] neg_lo:[1,0,0] neg_hi:[1,0,0]
  v_pk_fma_f32 v[70:71], v[38:39], v[120:121], v[122:123] neg_lo:[1,0,0] neg_hi:[1,0,0]
  v_pk_fma_f32 v[72:73], v[40:41], v[120:121], v[122:123] neg_lo:[1,0,0] neg_hi:[1,0,0]
  v_pk_fma_f32 v[74:75], v[42:43], v[120:121], v[122:123] neg_lo:[1,0,0] neg_hi:[1,0,0]
  v_pk_fma_f32 v[76:77], v[44:45], v[120:121], v[122:123] neg_lo:[1,0,0] neg_hi:[1,0,0]
  v_pk_fma_f32 v[78:79], v[46:47], v[120:121], v[122:123] neg_lo:[1,0,0] neg_hi:[1,0,0]
  v_cvt_pk_f16_f32 v96, v64, v65
  v_cvt_pk_f16_f32 v97, v66, v67
  v_cvt_pk_f16_f32 v98, v68, v69
  v_cvt_pk_f16_f32 v99, v70, v71
  v_cvt_pk_f16_f32 v100, v72, v73
  v_cvt_pk_f16_f32 v101, v74, v75
  v_cvt_pk_f16_f32 v102, v76, v77
  v_cvt_pk_f16_f32 v103, v78, v79
  ds_read2_b32 v[132:133], v166 offset0:2 offset1:1
  v_permlane32_swap_b32 v96, v98
  v_permlane32_swap_b32 v97, v99
  v_permlane32_swap_b32 v100, v102
  v_permlane32_swap_b32 v101, v103
  v_permlane16_swap_b32 v96, v97
  v_permlane16_swap_b32 v98, v99
  v_permlane16_swap_b32 v100, v101
  v_permlane16_swap_b32 v102, v103
  s_waitcnt lgkmcnt(0)
  v_readfirstlane_b32 s47, v132
  v_readfirstlane_b32 s78, v133
  v_and_b32 v96, v159, v96
  v_or_b32 v97, v158, v97
  v_or_b32 v98, v158, v98
  v_and_b32 v99, v159, v99
  v_and_b32 v100, v159, v100
  v_or_b32 v101, v158, v101
  v_or_b32 v102, v158, v102
  v_and_b32 v103, v159, v103
  s_min_u32 s78, s78, s47
  s_cmp_eq_u32 s78, 0
  s_cbranch_scc1 K_RARE
K_RB:
  s_sub_u32 s47, s47, 1
  s_cmp_lg_u32 s47, 0
  s_cbranch_scc1 K_US0_W
  buffer_store_dwordx4 v[96:99], v149, s[20:23], s61 offen offset:0
  buffer_store_dwordx4 v[100:103], v149, s[20:23], s61 offen offset:2048
  s_branch K_US0_D
K_US0_W:
  buffer_store_dwordx4 v[96:99], v149, s[20:23], s61 offen offset:0 sc1
  buffer_store_dwordx4 v[100:103], v149, s[20:23], s61 offen offset:2048 sc1
K_US0_D:
  v_mov_b32_dpp v124, v129 row_newbcast:4 row_mask:0xf bank_mask:0xf
  v_mov_b32_dpp v126, v136 row_newbcast:4 row_mask:0xf bank_mask:0xf
  v_mov_b32_dpp v125, v129 row_newbcast:12 row_mask:0xf bank_mask:0xf
  v_mov_b32_dpp v127, v136 row_newbcast:12 row_mask:0xf bank_mask:0xf
  v_pk_fma_f32 v[80:81], v[48:49], v[124:125], v[126:127] neg_lo:[1,0,0] neg_hi:[1,0,0]
  v_pk_fma_f32 v[82:83], v[50:51], v[124:125], v[126:127] neg_lo:[1,0,0] neg_hi:[1,0,0]
  v_pk_fma_f32 v[84:85], v[52:53], v[124:125], v[126:127] neg_lo:[1,0,0] neg_hi:[1,0,0]
  v_pk_fma_f32 v[86:87], v[54:55], v[124:125], v[126:127] neg_lo:[1,0,0] neg_hi:[1,0,0]
  v_pk_fma_f32 v[88:89], v[56:57], v[124:125], v[126:127] neg_lo:[1,0,0] neg_hi:[1,0,0]
  v_pk_fma_f32 v[90:91], v[58:59], v[124:125], v[126:127] neg_lo:[1,0,0] neg_hi:[1,0,0]
  v_pk_fma_f32 v[92:93], v[60:61], v[124:125], v[126:127] neg_lo:[1,0,0] neg_hi:[1,0,0]
  v_pk_fma_f32 v[94:95], v[62:63], v[124:125], v[126:127] neg_lo:[1,0,0] neg_hi:[1,0,0]
  v_cvt_pk_f16_f32 v104, v80, v81
  v_cvt_pk_f16_f32 v105, v82, v83
  v_cvt_pk_f16_f32 v106, v84, v85
  v_cvt_pk_f16_f32 v107, v86, v87
  v_cvt_pk_f16_f32 v108, v88, v89
  v_cvt_pk_f16_f32 v109, v90, v91
  v_cvt_pk_f16_f32 v110, v92, v93
  v_cvt_pk_f16_f32 v111, v94, v95
  v_permlane32_swap_b32 v104, v106
  v_permlane32_swap_b32 v105, v107
  v_permlane32_swap_b32 v108, v110
  v_permlane32_swap_b32 v109, v111
  v_permlane16_swap_b32 v104, v105
  v_permlane16_swap_b32 v106, v107
  v_permlane16_swap_b32 v108, v109
  v_permlane16_swap_b32 v110, v111
  v_and_b32 v104, v159, v104
  v_or_b32 v105, v158, v105
  v_or_b32 v106, v158, v106
  v_and_b32 v107, v159, v107
  v_and_b32 v108, v159, v108
  v_or_b32 v109, v158, v109
  v_or_b32 v110, v158, v110
  v_and_b32 v111, v159, v111
  s_cmp_lg_u32 s47, 0
  s_cbranch_scc1 K_US1_W
  buffer_store_dwordx4 v[104:107], v149, s[20:23], s77 offen offset:0
  buffer_store_dwordx4 v[108:111], v149, s[20:23], s77 offen offset:2048
  s_branch K_US1_D
K_US1_W:
  buffer_store_dwordx4 v[104:107], v149, s[20:23], s77 offen offset:0 sc1
  buffer_store_dwordx4 v[108:111], v149, s[20:23], s77 offen offset:2048 sc1
K_US1_D:
  buffer_load_dwordx4 v[96:99], v153, s[20:23], s75 offen sc1
  buffer_load_dwordx4 v[100:103], v153, s[20:23], s76 offen sc1
  buffer_load_dwordx4 v[104:107], v153, s[20:23], s36 offen sc1
  buffer_load_dwordx4 v[108:111], v153, s[20:23], s37 offen sc1
  v_fma_f32 v130, -v128, v133, v114
  v_mul_f32 v130, v130, v129
  v_cvt_pk_bf16_f32 v130, v130, v130
  v_ashrrev_i32 v134, 31, v130
  v_bitop3_b32 v130, v130, v134, v161 bitop3:0x1e
  v_and_or_b32 v130, v130, v160, v155
  s_mov_b32 exec_lo, 0x11111111
  s_mov_b32 exec_hi, 0x11111111
  ds_write_b64 v156, v[130:131] offset:128
  s_mov_b64 exec, 1
  ds_add_u32 v166, v167 offset:20
  s_mov_b64 exec, -1
  s_setprio 0
  v_pk_mul_f32 v[8:9], v[64:65], s[58:59] op_sel_hi:[1,0]
  v_pk_mul_f32 v[10:11], v[66:67], s[58:59] op_sel_hi:[1,0]
  v_pk_mul_f32 v[12:13], v[68:69], s[58:59] op_sel_hi:[1,0]
  v_pk_mul_f32 v[14:15], v[70:71], s[58:59] op_sel_hi:[1,0]
  v_exp_f32 v8, -v8
  v_lshlrev_b32 v16, 16, v28
  v_exp_f32 v9, -v9
  v_pk_add_f32 v[32:33], v[140:141], v[32:33] neg_lo:[0,1] neg_hi:[0,1]
  v_exp_f32 v10, -v10
  v_and_b32 v18, 0xffff0000, v28
  v_exp_f32 v11, -v11
  v_pk_add_f32 v[34:35], v[140:141], v[34:35] neg_lo:[0,1] neg_hi:[0,1]
  v_exp_f32 v12, -v12
  v_lshlrev_b32 v20, 16, v29
  v_exp_f32 v13, -v13
  v_pk_add_f32 v[36:37], v[140:141], v[36:37] neg_lo:[0,1] neg_hi:[0,1]
  v_exp_f32 v14, -v14
  v_and_b32 v22, 0xffff0000, v29
  v_exp_f32 v15, -v15
  v_pk_add_f32 v[38:39], v[140:141], v[38:39] neg_lo:[0,1] neg_hi:[0,1]
  v_pk_add_f32 v[8:9], v[8:9], 1.0 op_sel_hi:[1,0]
  v_pk_add_f32 v[10:11], v[10:11], 1.0 op_sel_hi:[1,0]
  v_pk_add_f32 v[12:13], v[12:13], 1.0 op_sel_hi:[1,0]
  v_pk_add_f32 v[14:15], v[14:15], 1.0 op_sel_hi:[1,0]
  v_rcp_f32 v8, v8
  v_pk_mul_f32 v[16:17], v[64:65], v[16:17] op_sel_hi:[1,0]
  v_rcp_f32 v9, v9
  v_rcp_f32 v10, v10
  v_pk_mul_f32 v[18:19], v[66:67], v[18:19] op_sel_hi:[1,0]
  v_rcp_f32 v11, v11
  v_rcp_f32 v12, v12
  v_pk_mul_f32 v[20:21], v[68:69], v[20:21] op_sel_hi:[1,0]
  v_rcp_f32 v13, v13
  v_rcp_f32 v14, v14
  v_pk_mul_f32 v[22:23], v[70:71], v[22:23] op_sel_hi:[1,0]
  v_rcp_f32 v15, v15
  v_pk_mul_f32 v[8:9], v[8:9], v[64:65]
  v_pk_mul_f32 v[10:11], v[10:11], v[66:67]
  v_pk_mul_f32 v[12:13], v[12:13], v[68:69]
  v_pk_mul_f32 v[14:15], v[14:15], v[70:71]
  v_pk_fma_f32 v[32:33], v[16:17], v[8:9], v[32:33]
  v_cvt_pk_bf16_f32 v64, v8, 0
  v_cvt_pk_bf16_f32 v65, 0, v9
  v_pk_fma_f32 v[34:35], v[18:19], v[10:11], v[34:35]
  v_cvt_pk_bf16_f32 v66, v10, 0
  v_cvt_pk_bf16_f32 v67, 0, v11
  v_pk_fma_f32 v[36:37], v[20:21], v[12:13], v[36:37]
  v_cvt_pk_bf16_f32 v68, v12, 0
  v_cvt_pk_bf16_f32 v69, 0, v13
  v_pk_fma_f32 v[38:39], v[22:23], v[14:15], v[38:39]
  v_cvt_pk_bf16_f32 v70, v14, 0
  v_cvt_pk_bf16_f32 v71, 0, v15
  v_pk_mul_f32 v[8:9], v[72:73], s[58:59] op_sel_hi:[1,0]
  v_pk_mul_f32 v[10:11], v[74:75], s[58:59] op_sel_hi:[1,0]
  v_pk_mul_f32 v[12:13], v[76:77], s[58:59] op_sel_hi:[1,0]
  v_pk_mul_f32 v[14:15], v[78:79], s[58:59] op_sel_hi:[1,0]
  v_exp_f32 v8, -v8
  v_lshlrev_b32 v16, 16, v30
  v_exp_f32 v9, -v9
  v_pk_add_f32 v[40:41], v[140:141], v[40:41] neg_lo:[0,1] neg_hi:[0,1]
  v_exp_f32 v10, -v10
  v_and_b32 v18, 0xffff0000, v30
  v_exp_f32 v11, -v11
  v_pk_add_f32 v[42:43], v[140:141], v[42:43] neg_lo:[0,1] neg_hi:[0,1]
  v_exp_f32 v12, -v12
  v_lshlrev_b32 v20, 16, v31
  v_exp_f32 v13, -v13
  v_pk_add_f32 v[44:45], v[140:141], v[44:45] neg_lo:[0,1] neg_hi:[0,1]
  v_exp_f32 v14, -v14
  v_and_b32 v22, 0xffff0000, v31
  v_exp_f32 v15, -v15
  v_pk_add_f32 v[46:47], v[140:141], v[46:47] neg_lo:[0,1] neg_hi:[0,1]
  v_pk_add_f32 v[8:9], v[8:9], 1.0 op_sel_hi:[1,0]
  v_pk_add_f32 v[10:11], v[10:11], 1.0 op_sel_hi:[1,0]
  v_pk_add_f32 v[12:13], v[12:13], 1.0 op_sel_hi:[1,0]
  v_pk_add_f32 v[14:15], v[14:15], 1.0 op_sel_hi:[1,0]
  v_rcp_f32 v8, v8
  v_pk_mul_f32 v[16:17], v[72:73], v[16:17] op_sel_hi:[1,0]
  v_rcp_f32 v9, v9
  v_rcp_f32 v10, v10
  v_pk_mul_f32 v[18:19], v[74:75], v[18:19] op_sel_hi:[1,0]
  v_rcp_f32 v11, v11
  v_rcp_f32 v12, v12
  v_pk_mul_f32 v[20:21], v[76:77], v[20:21] op_sel_hi:[1,0]
  v_rcp_f32 v13, v13
  v_rcp_f32 v14, v14
  v_pk_mul_f32 v[22:23], v[78:79], v[22:23] op_sel_hi:[1,0]
  v_rcp_f32 v15, v15
  v_pk_mul_f32 v[8:9], v[8:9], v[72:73]
  v_pk_mul_f32 v[10:11], v[10:11], v[74:75]
  v_pk_mul_f32 v[12:13], v[12:13], v[76:77]
  v_pk_mul_f32 v[14:15], v[14:15], v[78:79]
  v_pk_fma_f32 v[40:41], v[16:17], v[8:9], v[40:41]
  v_cvt_pk_bf16_f32 v72, v8, 0
  v_cvt_pk_bf16_f32 v73, 0, v9
  v_pk_fma_f32 v[42:43], v[18:19], v[10:11], v[42:43]
  v_cvt_pk_bf16_f32 v74, v10, 0
  v_cvt_pk_bf16_f32 v75, 0, v11
  v_pk_fma_f32 v[44:45], v[20:21], v[12:13], v[44:45]
  v_cvt_pk_bf16_f32 v76, v12, 0
  v_cvt_pk_bf16_f32 v77, 0, v13
  v_pk_fma_f32 v[46:47], v[22:23], v[14:15], v[46:47]
  v_cvt_pk_bf16_f32 v78, v14, 0
  v_cvt_pk_bf16_f32 v79, 0, v15
  v_pk_mul_f32 v[8:9], v[80:81], s[58:59] op_sel_hi:[1,0]
  v_pk_mul_f32 v[10:11], v[82:83], s[58:59] op_sel_hi:[1,0]
  v_pk_mul_f32 v[12:13], v[84:85], s[58:59] op_sel_hi:[1,0]
  v_pk_mul_f32 v[14:15], v[86:87], s[58:59] op_sel_hi:[1,0]
  v_exp_f32 v8, -v8
  v_lshlrev_b32 v16, 16, v28
  v_exp_f32 v9, -v9
  v_pk_add_f32 v[48:49], v[142:143], v[48:49] neg_lo:[0,1] neg_hi:[0,1]
  v_exp_f32 v10, -v10
  v_and_b32 v18, 0xffff0000, v28
  v_exp_f32 v11, -v11
  v_pk_add_f32 v[50:51], v[142:143], v[50:51] neg_lo:[0,1] neg_hi:[0,1]
  v_exp_f32 v12, -v12
  v_lshlrev_b32 v20, 16, v29
  v_exp_f32 v13, -v13
  v_pk_add_f32 v[52:53], v[142:143], v[52:53] neg_lo:[0,1] neg_hi:[0,1]
  v_exp_f32 v14, -v14
  v_and_b32 v22, 0xffff0000, v29
  v_exp_f32 v15, -v15
  v_pk_add_f32 v[54:55], v[142:143], v[54:55] neg_lo:[0,1] neg_hi:[0,1]
  v_pk_add_f32 v[8:9], v[8:9], 1.0 op_sel_hi:[1,0]
  v_pk_add_f32 v[10:11], v[10:11], 1.0 op_sel_hi:[1,0]
  v_pk_add_f32 v[12:13], v[12:13], 1.0 op_sel_hi:[1,0]
  v_pk_add_f32 v[14:15], v[14:15], 1.0 op_sel_hi:[1,0]
  v_rcp_f32 v8, v8
  v_pk_mul_f32 v[16:17], v[80:81], v[16:17] op_sel_hi:[1,0]
  v_rcp_f32 v9, v9
  v_rcp_f32 v10, v10
  v_pk_mul_f32 v[18:19], v[82:83], v[18:19] op_sel_hi:[1,0]
  v_rcp_f32 v11, v11
  v_rcp_f32 v12, v12
  v_pk_mul_f32 v[20:21], v[84:85], v[20:21] op_sel_hi:[1,0]
  v_rcp_f32 v13, v13
  v_rcp_f32 v14, v14
  v_pk_mul_f32 v[22:23], v[86:87], v[22:23] op_sel_hi:[1,0]
  v_rcp_f32 v15, v15
  v_pk_mul_f32 v[8:9], v[8:9], v[80:81]
  v_pk_mul_f32 v[10:11], v[10:11], v[82:83]
  v_pk_mul_f32 v[12:13], v[12:13], v[84:85]
  v_pk_mul_f32 v[14:15], v[14:15], v[86:87]
  v_pk_fma_f32 v[48:49], v[16:17], v[8:9], v[48:49]
  v_cvt_pk_bf16_f32 v80, v8, 0
  v_cvt_pk_bf16_f32 v81, 0, v9
  v_pk_fma_f32 v[50:51], v[18:19], v[10:11], v[50:51]
  v_cvt_pk_bf16_f32 v82, v10, 0
  v_cvt_pk_bf16_f32 v83, 0, v11
  v_pk_fma_f32 v[52:53], v[20:21], v[12:13], v[52:53]
  v_cvt_pk_bf16_f32 v84, v12, 0
  v_cvt_pk_bf16_f32 v85, 0, v13
  v_pk_fma_f32 v[54:55], v[22:23], v[14:15], v[54:55]
  v_cvt_pk_bf16_f32 v86, v14, 0
  v_cvt_pk_bf16_f32 v87, 0, v15
  s_setprio 3
  s_mov_b32 s38, 15
  s_waitcnt vmcnt(0)
  s_branch K_P2A
K_P2:
  s_waitcnt vmcnt(0)
K_P2A:
  s_sub_u32 s83, s83, 1
  s_cselect_b32 s39, 0, 0x30003
  v_bitop3_b32 v128, v96, v99, v97 bitop3:0xfd
  v_bitop3_b32 v128, v128, v98, s39 bitop3:0xa2
  v_bitop3_b32 v129, v100, v103, v101 bitop3:0xfd
  v_bitop3_b32 v129, v129, v102, s39 bitop3:0xa2
  v_bitop3_b32 v130, v104, v107, v105 bitop3:0xfd
  v_bitop3_b32 v130, v130, v106, s39 bitop3:0xa2
  v_bitop3_b32 v131, v108, v111, v109 bitop3:0xfd
  v_bitop3_b32 v131, v131, v110, s39 bitop3:0xa2
  v_cmp_ne_u32 s[4:5], 0, v128
  v_cmp_ne_u32 s[6:7], 0, v129
  v_cmp_ne_u32 s[8:9], 0, v130
  v_cmp_ne_u32 s[10:11], 0, v131
  s_cmp_eq_u64 s[4:5], 0
  s_cbranch_scc1 K_Q0
  buffer_load_dwordx4 v[96:99], v153, s[20:23], s75 offen sc1
K_Q0:
  s_cmp_eq_u64 s[6:7], 0
  s_cbranch_scc1 K_Q1
  buffer_load_dwordx4 v[100:103], v153, s[20:23], s76 offen sc1
K_Q1:
  s_cmp_eq_u64 s[8:9], 0
  s_cbranch_scc1 K_Q2
  buffer_load_dwordx4 v[104:107], v153, s[20:23], s36 offen sc1
K_Q2:
  s_cmp_eq_u64 s[10:11], 0
  s_cbranch_scc1 K_Q3
  buffer_load_dwordx4 v[108:111], v153, s[20:23], s37 offen sc1
K_Q3:
  s_cmp_lg_u64 s[4:5], 0
  s_cbranch_scc1 K_R0
  s_bitcmp0_b32 s38, 0
  s_cbranch_scc1 K_R0
  ds_write_b128 v154, v[96:99] offset:1312
  s_bitset0_b32 s38, 0
K_R0:
  s_cmp_lg_u64 s[6:7], 0
  s_cbranch_scc1 K_R1
  s_bitcmp0_b32 s38, 1
  s_cbranch_scc1 K_R1
  ds_write_b128 v154, v[100:103] offset:1568
  s_bitset0_b32 s38, 1
K_R1:
  s_cmp_lg_u64 s[8:9], 0
  s_cbranch_scc1 K_R2
  s_bitcmp0_b32 s38, 2
  s_cbranch_scc1 K_R2
  ds_write_b128 v154, v[104:107] offset:1824
  s_bitset0_b32 s38, 2
K_R2:
  s_cmp_lg_u64 s[10:11], 0
  s_cbranch_scc1 K_R3
  s_bitcmp0_b32 s38, 3
  s_cbranch_scc1 K_R3
  ds_write_b128 v154, v[108:111] offset:2080
  s_bitset0_b32 s38, 3
K_R3:
  s_cmp_lg_u32 s38, 0
  s_cbranch_scc1 K_P2
  s_max_i32 s83, s83, 0
  s_mov_b64 exec, 1
  ds_add_u32 v166, v167 offset:16
  s_mov_b64 exec, -1
  s_cmp_ge_u32 s29, 28
  s_cbranch_scc1 K_NOTL
  s_cmp_lg_u32 s17, 0
  s_cbranch_scc1 K_UD
  s_mov_b64 exec, 1
  ds_add_u32 v166, v167 offset:40
  s_mov_b64 exec, -1
  s_branch K_UGB
K_UG:
  s_sleep 1
K_UGB:
  ds_read_b32 v7, v166 offset:40
  s_waitcnt lgkmcnt(0)
  v_cmp_gt_u32 vcc, 4, v7
  s_cbranch_vccnz K_UG
  s_add_u32 m0, s16, 57344
  s_add_u32 s78, s15, 114688
  buffer_load_dwordx4 v162, s[68:71], s15 offen nt lds
  s_add_u32 m0, s16, 61440
  s_nop 0
  buffer_load_dwordx4 v162, s[68:71], s78 offen nt lds
K_UD:
  s_waitcnt vmcnt(0)
  s_branch K_HGB
K_HG:
  s_sleep 1
K_HGB:
  ds_read2_b32 v[128:129], v166 offset0:28 offset1:30
  s_waitcnt lgkmcnt(0)
  v_add_u32 v128, v128, v129
  v_cmp_gt_u32 vcc, 9, v128
  s_cbranch_vccnz K_HG
  s_add_u32 m0, s19, 19328
  s_nop 0
  buffer_load_dwordx4 v163, s[40:43], s18 offen nt lds
  s_add_u32 s18, s18, 32768
  s_add_u32 m0, s19, 23424
  s_nop 0
  buffer_load_dwordx4 v163, s[40:43], s18 offen nt lds
  s_add_u32 s18, s18, 32768
  s_mov_b64 exec, 1
  s_waitcnt vmcnt(2)
  ds_add_u32 v166, v167 offset:24
  s_mov_b64 exec, -1
  s_add_u32 m0, s19, 27520
  s_nop 0
  buffer_load_dwordx4 v163, s[40:43], s18 offen nt lds
  s_add_u32 s18, s18, 32768
  s_add_u32 m0, s19, 31616
  s_nop 0
  buffer_load_dwordx4 v163, s[40:43], s18 offen nt lds
  s_add_u32 s18, s18, 32768
  s_add_u32 m0, s19, 35712
  s_nop 0
  buffer_load_dwordx4 v163, s[40:43], s18 offen nt lds
  s_add_u32 s18, s18, 32768
  s_add_u32 m0, s19, 39808
  s_nop 0
  buffer_load_dwordx4 v163, s[40:43], s18 offen nt lds
  s_add_u32 s18, s18, 32768
  s_add_u32 m0, s19, 43904
  s_nop 0
  buffer_load_dwordx4 v163, s[40:43], s18 offen nt lds
  s_add_u32 s18, s18, 32768
  s_add_u32 m0, s19, 48000
  s_nop 0
  buffer_load_dwordx4 v163, s[40:43], s18 offen nt lds
  s_branch K_TLD
K_NOTL:
  s_branch K_TLB
K_TL:
  s_sleep 8
K_TLB:
  ds_read_b32 v7, v166 offset:120
  s_waitcnt lgkmcnt(0)
  v_cmp_eq_u32 vcc, 0, v7
  s_cbranch_vccnz K_TL
K_TLD:
  s_setprio 0
  ds_read_b128 v[128:131], v166 offset:96
  s_waitcnt lgkmcnt(0)
  v_readfirstlane_b32 s6, v128
  v_readfirstlane_b32 s7, v130
  s_andn2_b32 s6, 0xffe, s6
  s_andn2_b32 s7, 0xffe, s7
  s_lshr_b32 s78, s6, 5
  s_lshr_b32 s79, s7, 5
  s_cmp_eq_u32 s78, s60
  s_cselect_b32 s57, 0x55555555, 0
  s_cmp_eq_u32 s79, s60
  s_cselect_b32 s79, 0xaaaaaaaa, 0
  s_mov_b64 s[48:49], -1
  s_mov_b64 s[50:51], -1
  s_mov_b64 s[52:53], -1
  s_mov_b64 s[54:55], -1
  s_or_b32 s57, s57, s79
  s_cbranch_scc0 K_NOOW1
  v_add_u32 v7, 0, v157
  v_cmp_ne_u32 s[48:49], s6, v7
  v_cmp_ne_u32 vcc, s7, v7
  s_nop 0
  s_and_b64 s[48:49], s[48:49], vcc
  v_add_u32 v7, 2, v157
  v_cmp_ne_u32 s[50:51], s6, v7
  v_cmp_ne_u32 vcc, s7, v7
  s_nop 0
  s_and_b64 s[50:51], s[50:51], vcc
  v_add_u32 v7, 16, v157
  v_cmp_ne_u32 s[52:53], s6, v7
  v_cmp_ne_u32 vcc, s7, v7
  s_nop 0
  s_and_b64 s[52:53], s[52:53], vcc
  v_add_u32 v7, 18, v157
  v_cmp_ne_u32 s[54:55], s6, v7
  v_cmp_ne_u32 vcc, s7, v7
  s_nop 0
  s_and_b64 s[54:55], s[54:55], vcc
  v_mul_f32 v9, 0x3fb8aa3b, v89
  v_mul_f32 v8, 0x3fb8aa3b, v88
  v_mul_f32 v11, 0x3fb8aa3b, v91
  v_mul_f32 v10, 0x3fb8aa3b, v90
  v_mul_f32 v13, 0x3fb8aa3b, v93
  v_mul_f32 v12, 0x3fb8aa3b, v92
  v_mul_f32 v15, 0x3fb8aa3b, v95
  v_mul_f32 v14, 0x3fb8aa3b, v94
  v_exp_f32 v8, -v8
  v_lshlrev_b32 v16, 16, v30
  v_exp_f32 v9, -v9
  v_sub_f32 v57, v143, v57
  v_sub_f32 v56, v142, v56
  v_exp_f32 v10, -v10
  v_and_b32 v18, 0xffff0000, v30
  v_exp_f32 v11, -v11
  v_sub_f32 v59, v143, v59
  v_sub_f32 v58, v142, v58
  v_exp_f32 v12, -v12
  v_lshlrev_b32 v20, 16, v31
  v_exp_f32 v13, -v13
  v_sub_f32 v61, v143, v61
  v_sub_f32 v60, v142, v60
  v_exp_f32 v14, -v14
  v_and_b32 v22, 0xffff0000, v31
  v_exp_f32 v15, -v15
  v_sub_f32 v63, v143, v63
  v_sub_f32 v62, v142, v62
  v_add_f32 v9, 1.0, v9
  v_add_f32 v8, 1.0, v8
  v_add_f32 v11, 1.0, v11
  v_add_f32 v10, 1.0, v10
  v_add_f32 v13, 1.0, v13
  v_add_f32 v12, 1.0, v12
  v_add_f32 v15, 1.0, v15
  v_add_f32 v14, 1.0, v14
  v_rcp_f32 v8, v8
  v_mul_f32 v17, v89, v16
  v_mul_f32 v16, v88, v16
  v_rcp_f32 v9, v9
  v_rcp_f32 v10, v10
  v_mul_f32 v19, v91, v18
  v_mul_f32 v18, v90, v18
  v_rcp_f32 v11, v11
  v_rcp_f32 v12, v12
  v_mul_f32 v21, v93, v20
  v_mul_f32 v20, v92, v20
  v_rcp_f32 v13, v13
  v_rcp_f32 v14, v14
  v_mul_f32 v23, v95, v22
  v_mul_f32 v22, v94, v22
  v_rcp_f32 v15, v15
  v_mul_f32 v9, v9, v89
  v_mul_f32 v8, v8, v88
  v_mul_f32 v11, v11, v91
  v_mul_f32 v10, v10, v90
  v_mul_f32 v13, v13, v93
  v_mul_f32 v12, v12, v92
  v_mul_f32 v15, v15, v95
  v_mul_f32 v14, v14, v94
  v_fma_f32 v57, v17, v9, v57
  v_fma_f32 v56, v16, v8, v56
  v_cvt_pk_bf16_f32 v88, v8, 0
  v_cvt_pk_bf16_f32 v89, 0, v9
  v_fma_f32 v59, v19, v11, v59
  v_fma_f32 v58, v18, v10, v58
  v_cvt_pk_bf16_f32 v90, v10, 0
  v_cvt_pk_bf16_f32 v91, 0, v11
  v_fma_f32 v61, v21, v13, v61
  v_fma_f32 v60, v20, v12, v60
  v_cvt_pk_bf16_f32 v92, v12, 0
  v_cvt_pk_bf16_f32 v93, 0, v13
  v_fma_f32 v63, v23, v15, v63
  v_fma_f32 v62, v22, v14, v62
  v_cvt_pk_bf16_f32 v94, v14, 0
  v_cvt_pk_bf16_f32 v95, 0, v15
K_NOOW1:
  v_and_b32 v7, 3, v1
  v_mul_u32_u24 v7, 480, v7
  v_sub_u32 v154, v154, v7
  s_lshl_b32 s78, s30, 9
  v_subrev_u32 v154, s78, v154
  s_lshl_b32 s78, s30, 19
  s_sub_u32 s75, s75, s78
  s_sub_u32 s76, s76, s78
  s_lshl_b32 s78, s30, 2
  s_lshr_b32 s78, 0xc480, s78
  s_and_b32 s78, s78, 15
  v_mov_b32 v159, s78
  s_mov_b32 s78, 4
  s_mov_b64 exec, 1
  s_waitcnt vmcnt(0)
  ds_add_u32 v166, v167 offset:124
  s_mov_b64 exec, -1
  s_branch K_HW4B
K_HW4:
  s_sleep 6
K_HW4B:
  ds_read_b32 v7, v159 offset:48
  s_waitcnt lgkmcnt(0)
  v_cmp_gt_u32 vcc, 4, v7
  s_cbranch_vccnz K_HW4
  s_setprio 3
  s_branch K_YWB
K_YW:
K_YWB:
  ds_read_b128 v[128:131], v166 offset:48
  ds_read_b128 v[120:123], v154 offset:56320
  ds_read_b128 v[124:127], v154 offset:56576
  s_waitcnt lgkmcnt(2)
  v_min_u32 v128, v128, v129
  v_min3_u32 v128, v128, v130, v131
  v_cmp_gt_u32 vcc, s78, v128
  s_cbranch_vccnz K_YW
  s_waitcnt lgkmcnt(0)
  v_bitop3_b32 v128, v120, v121, v158 bitop3:0xa2
  v_bitop3_b32 v129, v124, v125, v158 bitop3:0xa2
  v_cmp_eq_u32 vcc, 0, v128
  v_cmp_eq_u32 s[4:5], 0, v129
  s_nop 0
  v_addc_co_u32 v120, vcc, 0, v120, vcc
  v_addc_co_u32 v124, vcc, 0, v124, s[4:5]
  s_cmp_lg_u32 s47, 0
  s_cbranch_scc1 K_YS_W
  buffer_store_dwordx4 v[120:123], v153, s[20:23], s75 offen
  buffer_store_dwordx4 v[124:127], v153, s[20:23], s76 offen
  s_branch K_YS_D
K_YS_W:
  buffer_store_dwordx4 v[120:123], v153, s[20:23], s75 offen sc1
  buffer_store_dwordx4 v[124:127], v153, s[20:23], s76 offen sc1
K_YS_D:
  s_add_u32 s75, s75, 0x200000
  s_add_u32 s76, s76, 0x200000
  v_add_u32 v154, 2048, v154
  s_add_u32 s78, s78, 4
  s_cmp_gt_u32 s78, 8
  s_cbranch_scc1 K_SENT
  s_branch K_HW8B
K_HW8:
  s_sleep 1
K_HW8B:
  ds_read_b32 v7, v159 offset:48
  s_waitcnt lgkmcnt(0)
  v_cmp_gt_u32 vcc, 8, v7
  s_cbranch_vccnz K_HW8
  s_branch K_YWB
K_SENT:
  s_cmp_eq_u32 s57, 0
  s_cbranch_scc1 K_NOOWN
  s_setprio 3
K_PO:
  buffer_load_dwordx4 v[96:99], v149, s[20:23], s61 offen offset:0 sc1
  buffer_load_dwordx4 v[100:103], v149, s[20:23], s61 offen offset:2048 sc1
  buffer_load_dwordx4 v[104:107], v149, s[20:23], s77 offen offset:0 sc1
  buffer_load_dwordx4 v[108:111], v149, s[20:23], s77 offen offset:2048 sc1
  s_sub_u32 s83, s83, 1
  s_waitcnt vmcnt(0)
  s_cbranch_scc1 K_POD
  v_bitop3_b32 v128, v96, v97, v158 bitop3:0xa2
  v_bitop3_b32 v129, v100, v101, v158 bitop3:0xa2
  v_bitop3_b32 v130, v104, v105, v158 bitop3:0xa2
  v_bitop3_b32 v131, v108, v109, v158 bitop3:0xa2
  v_cmp_eq_u32 s[4:5], 0, v128
  v_cmp_eq_u32 s[6:7], 0, v129
  v_cmp_eq_u32 s[8:9], 0, v130
  v_cmp_eq_u32 s[10:11], 0, v131
  s_andn2_b64 s[4:5], s[4:5], s[48:49]
  s_andn2_b64 s[6:7], s[6:7], s[50:51]
  s_andn2_b64 s[8:9], s[8:9], s[52:53]
  s_andn2_b64 s[10:11], s[10:11], s[54:55]
  s_or_b64 s[4:5], s[4:5], s[6:7]
  s_or_b64 s[8:9], s[8:9], s[10:11]
  s_or_b64 s[4:5], s[4:5], s[8:9]
  s_cbranch_scc1 K_PO
K_POD:
  s_max_i32 s83, s83, 0
  v_mov_b32 v132, 0
  v_mov_b32 v133, 0
  v_mov_b32 v134, s46
  v_lshlrev_b32 v7, 5, v1
  s_mov_b32 exec_lo, s57
  s_mov_b32 exec_hi, s57
  s_lshl_b32 s78, s28, 16
  s_add_u32 s78, s78, 0x50e000
  s_cmp_lg_u32 s47, 0
  s_cbranch_scc1 K_OS_W
  buffer_store_dwordx3 v[132:134], v7, s[32:35], s78 offen
  s_branch K_OS_D
K_OS_W:
  buffer_store_dwordx3 v[132:134], v7, s[32:35], s78 offen sc1
K_OS_D:
  s_mov_b64 exec, -1
  s_branch K_PYC
K_NOOWN:
  s_setprio 2
  v_pk_mul_f32 v[8:9], v[88:89], s[58:59] op_sel_hi:[1,0]
  v_pk_mul_f32 v[10:11], v[90:91], s[58:59] op_sel_hi:[1,0]
  v_pk_mul_f32 v[12:13], v[92:93], s[58:59] op_sel_hi:[1,0]
  v_pk_mul_f32 v[14:15], v[94:95], s[58:59] op_sel_hi:[1,0]
  v_exp_f32 v8, -v8
  v_lshlrev_b32 v16, 16, v30
  v_exp_f32 v9, -v9
  v_pk_add_f32 v[56:57], v[142:143], v[56:57] neg_lo:[0,1] neg_hi:[0,1]
  v_exp_f32 v10, -v10
  v_and_b32 v18, 0xffff0000, v30
  v_exp_f32 v11, -v11
  v_pk_add_f32 v[58:59], v[142:143], v[58:59] neg_lo:[0,1] neg_hi:[0,1]
  v_exp_f32 v12, -v12
  v_lshlrev_b32 v20, 16, v31
  v_exp_f32 v13, -v13
  v_pk_add_f32 v[60:61], v[142:143], v[60:61] neg_lo:[0,1] neg_hi:[0,1]
  v_exp_f32 v14, -v14
  v_and_b32 v22, 0xffff0000, v31
  v_exp_f32 v15, -v15
  v_pk_add_f32 v[62:63], v[142:143], v[62:63] neg_lo:[0,1] neg_hi:[0,1]
  v_pk_add_f32 v[8:9], v[8:9], 1.0 op_sel_hi:[1,0]
  v_pk_add_f32 v[10:11], v[10:11], 1.0 op_sel_hi:[1,0]
  v_pk_add_f32 v[12:13], v[12:13], 1.0 op_sel_hi:[1,0]
  v_pk_add_f32 v[14:15], v[14:15], 1.0 op_sel_hi:[1,0]
  v_rcp_f32 v8, v8
  v_pk_mul_f32 v[16:17], v[88:89], v[16:17] op_sel_hi:[1,0]
  v_rcp_f32 v9, v9
  v_rcp_f32 v10, v10
  v_pk_mul_f32 v[18:19], v[90:91], v[18:19] op_sel_hi:[1,0]
  v_rcp_f32 v11, v11
  v_rcp_f32 v12, v12
  v_pk_mul_f32 v[20:21], v[92:93], v[20:21] op_sel_hi:[1,0]
  v_rcp_f32 v13, v13
  v_rcp_f32 v14, v14
  v_pk_mul_f32 v[22:23], v[94:95], v[22:23] op_sel_hi:[1,0]
  v_rcp_f32 v15, v15
  v_pk_mul_f32 v[8:9], v[8:9], v[88:89]
  v_pk_mul_f32 v[10:11], v[10:11], v[90:91]
  v_pk_mul_f32 v[12:13], v[12:13], v[92:93]
  v_pk_mul_f32 v[14:15], v[14:15], v[94:95]
  v_pk_fma_f32 v[56:57], v[16:17], v[8:9], v[56:57]
  v_cvt_pk_bf16_f32 v88, v8, 0
  v_cvt_pk_bf16_f32 v89, 0, v9
  v_pk_fma_f32 v[58:59], v[18:19], v[10:11], v[58:59]
  v_cvt_pk_bf16_f32 v90, v10, 0
  v_cvt_pk_bf16_f32 v91, 0, v11
  v_pk_fma_f32 v[60:61], v[20:21], v[12:13], v[60:61]
  v_cvt_pk_bf16_f32 v92, v12, 0
  v_cvt_pk_bf16_f32 v93, 0, v13
  v_pk_fma_f32 v[62:63], v[22:23], v[14:15], v[62:63]
  v_cvt_pk_bf16_f32 v94, v14, 0
  v_cvt_pk_bf16_f32 v95, 0, v15
  buffer_load_dwordx4 v[96:99], v149, s[20:23], s61 offen offset:0 sc1
  buffer_load_dwordx4 v[100:103], v149, s[20:23], s61 offen offset:2048 sc1
  buffer_load_dwordx4 v[104:107], v149, s[20:23], s77 offen offset:0 sc1
  buffer_load_dwordx4 v[108:111], v149, s[20:23], s77 offen offset:2048 sc1
  s_waitcnt vmcnt(0)
  s_branch K_PYC
K_PY:
  s_mov_b64 exec, s[4:5]
  s_cbranch_execz K_PY0
  buffer_load_dwordx4 v[96:99], v149, s[20:23], s61 offen offset:0 sc1
K_PY0:
  s_mov_b64 exec, s[6:7]
  s_cbranch_execz K_PY1
  buffer_load_dwordx4 v[100:103], v149, s[20:23], s61 offen offset:2048 sc1
K_PY1:
  s_mov_b64 exec, s[8:9]
  s_cbranch_execz K_PY2
  buffer_load_dwordx4 v[104:107], v149, s[20:23], s77 offen offset:0 sc1
K_PY2:
  s_mov_b64 exec, s[10:11]
  s_cbranch_execz K_PY3
  buffer_load_dwordx4 v[108:111], v149, s[20:23], s77 offen offset:2048 sc1
K_PY3:
  s_mov_b64 exec, -1
  s_sub_u32 s83, s83, 1
  s_waitcnt vmcnt(0)
  s_cbranch_scc1 K_PYD
K_PYC:
  v_bitop3_b32 v128, v96, v97, v158 bitop3:0xa2
  v_bitop3_b32 v129, v100, v101, v158 bitop3:0xa2
  v_bitop3_b32 v130, v104, v105, v158 bitop3:0xa2
  v_bitop3_b32 v131, v108, v109, v158 bitop3:0xa2
  v_cmp_eq_u32 s[4:5], 0, v128
  v_cmp_eq_u32 s[6:7], 0, v129
  v_cmp_eq_u32 s[8:9], 0, v130
  v_cmp_eq_u32 s[10:11], 0, v131
  s_or_b64 s[12:13], s[4:5], s[6:7]
  s_or_b64 s[14:15], s[8:9], s[10:11]
  s_or_b64 s[12:13], s[12:13], s[14:15]
  s_cbranch_scc1 K_PY
K_PYD:
  v_permlane32_swap_b32 v96, v98
  v_permlane32_swap_b32 v97, v99
  v_permlane32_swap_b32 v100, v102
  v_permlane32_swap_b32 v101, v103
  v_permlane16_swap_b32 v96, v97
  v_permlane16_swap_b32 v98, v99
  v_permlane16_swap_b32 v100, v101
  v_permlane16_swap_b32 v102, v103
  v_dot2c_f32_bf16 v32, v96, v64
  v_dot2c_f32_bf16 v34, v97, v66
  v_dot2c_f32_bf16 v36, v98, v68
  v_dot2c_f32_bf16 v38, v99, v70
  v_dot2c_f32_bf16 v40, v100, v72
  v_dot2c_f32_bf16 v42, v101, v74
  v_dot2c_f32_bf16 v44, v102, v76
  v_dot2c_f32_bf16 v46, v103, v78
  v_dot2c_f32_bf16 v33, v96, v65
  v_dot2c_f32_bf16 v35, v97, v67
  v_dot2c_f32_bf16 v37, v98, v69
  v_dot2c_f32_bf16 v39, v99, v71
  v_dot2c_f32_bf16 v41, v100, v73
  v_dot2c_f32_bf16 v43, v101, v75
  v_dot2c_f32_bf16 v45, v102, v77
  v_dot2c_f32_bf16 v47, v103, v79
  v_cvt_pk_bf16_f32 v8, v32, v34
  v_cvt_pk_bf16_f32 v9, v36, v38
  v_cvt_pk_bf16_f32 v10, v40, v42
  v_cvt_pk_bf16_f32 v11, v44, v46
  s_mov_b64 exec, s[48:49]
  buffer_store_dwordx4 v[8:11], v149, s[20:23], s61 offen offset:0
  s_mov_b64 exec, -1
  v_cvt_pk_bf16_f32 v12, v33, v35
  v_cvt_pk_bf16_f32 v13, v37, v39
  v_cvt_pk_bf16_f32 v14, v41, v43
  v_cvt_pk_bf16_f32 v15, v45, v47
  s_mov_b64 exec, s[50:51]
  buffer_store_dwordx4 v[12:15], v149, s[20:23], s61 offen offset:2048
  s_mov_b64 exec, -1
  v_permlane32_swap_b32 v104, v106
  v_permlane32_swap_b32 v105, v107
  v_permlane32_swap_b32 v108, v110
  v_permlane32_swap_b32 v109, v111
  v_permlane16_swap_b32 v104, v105
  v_permlane16_swap_b32 v106, v107
  v_permlane16_swap_b32 v108, v109
  v_permlane16_swap_b32 v110, v111
  v_dot2c_f32_bf16 v48, v104, v80
  v_dot2c_f32_bf16 v50, v105, v82
  v_dot2c_f32_bf16 v52, v106, v84
  v_dot2c_f32_bf16 v54, v107, v86
  v_dot2c_f32_bf16 v56, v108, v88
  v_dot2c_f32_bf16 v58, v109, v90
  v_dot2c_f32_bf16 v60, v110, v92
  v_dot2c_f32_bf16 v62, v111, v94
  v_dot2c_f32_bf16 v49, v104, v81
  v_dot2c_f32_bf16 v51, v105, v83
  v_dot2c_f32_bf16 v53, v106, v85
  v_dot2c_f32_bf16 v55, v107, v87
  v_dot2c_f32_bf16 v57, v108, v89
  v_dot2c_f32_bf16 v59, v109, v91
  v_dot2c_f32_bf16 v61, v110, v93
  v_dot2c_f32_bf16 v63, v111, v95
  v_cvt_pk_bf16_f32 v16, v48, v50
  v_cvt_pk_bf16_f32 v17, v52, v54
  v_cvt_pk_bf16_f32 v18, v56, v58
  v_cvt_pk_bf16_f32 v19, v60, v62
  s_mov_b64 exec, s[52:53]
  buffer_store_dwordx4 v[16:19], v149, s[20:23], s77 offen offset:0
  s_mov_b64 exec, -1
  v_cvt_pk_bf16_f32 v20, v49, v51
  v_cvt_pk_bf16_f32 v21, v53, v55
  v_cvt_pk_bf16_f32 v22, v57, v59
  v_cvt_pk_bf16_f32 v23, v61, v63
  s_mov_b64 exec, s[54:55]
  buffer_store_dwordx4 v[20:23], v149, s[20:23], s77 offen offset:2048
  s_mov_b64 exec, -1
  s_endpgm
K_RARE:
  s_sleep 1
  ds_read2_b32 v[132:133], v166 offset0:2 offset1:1
  s_waitcnt lgkmcnt(0)
  v_readfirstlane_b32 s47, v132
  v_readfirstlane_b32 s78, v133
  s_nop 0
  s_min_u32 s78, s78, s47
  s_cmp_eq_u32 s78, 0
  s_cbranch_scc1 K_RARE
  s_branch K_RB
.p2align 6
K_C:
  s_sub_u32 s30, s30, 4
  s_setprio 2
  s_lshr_b32 s3, s29, 3
  s_lshl_b32 s3, s3, 5
  s_and_b32 s55, s29, 7
  s_add_u32 s3, s3, s55
  s_lshl_b32 s55, s28, 7
  s_add_u32 s3, s3, s55
  s_lshr_b32 s59, s30, 1
  s_lshl_b32 s55, s59, 3
  s_add_u32 s56, s3, s55
  s_lshl_b32 s57, s56, 1
  s_and_b32 s57, s57, -4
  v_lshlrev_b32 v95, 4, v1
  v_and_b32 v96, 15, v1
  v_lshrrev_b32 v97, 4, v1
  v_mov_b32 v20, 0
  v_mov_b32 v21, 0
  v_mov_b32 v22, 0
  v_mov_b32 v23, 0
  s_mov_b32 s34, 0x800000
  s_mov_b32 s35, 0x00020000
  s_waitcnt lgkmcnt(0)
  s_load_dword s47, s[12:13], s57
  s_mov_b32 s32, s42
  s_mov_b32 s33, s43
  s_barrier
  s_mov_b32 m0, 82176
  s_cmp_lg_u32 s30, 2
  s_cbranch_scc1 K_NOT
  s_lshl_b32 s60, s28, 16
  s_lshl_b32 s61, s29, 11
  s_add_u32 s60, s60, s61
  s_add_u32 s60, s60, 0x500000
  buffer_load_dwordx4 v95, s[32:35], s60 offen sc1 lds
  buffer_load_dwordx4 v95, s[32:35], s60 offen offset:1024 sc1 lds
  s_lshl_b32 s61, s28, 10
  s_add_u32 s61, s61, 0x441000
  buffer_load_dwordx4 v95, s[32:35], s61 offen sc1 lds
  s_add_u32 s61, s61, 0xffbc1000
K_NOT:
  s_cmp_lg_u32 s30, 1
  s_cbranch_scc1 K_NOSM
  global_load_dwordx4 v[128:131], v95, s[18:19]
  global_load_dwordx4 v[132:135], v95, s[18:19] offset:1024
K_NOSM:
  s_cmp_lt_u32 s30, 3
  s_cbranch_scc1 K_NOBD
  s_getpc_b64 s[60:61]
K_PC2:
  s_lshl_b32 s62, s30, 10
  s_add_u32 m0, s62, 69888
  s_add_u32 s62, s62, K_BAND - K_PC2 - 3072
  s_add_u32 s60, s60, s62
  s_addc_u32 s61, s61, 0
  global_load_lds_dwordx4 v95, s[60:61]
K_NOBD:
  s_mov_b32 s4, s20
  s_mov_b32 s5, s21
  s_mov_b32 s6, 0x700000
  s_mov_b32 s7, 0x00020000
  s_mov_b32 s8, s22
  s_mov_b32 s9, s23
  s_mov_b32 s10, 0x700000
  s_mov_b32 s11, 0x00020000
  s_cmp_ge_u32 s29, 28
  s_cselect_b32 s6, 0, s6
  s_cselect_b32 s10, 0, s10
  s_and_b32 s16, s30, 2
  s_lshl_b32 s16, s16, 2
  v_lshl_or_b32 v88, v97, 1, s16
  v_xor_b32 v88, v88, v96
  v_mul_u32_u24 v18, 7168, v97
  v_lshl_add_u32 v88, v88, 4, v18
  s_lshl_b32 s16, s28, 5
  s_add_u32 s16, s16, s30
  s_mul_i32 s16, s16, 28672
  s_lshl_b32 s17, s29, 8
  s_add_u32 s16, s16, s17
  s_add_u32 s17, s16, 229376
  s_add_u32 s18, s16, 458752
  s_add_u32 s19, s16, 688128
  s_lshl_b32 s36, s30, 10
  s_add_u32 s36, s36, 84224
  s_add_u32 m0, s36, 0
  s_nop 0
  buffer_load_dwordx4 v88, s[4:7], s16 offen nt lds
  s_mov_b32 s52, s59
  s_lshr_b32 s53, s30, 2
  s_xor_b32 s53, s53, s30
  s_and_b32 s53, s53, 1
  s_mul_i32 s66, s52, 4640
  s_add_u32 s66, s66, 768
  v_add_u32 v11, s66, v95
  s_mov_b32 exec_hi, 3
  ds_write_b128 v11, v[20:23]
  s_mov_b32 exec_hi, -1
  s_mul_i32 s68, s52, 4160
  s_add_u32 s68, s68, 56320
  s_lshl_b32 s67, s53, 11
  s_add_u32 s67, s67, s68
  v_add_u32 v90, s67, v95
  ds_write_b128 v90, v[20:23]
  ds_write_b128 v90, v[20:23] offset:1024
  s_mov_b32 s67, 0x32a57060
  s_mov_b32 s71, 0x3f317218
  s_lshl_b32 s61, s30, 2
  v_mov_b32 v92, s61
  s_xor_b32 s61, s61, 4
  v_mov_b32 v93, s61
  s_mul_i32 s69, s52, 9216
  s_add_u32 s69, s69, 19328
  s_xor_b32 s70, s53, 1
  s_mul_i32 s70, s70, 4608
  s_add_u32 s70, s70, s69
  s_sub_u32 m0, s70, 16384
  v_mul_u32_u24 v41, 288, v96
  v_lshl_add_u32 v41, v97, 4, v41
  v_add_u32 v41, s70, v41
  v_add_u32 v99, s69, v95
  s_lshl_b32 s60, s52, 8
  s_add_u32 s60, s60, 78080
  v_lshl_add_u32 v17, v1, 2, s60
  s_lshl_b32 s61, s53, 7
  s_add_u32 s60, s60, s61
  v_lshl_add_u32 v16, v1, 1, s60
  v_mov_b32 v2, 0
  v_mov_b32 v3, 0
  v_mov_b32 v4, 0
  v_mov_b32 v5, 0
  v_mov_b32 v42, 0x3c00
  s_mov_b32 s37, m0
  s_mov_b32 s72, -1
  s_mov_b32 s73, 0
  s_cmp_eq_u32 s53, 0
  s_cbranch_scc0 K_HA
  v_lshlrev_b32 v124, 8, v97
  v_lshl_add_u32 v124, v96, 4, v124
  v_sub_u32 v124, 562, v124
  v_add_u32 v124, s68, v124
  v_lshrrev_b32 v125, 1, v97
  v_lshlrev_b32 v125, 8, v125
  v_lshl_add_u32 v125, v96, 4, v125
  v_and_b32 v30, 1, v97
  v_lshl_add_u32 v125, v30, 3, v125
  v_sub_u32 v125, 1080, v125
  v_add_u32 v125, s68, v125
  v_add_u32 v126, 2, v124
  v_add_u32 v127, 1986, v124
  v_lshlrev_b32 v12, 5, v96
  v_lshl_add_u32 v9, v97, 3, v12
  v_lshl_add_u32 v12, v97, 4, v12
  v_add_u32 v12, s66, v12
  v_add_u32 v9, s68, v9
  v_add_u32 v13, 72960, v95
  v_and_b32 v11, 1, v96
  v_xor_b32 v11, 1, v11
  v_mul_u32_u24 v11, 1986, v11
  v_lshlrev_b32 v10, 1, v96
  v_sub_u32 v11, v11, v10
  s_add_u32 s78, s68, 30
  v_add_u32 v11, s78, v11
  v_lshl_add_u32 v10, v97, 4, v11
  v_lshl_add_u32 v14, v97, 3, v11
  v_add_u32 v14, 1120, v14
  v_add_u32 v11, 512, v10
  s_lshl_b32 s79, s52, 2
  v_mov_b32 v15, s79
  v_mov_b32 v8, 0
  s_branch K_AD
K_HA:
  v_and_b32 v28, 1, v96
  v_lshrrev_b32 v29, 1, v96
  v_lshlrev_b32 v124, 8, v28
  v_lshlrev_b32 v30, 1, v29
  v_sub_u32 v124, v124, v30
  v_lshlrev_b32 v125, 5, v97
  v_sub_u32 v124, v124, v125
  v_add_u32 v124, 1390, v124
  v_add_u32 v124, s68, v124
  v_lshlrev_b32 v125, 1, v28
  v_sub_u32 v125, v124, v125
  v_add_u32 v125, -126, v125
  v_mul_u32_u24 v126, 158, v28
  v_sub_u32 v126, v126, v30
  v_lshlrev_b32 v31, 6, v97
  v_sub_u32 v126, v126, v31
  v_add_u32 v126, 1712, v126
  v_add_u32 v126, s68, v126
  v_lshrrev_b32 v28, 2, v96
  v_lshl_add_u32 v11, v97, 3, v28
  v_lshlrev_b32 v11, 8, v11
  v_and_b32 v29, 1, v97
  v_lshl_or_b32 v28, v29, 2, v28
  v_lshl_or_b32 v11, v28, 5, v11
  v_and_b32 v28, 3, v1
  s_lshl_b32 s78, s52, 6
  v_xor_b32 v11, s78, v11
  v_lshlrev_b32 v9, 4, v28
  v_xor_b32 v9, v9, v11
  v_add_u32 v9, 19328, v9
  v_lshl_add_u32 v11, v28, 3, v11
  v_xor_b32 v12, 32, v11
  v_add_u32 v11, 84224, v11
  v_add_u32 v12, 84224, v12
  v_lshlrev_b32 v8, 6, v28
  v_and_b32 v29, 12, v1
  v_lshl_add_u32 v8, v29, 2, v8
  v_mul_u32_u24 v10, 320, v28
  v_lshl_add_u32 v10, v97, 4, v10
  v_add_u32 v10, 149760, v10
  v_lshrrev_b32 v28, 5, v1
  v_and_b32 v29, 31, v1
  v_lshlrev_b32 v14, 4, v29
  v_lshl_add_u32 v14, v28, 11, v14
  v_mul_u32_u24 v13, 320, v28
  v_lshl_add_u32 v13, v29, 1, v13
  s_add_u32 s78, s78, 151040
  v_add_u32 v13, s78, v13
  v_mov_b32 v15, 0
K_AD:
  s_waitcnt lgkmcnt(0)
  s_lshl_b32 s60, s47, 16
  s_and_b32 s61, s47, s31
  s_bitcmp1_b32 s56, 0
  s_cselect_b32 s60, s61, s60
  v_mov_b32 v116, s60
  v_mul_f32 v118, s58, v116
  v_fma_f32 v119, v116, s58, -v118
  v_exp_f32 v117, v118
  v_fmac_f32 v119, s67, v116
  v_mul_f32 v119, s71, v119
  v_fmac_f32 v117, v117, v119
  v_cvt_pk_bf16_f32 v117, 0, v117
  v_mul_f32 v91, s58, v117
  v_mul_f32 v90, 0.15915494, v117
  s_branch K_PWB
K_PW:
  s_sleep 1
K_PWB:
  ds_read_b32 v18, v20 offset:12
  s_waitcnt lgkmcnt(0)
  v_cmp_gt_u32 vcc, 4, v18
  s_cbranch_vccnz K_PW
  ds_read_u16_d16_hi v2, v16
  ds_read_u16_d16_hi v3, v16 offset:1024
  ds_read_b32 v6, v17 offset:2048
  ds_read_b32 v7, v17 offset:3072
  ds_read_u16_d16_hi v4, v16 offset:2048
  ds_read_u16_d16_hi v5, v16 offset:3072
  s_waitcnt lgkmcnt(5)
  v_mul_f32 v2, 0x3fb8aa3b, v2
  s_waitcnt lgkmcnt(4)
  v_mul_f32 v118, v3, v90
  v_exp_f32 v116, v2
  v_mul_f32 v119, 0x43000000, v118
  v_fract_f32 v118, v118
  v_fract_f32 v119, v119
  s_waitcnt lgkmcnt(2)
  v_and_b32 v6, 0x7fff7fff, v6
  v_and_b32 v7, 0x7fff7fff, v7
  v_cvt_pk_bf16_f32 v116, v116, v116
  v_pk_max_u16 v6, v6, v7
  v_and_b32 v116, 0xffff0000, v116
  v_pk_max_u16 v6, v6, v6 op_sel:[0,1] op_sel_hi:[1,0]
  v_mul_f32 v116, v116, v91
  v_sin_f32 v26, v119
  v_mul_f32 v120, 0x43000000, v116
  v_max_u32_dpp v6, v6, v6 quad_perm:[1,0,3,2] row_mask:0xf bank_mask:0xf
  v_exp_f32 v116, -v116
  v_cos_f32 v27, v119
  v_max_u32_dpp v6, v6, v6 quad_perm:[2,3,0,1] row_mask:0xf bank_mask:0xf
  v_cos_f32 v119, v118
  v_sin_f32 v118, v118
  v_max_u32_dpp v6, v6, v6 row_half_mirror row_mask:0xf bank_mask:0xf
  v_exp_f32 v120, -v120
  v_mul_f32 v119, v119, v116
  v_max_u32_dpp v6, v6, v6 row_mirror row_mask:0xf bank_mask:0xf
  v_mul_f32 v118, v118, v116
  v_mul_f32 v26, v26, v120
  v_max_u32_dpp v6, v6, v6 row_bcast:15 row_mask:0xa bank_mask:0xf
  v_mul_f32 v27, v27, v120
  v_add_f32 v117, v117, v117
  v_max_u32_dpp v6, v6, v6 row_bcast:31 row_mask:0xc bank_mask:0xf
  v_pk_mul_f32 v[24:25], v[118:119], v[118:119] op_sel:[1,0] op_sel_hi:[1,1]
  v_mul_f32 v6, v6, v117
  v_pk_fma_f32 v[24:25], v[118:119], v[118:119], v[24:25] op_sel:[1,0,0] op_sel_hi:[0,0,1] neg_hi:[1,0,0]
  v_readlane_b32 s78, v6, 63
  s_nop 0
  s_lshr_b32 s78, s78, 23
  s_max_u32 s78, s78, 33
  s_min_u32 s78, s78, 233
  s_sub_u32 s70, s78, 6
  s_sub_u32 s78, 260, s78
  s_lshl_b32 s70, s70, 23
  s_lshl_b32 s78, s78, 23
  v_mul_f32 v117, s78, v117
  s_waitcnt lgkmcnt(0)
  v_mul_f32 v33, v4, v117
  v_mul_f32 v32, v5, v117
  v_pk_mul_f32 v[120:121], v[24:25], v[24:25] op_sel:[1,0] op_sel_hi:[1,1]
  s_add_u32 m0, s36, 32768
  s_nop 0
  buffer_load_dwordx4 v88, s[8:11], s16 offen nt lds
  s_mov_b32 m0, s37
  v_cvt_pk_f16_f32 v100, v33, -v32
  v_cvt_pk_f16_f32 v101, v119, -v118
  v_pk_fma_f32 v[120:121], v[24:25], v[24:25], v[120:121] op_sel:[1,0,0] op_sel_hi:[0,0,1] neg_hi:[1,0,0]
  v_cvt_pk_f16_f32 v102, v25, -v24
  v_pk_mul_f16 v103, v100, v101 op_sel:[0,0] op_sel_hi:[0,1]
  v_pk_mul_f32 v[122:123], v[120:121], v[120:121] op_sel:[1,0] op_sel_hi:[1,1]
  v_pk_mul_f16 v104, v100, v102 op_sel:[0,0] op_sel_hi:[0,1]
  v_pk_fma_f16 v103, v100, v101, v103 op_sel:[1,1,0] op_sel_hi:[1,0,1] neg_lo:[1,0,0]
  v_pk_fma_f32 v[122:123], v[120:121], v[120:121], v[122:123] op_sel:[1,0,0] op_sel_hi:[0,0,1] neg_hi:[1,0,0]
  v_pk_fma_f16 v104, v100, v102, v104 op_sel:[1,1,0] op_sel_hi:[1,0,1] neg_lo:[1,0,0]
  v_pk_mul_f32 v[16:17], v[24:25], v[118:119] op_sel:[1,0] op_sel_hi:[1,1]
  v_pk_mul_f32 v[18:19], v[122:123], v[122:123] op_sel:[1,0] op_sel_hi:[1,1]
  v_cvt_pk_f16_f32 v105, v121, -v120
  v_pk_fma_f32 v[16:17], v[118:119], v[24:25], v[16:17] op_sel:[1,0,0] op_sel_hi:[0,0,1] neg_hi:[1,0,0]
  v_pk_fma_f32 v[18:19], v[122:123], v[122:123], v[18:19] op_sel:[1,0,0] op_sel_hi:[0,0,1] neg_hi:[1,0,0]
  v_pk_mul_f16 v106, v100, v105 op_sel:[0,0] op_sel_hi:[0,1]
  v_cvt_pk_f16_f32 v107, v17, -v16
  v_pk_mul_f32 v[20:21], v[18:19], v[18:19] op_sel:[1,0] op_sel_hi:[1,1]
  v_pk_fma_f16 v106, v100, v105, v106 op_sel:[1,1,0] op_sel_hi:[1,0,1] neg_lo:[1,0,0]
  v_pk_mul_f16 v108, v100, v107 op_sel:[0,0] op_sel_hi:[0,1]
  v_pk_fma_f32 v[20:21], v[18:19], v[18:19], v[20:21] op_sel:[1,0,0] op_sel_hi:[0,0,1] neg_hi:[1,0,0]
  v_pk_mul_f16 v109, v105, v101 op_sel:[0,0] op_sel_hi:[0,1]
  v_pk_fma_f16 v108, v100, v107, v108 op_sel:[1,1,0] op_sel_hi:[1,0,1] neg_lo:[1,0,0]
  v_pk_mul_f32 v[22:23], v[20:21], v[20:21] op_sel:[1,0] op_sel_hi:[1,1]
  v_pk_fma_f16 v109, v105, v101, v109 op_sel:[1,1,0] op_sel_hi:[1,0,1] neg_lo:[1,0,0]
  v_pk_mul_f16 v110, v105, v102 op_sel:[0,0] op_sel_hi:[0,1]
  v_pk_fma_f32 v[22:23], v[20:21], v[20:21], v[22:23] op_sel:[1,0,0] op_sel_hi:[0,0,1] neg_hi:[1,0,0]
  v_pk_mul_f16 v111, v100, v109 op_sel:[0,0] op_sel_hi:[0,1]
  v_pk_fma_f16 v110, v105, v102, v110 op_sel:[1,1,0] op_sel_hi:[1,0,1] neg_lo:[1,0,0]
  v_pk_mul_f16 v112, v105, v107 op_sel:[0,0] op_sel_hi:[0,1]
  v_pk_fma_f16 v111, v100, v109, v111 op_sel:[1,1,0] op_sel_hi:[1,0,1] neg_lo:[1,0,0]
  v_pk_mul_f16 v113, v100, v110 op_sel:[0,0] op_sel_hi:[0,1]
  v_pk_fma_f16 v112, v105, v107, v112 op_sel:[1,1,0] op_sel_hi:[1,0,1] neg_lo:[1,0,0]
  v_pk_mul_f32 v[28:29], v[32:33], v[26:27] op_sel:[1,0] op_sel_hi:[1,1]
  v_pk_fma_f16 v113, v100, v110, v113 op_sel:[1,1,0] op_sel_hi:[1,0,1] neg_lo:[1,0,0]
  v_pk_mul_f16 v114, v100, v112 op_sel:[0,0] op_sel_hi:[0,1]
  v_pk_fma_f32 v[28:29], v[26:27], v[32:33], v[28:29] op_sel:[1,0,0] op_sel_hi:[0,0,1] neg_hi:[1,0,0]
  v_cvt_pk_f16_f32 v115, v123, v122
  v_pk_fma_f16 v114, v100, v112, v114 op_sel:[1,1,0] op_sel_hi:[1,0,1] neg_lo:[1,0,0]
  v_cvt_pk_f16_f32 v116, v29, -v28
  v_cvt_pk_f16_f32 v117, v19, v18
  ds_write_addtid_b32 v100 offset:16384
  ds_write_addtid_b32 v103 offset:16672
  ds_write_addtid_b32 v104 offset:16960
  ds_write_addtid_b32 v108 offset:17248
  ds_write_addtid_b32 v106 offset:17536
  ds_write_addtid_b32 v111 offset:17824
  ds_write_addtid_b32 v113 offset:18112
  ds_write_addtid_b32 v114 offset:18400
  s_add_u32 m0, s36, 8192
  s_nop 0
  buffer_load_dwordx4 v88, s[4:7], s17 offen nt lds
  s_mov_b32 m0, s37
  v_pk_mul_f16 v2, v116, v101 op_sel:[0,0] op_sel_hi:[0,1]
  v_pk_mul_f16 v3, v116, v102 op_sel:[0,0] op_sel_hi:[0,1]
  v_pk_mul_f16 v4, v116, v107 op_sel:[0,0] op_sel_hi:[0,1]
  v_pk_fma_f16 v2, v116, v101, v2 op_sel:[1,1,0] op_sel_hi:[1,0,1] neg_lo:[1,0,0]
  v_pk_fma_f16 v3, v116, v102, v3 op_sel:[1,1,0] op_sel_hi:[1,0,1] neg_lo:[1,0,0]
  v_pk_fma_f16 v4, v116, v107, v4 op_sel:[1,1,0] op_sel_hi:[1,0,1] neg_lo:[1,0,0]
  v_pk_mul_f16 v5, v116, v105 op_sel:[0,0] op_sel_hi:[0,1]
  v_pk_mul_f16 v6, v116, v109 op_sel:[0,0] op_sel_hi:[0,1]
  v_pk_mul_f16 v7, v116, v110 op_sel:[0,0] op_sel_hi:[0,1]
  v_pk_fma_f16 v5, v116, v105, v5 op_sel:[1,1,0] op_sel_hi:[1,0,1] neg_lo:[1,0,0]
  v_pk_fma_f16 v6, v116, v109, v6 op_sel:[1,1,0] op_sel_hi:[1,0,1] neg_lo:[1,0,0]
  v_pk_fma_f16 v7, v116, v110, v7 op_sel:[1,1,0] op_sel_hi:[1,0,1] neg_lo:[1,0,0]
  v_pk_mul_f16 v40, v116, v112 op_sel:[0,0] op_sel_hi:[0,1]
  v_cvt_pk_f16_f32 v43, v21, v20
  v_pk_mul_f32 v[30:31], v[18:19], v[122:123] op_sel:[1,0] op_sel_hi:[1,1]
  v_pk_fma_f16 v40, v116, v112, v40 op_sel:[1,1,0] op_sel_hi:[1,0,1] neg_lo:[1,0,0]
  v_cvt_pk_f16_f32 v90, v23, v22
  v_pk_fma_f32 v[30:31], v[122:123], v[18:19], v[30:31] op_sel:[1,0,0] op_sel_hi:[0,0,1] neg_hi:[1,0,0]
  ds_write_addtid_b32 v116 offset:18688
  ds_write_addtid_b32 v2 offset:18976
  ds_write_addtid_b32 v3 offset:19264
  ds_write_addtid_b32 v4 offset:19552
  ds_write_addtid_b32 v5 offset:19840
  ds_write_addtid_b32 v6 offset:20128
  ds_write_addtid_b32 v7 offset:20416
  ds_write_addtid_b32 v40 offset:20704
  ds_read_b128 v[60:63], v41 offset:0
  ds_read_b128 v[64:67], v41 offset:64
  ds_read_b128 v[68:71], v41 offset:128
  ds_read_b128 v[72:75], v41 offset:192
  ds_write_addtid_b32 v42 offset:16384
  v_cvt_pk_f16_f32 v91, v31, v30
  v_pk_mul_f16 v103, v43, v115 op_sel:[0,0] op_sel_hi:[0,1]
  v_pk_mul_f16 v104, v43, v117 op_sel:[0,0] op_sel_hi:[0,1]
  v_pk_mul_f16 v108, v43, v91 op_sel:[0,0] op_sel_hi:[0,1]
  v_pk_fma_f16 v103, v43, v115, v103 op_sel:[1,1,0] op_sel_hi:[1,0,1] neg_lo:[1,0,0]
  v_pk_fma_f16 v104, v43, v117, v104 op_sel:[1,1,0] op_sel_hi:[1,0,1] neg_lo:[1,0,0]
  v_pk_fma_f16 v108, v43, v91, v108 op_sel:[1,1,0] op_sel_hi:[1,0,1] neg_lo:[1,0,0]
  v_pk_mul_f32 v[34:35], v[22:23], v[20:21] op_sel:[1,0] op_sel_hi:[1,1]
  v_pk_mul_f16 v106, v90, v115 op_sel:[0,0] op_sel_hi:[0,1]
  v_mov_b32 v136, 0
  v_mov_b32 v137, 1
  s_waitcnt vmcnt(3)
  s_mov_b64 exec, 1
  ds_add_u32 v136, v137 offset:28
  s_mov_b64 exec, -1
  s_cmp_lg_u32 s30, 1
  s_cbranch_scc1 K_NOSW
  v_mov_b32 v138, 0
  v_dot2c_f32_bf16 v138, 0x3f803f80, v128
  v_dot2c_f32_bf16 v138, 0x3f803f80, v129
  v_dot2c_f32_bf16 v138, 0x3f803f80, v130
  v_dot2c_f32_bf16 v138, 0x3f803f80, v131
  v_dot2c_f32_bf16 v138, 0x3f803f80, v132
  v_dot2c_f32_bf16 v138, 0x3f803f80, v133
  v_dot2c_f32_bf16 v138, 0x3f803f80, v134
  v_dot2c_f32_bf16 v138, 0x3f803f80, v135
  s_nop 2
  v_add_f32_dpp v138, v138, v138 quad_perm:[1,0,3,2] row_mask:0xf bank_mask:0xf
  s_nop 1
  v_add_f32_dpp v138, v138, v138 quad_perm:[2,3,0,1] row_mask:0xf bank_mask:0xf
  s_nop 1
  v_add_f32_dpp v138, v138, v138 row_half_mirror row_mask:0xf bank_mask:0xf
  s_nop 1
  v_add_f32_dpp v138, v138, v138 row_mirror row_mask:0xf bank_mask:0xf
  s_nop 1
  v_add_f32_dpp v138, v138, v138 row_bcast:15 row_mask:0xa bank_mask:0xf
  s_nop 1
  v_add_f32_dpp v138, v138, v138 row_bcast:31 row_mask:0xc bank_mask:0xf
  v_or_b32 v138, 1, v138
  s_mov_b32 exec_lo, 0
  s_mov_b32 exec_hi, 0x80000000
  ds_write_b32 v136, v138 offset:4
  s_mov_b64 exec, -1
K_NOSW:
  ds_write_addtid_b32 v115 offset:16672
  ds_write_addtid_b32 v117 offset:16960
  ds_write_addtid_b32 v43 offset:17536
  ds_write_addtid_b32 v91 offset:17248
  ds_write_addtid_b32 v90 offset:18688
  ds_write_addtid_b32 v103 offset:17824
  ds_write_addtid_b32 v104 offset:18112
  ds_write_addtid_b32 v108 offset:18400
  v_pk_fma_f32 v[34:35], v[20:21], v[22:23], v[34:35] op_sel:[1,0,0] op_sel_hi:[0,0,1] neg_hi:[1,0,0]
  v_pk_fma_f16 v106, v90, v115, v106 op_sel:[1,1,0] op_sel_hi:[1,0,1] neg_lo:[1,0,0]
  s_add_u32 m0, s36, 40960
  s_nop 0
  buffer_load_dwordx4 v88, s[8:11], s17 offen nt lds
  s_mov_b32 m0, s37
  v_pk_mul_f16 v111, v90, v117 op_sel:[0,0] op_sel_hi:[0,1]
  v_cvt_pk_f16_f32 v113, v35, v34
  v_pk_mul_f16 v114, v90, v91 op_sel:[0,0] op_sel_hi:[0,1]
  v_pk_fma_f16 v111, v90, v117, v111 op_sel:[1,1,0] op_sel_hi:[1,0,1] neg_lo:[1,0,0]
  v_pk_mul_f16 v101, v113, v115 op_sel:[0,0] op_sel_hi:[0,1]
  v_pk_fma_f16 v114, v90, v91, v114 op_sel:[1,1,0] op_sel_hi:[1,0,1] neg_lo:[1,0,0]
  v_pk_mul_f16 v107, v113, v117 op_sel:[0,0] op_sel_hi:[0,1]
  v_pk_fma_f16 v101, v113, v115, v101 op_sel:[1,1,0] op_sel_hi:[1,0,1] neg_lo:[1,0,0]
  v_pk_mul_f16 v109, v113, v91 op_sel:[0,0] op_sel_hi:[0,1]
  v_pk_fma_f16 v107, v113, v117, v107 op_sel:[1,1,0] op_sel_hi:[1,0,1] neg_lo:[1,0,0]
  v_pk_mul_f32 v[36:37], v[26:27], v[26:27] op_sel:[1,0] op_sel_hi:[1,1]
  v_pk_fma_f16 v109, v113, v91, v109 op_sel:[1,1,0] op_sel_hi:[1,0,1] neg_lo:[1,0,0]
  v_cvt_pk_f16_f32 v112, v27, -v26
  v_pk_fma_f32 v[36:37], v[26:27], v[26:27], v[36:37] op_sel:[1,0,0] op_sel_hi:[0,0,1] neg_hi:[1,0,0]
  ds_write_addtid_b32 v113 offset:19840
  ds_write_addtid_b32 v106 offset:18976
  ds_write_addtid_b32 v111 offset:19264
  ds_write_addtid_b32 v114 offset:19552
  ds_write_addtid_b32 v101 offset:20128
  ds_write_addtid_b32 v107 offset:20416
  ds_write_addtid_b32 v109 offset:20704
  ds_read_b128 v[44:47], v41 offset:0
  ds_read_b128 v[48:51], v41 offset:64
  ds_read_b128 v[52:55], v41 offset:128
  ds_read_b128 v[56:59], v41 offset:192
  v_cvt_pk_f16_f32 v116, v37, -v36
  v_pk_mul_f32 v[38:39], v[36:37], v[26:27] op_sel:[1,0] op_sel_hi:[1,1]
  v_pk_mul_f32 v[120:121], v[36:37], v[36:37] op_sel:[1,0] op_sel_hi:[1,1]
  v_pk_mul_f16 v2, v100, v116 op_sel:[0,0] op_sel_hi:[0,1]
  v_pk_fma_f32 v[38:39], v[26:27], v[36:37], v[38:39] op_sel:[1,0,0] op_sel_hi:[0,0,1] neg_hi:[1,0,0]
  v_pk_fma_f32 v[120:121], v[36:37], v[36:37], v[120:121] op_sel:[1,0,0] op_sel_hi:[0,0,1] neg_hi:[1,0,0]
  v_pk_fma_f16 v2, v100, v116, v2 op_sel:[1,1,0] op_sel_hi:[1,0,1] neg_lo:[1,0,0]
  v_cvt_pk_f16_f32 v3, v39, -v38
  v_pk_mul_f32 v[24:25], v[32:33], v[120:121] op_sel:[1,0] op_sel_hi:[1,1]
  v_pk_mul_f16 v4, v2, v102 op_sel:[0,0] op_sel_hi:[0,1]
  v_pk_mul_f16 v5, v2, v105 op_sel:[0,0] op_sel_hi:[0,1]
  v_pk_mul_f16 v6, v2, v110 op_sel:[0,0] op_sel_hi:[0,1]
  v_pk_fma_f16 v4, v2, v102, v4 op_sel:[1,1,0] op_sel_hi:[1,0,1] neg_lo:[1,0,0]
  v_pk_fma_f16 v5, v2, v105, v5 op_sel:[1,1,0] op_sel_hi:[1,0,1] neg_lo:[1,0,0]
  v_pk_fma_f16 v6, v2, v110, v6 op_sel:[1,1,0] op_sel_hi:[1,0,1] neg_lo:[1,0,0]
  v_pk_mul_f16 v7, v100, v3 op_sel:[0,0] op_sel_hi:[0,1]
  v_pk_fma_f32 v[24:25], v[120:121], v[32:33], v[24:25] op_sel:[1,0,0] op_sel_hi:[0,0,1] neg_hi:[1,0,0]
  v_pk_fma_f16 v7, v100, v3, v7 op_sel:[1,1,0] op_sel_hi:[1,0,1] neg_lo:[1,0,0]
  v_cvt_pk_f16_f32 v40, v25, -v24
  v_pk_mul_f32 v[118:119], v[24:25], v[120:121] op_sel:[1,0] op_sel_hi:[1,1]
  v_pk_mul_f16 v43, v7, v102 op_sel:[0,0] op_sel_hi:[0,1]
  v_pk_mul_f16 v103, v7, v105 op_sel:[0,0] op_sel_hi:[0,1]
  v_pk_mul_f16 v104, v7, v110 op_sel:[0,0] op_sel_hi:[0,1]
  s_waitcnt lgkmcnt(0)
  s_add_u32 m0, s36, 16384
  s_nop 0
  buffer_load_dwordx4 v88, s[4:7], s18 offen nt lds
  s_mov_b32 m0, s37
  v_mfma_f32_16x16x32_f16 v[76:79], v[60:63], v[44:47], 0
  v_mfma_f32_16x16x32_f16 v[76:79], v[64:67], v[48:51], v[76:79]
  v_mfma_f32_16x16x32_f16 v[76:79], v[68:71], v[52:55], v[76:79]
  v_mfma_f32_16x16x32_f16 v[76:79], v[72:75], v[56:59], v[76:79]
  v_pk_fma_f16 v43, v7, v102, v43 op_sel:[1,1,0] op_sel_hi:[1,0,1] neg_lo:[1,0,0]
  v_pk_fma_f16 v103, v7, v105, v103 op_sel:[1,1,0] op_sel_hi:[1,0,1] neg_lo:[1,0,0]
  v_pk_fma_f16 v104, v7, v110, v104 op_sel:[1,1,0] op_sel_hi:[1,0,1] neg_lo:[1,0,0]
  v_pk_mul_f16 v108, v40, v105 op_sel:[0,0] op_sel_hi:[0,1]
  ds_write_addtid_b32 v2 offset:16384
  ds_write_addtid_b32 v4 offset:16672
  ds_write_addtid_b32 v5 offset:16960
  ds_write_addtid_b32 v6 offset:17248
  ds_write_addtid_b32 v7 offset:17536
  ds_write_addtid_b32 v43 offset:17824
  ds_write_addtid_b32 v103 offset:18112
  ds_write_addtid_b32 v40 offset:18688
  v_pk_fma_f16 v108, v40, v105, v108 op_sel:[1,1,0] op_sel_hi:[1,0,1] neg_lo:[1,0,0]
  v_pk_mul_f16 v90, v40, v112 op_sel:[0,0] op_sel_hi:[0,1]
  v_pk_mul_f16 v115, v40, v116 op_sel:[0,0] op_sel_hi:[0,1]
  v_pk_mul_f16 v117, v40, v3 op_sel:[0,0] op_sel_hi:[0,1]
  v_pk_fma_f16 v90, v40, v112, v90 op_sel:[1,1,0] op_sel_hi:[1,0,1] neg_lo:[1,0,0]
  v_pk_fma_f16 v115, v40, v116, v115 op_sel:[1,1,0] op_sel_hi:[1,0,1] neg_lo:[1,0,0]
  v_pk_fma_f16 v117, v40, v3, v117 op_sel:[1,1,0] op_sel_hi:[1,0,1] neg_lo:[1,0,0]
  v_pk_mul_f16 v91, v90, v105 op_sel:[0,0] op_sel_hi:[0,1]
  v_pk_mul_f16 v113, v115, v105 op_sel:[0,0] op_sel_hi:[0,1]
  v_pk_mul_f16 v106, v117, v105 op_sel:[0,0] op_sel_hi:[0,1]
  v_pk_fma_f16 v91, v90, v105, v91 op_sel:[1,1,0] op_sel_hi:[1,0,1] neg_lo:[1,0,0]
  v_pk_fma_f16 v113, v115, v105, v113 op_sel:[1,1,0] op_sel_hi:[1,0,1] neg_lo:[1,0,0]
  v_pk_fma_f16 v106, v117, v105, v106 op_sel:[1,1,0] op_sel_hi:[1,0,1] neg_lo:[1,0,0]
  v_pk_fma_f32 v[118:119], v[120:121], v[24:25], v[118:119] op_sel:[1,0,0] op_sel_hi:[0,0,1] neg_hi:[1,0,0]
  ds_write_addtid_b32 v104 offset:18400
  ds_write_addtid_b32 v108 offset:18976
  ds_write_addtid_b32 v90 offset:19264
  ds_write_addtid_b32 v91 offset:19552
  ds_write_addtid_b32 v115 offset:19840
  ds_write_addtid_b32 v113 offset:20128
  ds_write_addtid_b32 v117 offset:20416
  ds_write_addtid_b32 v106 offset:20704
  ds_read_b128 v[60:63], v41 offset:0
  ds_read_b128 v[64:67], v41 offset:64
  ds_read_b128 v[68:71], v41 offset:128
  ds_read_b128 v[72:75], v41 offset:192
  v_cvt_pk_f16_f32 v111, v119, -v118
  v_pk_mul_f32 v[16:17], v[118:119], v[120:121] op_sel:[1,0] op_sel_hi:[1,1]
  v_pk_mul_f16 v114, v111, v112 op_sel:[0,0] op_sel_hi:[0,1]
  v_pk_mul_f16 v101, v111, v116 op_sel:[0,0] op_sel_hi:[0,1]
  v_pk_mul_f16 v107, v111, v3 op_sel:[0,0] op_sel_hi:[0,1]
  v_pk_fma_f16 v114, v111, v112, v114 op_sel:[1,1,0] op_sel_hi:[1,0,1] neg_lo:[1,0,0]
  v_pk_fma_f16 v101, v111, v116, v101 op_sel:[1,1,0] op_sel_hi:[1,0,1] neg_lo:[1,0,0]
  v_pk_fma_f16 v107, v111, v3, v107 op_sel:[1,1,0] op_sel_hi:[1,0,1] neg_lo:[1,0,0]
  v_pk_fma_f32 v[16:17], v[120:121], v[118:119], v[16:17] op_sel:[1,0,0] op_sel_hi:[0,0,1] neg_hi:[1,0,0]
  v_cvt_pk_f16_f32 v109, v17, -v16
  v_pk_mul_f32 v[28:29], v[16:17], v[120:121] op_sel:[1,0] op_sel_hi:[1,1]
  v_pk_mul_f16 v100, v109, v112 op_sel:[0,0] op_sel_hi:[0,1]
  v_pk_mul_f16 v102, v109, v116 op_sel:[0,0] op_sel_hi:[0,1]
  v_pk_mul_f16 v110, v109, v3 op_sel:[0,0] op_sel_hi:[0,1]
  v_pk_fma_f16 v100, v109, v112, v100 op_sel:[1,1,0] op_sel_hi:[1,0,1] neg_lo:[1,0,0]
  v_pk_fma_f16 v102, v109, v116, v102 op_sel:[1,1,0] op_sel_hi:[1,0,1] neg_lo:[1,0,0]
  v_pk_fma_f16 v110, v109, v3, v110 op_sel:[1,1,0] op_sel_hi:[1,0,1] neg_lo:[1,0,0]
  v_pk_fma_f32 v[28:29], v[120:121], v[16:17], v[28:29] op_sel:[1,0,0] op_sel_hi:[0,0,1] neg_hi:[1,0,0]
  ds_write_addtid_b32 v111 offset:16384
  ds_write_addtid_b32 v114 offset:16672
  ds_write_addtid_b32 v101 offset:16960
  ds_write_addtid_b32 v107 offset:17248
  ds_write_addtid_b32 v109 offset:17536
  ds_write_addtid_b32 v100 offset:17824
  ds_write_addtid_b32 v102 offset:18112
  ds_write_addtid_b32 v110 offset:18400
  s_waitcnt lgkmcnt(8)
  v_mfma_f32_16x16x32_f16 v[80:83], v[60:63], v[44:47], 0
  v_mfma_f32_16x16x32_f16 v[80:83], v[64:67], v[48:51], v[80:83]
  v_mfma_f32_16x16x32_f16 v[80:83], v[68:71], v[52:55], v[80:83]
  v_mfma_f32_16x16x32_f16 v[80:83], v[72:75], v[56:59], v[80:83]
  v_cvt_pk_f16_f32 v2, v29, -v28
  ds_write_addtid_b32 v2 offset:18688
  ds_read_b128 v[60:63], v41 offset:0
  ds_read_b128 v[64:67], v41 offset:64
  ds_read_b128 v[68:71], v41 offset:128
  ds_read_b128 v[72:75], v41 offset:192
  s_waitcnt lgkmcnt(0)
  v_mfma_f32_16x16x32_f16 v[84:87], v[60:63], v[44:47], 0
  v_mfma_f32_16x16x32_f16 v[84:87], v[64:67], v[48:51], v[84:87]
  v_mfma_f32_16x16x32_f16 v[84:87], v[68:71], v[52:55], v[84:87]
  v_mfma_f32_16x16x32_f16 v[84:87], v[72:75], v[56:59], v[84:87]
  s_cmp_eq_u32 s53, 0
  s_cbranch_scc0 K_FAR
  ds_write_b128 v99, v[80:83] offset:5120
  s_nop 4
  ds_write_b128 v99, v[84:87] offset:6144
  v_mov_b32 v94, 1
  ds_write_b32 v92, v94 offset:64
  s_branch K_PS1B
K_PS1:
K_PS1B:
  ds_read_b32 v94, v93 offset:64
  s_waitcnt lgkmcnt(0)
  v_cmp_gt_u32 vcc, 1, v94
  s_cbranch_vccnz K_PS1
  s_cmp_ge_u32 s30, 4
  s_cbranch_scc1 K_PS1_NO
  s_add_u32 m0, s36, 49152
  s_nop 0
  buffer_load_dwordx4 v88, s[8:11], s18 offen nt lds
  s_add_u32 m0, s36, 53248
  s_add_u32 s60, s18, 114688
  buffer_load_dwordx4 v88, s[8:11], s60 offen nt lds
  s_add_u32 m0, s36, 24576
  s_nop 0
  buffer_load_dwordx4 v88, s[4:7], s19 offen nt lds
  s_add_u32 m0, s36, 28672
  s_add_u32 s60, s19, 114688
  buffer_load_dwordx4 v88, s[4:7], s60 offen nt lds
K_PS1_NO:
  ds_read_b128 v[16:19], v99 offset:1024
  ds_read_b128 v[24:27], v99
  s_waitcnt lgkmcnt(1)
  v_pk_add_f32 v[80:81], v[80:81], v[16:17]
  v_pk_add_f32 v[82:83], v[82:83], v[18:19]
  s_waitcnt lgkmcnt(0)
  v_pk_add_f32 v[76:77], v[76:77], v[24:25]
  v_pk_add_f32 v[78:79], v[78:79], v[26:27]
  v_mov_b32_dpp v28, v80 row_shl:1 row_mask:0xf bank_mask:0xf
  v_writelane_b32 v28, 0, 33
  s_mov_b32 exec_hi, 3
  v_cndmask_b32 v29, v80, v81, s[72:73]
  v_cndmask_b32 v30, v81, v82, s[72:73]
  v_cndmask_b32 v28, v28, v83, s[72:73]
  v_cvt_pk_f16_f32 v16, v28, v30
  v_cvt_pk_f16_f32 v17, v30, v30
  v_cvt_pk_f16_f32 v18, v29, v80
  v_cvt_pk_f16_f32 v19, v80, v80
  v_cvt_pk_f16_f32 v20, v30, v29
  ds_write_b16 v124, v16
  ds_write2_b32 v126, v17, v20 offset0:0 offset1:1
  ds_write_b32 v126, v19 offset:8
  ds_write_b16 v124, v19 offset:14
  ds_write2_b32 v127, v16, v17 offset0:0 offset1:1
  ds_write2_b32 v127, v18, v19 offset0:2 offset1:3
  s_mov_b32 exec_hi, -1
  v_cvt_pk_f16_f32 v24, v79, v78
  v_cvt_pk_f16_f32 v25, v77, v76
  v_cvt_pk_f16_f32 v26, v78, v77
  ds_write_b64 v125, v[24:25]
  ds_write_b16 v125, v24 offset:1986
  ds_write_b32 v125, v26 offset:1988
  ds_write_b16_d16_hi v125, v25 offset:1992
  v_mov_b32 v8, s70
  ds_read2_b32 v[96:97], v11 offset0:128 offset1:129
  ds_read2_b32 v[98:99], v11 offset0:130 offset1:131
  ds_read2_b32 v[100:101], v10 offset0:128 offset1:129
  ds_read2_b32 v[102:103], v10 offset0:130 offset1:131
  ds_read2_b32 v[92:93], v10 offset0:0 offset1:1
  ds_read2_b32 v[94:95], v10 offset0:2 offset1:3
  ds_read2_b32 v[104:105], v11 offset0:112 offset1:113
  ds_read2_b32 v[106:107], v11 offset0:114 offset1:115
  ds_read2_b32 v[108:109], v10 offset0:112 offset1:113
  ds_read2_b32 v[110:111], v10 offset0:114 offset1:115
  s_waitcnt lgkmcnt(8)
  ds_read2_b32 v[128:129], v11 offset0:96 offset1:97
  ds_read2_b32 v[130:131], v11 offset0:98 offset1:99
  ds_read2_b32 v[132:133], v10 offset0:96 offset1:97
  ds_read2_b32 v[134:135], v10 offset0:98 offset1:99
  s_waitcnt lgkmcnt(8)
  ds_read2_b32 v[136:137], v11 offset0:80 offset1:81
  ds_read2_b32 v[138:139], v11 offset0:82 offset1:83
  ds_read2_b32 v[140:141], v10 offset0:80 offset1:81
  ds_read2_b32 v[142:143], v10 offset0:82 offset1:83
  s_waitcnt lgkmcnt(8)
  ds_read2_b32 v[144:145], v11 offset0:64 offset1:65
  ds_read2_b32 v[146:147], v11 offset0:66 offset1:67
  ds_read2_b32 v[148:149], v10 offset0:64 offset1:65
  ds_read2_b32 v[150:151], v10 offset0:66 offset1:67
  s_waitcnt lgkmcnt(8)
  ds_read2_b32 v[152:153], v11 offset0:48 offset1:49
  ds_read2_b32 v[154:155], v11 offset0:50 offset1:51
  ds_read2_b32 v[156:157], v10 offset0:48 offset1:49
  ds_read2_b32 v[158:159], v10 offset0:50 offset1:51
  s_branch K_FWB
K_FW:
  s_sleep 1
K_FWB:
  ds_read_b32 v6, v15 offset:640
  s_waitcnt lgkmcnt(0)
  v_cmp_eq_u32 vcc, 0, v6
  s_cbranch_vccnz K_FW
  v_readfirstlane_b32 s71, v6
  ds_read2_b32 v[48:49], v14 offset0:16 offset1:17
  ds_read2_b32 v[50:51], v14 offset0:112 offset1:113
  ds_read2_b32 v[52:53], v14 offset0:8 offset1:9
  ds_read2_b32 v[54:55], v14 offset0:104 offset1:105
  ds_read2_b32 v[56:57], v14 offset0:0 offset1:1
  ds_read2_b32 v[58:59], v14 offset0:96 offset1:97
  ds_read2_b32 v[60:61], v14 offset0:48 offset1:49
  ds_read2_b32 v[62:63], v14 offset0:80 offset1:81
  ds_read2_b32 v[64:65], v14 offset0:40 offset1:41
  ds_read2_b32 v[66:67], v14 offset0:72 offset1:73
  ds_read2_b32 v[68:69], v14 offset0:32 offset1:33
  s_waitcnt lgkmcnt(4)
  ds_read2_b32 v[70:71], v14 offset0:64 offset1:65
  ds_read2_b32 v[72:73], v14 offset0:152 offset1:153
  ds_read2_b32 v[74:75], v14 offset0:192 offset1:193
  ds_read2_b32 v[76:77], v14 offset0:144 offset1:145
  ds_read2_b32 v[78:79], v14 offset0:184 offset1:185
  ds_read2_b32 v[80:81], v14 offset0:136 offset1:137
  ds_read2_b32 v[82:83], v14 offset0:176 offset1:177
  ds_read2_b32 v[84:85], v14 offset0:128 offset1:129
  ds_read2_b32 v[86:87], v14 offset0:168 offset1:169
  v_mov_b32 v6, 0
  s_branch K_BWB
K_BW:
  s_sleep 1
K_BWB:
  ds_read_b32 v7, v6 offset:28
  s_waitcnt lgkmcnt(0)
  v_cmp_gt_u32 vcc, 8, v7
  s_cbranch_vccnz K_BW
  s_setprio 1
  v_mov_b32 v6, 0
  v_mov_b32 v7, 1
  s_waitcnt vmcnt(0)
  s_mov_b64 exec, 1
  ds_add_u32 v6, v7 offset:112
  s_mov_b64 exec, -1
  s_branch K_W1NB
K_W1N:
  s_sleep 1
K_W1NB:
  ds_read_b32 v7, v6 offset:16
  s_waitcnt lgkmcnt(0)
  v_cmp_gt_u32 vcc, 4, v7
  s_cbranch_vccnz K_W1N
  ds_read_b128 v[112:115], v12 offset:512
  ds_read_b128 v[116:119], v12 offset:1024
  ds_read_b128 v[120:123], v12 offset:1536
  ds_read_b128 v[124:127], v12 offset:2048
  ds_read_b128 v[2:5], v12 offset:2560
  ds_read_b128 v[160:163], v12 offset:3072
  ds_read_b128 v[164:167], v12 offset:3584
  s_waitcnt lgkmcnt(6)
  v_mfma_f32_16x16x32_f16 v[16:19], v[96:99], v[112:115], 0
  v_mfma_f32_16x16x32_f16 v[20:23], v[100:103], v[112:115], 0
  v_mfma_f32_16x16x32_f16 v[24:27], v[92:95], v[112:115], 0
  ds_read_b128 v[112:115], v12 offset:4096
  s_waitcnt lgkmcnt(6)
  v_mfma_f32_16x16x32_f16 v[20:23], v[96:99], v[116:119], v[20:23]
  v_mfma_f32_16x16x32_f16 v[24:27], v[100:103], v[116:119], v[24:27]
  v_mfma_f32_16x16x32_f16 v[28:31], v[92:95], v[116:119], 0
  ds_read_b128 v[116:119], v12 offset:448
  s_waitcnt lgkmcnt(2)
  v_mfma_f32_16x16x32_f16 v[24:27], v[96:99], v[120:123], v[24:27]
  v_mfma_f32_16x16x32_f16 v[28:31], v[100:103], v[120:123], v[28:31]
  v_mfma_f32_16x16x32_f16 v[32:35], v[92:95], v[120:123], 0
  ds_read_b128 v[120:123], v12 offset:960
  v_mfma_f32_16x16x32_f16 v[28:31], v[96:99], v[124:127], v[28:31]
  v_mfma_f32_16x16x32_f16 v[32:35], v[100:103], v[124:127], v[32:35]
  v_mfma_f32_16x16x32_f16 v[36:39], v[92:95], v[124:127], 0
  ds_read_b128 v[124:127], v12 offset:1472
  v_mfma_f32_16x16x32_f16 v[32:35], v[96:99], v[2:5], v[32:35]
  v_mfma_f32_16x16x32_f16 v[36:39], v[100:103], v[2:5], v[36:39]
  v_mfma_f32_16x16x32_f16 v[40:43], v[92:95], v[2:5], 0
  ds_read_b128 v[2:5], v12 offset:1984
  v_mfma_f32_16x16x32_f16 v[36:39], v[96:99], v[160:163], v[36:39]
  v_mfma_f32_16x16x32_f16 v[40:43], v[100:103], v[160:163], v[40:43]
  v_mfma_f32_16x16x32_f16 v[44:47], v[92:95], v[160:163], 0
  ds_read_b128 v[160:163], v12 offset:2496
  v_mfma_f32_16x16x32_f16 v[40:43], v[96:99], v[164:167], v[40:43]
  v_mfma_f32_16x16x32_f16 v[44:47], v[100:103], v[164:167], v[44:47]
  ds_read_b128 v[164:167], v12 offset:3008
  s_waitcnt lgkmcnt(2)
  v_mfma_f32_16x16x32_f16 v[44:47], v[96:99], v[112:115], v[44:47]
  ds_read_b128 v[112:115], v12 offset:3520
  ds_read2_b32 v[96:97], v11 offset0:32 offset1:33
  v_mfma_f32_16x16x32_f16 v[16:19], v[104:107], v[116:119], v[16:19]
  ds_read2_b32 v[98:99], v11 offset0:34 offset1:35
  ds_read2_b32 v[100:101], v10 offset0:32 offset1:33
  v_mfma_f32_16x16x32_f16 v[20:23], v[108:111], v[116:119], v[20:23]
  ds_read_b128 v[116:119], v12 offset:4032
  ds_read2_b32 v[102:103], v10 offset0:34 offset1:35
  v_mfma_f32_16x16x32_f16 v[20:23], v[104:107], v[120:123], v[20:23]
  ds_read_b128 v[88:91], v13 offset:0
  ds_read_b128 v[92:95], v13 offset:1024
  v_mfma_f32_16x16x32_f16 v[24:27], v[108:111], v[120:123], v[24:27]
  ds_read_b128 v[120:123], v12 offset:384
  v_mfma_f32_16x16x32_f16 v[24:27], v[104:107], v[124:127], v[24:27]
  v_mfma_f32_16x16x32_f16 v[28:31], v[108:111], v[124:127], v[28:31]
  ds_read_b128 v[124:127], v12 offset:896
  v_mfma_f32_16x16x32_f16 v[28:31], v[104:107], v[2:5], v[28:31]
  v_mfma_f32_16x16x32_f16 v[32:35], v[108:111], v[2:5], v[32:35]
  s_waitcnt lgkmcnt(2)
  v_mfma_f32_16x16x32_f16 v[32:35], v[104:107], v[160:163], v[32:35]
  ds_read_b128 v[2:5], v12 offset:1408
  v_mfma_f32_16x16x32_f16 v[36:39], v[108:111], v[160:163], v[36:39]
  ds_read_b128 v[160:163], v12 offset:1920
  v_mfma_f32_16x16x32_f16 v[36:39], v[104:107], v[164:167], v[36:39]
  v_mfma_f32_16x16x32_f16 v[40:43], v[108:111], v[164:167], v[40:43]
  ds_read_b128 v[164:167], v12 offset:2432
  v_mfma_f32_16x16x32_f16 v[40:43], v[104:107], v[112:115], v[40:43]
  v_mfma_f32_16x16x32_f16 v[44:47], v[108:111], v[112:115], v[44:47]
  ds_read_b128 v[112:115], v12 offset:2944
  v_mfma_f32_16x16x32_f16 v[44:47], v[104:107], v[116:119], v[44:47]
  ds_read_b128 v[116:119], v12 offset:3456
  s_waitcnt lgkmcnt(3)
  v_mfma_f32_16x16x32_f16 v[16:19], v[128:131], v[120:123], v[16:19]
  ds_read2_b32 v[104:105], v11 offset0:16 offset1:17
  ds_read2_b32 v[106:107], v11 offset0:18 offset1:19
  v_mfma_f32_16x16x32_f16 v[20:23], v[132:135], v[120:123], v[20:23]
  ds_read_b128 v[120:123], v12 offset:3968
  ds_read2_b32 v[108:109], v10 offset0:16 offset1:17
  v_mfma_f32_16x16x32_f16 v[20:23], v[128:131], v[124:127], v[20:23]
  ds_read2_b32 v[110:111], v10 offset0:18 offset1:19
  v_mfma_f32_16x16x32_f16 v[24:27], v[132:135], v[124:127], v[24:27]
  ds_read_b128 v[124:127], v12 offset:320
  v_mfma_f32_16x16x32_f16 v[24:27], v[128:131], v[2:5], v[24:27]
  v_mfma_f32_16x16x32_f16 v[28:31], v[132:135], v[2:5], v[28:31]
  ds_read_b128 v[2:5], v12 offset:832
  v_mfma_f32_16x16x32_f16 v[28:31], v[128:131], v[160:163], v[28:31]
  v_mfma_f32_16x16x32_f16 v[32:35], v[132:135], v[160:163], v[32:35]
  ds_read_b128 v[160:163], v12 offset:1344
  s_waitcnt lgkmcnt(3)
  v_mfma_f32_16x16x32_f16 v[32:35], v[128:131], v[164:167], v[32:35]
  v_mfma_f32_16x16x32_f16 v[36:39], v[132:135], v[164:167], v[36:39]
  ds_read_b128 v[164:167], v12 offset:1856
  v_mfma_f32_16x16x32_f16 v[36:39], v[128:131], v[112:115], v[36:39]
  v_mfma_f32_16x16x32_f16 v[40:43], v[132:135], v[112:115], v[40:43]
  ds_read_b128 v[112:115], v12 offset:2368
  v_mfma_f32_16x16x32_f16 v[40:43], v[128:131], v[116:119], v[40:43]
  v_mfma_f32_16x16x32_f16 v[44:47], v[132:135], v[116:119], v[44:47]
  ds_read_b128 v[116:119], v12 offset:2880
  v_mfma_f32_16x16x32_f16 v[44:47], v[128:131], v[120:123], v[44:47]
  ds_read_b128 v[120:123], v12 offset:3392
  s_waitcnt lgkmcnt(3)
  v_mfma_f32_16x16x32_f16 v[16:19], v[136:139], v[124:127], v[16:19]
  ds_read_b128 v[128:131], v13 offset:2048
  ds_read_b128 v[132:135], v13 offset:3072
  v_mfma_f32_16x16x32_f16 v[20:23], v[140:143], v[124:127], v[20:23]
  ds_read_b128 v[124:127], v12 offset:3904
  v_mfma_f32_16x16x32_f16 v[20:23], v[136:139], v[2:5], v[20:23]
  v_mfma_f32_16x16x32_f16 v[24:27], v[140:143], v[2:5], v[24:27]
  ds_read_b128 v[2:5], v12 offset:256
  v_mfma_f32_16x16x32_f16 v[24:27], v[136:139], v[160:163], v[24:27]
  v_mfma_f32_16x16x32_f16 v[28:31], v[140:143], v[160:163], v[28:31]
  ds_read_b128 v[160:163], v12 offset:768
  v_mfma_f32_16x16x32_f16 v[28:31], v[136:139], v[164:167], v[28:31]
  v_mfma_f32_16x16x32_f16 v[32:35], v[140:143], v[164:167], v[32:35]
  ds_read_b128 v[164:167], v12 offset:1280
  s_waitcnt lgkmcnt(3)
  v_mfma_f32_16x16x32_f16 v[32:35], v[136:139], v[112:115], v[32:35]
  v_mfma_f32_16x16x32_f16 v[36:39], v[140:143], v[112:115], v[36:39]
  ds_read_b128 v[112:115], v12 offset:1792
  v_mfma_f32_16x16x32_f16 v[36:39], v[136:139], v[116:119], v[36:39]
  v_mfma_f32_16x16x32_f16 v[40:43], v[140:143], v[116:119], v[40:43]
  ds_read_b128 v[116:119], v12 offset:2304
  v_mfma_f32_16x16x32_f16 v[40:43], v[136:139], v[120:123], v[40:43]
  v_mfma_f32_16x16x32_f16 v[44:47], v[140:143], v[120:123], v[44:47]
  ds_read_b128 v[120:123], v12 offset:2816
  v_mfma_f32_16x16x32_f16 v[44:47], v[136:139], v[124:127], v[44:47]
  ds_read_b128 v[124:127], v12 offset:3328
  s_waitcnt lgkmcnt(3)
  v_mfma_f32_16x16x32_f16 v[16:19], v[144:147], v[2:5], v[16:19]
  ds_read_b128 v[140:143], v12 offset:496
  ds_read_b128 v[136:139], v13 offset:4096
  v_mfma_f32_16x16x32_f16 v[20:23], v[148:151], v[2:5], v[20:23]
  ds_read_b128 v[2:5], v12 offset:3840
  v_mfma_f32_16x16x32_f16 v[20:23], v[144:147], v[160:163], v[20:23]
  v_mfma_f32_16x16x32_f16 v[24:27], v[148:151], v[160:163], v[24:27]
  ds_read_b128 v[160:163], v12 offset:192
  v_mfma_f32_16x16x32_f16 v[24:27], v[144:147], v[164:167], v[24:27]
  v_mfma_f32_16x16x32_f16 v[28:31], v[148:151], v[164:167], v[28:31]
  ds_read_b128 v[164:167], v12 offset:704
  v_mfma_f32_16x16x32_f16 v[28:31], v[144:147], v[112:115], v[28:31]
  s_waitcnt lgkmcnt(2)
  v_pk_mul_f16 v136, v136, s71 op_sel_hi:[1,0]
  v_mfma_f32_16x16x32_f16 v[32:35], v[148:151], v[112:115], v[32:35]
  ds_read_b128 v[112:115], v12 offset:1216
  v_pk_mul_f16 v137, v137, s71 op_sel_hi:[1,0]
  v_mfma_f32_16x16x32_f16 v[32:35], v[144:147], v[116:119], v[32:35]
  v_pk_mul_f16 v138, v138, s71 op_sel_hi:[1,0]
  v_pk_mul_f16 v139, v139, s71 op_sel_hi:[1,0]
  v_mfma_f32_16x16x32_f16 v[36:39], v[148:151], v[116:119], v[36:39]
  ds_read_b128 v[116:119], v12 offset:1728
  v_mfma_f32_16x16x32_f16 v[36:39], v[144:147], v[120:123], v[36:39]
  v_mfma_f32_16x16x32_f16 v[40:43], v[148:151], v[120:123], v[40:43]
  ds_read_b128 v[120:123], v12 offset:2240
  v_mfma_f32_16x16x32_f16 v[40:43], v[144:147], v[124:127], v[40:43]
  v_mfma_f32_16x16x32_f16 v[44:47], v[148:151], v[124:127], v[44:47]
  ds_read_b128 v[124:127], v12 offset:2752
  v_mfma_f32_16x16x32_f16 v[44:47], v[144:147], v[2:5], v[44:47]
  ds_read_b128 v[2:5], v12 offset:3264
  s_waitcnt lgkmcnt(3)
  v_mfma_f32_16x16x32_f16 v[16:19], v[152:155], v[160:163], v[16:19]
  ds_read_b128 v[144:147], v12 offset:512
  ds_read_b128 v[148:151], v12 offset:16
  v_mfma_f32_16x16x32_f16 v[20:23], v[156:159], v[160:163], v[20:23]
  ds_read_b128 v[160:163], v12 offset:3776
  v_mfma_f32_16x16x32_f16 v[20:23], v[152:155], v[164:167], v[20:23]
  v_mfma_f32_16x16x32_f16 v[24:27], v[156:159], v[164:167], v[24:27]
  ds_read_b128 v[164:167], v12 offset:128
  v_mfma_f32_16x16x32_f16 v[24:27], v[152:155], v[112:115], v[24:27]
  v_mfma_f32_16x16x32_f16 v[28:31], v[156:159], v[112:115], v[28:31]
  ds_read_b128 v[112:115], v12 offset:640
  v_mfma_f32_16x16x32_f16 v[28:31], v[152:155], v[116:119], v[28:31]
  v_mfma_f32_16x16x32_f16 v[32:35], v[156:159], v[116:119], v[32:35]
  ds_read_b128 v[116:119], v12 offset:1152
  s_waitcnt lgkmcnt(3)
  v_mfma_f32_16x16x32_f16 v[32:35], v[152:155], v[120:123], v[32:35]
  v_mfma_f32_16x16x32_f16 v[36:39], v[156:159], v[120:123], v[36:39]
  ds_read_b128 v[120:123], v12 offset:1664
  v_mfma_f32_16x16x32_f16 v[36:39], v[152:155], v[124:127], v[36:39]
  v_mfma_f32_16x16x32_f16 v[40:43], v[156:159], v[124:127], v[40:43]
  ds_read_b128 v[124:127], v12 offset:2176
  v_mfma_f32_16x16x32_f16 v[40:43], v[152:155], v[2:5], v[40:43]
  v_mfma_f32_16x16x32_f16 v[44:47], v[156:159], v[2:5], v[44:47]
  ds_read_b128 v[2:5], v12 offset:2688
  v_mfma_f32_16x16x32_f16 v[44:47], v[152:155], v[160:163], v[44:47]
  ds_read_b128 v[160:163], v12 offset:3200
  s_waitcnt lgkmcnt(3)
  v_mfma_f32_16x16x32_f16 v[16:19], v[96:99], v[164:167], v[16:19]
  v_mfma_f32_16x16x32_f16 v[20:23], v[100:103], v[164:167], v[20:23]
  ds_read_b128 v[164:167], v12 offset:3712
  v_mfma_f32_16x16x32_f16 v[20:23], v[96:99], v[112:115], v[20:23]
  v_mfma_f32_16x16x32_f16 v[24:27], v[100:103], v[112:115], v[24:27]
  ds_read_b128 v[112:115], v12 offset:64
  v_mfma_f32_16x16x32_f16 v[24:27], v[96:99], v[116:119], v[24:27]
  v_mfma_f32_16x16x32_f16 v[28:31], v[100:103], v[116:119], v[28:31]
  ds_read_b128 v[116:119], v12 offset:576
  v_mfma_f32_16x16x32_f16 v[28:31], v[96:99], v[120:123], v[28:31]
  v_mfma_f32_16x16x32_f16 v[32:35], v[100:103], v[120:123], v[32:35]
  ds_read_b128 v[120:123], v12 offset:1088
  s_waitcnt lgkmcnt(3)
  v_mfma_f32_16x16x32_f16 v[32:35], v[96:99], v[124:127], v[32:35]
  v_mfma_f32_16x16x32_f16 v[36:39], v[100:103], v[124:127], v[36:39]
  ds_read_b128 v[124:127], v12 offset:1600
  v_mfma_f32_16x16x32_f16 v[36:39], v[96:99], v[2:5], v[36:39]
  v_mfma_f32_16x16x32_f16 v[40:43], v[100:103], v[2:5], v[40:43]
  ds_read_b128 v[2:5], v12 offset:2112
  v_mfma_f32_16x16x32_f16 v[40:43], v[96:99], v[160:163], v[40:43]
  v_mfma_f32_16x16x32_f16 v[44:47], v[100:103], v[160:163], v[44:47]
  ds_read_b128 v[160:163], v12 offset:2624
  v_mfma_f32_16x16x32_f16 v[44:47], v[96:99], v[164:167], v[44:47]
  ds_read_b128 v[164:167], v12 offset:3136
  s_waitcnt lgkmcnt(3)
  v_mfma_f32_16x16x32_f16 v[16:19], v[104:107], v[112:115], v[16:19]
  v_mfma_f32_16x16x32_f16 v[20:23], v[108:111], v[112:115], v[20:23]
  ds_read_b128 v[112:115], v12 offset:3648
  v_mfma_f32_16x16x32_f16 v[20:23], v[104:107], v[116:119], v[20:23]
  v_mfma_f32_16x16x32_f16 v[24:27], v[108:111], v[116:119], v[24:27]
  v_mul_f32 v16, v16, v8
  v_mul_f32 v17, v17, v8
  v_mfma_f32_16x16x32_f16 v[24:27], v[104:107], v[120:123], v[24:27]
  v_mul_f32 v18, v18, v8
  v_mul_f32 v19, v19, v8
  v_mfma_f32_16x16x32_f16 v[28:31], v[108:111], v[120:123], v[28:31]
  v_cvt_pk_bf16_f32 v16, v16, v17
  v_cvt_pk_bf16_f32 v17, v18, v19
  v_mfma_f32_16x16x32_f16 v[28:31], v[104:107], v[124:127], v[28:31]
  ds_write_b64 v9, v[16:17] offset:0
  v_mfma_f32_16x16x32_f16 v[32:35], v[108:111], v[124:127], v[32:35]
  v_mul_f32 v20, v20, v8
  s_waitcnt lgkmcnt(1)
  v_mfma_f32_16x16x32_f16 v[32:35], v[104:107], v[2:5], v[32:35]
  v_mul_f32 v21, v21, v8
  v_mul_f32 v22, v22, v8
  v_mfma_f32_16x16x32_f16 v[36:39], v[108:111], v[2:5], v[36:39]
  v_mul_f32 v23, v23, v8
  v_cvt_pk_bf16_f32 v20, v20, v21
  v_mfma_f32_16x16x32_f16 v[36:39], v[104:107], v[160:163], v[36:39]
  v_cvt_pk_bf16_f32 v21, v22, v23
  ds_read_b128 v[116:119], v12 offset:1008
  v_mfma_f32_16x16x32_f16 v[40:43], v[108:111], v[160:163], v[40:43]
  ds_write_b64 v9, v[20:21] offset:512
  v_mfma_f32_16x16x32_f16 v[152:155], v[140:143], v[88:91], 0
  ds_read_b128 v[120:123], v12 offset:1024
  v_mfma_f32_16x16x32_f16 v[156:159], v[140:143], v[92:95], 0
  v_mfma_f32_16x16x32_f16 v[40:43], v[104:107], v[164:167], v[40:43]
  v_mfma_f32_16x16x32_f16 v[44:47], v[108:111], v[164:167], v[44:47]
  v_cvt_pk_f16_f32 v152, v152, v153
  v_cvt_pk_f16_f32 v153, v154, v155
  v_mfma_f32_16x16x32_f16 v[44:47], v[104:107], v[112:115], v[44:47]
  v_cvt_pk_f16_f32 v154, v156, v157
  v_cvt_pk_f16_f32 v155, v158, v159
  v_mfma_f32_16x16x32_f16 v[96:99], v[140:143], v[128:131], 0
  ds_read_b128 v[140:143], v12 offset:528
  v_mfma_f32_16x16x32_f16 v[100:103], v[144:147], v[132:135], 0
  v_mfma_f32_16x16x32_f16 v[24:27], v[152:155], v[48:51], v[24:27]
  v_mfma_f32_16x16x32_f16 v[28:31], v[152:155], v[52:55], v[28:31]
  v_cvt_pk_f16_f32 v96, v96, v97
  v_cvt_pk_f16_f32 v97, v98, v99
  v_mfma_f32_16x16x32_f16 v[32:35], v[152:155], v[56:59], v[32:35]
  v_cvt_pk_f16_f32 v98, v100, v101
  v_cvt_pk_f16_f32 v99, v102, v103
  v_mfma_f32_16x16x32_f16 v[152:155], v[144:147], v[92:95], 0
  v_mfma_f32_16x16x32_f16 v[156:159], v[144:147], v[88:91], 0
  ds_read_b128 v[144:147], v12 offset:1520
  v_mfma_f32_16x16x32_f16 v[32:35], v[96:99], v[72:75], v[32:35]
  v_mfma_f32_16x16x32_f16 v[36:39], v[96:99], v[76:79], v[36:39]
  v_cvt_pk_f16_f32 v152, v152, v153
  v_cvt_pk_f16_f32 v153, v154, v155
  v_mfma_f32_16x16x32_f16 v[40:43], v[96:99], v[80:83], v[40:43]
  v_cvt_pk_f16_f32 v154, v156, v157
  v_cvt_pk_f16_f32 v155, v158, v159
  v_mfma_f32_16x16x32_f16 v[44:47], v[96:99], v[84:87], v[44:47]
  v_mfma_f32_16x16x32_f16 v[28:31], v[136:139], v[148:151], v[28:31]
  ds_read_b128 v[148:151], v12 offset:1536
  s_waitcnt lgkmcnt(1)
  v_mfma_f32_16x16x32_f16 v[96:99], v[116:119], v[88:91], 0
  v_mfma_f32_16x16x32_f16 v[100:103], v[116:119], v[92:95], 0
  v_mfma_f32_16x16x32_f16 v[24:27], v[152:155], v[60:63], v[24:27]
  v_mfma_f32_16x16x32_f16 v[28:31], v[152:155], v[64:67], v[28:31]
  v_cvt_pk_f16_f32 v96, v96, v97
  v_cvt_pk_f16_f32 v97, v98, v99
  v_mfma_f32_16x16x32_f16 v[32:35], v[152:155], v[68:71], v[32:35]
  v_cvt_pk_f16_f32 v98, v100, v101
  v_cvt_pk_f16_f32 v99, v102, v103
  v_mfma_f32_16x16x32_f16 v[152:155], v[116:119], v[128:131], 0
  v_mul_f32 v24, v24, v8
  v_mul_f32 v25, v25, v8
  v_mfma_f32_16x16x32_f16 v[156:159], v[120:123], v[132:135], 0
  v_mul_f32 v26, v26, v8
  v_mul_f32 v27, v27, v8
  v_mfma_f32_16x16x32_f16 v[28:31], v[96:99], v[48:51], v[28:31]
  v_cvt_pk_bf16_f32 v24, v24, v25
  v_cvt_pk_bf16_f32 v25, v26, v27
  v_mfma_f32_16x16x32_f16 v[32:35], v[96:99], v[52:55], v[32:35]
  ds_write_b64 v9, v[24:25] offset:1024
  v_mfma_f32_16x16x32_f16 v[36:39], v[96:99], v[56:59], v[36:39]
  v_cvt_pk_f16_f32 v152, v152, v153
  v_cvt_pk_f16_f32 v153, v154, v155
  v_mfma_f32_16x16x32_f16 v[96:99], v[120:123], v[92:95], 0
  v_cvt_pk_f16_f32 v154, v156, v157
  v_cvt_pk_f16_f32 v155, v158, v159
  v_mfma_f32_16x16x32_f16 v[100:103], v[120:123], v[88:91], 0
  ds_read_b128 v[116:119], v12 offset:1040
  ds_read_b128 v[120:123], v12 offset:2032
  v_mfma_f32_16x16x32_f16 v[36:39], v[152:155], v[72:75], v[36:39]
  v_mfma_f32_16x16x32_f16 v[40:43], v[152:155], v[76:79], v[40:43]
  v_cvt_pk_f16_f32 v96, v96, v97
  v_cvt_pk_f16_f32 v97, v98, v99
  v_mfma_f32_16x16x32_f16 v[44:47], v[152:155], v[80:83], v[44:47]
  v_cvt_pk_f16_f32 v98, v100, v101
  v_cvt_pk_f16_f32 v99, v102, v103
  v_mfma_f32_16x16x32_f16 v[32:35], v[136:139], v[140:143], v[32:35]
  ds_read_b128 v[140:143], v12 offset:2048
  v_mfma_f32_16x16x32_f16 v[152:155], v[144:147], v[88:91], 0
  v_mfma_f32_16x16x32_f16 v[156:159], v[144:147], v[92:95], 0
  v_mfma_f32_16x16x32_f16 v[28:31], v[96:99], v[60:63], v[28:31]
  v_mov_b32 v7, 4
  v_mfma_f32_16x16x32_f16 v[32:35], v[96:99], v[64:67], v[32:35]
  v_cvt_pk_f16_f32 v152, v152, v153
  v_cvt_pk_f16_f32 v153, v154, v155
  v_mfma_f32_16x16x32_f16 v[36:39], v[96:99], v[68:71], v[36:39]
  v_cvt_pk_f16_f32 v154, v156, v157
  v_cvt_pk_f16_f32 v155, v158, v159
  v_mfma_f32_16x16x32_f16 v[96:99], v[144:147], v[128:131], 0
  v_mul_f32 v28, v28, v8
  s_waitcnt lgkmcnt(0)
  v_mfma_f32_16x16x32_f16 v[100:103], v[148:151], v[132:135], 0
  v_mul_f32 v29, v29, v8
  v_mul_f32 v30, v30, v8
  v_mfma_f32_16x16x32_f16 v[32:35], v[152:155], v[48:51], v[32:35]
  v_mul_f32 v31, v31, v8
  v_cvt_pk_bf16_f32 v28, v28, v29
  v_mfma_f32_16x16x32_f16 v[36:39], v[152:155], v[52:55], v[36:39]
  v_cvt_pk_f16_f32 v96, v96, v97
  v_cvt_pk_f16_f32 v97, v98, v99
  v_mfma_f32_16x16x32_f16 v[40:43], v[152:155], v[56:59], v[40:43]
  v_cvt_pk_f16_f32 v98, v100, v101
  v_cvt_pk_f16_f32 v99, v102, v103
  v_mfma_f32_16x16x32_f16 v[152:155], v[148:151], v[92:95], 0
  v_cvt_pk_bf16_f32 v29, v30, v31
  ds_read_b128 v[144:147], v12 offset:1552
  v_mfma_f32_16x16x32_f16 v[156:159], v[148:151], v[88:91], 0
  ds_write_b64 v9, v[28:29] offset:1536
  v_mfma_f32_16x16x32_f16 v[40:43], v[96:99], v[72:75], v[40:43]
  ds_write_b32 v15, v7 offset:48
  v_mfma_f32_16x16x32_f16 v[44:47], v[96:99], v[76:79], v[44:47]
  v_cvt_pk_f16_f32 v152, v152, v153
  v_cvt_pk_f16_f32 v153, v154, v155
  v_mfma_f32_16x16x32_f16 v[36:39], v[136:139], v[116:119], v[36:39]
  v_cvt_pk_f16_f32 v154, v156, v157
  v_cvt_pk_f16_f32 v155, v158, v159
  v_mfma_f32_16x16x32_f16 v[96:99], v[120:123], v[88:91], 0
  ds_read_b128 v[148:151], v12 offset:2544
  ds_read_b128 v[116:119], v12 offset:2560
  v_mfma_f32_16x16x32_f16 v[100:103], v[120:123], v[92:95], 0
  v_mfma_f32_16x16x32_f16 v[32:35], v[152:155], v[60:63], v[32:35]
  v_mfma_f32_16x16x32_f16 v[36:39], v[152:155], v[64:67], v[36:39]
  v_cvt_pk_f16_f32 v96, v96, v97
  v_cvt_pk_f16_f32 v97, v98, v99
  v_mfma_f32_16x16x32_f16 v[40:43], v[152:155], v[68:71], v[40:43]
  v_cvt_pk_f16_f32 v98, v100, v101
  v_cvt_pk_f16_f32 v99, v102, v103
  v_mfma_f32_16x16x32_f16 v[152:155], v[120:123], v[128:131], 0
  v_mul_f32 v32, v32, v8
  v_mul_f32 v33, v33, v8
  v_mfma_f32_16x16x32_f16 v[156:159], v[140:143], v[132:135], 0
  v_mul_f32 v34, v34, v8
  v_mul_f32 v35, v35, v8
  v_mfma_f32_16x16x32_f16 v[36:39], v[96:99], v[48:51], v[36:39]
  v_cvt_pk_bf16_f32 v32, v32, v33
  v_cvt_pk_bf16_f32 v33, v34, v35
  v_mfma_f32_16x16x32_f16 v[40:43], v[96:99], v[52:55], v[40:43]
  ds_write_b64 v9, v[32:33] offset:2048
  v_mfma_f32_16x16x32_f16 v[44:47], v[96:99], v[56:59], v[44:47]
  v_cvt_pk_f16_f32 v152, v152, v153
  v_cvt_pk_f16_f32 v153, v154, v155
  v_mfma_f32_16x16x32_f16 v[96:99], v[140:143], v[92:95], 0
  v_cvt_pk_f16_f32 v154, v156, v157
  v_cvt_pk_f16_f32 v155, v158, v159
  v_mfma_f32_16x16x32_f16 v[100:103], v[140:143], v[88:91], 0
  ds_read_b128 v[120:123], v12 offset:2064
  ds_read_b128 v[140:143], v12 offset:3056
  v_mfma_f32_16x16x32_f16 v[44:47], v[152:155], v[72:75], v[44:47]
  s_waitcnt lgkmcnt(3)
  v_mfma_f32_16x16x32_f16 v[40:43], v[136:139], v[144:147], v[40:43]
  v_cvt_pk_f16_f32 v96, v96, v97
  v_cvt_pk_f16_f32 v97, v98, v99
  v_mfma_f32_16x16x32_f16 v[152:155], v[148:151], v[88:91], 0
  v_cvt_pk_f16_f32 v98, v100, v101
  v_cvt_pk_f16_f32 v99, v102, v103
  v_mfma_f32_16x16x32_f16 v[156:159], v[148:151], v[92:95], 0
  ds_read_b128 v[144:147], v12 offset:3072
  v_mfma_f32_16x16x32_f16 v[36:39], v[96:99], v[60:63], v[36:39]
  v_mfma_f32_16x16x32_f16 v[40:43], v[96:99], v[64:67], v[40:43]
  v_cvt_pk_f16_f32 v152, v152, v153
  v_cvt_pk_f16_f32 v153, v154, v155
  v_mfma_f32_16x16x32_f16 v[44:47], v[96:99], v[68:71], v[44:47]
  v_cvt_pk_f16_f32 v154, v156, v157
  v_cvt_pk_f16_f32 v155, v158, v159
  v_mfma_f32_16x16x32_f16 v[96:99], v[116:119], v[92:95], 0
  v_mul_f32 v36, v36, v8
  v_mul_f32 v37, v37, v8
  v_mfma_f32_16x16x32_f16 v[100:103], v[116:119], v[88:91], 0
  v_mul_f32 v38, v38, v8
  v_mul_f32 v39, v39, v8
  v_mfma_f32_16x16x32_f16 v[40:43], v[152:155], v[48:51], v[40:43]
  v_cvt_pk_bf16_f32 v36, v36, v37
  v_cvt_pk_bf16_f32 v37, v38, v39
  v_mfma_f32_16x16x32_f16 v[44:47], v[152:155], v[52:55], v[44:47]
  v_cvt_pk_f16_f32 v96, v96, v97
  s_waitcnt lgkmcnt(0)
  v_mfma_f32_16x16x32_f16 v[44:47], v[136:139], v[120:123], v[44:47]
  ds_write_b64 v9, v[36:37] offset:2560
  v_mfma_f32_16x16x32_f16 v[152:155], v[140:143], v[88:91], 0
  v_cvt_pk_f16_f32 v97, v98, v99
  v_cvt_pk_f16_f32 v98, v100, v101
  v_mfma_f32_16x16x32_f16 v[156:159], v[140:143], v[92:95], 0
  v_cvt_pk_f16_f32 v99, v102, v103
  s_nop 1
  v_mfma_f32_16x16x32_f16 v[40:43], v[96:99], v[60:63], v[40:43]
  v_mfma_f32_16x16x32_f16 v[44:47], v[96:99], v[64:67], v[44:47]
  v_cvt_pk_f16_f32 v152, v152, v153
  v_cvt_pk_f16_f32 v153, v154, v155
  v_mfma_f32_16x16x32_f16 v[96:99], v[144:147], v[92:95], 0
  v_cvt_pk_f16_f32 v154, v156, v157
  v_cvt_pk_f16_f32 v155, v158, v159
  v_mfma_f32_16x16x32_f16 v[100:103], v[144:147], v[88:91], 0
  v_mul_f32 v40, v40, v8
  v_mul_f32 v41, v41, v8
  v_mfma_f32_16x16x32_f16 v[44:47], v[152:155], v[48:51], v[44:47]
  s_nop 1
  v_cvt_pk_f16_f32 v96, v96, v97
  v_cvt_pk_f16_f32 v97, v98, v99
  s_nop 0
  v_cvt_pk_f16_f32 v98, v100, v101
  v_cvt_pk_f16_f32 v99, v102, v103
  s_nop 1
  v_mfma_f32_16x16x32_f16 v[44:47], v[96:99], v[60:63], v[44:47]
  v_mul_f32 v42, v42, v8
  v_mul_f32 v43, v43, v8
  v_cvt_pk_bf16_f32 v40, v40, v41
  v_cvt_pk_bf16_f32 v41, v42, v43
  ds_write_b64 v9, v[40:41] offset:3072
  s_nop 2
  v_mul_f32 v44, v44, v8
  v_mul_f32 v45, v45, v8
  v_mul_f32 v46, v46, v8
  v_mul_f32 v47, v47, v8
  v_cvt_pk_bf16_f32 v44, v44, v45
  v_cvt_pk_bf16_f32 v45, v46, v47
  ds_write_b64 v9, v[44:45] offset:3584
  v_mov_b32 v7, 8
  ds_write_b32 v15, v7 offset:48
  s_endpgm
.p2align 6
K_FAR:
  ds_write_b128 v99, v[76:79]
  ds_write_b128 v99, v[80:83] offset:1024
  s_nop 0
  v_mov_b32 v94, 1
  ds_write_b32 v92, v94 offset:64
  s_branch K_PS2B
K_PS2:
K_PS2B:
  ds_read_b32 v94, v93 offset:64
  s_waitcnt lgkmcnt(0)
  v_cmp_gt_u32 vcc, 1, v94
  s_cbranch_vccnz K_PS2
  s_cmp_ge_u32 s30, 4
  s_cbranch_scc1 K_PS2_NO
  s_add_u32 m0, s36, 49152
  s_nop 0
  buffer_load_dwordx4 v88, s[8:11], s18 offen nt lds
  s_add_u32 m0, s36, 53248
  s_add_u32 s60, s18, 114688
  buffer_load_dwordx4 v88, s[8:11], s60 offen nt lds
  s_add_u32 m0, s36, 24576
  s_nop 0
  buffer_load_dwordx4 v88, s[4:7], s19 offen nt lds
  s_add_u32 m0, s36, 28672
  s_add_u32 s60, s19, 114688
  buffer_load_dwordx4 v88, s[4:7], s60 offen nt lds
K_PS2_NO:
  ds_read_b128 v[16:19], v99 offset:5120
  ds_read_b128 v[20:23], v99 offset:6144
  s_waitcnt lgkmcnt(1)
  v_pk_add_f32 v[80:81], v[80:81], v[16:17]
  v_pk_add_f32 v[82:83], v[82:83], v[18:19]
  s_waitcnt lgkmcnt(0)
  v_pk_add_f32 v[84:85], v[84:85], v[20:21]
  v_pk_add_f32 v[86:87], v[86:87], v[22:23]
  v_cvt_pk_f16_f32 v16, v80, v81
  v_cvt_pk_f16_f32 v17, v82, v83
  v_cvt_pk_f16_f32 v18, v84, v85
  v_cvt_pk_f16_f32 v19, v86, v87
  v_cvt_pk_f16_f32 v89, v84, v84
  s_mov_b32 exec_lo, 0
  ds_write_b16 v125, v17
  ds_write_b16 v125, v17 offset:1986
  ds_write_b16_d16_hi v124, v17
  ds_write_b16_d16_hi v124, v17 offset:1986
  s_mov_b32 exec_hi, -4
  ds_write_b16 v125, v16 offset:16
  ds_write_b16 v125, v16 offset:2002
  ds_write_b16_d16_hi v124, v16 offset:16
  ds_write_b16_d16_hi v124, v16 offset:2002
  s_mov_b32 exec_hi, 1
  s_mov_b32 exec_lo, -2
  ds_write_b16 v126, v18 offset:48
  ds_write_b16 v126, v18 offset:2034
  s_mov_b32 exec_hi, 0
  s_mov_b32 exec_lo, -1
  ds_write_b16_d16_hi v126, v18 offset:32
  ds_write_b16_d16_hi v126, v18 offset:2018
  ds_write_b16 v126, v19 offset:16
  ds_write_b16 v126, v19 offset:2002
  ds_write_b16_d16_hi v126, v19
  ds_write_b16_d16_hi v126, v19 offset:1986
  s_mov_b64 exec, -1
  v_or_b32 v127, 0x10000, v89
  s_lshl_b32 s79, s52, 2
  v_mov_b32 v4, s79
  v_mov_b32 v93, 1
  s_mov_b64 exec, 1
  ds_write_b32 v4, v127 offset:640
  s_mov_b64 exec, -1
  s_mov_b64 exec, 1
  s_waitcnt vmcnt(0)
  ds_add_u32 v15, v93 offset:112
  s_mov_b64 exec, -1
  s_setprio 3
  s_lshl_b32 s62, s29, 14
  s_lshl_b32 s79, s52, 9
  s_add_u32 s62, s62, s79
  s_add_u32 s62, s62, 0x450000
  s_add_u32 s63, s62, 4096
  s_add_u32 s64, s62, 8192
  s_add_u32 s65, s62, 12288
  s_lshl_b32 s73, s28, 11
  s_add_u32 s73, s73, s62
  s_lshl_b32 s77, s28, 16
  s_add_u32 s77, s77, 0x500000
  s_lshl_b32 s57, s29, 11
  s_add_u32 s57, s57, s79
  s_add_u32 s57, s57, s77
  s_mov_b64 s[54:55], s[14:15]
  s_mov_b32 s12, 0x07060503
  s_mov_b32 s13, 0x07060502
  s_mov_b32 s14, 0x07060501
  s_mov_b32 s15, 0x04000c0c
  s_mov_b32 s16, 0x0706000c
  s_lshl_b32 s18, s28, 8
  s_cmp_lg_u32 s30, 1
  s_cbranch_scc1 K_NOKP
  v_mov_b32 v92, 0x3f803f80
  v_mov_b32 v93, v92
  v_lshlrev_b32 v3, 3, v1
  v_add_u32 v3, 150400, v3
  ds_write_b64 v3, v[92:93]
  ds_write_b64 v3, v[92:93] offset:64
  v_lshlrev_b32 v2, 3, v1
  s_setprio 3
  s_lshl_b32 s60, s28, 10
  s_add_u32 s60, s60, 0x441000
  s_mov_b32 s83, 0x20000
  v_add_u32 v3, s18, v95
  s_mov_b32 m0, 149760
  s_branch K_KWB
K_KW:
  s_sleep 1
K_KWB:
  ds_read_b32 v93, v15 offset:20
  s_waitcnt lgkmcnt(0)
  v_cmp_gt_u32 vcc, 4, v93
  s_cbranch_vccnz K_KW
  ds_read_b64 v[72:73], v2 offset:128
  ds_read_b32 v5, v15 offset:8
  ds_read2_b32 v[74:75], v15 offset0:0 offset1:0
  s_lshl_b32 s61, s29, 5
  s_add_u32 s61, s61, s60
  s_waitcnt lgkmcnt(0)
  v_readfirstlane_b32 s46, v74
  v_readfirstlane_b32 s47, v5
  s_nop 0
  s_sub_u32 s47, s47, 1
  v_mov_b32 v80, v72
  s_nop 1
  v_max_u32_dpp v80, v80, v80 quad_perm:[1,0,3,2] row_mask:0xf bank_mask:0xf
  s_nop 1
  v_max_u32_dpp v80, v80, v80 quad_perm:[2,3,0,1] row_mask:0xf bank_mask:0xf
  s_nop 1
  v_max_u32_dpp v80, v80, v80 row_half_mirror row_mask:0xf bank_mask:0xf
  s_nop 1
  v_max_u32_dpp v80, v80, v80 row_mirror row_mask:0xf bank_mask:0xf
  s_nop 1
  v_max_u32_dpp v80, v80, v80 row_bcast:15 row_mask:0xa bank_mask:0xf
  s_nop 1
  v_max_u32_dpp v80, v80, v80 row_bcast:31 row_mask:0xc bank_mask:0xf
  s_nop 0
  v_readlane_b32 s78, v80, 63
  s_nop 1
  v_cmp_ne_u32 s[66:67], s78, v72
  s_nop 1
  v_cndmask_b32 v80, 0, v72, s[66:67]
  s_nop 1
  v_max_u32_dpp v80, v80, v80 quad_perm:[1,0,3,2] row_mask:0xf bank_mask:0xf
  s_nop 1
  v_max_u32_dpp v80, v80, v80 quad_perm:[2,3,0,1] row_mask:0xf bank_mask:0xf
  s_nop 1
  v_max_u32_dpp v80, v80, v80 row_half_mirror row_mask:0xf bank_mask:0xf
  s_nop 1
  v_max_u32_dpp v80, v80, v80 row_mirror row_mask:0xf bank_mask:0xf
  s_nop 1
  v_max_u32_dpp v80, v80, v80 row_bcast:15 row_mask:0xa bank_mask:0xf
  s_nop 1
  v_max_u32_dpp v80, v80, v80 row_bcast:31 row_mask:0xc bank_mask:0xf
  s_nop 0
  v_readlane_b32 s79, v80, 63
  v_cndmask_b32 v80, 0, 16, s[66:67]
  s_nop 0
  v_cmp_le_u32 vcc, s79, v72
  s_nop 0
  s_mov_b64 exec, vcc
  s_cmp_lg_u32 s47, 0
  s_cbranch_scc1 K_KS_W
  buffer_store_dwordx4 v[72:75], v80, s[32:35], s61 offen
  s_branch K_KS_D
K_KS_W:
  buffer_store_dwordx4 v[72:75], v80, s[32:35], s61 offen sc1
K_KS_D:
  s_lshl_b32 s61, s28, 9
  s_add_u32 s61, s61, s29
  s_lshl1_add_u32 s61, s61, 0x2000
  s_mov_b64 exec, 0xffff
  v_lshlrev_b32 v80, 6, v1
  s_mov_b64 exec, -1
  buffer_load_dwordx4 v[76:79], v95, s[32:35], s60 offen sc1
  s_mov_b32 exec_lo, 0xfff00000
  v_add_u32 v3, -320, v3
  s_mov_b32 exec_lo, -1
  s_mov_b64 s[70:71], 0
K_P3:
  s_waitcnt vmcnt(0)
  v_cmp_eq_u32 s[68:69], s46, v78
  v_mov_b32 v73, v77
  s_nop 0
  v_cndmask_b32 v72, 0, v76, s[68:69]
  s_cmp_eq_u64 s[68:69], -1
  s_cbranch_scc1 K_P3N
  buffer_load_dwordx4 v[76:79], v95, s[32:35], s60 offen sc1
  s_branch K_P3M
K_P3N:
K_P3M:
  v_mov_b32 v80, v72
  s_nop 1
  v_max_u32_dpp v80, v80, v80 quad_perm:[1,0,3,2] row_mask:0xf bank_mask:0xf
  s_nop 1
  v_max_u32_dpp v80, v80, v80 quad_perm:[2,3,0,1] row_mask:0xf bank_mask:0xf
  s_nop 1
  v_max_u32_dpp v80, v80, v80 row_half_mirror row_mask:0xf bank_mask:0xf
  s_nop 1
  v_max_u32_dpp v80, v80, v80 row_mirror row_mask:0xf bank_mask:0xf
  s_nop 1
  v_max_u32_dpp v80, v80, v80 row_bcast:15 row_mask:0xa bank_mask:0xf
  s_nop 1
  v_max_u32_dpp v80, v80, v80 row_bcast:31 row_mask:0xc bank_mask:0xf
  s_nop 0
  v_readlane_b32 s78, v80, 63
  s_nop 1
  v_cmp_ne_u32 s[66:67], s78, v72
  s_nop 1
  v_cndmask_b32 v80, 0, v72, s[66:67]
  s_nop 1
  v_max_u32_dpp v80, v80, v80 quad_perm:[1,0,3,2] row_mask:0xf bank_mask:0xf
  s_nop 1
  v_max_u32_dpp v80, v80, v80 quad_perm:[2,3,0,1] row_mask:0xf bank_mask:0xf
  s_nop 1
  v_max_u32_dpp v80, v80, v80 row_half_mirror row_mask:0xf bank_mask:0xf
  s_nop 1
  v_max_u32_dpp v80, v80, v80 row_mirror row_mask:0xf bank_mask:0xf
  s_nop 1
  v_max_u32_dpp v80, v80, v80 row_bcast:15 row_mask:0xa bank_mask:0xf
  s_nop 1
  v_max_u32_dpp v80, v80, v80 row_bcast:31 row_mask:0xc bank_mask:0xf
  s_nop 0
  v_readlane_b32 s79, v80, 63
  s_nop 0
  s_cmp_eq_u64 s[78:79], s[70:71]
  s_cbranch_scc1 K_P3S
  s_mov_b64 s[70:71], s[78:79]
  s_andn2_b32 s78, 0xffe, s78
  s_andn2_b32 s61, 0xffe, s79
  v_mov_b32 v92, s78
  s_mov_b32 exec_lo, 0xfff00000
  s_mov_b32 exec_hi, 15
  v_mov_b32 v92, s61
  s_mov_b32 exec_lo, 0xfff0ffff
  v_lshl_add_u32 v92, v92, 10, v3
  global_load_lds_dwordx4 v92, s[44:45]
  s_mov_b64 exec, -1
K_P3S:
  s_sub_u32 s83, s83, 1
  s_cbranch_scc1 K_P3D
  s_cmp_lg_u64 s[68:69], -1
  s_cbranch_scc1 K_P3
K_P3D:
  ds_write_b32 v15, v93 offset:692
  v_cndmask_b32 v80, 0, 8, s[66:67]
  v_cmp_le_u32 vcc, s79, v72
  s_nop 0
  s_mov_b64 exec, vcc
  v_mov_b32 v93, 1
  ds_write_b64 v80, v[72:73] offset:96
  s_waitcnt vmcnt(0)
  ds_write_b32 v15, v93 offset:120
  s_mov_b64 exec, 1
  s_cmp_lg_u32 s2, 0
  s_cbranch_scc1 K_NOZ
  s_mov_b32 s78, 0x0
  buffer_store_dword v74, v15, s[32:35], s78 offen sc1
  s_mov_b32 s78, 0x580000
  v_mov_b32 v75, 0x01000193
  buffer_atomic_add v75, v15, s[32:35], s78 offen sc1
K_NOZ:
  s_mov_b64 exec, -1
  s_setprio 3
K_NOKP:
  s_branch K_XWB
K_XW:
  s_sleep 4
K_XWB:
  ds_read_b32 v92, v15 offset:120
  s_waitcnt lgkmcnt(0)
  v_cmp_eq_u32 vcc, 0, v92
  s_cbranch_vccnz K_XW
  s_mov_b32 m0, 82176
  s_mov_b32 exec_hi, 0
  s_mov_b32 exec_hi, -1
  ds_read_b32 v5, v15 offset:8
  ds_read_b128 v[40:43], v15 offset:96
  ds_read_b32 v90, v15 offset:0
  ds_read_b128 v[48:51], v10 offset:0
  ds_read_b128 v[52:55], v10 offset:64
  ds_read_b128 v[56:59], v10 offset:128
  ds_read_b128 v[60:63], v10 offset:192
  s_waitcnt lgkmcnt(4)
  v_mov_b32 v93, 1
  v_mov_b32 v35, v90
  v_and_b32 v44, 0xffff0000, v41
  v_and_b32 v45, 0xffff0000, v43
  v_lshlrev_b32 v46, 16, v41
  v_lshlrev_b32 v47, 16, v43
  v_rcp_f32 v44, v44
  v_rcp_f32 v45, v45
  v_readfirstlane_b32 s47, v5
  s_nop 0
  s_sub_u32 s47, s47, 1
  s_cmp_ge_u32 s29, 28
  s_cbranch_scc1 K_NOFFN
  s_setprio 3
  s_branch K_EWB
K_EW:
  s_sleep 1
K_EWB:
  ds_read_b32 v92, v15 offset:112
  s_waitcnt lgkmcnt(0)
  v_cmp_gt_u32 vcc, 8, v92
  s_cbranch_vccnz K_EW
  ds_read_b64_tr_b16 v[64:65], v11 offset:0
  ds_read_b64_tr_b16 v[66:67], v11 offset:1024
  ds_read_b64_tr_b16 v[68:69], v12 offset:0
  ds_read_b64_tr_b16 v[70:71], v12 offset:1024
  ds_read_b64_tr_b16 v[72:73], v11 offset:32768
  ds_read_b64_tr_b16 v[74:75], v11 offset:33792
  ds_read_b64_tr_b16 v[76:77], v12 offset:32768
  ds_read_b64_tr_b16 v[78:79], v12 offset:33792
  ds_read_b64_tr_b16 v[80:81], v11 offset:8192
  ds_read_b64_tr_b16 v[82:83], v11 offset:9216
  ds_read_b64_tr_b16 v[84:85], v12 offset:8192
  ds_read_b64_tr_b16 v[86:87], v12 offset:9216
  s_waitcnt lgkmcnt(10)
  v_mfma_f32_16x16x32_bf16 v[16:19], v[48:51], v[64:67], 0
  ds_read_b64_tr_b16 v[64:65], v11 offset:40960
  ds_read_b64_tr_b16 v[66:67], v11 offset:41984
  s_waitcnt lgkmcnt(10)
  v_mfma_f32_16x16x32_bf16 v[24:27], v[48:51], v[68:71], 0
  ds_read_b64_tr_b16 v[68:69], v12 offset:40960
  ds_read_b64_tr_b16 v[70:71], v12 offset:41984
  s_waitcnt lgkmcnt(10)
  v_mfma_f32_16x16x32_bf16 v[20:23], v[48:51], v[72:75], 0
  ds_read_b64_tr_b16 v[72:73], v11 offset:16384
  ds_read_b64_tr_b16 v[74:75], v11 offset:17408
  s_waitcnt lgkmcnt(10)
  v_mfma_f32_16x16x32_bf16 v[28:31], v[48:51], v[76:79], 0
  ds_read_b64_tr_b16 v[76:77], v12 offset:16384
  ds_read_b64_tr_b16 v[78:79], v12 offset:17408
  s_waitcnt lgkmcnt(10)
  v_mfma_f32_16x16x32_bf16 v[16:19], v[52:55], v[80:83], v[16:19]
  ds_read_b64_tr_b16 v[80:81], v11 offset:49152
  ds_read_b64_tr_b16 v[82:83], v11 offset:50176
  s_waitcnt lgkmcnt(10)
  v_mfma_f32_16x16x32_bf16 v[24:27], v[52:55], v[84:87], v[24:27]
  ds_read_b64_tr_b16 v[84:85], v12 offset:49152
  ds_read_b64_tr_b16 v[86:87], v12 offset:50176
  s_waitcnt lgkmcnt(10)
  v_mfma_f32_16x16x32_bf16 v[20:23], v[52:55], v[64:67], v[20:23]
  ds_read_b64_tr_b16 v[64:65], v11 offset:24576
  ds_read_b64_tr_b16 v[66:67], v11 offset:25600
  s_waitcnt lgkmcnt(10)
  v_mfma_f32_16x16x32_bf16 v[28:31], v[52:55], v[68:71], v[28:31]
  ds_read_b64_tr_b16 v[68:69], v12 offset:24576
  ds_read_b64_tr_b16 v[70:71], v12 offset:25600
  s_waitcnt lgkmcnt(10)
  v_mfma_f32_16x16x32_bf16 v[16:19], v[56:59], v[72:75], v[16:19]
  s_waitcnt lgkmcnt(8)
  v_mfma_f32_16x16x32_bf16 v[24:27], v[56:59], v[76:79], v[24:27]
  s_waitcnt lgkmcnt(6)
  v_mfma_f32_16x16x32_bf16 v[20:23], v[56:59], v[80:83], v[20:23]
  s_waitcnt lgkmcnt(4)
  v_mfma_f32_16x16x32_bf16 v[28:31], v[56:59], v[84:87], v[28:31]
  s_waitcnt lgkmcnt(2)
  v_mfma_f32_16x16x32_bf16 v[16:19], v[60:63], v[64:67], v[16:19]
  s_waitcnt lgkmcnt(0)
  v_mfma_f32_16x16x32_bf16 v[24:27], v[60:63], v[68:71], v[24:27]
  s_branch K_GWB
K_GW:
  s_sleep 1
K_GWB:
  ds_read_b32 v92, v15 offset:24
  s_waitcnt lgkmcnt(0)
  v_cmp_gt_u32 vcc, 4, v92
  s_cbranch_vccnz K_GW
  ds_read_b64_tr_b16 v[64:65], v11 offset:57344
  ds_read_b64_tr_b16 v[66:67], v11 offset:58368
  ds_read_b64_tr_b16 v[68:69], v12 offset:57344
  ds_read_b64_tr_b16 v[70:71], v12 offset:58368
  s_waitcnt lgkmcnt(2)
  v_mfma_f32_16x16x32_bf16 v[20:23], v[60:63], v[64:67], v[20:23]
  s_waitcnt lgkmcnt(0)
  v_mfma_f32_16x16x32_bf16 v[28:31], v[60:63], v[68:71], v[28:31]
  s_mov_b32 exec_lo, 0xffff0000
  s_mov_b32 exec_hi, 0
  v_mov_b32 v16, v24
  v_mov_b32 v17, v25
  v_mov_b32 v18, v26
  s_nop 2
  v_mov_b32 v20, v28
  v_mov_b32 v21, v29
  v_mov_b32 v22, v30
  s_mov_b32 exec_lo, -1
  v_fma_f32 v16, -v46, v18, v16
  v_fma_f32 v17, -v47, v18, v17
  v_fma_f32 v18, -v46, v22, v20
  v_fma_f32 v19, -v47, v22, v21
  v_mul_f32 v16, v16, v44
  v_mul_f32 v17, v17, v45
  v_mul_f32 v19, v19, v45
  v_mul_f32 v18, v18, v44
  v_perm_b32 v32, v16, v19, s12
  v_perm_b32 v33, v17, v19, s13
  v_perm_b32 v34, v18, v19, s14
  buffer_store_dwordx4 v[32:35], v95, s[32:35], s73 offen sc1
  s_mov_b32 exec_hi, -1
K_NOFFN:
  s_cmp_lg_u32 s30, 1
  s_cbranch_scc1 K_NOFP
  s_setprio 0
  v_and_b32 v3, 16, v1
  v_lshrrev_b32 v3, 1, v3
  ds_read_b64 v[100:101], v3 offset:96
  v_and_b32 v7, 3, v1
  v_lshl_add_u32 v5, v7, 3, s3
  v_lshlrev_b32 v5, 1, v5
  global_load_ushort v102, v5, s[54:55]
  v_lshrrev_b32 v106, 2, v1
  v_lshlrev_b32 v106, 11, v106
  v_lshl_add_u32 v106, v7, 4, v106
  s_lshl_b32 s61, s29, 6
  s_add_u32 s60, s77, s61
  s_add_u32 s61, s60, 0x8000
  s_waitcnt lgkmcnt(0)
  v_not_b32 v6, v100
  v_and_b32 v6, 0xffe, v6
  v_mul_u32_u24 v104, 4160, v7
  v_add_u32 v104, v104, v6
  v_lshl_add_u32 v107, v6, 10, v5
  global_load_ushort v103, v107, s[44:45]
  v_and_b32 v5, s31, v100
  v_ashrrev_i32 v3, 31, v5
  v_not_b32 v3, v3
  v_or_b32 v3, 0x80000000, v3
  v_xor_b32 v5, v5, v3
  v_and_b32 v5, s31, v5
  v_mul_f32 v105, s58, v5
  v_exp_f32 v105, -v105
  v_and_b32 v108, s31, v101
  v_lshlrev_b32 v101, 16, v101
  v_add_f32 v105, 1.0, v105
  v_rcp_f32 v105, v105
  v_rcp_f32 v109, v108
  s_nop 0
  v_fma_f32 v108, -v108, v109, 1.0
  v_fmac_f32 v109, v108, v109
  v_cvt_pk_bf16_f32 v105, 0, v105
  s_setprio 3
  s_branch K_FPD
K_NOFP:
  s_sleep 8
K_FPD:
  s_cmp_ge_u32 s29, 28
  s_cbranch_scc1 K_NOG2
  s_mov_b32 s83, 0x20000
  buffer_load_dwordx4 v[64:67], v14, s[32:35], s62 offen sc1
  buffer_load_dwordx4 v[68:71], v14, s[32:35], s63 offen sc1
  buffer_load_dwordx4 v[72:75], v14, s[32:35], s64 offen sc1
  buffer_load_dwordx4 v[76:79], v14, s[32:35], s65 offen sc1
  s_waitcnt vmcnt(0)
  ds_read_b32 v91, v15 offset:124
  v_bitop3_b32 v92, v67, v71, v90 bitop3:0x7e
  v_bitop3_b32 v88, v75, v79, v90 bitop3:0x7e
  v_or_b32 v92, v92, v88
  v_cmp_ne_u32 vcc, 0, v92
  s_cbranch_vccnz K_P4
K_P4D:
  v_perm_b32 v67, v64, v65, s15
  v_perm_b32 v71, v68, v69, s15
  v_perm_b32 v75, v72, v73, s15
  v_perm_b32 v79, v76, v77, s15
  v_perm_b32 v67, v67, v66, s16
  v_perm_b32 v71, v71, v70, s16
  v_perm_b32 v75, v75, v74, s16
  v_perm_b32 v79, v79, v78, s16
  s_waitcnt lgkmcnt(0)
  v_cmp_gt_u32 vcc, 4, v91
  s_cbranch_vccnz K_WW
K_WWD:
  v_add_f32 v64, v64, v72
  v_add_f32 v65, v65, v73
  v_add_f32 v66, v66, v74
  v_add_f32 v67, v67, v75
  v_add_f32 v68, v68, v76
  v_add_f32 v69, v69, v77
  v_add_f32 v70, v70, v78
  v_add_f32 v71, v71, v79
  v_add_f32 v64, v64, v68
  v_add_f32 v65, v65, v69
  v_add_f32 v66, v66, v70
  v_add_f32 v67, v67, v71
  ds_read_b64_tr_b16 v[40:41], v9 offset:0
  v_permlane32_swap_b32 v64, v65
  ds_read_b64_tr_b16 v[42:43], v9 offset:1024
  v_permlane32_swap_b32 v66, v67
  ds_read_b64_tr_b16 v[44:45], v9 offset:8
  v_add_f32 v64, v64, v65
  ds_read_b64_tr_b16 v[46:47], v9 offset:1032
  v_add_f32 v66, v66, v67
  ds_read_b64_tr_b16 v[80:81], v9 offset:8192
  v_cvt_pk_bf16_f32 v64, 0, v64
  ds_read_b64_tr_b16 v[82:83], v9 offset:9216
  v_cvt_pk_bf16_f32 v66, 0, v66
  ds_read_b64_tr_b16 v[84:85], v9 offset:8200
  v_mul_f32 v65, 0xbfb8aa3b, v64
  ds_read_b64_tr_b16 v[86:87], v9 offset:9224
  v_mul_f32 v66, v66, v64
  ds_read_b64_tr_b16 v[112:113], v9 offset:16384
  v_exp_f32 v65, v65
  ds_read_b64_tr_b16 v[114:115], v9 offset:17408
  v_add_f32 v65, 1.0, v65
  ds_read_b64_tr_b16 v[116:117], v9 offset:16392
  v_rcp_f32 v65, v65
  ds_read_b64_tr_b16 v[118:119], v9 offset:17416
  v_mul_f32 v65, v65, v66
  v_cvt_pk_bf16_f32 v65, v65, v65
  ds_write_b16 v13, v65
  s_mov_b64 exec, 1
  ds_add_u32 v15, v93 offset:116
  s_mov_b64 exec, -1
  s_waitcnt lgkmcnt(8)
  ds_read_b64_tr_b16 v[120:121], v9 offset:24576
  ds_read_b64_tr_b16 v[122:123], v9 offset:25600
  ds_read_b64_tr_b16 v[124:125], v9 offset:24584
  ds_read_b64_tr_b16 v[126:127], v9 offset:25608
  s_branch K_HWB
K_HW:
K_HWB:
  ds_read_b32 v92, v15 offset:116
  s_waitcnt lgkmcnt(0)
  v_cmp_gt_u32 vcc, 4, v92
  s_cbranch_vccnz K_HW
  ds_read_b128 v[48:51], v10 offset:1280
  ds_read_b128 v[52:55], v10 offset:1344
  ds_read_b128 v[56:59], v10 offset:1408
  ds_read_b128 v[60:63], v10 offset:1472
  s_waitcnt lgkmcnt(3)
  v_mfma_f32_16x16x32_bf16 v[16:19], v[48:51], v[40:43], 0
  v_mfma_f32_16x16x32_bf16 v[20:23], v[48:51], v[44:47], 0
  s_waitcnt lgkmcnt(2)
  v_mfma_f32_16x16x32_bf16 v[16:19], v[52:55], v[80:83], v[16:19]
  v_mfma_f32_16x16x32_bf16 v[20:23], v[52:55], v[84:87], v[20:23]
  s_waitcnt lgkmcnt(1)
  v_mfma_f32_16x16x32_bf16 v[16:19], v[56:59], v[112:115], v[16:19]
  v_mfma_f32_16x16x32_bf16 v[20:23], v[56:59], v[116:119], v[20:23]
  s_waitcnt lgkmcnt(0)
  v_mfma_f32_16x16x32_bf16 v[16:19], v[60:63], v[120:123], v[16:19]
  v_mfma_f32_16x16x32_bf16 v[20:23], v[60:63], v[124:127], v[20:23]
  s_mov_b64 exec, 0xffff
  s_nop 5
  v_mov_b32 v18, v90
  v_mov_b32 v22, v90
  s_cmp_lg_u32 s47, 0
  s_cbranch_scc1 K_DS_W
  buffer_store_dwordx3 v[16:18], v8, s[32:35], s57 offen
  buffer_store_dwordx3 v[20:22], v8, s[32:35], s57 offen offset:256
  s_branch K_DS_D
K_DS_W:
  buffer_store_dwordx3 v[16:18], v8, s[32:35], s57 offen sc1
  buffer_store_dwordx3 v[20:22], v8, s[32:35], s57 offen offset:256 sc1
K_DS_D:
  s_mov_b64 exec, -1
K_NOG2:
  s_cmp_lg_u32 s30, 1
  s_cbranch_scc1 K_CDONE
  s_branch K_YAB
K_YA:
  s_sleep 2
K_YAB:
  ds_read_b128 v[32:35], v15 offset:48
  ds_read_u16 v40, v104 offset:56320
  s_waitcnt lgkmcnt(1)
  v_and_b32 v92, v32, v33
  v_bitop3_b32 v92, v92, v34, v35 bitop3:0x80
  v_cmp_ne_u32 vcc, 8, v92
  s_cbranch_vccnz K_YA
  v_mov_b32 v52, 0
  v_mov_b32 v53, 0
  v_mov_b32 v54, v90
  buffer_load_dwordx3 v[48:50], v106, s[32:35], s60 offen sc1
  s_mov_b32 exec_hi, 0x5ffff
  buffer_load_dwordx3 v[52:54], v106, s[32:35], s61 offen sc1
  s_mov_b32 exec_hi, -1
  s_mov_b32 s83, 0x20000
  s_waitcnt vmcnt(2) lgkmcnt(0)
  v_lshlrev_b32 v103, 16, v103
  v_lshlrev_b32 v102, 16, v102
  v_lshlrev_b32 v40, 16, v40
  v_sub_f32 v25, v103, v101
  v_cvt_pk_bf16_f32 v25, 0, v25
  v_mul_f32 v25, v25, v109
  v_cvt_pk_bf16_f32 v25, 0, v25
  v_mul_f32 v26, v25, v102
  v_cvt_pk_bf16_f32 v26, 0, v26
  v_add_f32 v26, v26, v40
  v_cvt_pk_bf16_f32 v26, 0, v26
  s_waitcnt vmcnt(0)
  s_branch K_DC
K_DP:
  buffer_load_dwordx3 v[48:50], v106, s[32:35], s60 offen sc1
  s_mov_b32 exec_hi, 0x5ffff
  buffer_load_dwordx3 v[52:54], v106, s[32:35], s61 offen sc1
  s_mov_b32 exec_hi, -1
  s_sub_u32 s83, s83, 1
  s_waitcnt vmcnt(0)
  s_cbranch_scc1 K_DD
K_DC:
  v_bitop3_b32 v92, v50, v54, v90 bitop3:0x7e
  v_cmp_ne_u32 vcc, 0, v92
  s_cbranch_vccnz K_DP
K_DD:
  v_pk_add_f32 v[48:49], v[48:49], v[52:53]
  s_nop 1
  v_permlane16_swap_b32 v48, v49
  v_add_f32 v48, v48, v49
  v_mov_b32 v49, v48
  s_nop 1
  v_permlane32_swap_b32 v48, v49
  v_add_f32 v48, v48, v49
  s_nop 1
  v_add_f32_dpp v48, v48, v48 row_ror:4 row_mask:0xf bank_mask:0xf
  s_nop 1
  v_add_f32_dpp v48, v48, v48 row_ror:8 row_mask:0xf bank_mask:0xf
  v_fma_f32 v20, v48, v105, v25
  v_mul_f32 v23, 0xbfb8aa3b, v20
  v_mul_f32 v20, v20, v26
  v_exp_f32 v23, v23
  s_nop 0
  v_add_f32 v23, 1.0, v23
  v_rcp_f32 v23, v23
  s_nop 0
  v_fma_f32 v23, v23, v20, v103
  v_cvt_pk_bf16_f32 v23, v23, v23
  s_mov_b64 exec, 0x000f000f
  global_store_short v107, v23, s[26:27]
K_CDONE:
  s_endpgm
K_WW:
  ds_read_b32 v91, v15 offset:124
  s_waitcnt lgkmcnt(0)
  v_cmp_gt_u32 vcc, 4, v91
  s_cbranch_vccnz K_WW
  s_branch K_WWD
K_P4:
  s_sleep 2
  v_cmp_ne_u32 vcc, v67, v90
  s_cbranch_vccz K_P4_0
  s_mov_b64 exec, vcc
  buffer_load_dwordx4 v[64:67], v14, s[32:35], s62 offen sc1
  s_mov_b64 exec, -1
K_P4_0:
  v_cmp_ne_u32 vcc, v71, v90
  s_cbranch_vccz K_P4_1
  s_mov_b64 exec, vcc
  buffer_load_dwordx4 v[68:71], v14, s[32:35], s63 offen sc1
  s_mov_b64 exec, -1
K_P4_1:
  v_cmp_ne_u32 vcc, v75, v90
  s_cbranch_vccz K_P4_2
  s_mov_b64 exec, vcc
  buffer_load_dwordx4 v[72:75], v14, s[32:35], s64 offen sc1
  s_mov_b64 exec, -1
K_P4_2:
  v_cmp_ne_u32 vcc, v79, v90
  s_cbranch_vccz K_P4_3
  s_mov_b64 exec, vcc
  buffer_load_dwordx4 v[76:79], v14, s[32:35], s65 offen sc1
  s_mov_b64 exec, -1
K_P4_3:
  s_sub_u32 s83, s83, 1
  s_waitcnt vmcnt(0)
  v_bitop3_b32 v92, v67, v71, v90 bitop3:0x7e
  v_bitop3_b32 v88, v75, v79, v90 bitop3:0x7e
  s_cbranch_scc1 K_P4D
  v_or_b32 v92, v92, v88
  v_cmp_ne_u32 vcc, 0, v92
  s_cbranch_vccnz K_P4
  s_branch K_P4D
K_END:
  s_endpgm
.p2align 4
.type K_BAND,@object
.size K_BAND, 5120
K_BAND:
.long 0x0, 0x0, 0x0, 0x3c003c00
.long 0x0, 0x0, 0x0, 0x3c000000
.long 0x0, 0x0, 0x0, 0x0
.long 0x0, 0x0, 0x0, 0x0
.long 0x0, 0x0, 0x0, 0x0
.long 0x0, 0x0, 0x0, 0x0
.long 0x0, 0x0, 0x0, 0x0
.long 0x0, 0x0, 0x0, 0x0
.long 0x0, 0x0, 0x0, 0x0
.long 0x0, 0x0, 0x0, 0x0
.long 0x0, 0x0, 0x0, 0x0
.long 0x0, 0x0, 0x0, 0x0
.long 0x0, 0x0, 0x0, 0x0
.long 0x0, 0x0, 0x0, 0x0
.long 0x0, 0x0, 0x0, 0x0
.long 0x0, 0x0, 0x0, 0x0
.long 0x3c003c00, 0x3c00, 0x0, 0x0
.long 0x3c003c00, 0x3c003c00, 0x0, 0x0
.long 0x3c003c00, 0x3c003c00, 0x3c00, 0x0
.long 0x3c000000, 0x3c003c00, 0x3c003c00, 0x0
.long 0x0, 0x3c003c00, 0x3c003c00, 0x3c00
.long 0x0, 0x3c000000, 0x3c003c00, 0x3c003c00
.long 0x0, 0x0, 0x3c003c00, 0x3c003c00
.long 0x0, 0x0, 0x3c000000, 0x3c003c00
.long 0x0, 0x0, 0x0, 0x3c003c00
.long 0x0, 0x0, 0x0, 0x3c000000
.long 0x0, 0x0, 0x0, 0x0
.long 0x0, 0x0, 0x0, 0x0
.long 0x0, 0x0, 0x0, 0x0
.long 0x0, 0x0, 0x0, 0x0
.long 0x0, 0x0, 0x0, 0x0
.long 0x0, 0x0, 0x0, 0x0
.long 0x0, 0x0, 0x0, 0x0
.long 0x0, 0x0, 0x0, 0x0
.long 0x0, 0x0, 0x0, 0x0
.long 0x0, 0x0, 0x0, 0x0
.long 0x0, 0x0, 0x0, 0x0
.long 0x0, 0x0, 0x0, 0x0
.long 0x3c00, 0x0, 0x0, 0x0
.long 0x3c003c00, 0x0, 0x0, 0x0
.long 0x3c003c00, 0x3c00, 0x0, 0x0
.long 0x3c003c00, 0x3c003c00, 0x0, 0x0
.long 0x3c003c00, 0x3c003c00, 0x3c00, 0x0
.long 0x3c000000, 0x3c003c00, 0x3c003c00, 0x0
.long 0x0, 0x3c003c00, 0x3c003c00, 0x3c00
.long 0x0, 0x3c000000, 0x3c003c00, 0x3c003c00
.long 0x0, 0x0, 0x3c003c00, 0x3c003c00
.long 0x0, 0x0, 0x3c000000, 0x3c003c00
.long 0x0, 0x0, 0x0, 0x0
.long 0x0, 0x0, 0x0, 0x0
.long 0x0, 0x0, 0x0, 0x0
.long 0x0, 0x0, 0x0, 0x0
.long 0x0, 0x0, 0x0, 0x0
.long 0x0, 0x0, 0x0, 0x0
.long 0x0, 0x0, 0x0, 0x0
.long 0x0, 0x0, 0x0, 0x0
.long 0x0, 0x0, 0x0, 0x0
.long 0x0, 0x0, 0x0, 0x0
.long 0x0, 0x0, 0x0, 0x0
.long 0x0, 0x0, 0x0, 0x0
.long 0x0, 0x0, 0x0, 0x0
.long 0x0, 0x0, 0x0, 0x0
.long 0x3c00, 0x0, 0x0, 0x0
.long 0x3c003c00, 0x0, 0x0, 0x0
.long 0x0, 0x0, 0x0, 0x0
.long 0x0, 0x0, 0x0, 0x0
.long 0x0, 0x0, 0x0, 0x0
.long 0x0, 0x0, 0x0, 0x0
.long 0x0, 0x0, 0x0, 0x0
.long 0x0, 0x0, 0x0, 0x0
.long 0x0, 0x0, 0x0, 0x0
.long 0x0, 0x0, 0x0, 0x0
.long 0x0, 0x0, 0x0, 0x0
.long 0x0, 0x0, 0x0, 0x0
.long 0x0, 0x0, 0x0, 0x0
.long 0x0, 0x0, 0x0, 0x0
.long 0x0, 0x0, 0x0, 0x0
.long 0x0, 0x0, 0x0, 0x0
.long 0x0, 0x0, 0x0, 0x0
.long 0x0, 0x0, 0x0, 0x0
.long 0x0, 0x3c000000, 0x3c003c00, 0x0
.long 0x0, 0x0, 0x3c003c00, 0x3c00
.long 0x0, 0x0, 0x3c000000, 0x3c003c00
.long 0x0, 0x0, 0x0, 0x3c003c00
.long 0x0, 0x0, 0x0, 0x3c000000
.long 0x0, 0x0, 0x0, 0x0
.long 0x0, 0x0, 0x0, 0x0
.long 0x0, 0x0, 0x0, 0x0
.long 0x0, 0x0, 0x0, 0x0
.long 0x0, 0x0, 0x0, 0x0
.long 0x0, 0x0, 0x0, 0x0
.long 0x0, 0x0, 0x0, 0x0
.long 0x0, 0x0, 0x0, 0x0
.long 0x0, 0x0, 0x0, 0x0
.long 0x0, 0x0, 0x0, 0x0
.long 0x0, 0x0, 0x0, 0x0
.long 0x0, 0x0, 0x0, 0x0
.long 0x0, 0x0, 0x0, 0x0
.long 0x0, 0x0, 0x0, 0x0
.long 0x3c00, 0x0, 0x0, 0x0
.long 0x3c003c00, 0x0, 0x0, 0x0
.long 0x3c003c00, 0x3c00, 0x0, 0x0
.long 0x3c000000, 0x3c003c00, 0x0, 0x0
.long 0x0, 0x3c003c00, 0x3c00, 0x0
.long 0x0, 0x3c000000, 0x3c003c00, 0x0
.long 0x0, 0x0, 0x3c003c00, 0x3c00
.long 0x0, 0x0, 0x3c000000, 0x3c003c00
.long 0x0, 0x0, 0x0, 0x3c003c00
.long 0x0, 0x0, 0x0, 0x3c000000
.long 0x0, 0x0, 0x0, 0x0
.long 0x0, 0x0, 0x0, 0x0
.long 0x0, 0x0, 0x0, 0x0
.long 0x0, 0x0, 0x0, 0x0
.long 0x0, 0x0, 0x0, 0x0
.long 0x0, 0x0, 0x0, 0x0
.long 0x0, 0x0, 0x0, 0x0
.long 0x0, 0x0, 0x0, 0x0
.long 0x0, 0x0, 0x0, 0x0
.long 0x0, 0x0, 0x0, 0x0
.long 0x0, 0x0, 0x0, 0x0
.long 0x0, 0x0, 0x0, 0x0
.long 0x0, 0x0, 0x0, 0x0
.long 0x0, 0x0, 0x0, 0x0
.long 0x3c00, 0x0, 0x0, 0x0
.long 0x3c003c00, 0x0, 0x0, 0x0
.long 0x3c003c00, 0x3c00, 0x0, 0x0
.long 0x3c000000, 0x3c003c00, 0x0, 0x0
.long 0x0, 0x3c003c00, 0x3c00, 0x0
.long 0x0, 0x0, 0x3c003c00, 0x3c003c00
.long 0x0, 0x0, 0x3c000000, 0x3c003c00
.long 0x0, 0x0, 0x0, 0x3c003c00
.long 0x0, 0x0, 0x0, 0x3c000000
.long 0x0, 0x0, 0x0, 0x0
.long 0x0, 0x0, 0x0, 0x0
.long 0x0, 0x0, 0x0, 0x0
.long 0x0, 0x0, 0x0, 0x0
.long 0x0, 0x0, 0x0, 0x0
.long 0x0, 0x0, 0x0, 0x0
.long 0x0, 0x0, 0x0, 0x0
.long 0x0, 0x0, 0x0, 0x0
.long 0x0, 0x0, 0x0, 0x0
.long 0x0, 0x0, 0x0, 0x0
.long 0x0, 0x0, 0x0, 0x0
.long 0x0, 0x0, 0x0, 0x0
.long 0x3c003c00, 0x3c003c00, 0x3c00, 0x0
.long 0x3c003c00, 0x3c003c00, 0x3c003c00, 0x0
.long 0x3c003c00, 0x3c003c00, 0x3c003c00, 0x3c00
.long 0x3c003c00, 0x3c003c00, 0x3c003c00, 0x3c003c00
.long 0x3c003c00, 0x3c003c00, 0x3c003c00, 0x3c003c00
.long 0x3c000000, 0x3c003c00, 0x3c003c00, 0x3c003c00
.long 0x0, 0x3c003c00, 0x3c003c00, 0x3c003c00
.long 0x0, 0x3c000000, 0x3c003c00, 0x3c003c00
.long 0x0, 0x0, 0x3c003c00, 0x3c003c00
.long 0x0, 0x0, 0x3c000000, 0x3c003c00
.long 0x0, 0x0, 0x0, 0x3c003c00
.long 0x0, 0x0, 0x0, 0x3c000000
.long 0x0, 0x0, 0x0, 0x0
.long 0x0, 0x0, 0x0, 0x0
.long 0x0, 0x0, 0x0, 0x0
.long 0x0, 0x0, 0x0, 0x0
.long 0x0, 0x0, 0x0, 0x0
.long 0x0, 0x0, 0x0, 0x0
.long 0x0, 0x0, 0x0, 0x0
.long 0x0, 0x0, 0x0, 0x0
.long 0x3c00, 0x0, 0x0, 0x0
.long 0x3c003c00, 0x0, 0x0, 0x0
.long 0x3c003c00, 0x3c00, 0x0, 0x0
.long 0x3c003c00, 0x3c003c00, 0x0, 0x0
.long 0x3c003c00, 0x3c003c00, 0x3c00, 0x0
.long 0x3c003c00, 0x3c003c00, 0x3c003c00, 0x0
.long 0x3c003c00, 0x3c003c00, 0x3c003c00, 0x3c00
.long 0x3c003c00, 0x3c003c00, 0x3c003c00, 0x3c003c00
.long 0x3c003c00, 0x3c003c00, 0x3c003c00, 0x3c003c00
.long 0x3c000000, 0x3c003c00, 0x3c003c00, 0x3c003c00
.long 0x0, 0x3c003c00, 0x3c003c00, 0x3c003c00
.long 0x0, 0x3c000000, 0x3c003c00, 0x3c003c00
.long 0x0, 0x0, 0x0, 0x0
.long 0x0, 0x0, 0x0, 0x0
.long 0x0, 0x0, 0x0, 0x0
.long 0x0, 0x0, 0x0, 0x0
.long 0x0, 0x0, 0x0, 0x0
.long 0x0, 0x0, 0x0, 0x0
.long 0x0, 0x0, 0x0, 0x0
.long 0x0, 0x0, 0x0, 0x0
.long 0x0, 0x0, 0x0, 0x0
.long 0x0, 0x0, 0x0, 0x0
.long 0x0, 0x0, 0x0, 0x0
.long 0x0, 0x0, 0x0, 0x0
.long 0x3c00, 0x0, 0x0, 0x0
.long 0x3c003c00, 0x0, 0x0, 0x0
.long 0x3c003c00, 0x3c00, 0x0, 0x0
.long 0x3c003c00, 0x3c003c00, 0x0, 0x0
.long 0x0, 0x0, 0x3c000000, 0x3c003c00
.long 0x0, 0x0, 0x0, 0x3c003c00
.long 0x0, 0x0, 0x0, 0x3c000000
.long 0x0, 0x0, 0x0, 0x0
.long 0x0, 0x0, 0x0, 0x0
.long 0x0, 0x0, 0x0, 0x0
.long 0x0, 0x0, 0x0, 0x0
.long 0x0, 0x0, 0x0, 0x0
.long 0x0, 0x0, 0x0, 0x0
.long 0x0, 0x0, 0x0, 0x0
.long 0x0, 0x0, 0x0, 0x0
.long 0x0, 0x0, 0x0, 0x0
.long 0x0, 0x0, 0x0, 0x0
.long 0x0, 0x0, 0x0, 0x0
.long 0x0, 0x0, 0x0, 0x0
.long 0x0, 0x0, 0x0, 0x0
.long 0x3c003c00, 0x3c003c00, 0x0, 0x0
.long 0x3c003c00, 0x3c003c00, 0x3c00, 0x0
.long 0x3c003c00, 0x3c003c00, 0x3c003c00, 0x0
.long 0x3c003c00, 0x3c003c00, 0x3c003c00, 0x3c00
.long 0x3c000000, 0x3c003c00, 0x3c003c00, 0x3c003c00
.long 0x0, 0x3c003c00, 0x3c003c00, 0x3c003c00
.long 0x0, 0x3c000000, 0x3c003c00, 0x3c003c00
.long 0x0, 0x0, 0x3c003c00, 0x3c003c00
.long 0x0, 0x0, 0x3c000000, 0x3c003c00
.long 0x0, 0x0, 0x0, 0x3c003c00
.long 0x0, 0x0, 0x0, 0x3c000000
.long 0x0, 0x0, 0x0, 0x0
.long 0x0, 0x0, 0x0, 0x0
.long 0x0, 0x0, 0x0, 0x0
.long 0x0, 0x0, 0x0, 0x0
.long 0x0, 0x0, 0x0, 0x0
.long 0x0, 0x0, 0x0, 0x0
.long 0x0, 0x0, 0x0, 0x0
.long 0x0, 0x0, 0x0, 0x0
.long 0x0, 0x0, 0x0, 0x0
.long 0x0, 0x0, 0x0, 0x0
.long 0x3c00, 0x0, 0x0, 0x0
.long 0x3c003c00, 0x0, 0x0, 0x0
.long 0x3c003c00, 0x3c00, 0x0, 0x0
.long 0x3c003c00, 0x3c003c00, 0x0, 0x0
.long 0x3c003c00, 0x3c003c00, 0x3c00, 0x0
.long 0x3c003c00, 0x3c003c00, 0x3c003c00, 0x0
.long 0x3c003c00, 0x3c003c00, 0x3c003c00, 0x3c00
.long 0x3c000000, 0x3c003c00, 0x3c003c00, 0x3c003c00
.long 0x0, 0x3c003c00, 0x3c003c00, 0x3c003c00
.long 0x0, 0x3c000000, 0x3c003c00, 0x3c003c00
.long 0x0, 0x0, 0x3c003c00, 0x3c003c00
.long 0x0, 0x0, 0x0, 0x0
.long 0x0, 0x0, 0x0, 0x0
.long 0x0, 0x0, 0x0, 0x0
.long 0x0, 0x0, 0x0, 0x0
.long 0x0, 0x0, 0x0, 0x0
.long 0x0, 0x0, 0x0, 0x0
.long 0x0, 0x0, 0x0, 0x0
.long 0x0, 0x0, 0x0, 0x0
.long 0x0, 0x0, 0x0, 0x0
.long 0x0, 0x0, 0x0, 0x0
.long 0x0, 0x0, 0x0, 0x0
.long 0x0, 0x0, 0x0, 0x0
.long 0x0, 0x0, 0x0, 0x0
.long 0x3c00, 0x0, 0x0, 0x0
.long 0x3c003c00, 0x0, 0x0, 0x0
.long 0x3c003c00, 0x3c00, 0x0, 0x0
.long 0x0, 0x0, 0x3c003c00, 0x3c003c00
.long 0x0, 0x0, 0x3c000000, 0x3c003c00
.long 0x0, 0x0, 0x0, 0x3c003c00
.long 0x0, 0x0, 0x0, 0x3c000000
.long 0x0, 0x0, 0x0, 0x0
.long 0x0, 0x0, 0x0, 0x0
.long 0x0, 0x0, 0x0, 0x0
.long 0x0, 0x0, 0x0, 0x0
.long 0x0, 0x0, 0x0, 0x0
.long 0x0, 0x0, 0x0, 0x0
.long 0x0, 0x0, 0x0, 0x0
.long 0x0, 0x0, 0x0, 0x0
.long 0x0, 0x0, 0x0, 0x0
.long 0x0, 0x0, 0x0, 0x0
.long 0x0, 0x0, 0x0, 0x0
.long 0x0, 0x0, 0x0, 0x0
.long 0x3c003c00, 0x3c00, 0x0, 0x0
.long 0x3c003c00, 0x3c003c00, 0x0, 0x0
.long 0x3c003c00, 0x3c003c00, 0x3c00, 0x0
.long 0x3c003c00, 0x3c003c00, 0x3c003c00, 0x0
.long 0x3c003c00, 0x3c003c00, 0x3c003c00, 0x3c00
.long 0x3c000000, 0x3c003c00, 0x3c003c00, 0x3c003c00
.long 0x0, 0x3c003c00, 0x3c003c00, 0x3c003c00
.long 0x0, 0x3c000000, 0x3c003c00, 0x3c003c00
.long 0x0, 0x0, 0x3c003c00, 0x3c003c00
.long 0x0, 0x0, 0x3c000000, 0x3c003c00
.long 0x0, 0x0, 0x0, 0x3c003c00
.long 0x0, 0x0, 0x0, 0x3c000000
.long 0x0, 0x0, 0x0, 0x0
.long 0x0, 0x0, 0x0, 0x0
.long 0x0, 0x0, 0x0, 0x0
.long 0x0, 0x0, 0x0, 0x0
.long 0x0, 0x0, 0x0, 0x0
.long 0x0, 0x0, 0x0, 0x0
.long 0x0, 0x0, 0x0, 0x0
.long 0x0, 0x0, 0x0, 0x0
.long 0x0, 0x0, 0x0, 0x0
.long 0x0, 0x0, 0x0, 0x0
.long 0x3c00, 0x0, 0x0, 0x0
.long 0x3c003c00, 0x0, 0x0, 0x0
.long 0x3c003c00, 0x3c00, 0x0, 0x0
.long 0x3c003c00, 0x3c003c00, 0x0, 0x0
.long 0x3c003c00, 0x3c003c00, 0x3c00, 0x0
.long 0x3c003c00, 0x3c003c00, 0x3c003c00, 0x0
.long 0x3c003c00, 0x3c003c00, 0x3c003c00, 0x3c00
.long 0x3c000000, 0x3c003c00, 0x3c003c00, 0x3c003c00
.long 0x0, 0x3c003c00, 0x3c003c00, 0x3c003c00
.long 0x0, 0x3c000000, 0x3c003c00, 0x3c003c00
.long 0x0, 0x0, 0x0, 0x0
.long 0x0, 0x0, 0x0, 0x0
.long 0x0, 0x0, 0x0, 0x0
.long 0x0, 0x0, 0x0, 0x0
.long 0x0, 0x0, 0x0, 0x0
.long 0x0, 0x0, 0x0, 0x0
.long 0x0, 0x0, 0x0, 0x0
.long 0x0, 0x0, 0x0, 0x0
.long 0x0, 0x0, 0x0, 0x0
.long 0x0, 0x0, 0x0, 0x0
.long 0x0, 0x0, 0x0, 0x0
.long 0x0, 0x0, 0x0, 0x0
.long 0x0, 0x0, 0x0, 0x0
.long 0x0, 0x0, 0x0, 0x0
.long 0x3c00, 0x0, 0x0, 0x0
.long 0x3c003c00, 0x0, 0x0, 0x0

.section .rodata,"a"
.p2align 6
.amdhsa_kernel recurrent_scan__ssm_conv_s4d__moe_arch_mod__prompt_kernel
  .amdhsa_next_free_vgpr 168
  .amdhsa_next_free_sgpr 96
  .amdhsa_accum_offset 168
  .amdhsa_group_segment_fixed_size 0
  .amdhsa_kernarg_size 120
  .amdhsa_user_sgpr_count 2
  .amdhsa_user_sgpr_kernarg_segment_ptr 1
  .amdhsa_system_sgpr_workgroup_id_x 1
.end_amdhsa_kernel
```
